```python
import torch

def _softmax(x, axis=-1):
    return torch.softmax(x, dim=axis)
def _gelu(x):
    return torch.nn.functional.gelu(x, approximate="tanh")
def _silu(x):
    return torch.nn.functional.silu(x)
def _sigmoid(x):
    return torch.sigmoid(x)
def _layernorm(x, axis=-1, eps=1e-5):
    m = x.mean(dim=axis, keepdim=True)
    v = x.var(dim=axis, keepdim=True, unbiased=False)
    return (x - m) / torch.sqrt(v + eps)
def _scatter_add(tgt, idx, src, axis=0):
    return tgt.clone().index_add_(axis, idx, src)
def _segment_sum(src, seg, n):
    out = torch.zeros((n,) + src.shape[1:], dtype=src.dtype)
    return out.index_add_(0, seg, src)
def _pad(x, pw):
    flat = tuple(v for pair in reversed(pw) for v in pair)
    return torch.nn.functional.pad(x, flat)

kernel_name = 'gated_mix__linear_attn_block__dense_activation_relu__prompt'

def setup_inputs():

    _w = (lambda a: (lambda t: t.to(torch.bfloat16) if t.is_floating_point() else t)(torch.as_tensor(a)))
    def _A_setup():
        B, S, D = 1, 2048, 576
        return {
            "x": _w((lambda *s: torch.randn(*s, dtype=torch.bfloat16) * 0.05)(B, S, D)),
            "wqkv": _w((lambda *s: torch.randn(*s, dtype=torch.bfloat16) * 0.8)(D, 3 * D)),
            "wo": _w((lambda *s: torch.randn(*s, dtype=torch.bfloat16) * 0.2)(D, D)),
        }
    _A_in = _A_setup()

    def _B_setup():
        B, S, D, Dff = 1, 2048, 576, 4608
        return {
            "x": _w((lambda *s: torch.randn(*s, dtype=torch.bfloat16) * 0.05)(B, S, D)),
            "w1": _w((lambda *s: torch.randn(*s, dtype=torch.bfloat16) * 0.05)(D, Dff)),
            "w2": _w((lambda *s: torch.randn(*s, dtype=torch.bfloat16) * 0.05)(Dff, D)),
        }
    _B_in = _B_setup()

    return {
        "A_x": _A_in["x"],
        "A_wqkv": _A_in["wqkv"],
        "A_wo": _A_in["wo"],
        "B_x": _B_in["x"],
        "B_w1": _B_in["w1"],
        "B_w2": _B_in["w2"],
        "gate_w": _w((lambda *s: torch.randn(*s, dtype=torch.bfloat16) * 0.05)(576) * 16.0),
    }

def reference(A_x, A_wqkv, A_wo, B_x, B_w1, B_w2, gate_w):
    def _A_ref(x, wqkv, wo):
        B, S, D = x.shape
        H = 32; Dh = D // H
        qkv = (lambda x, *d: x.permute(*d))((x @ wqkv).reshape(B, S, 3, H, Dh), 2, 0, 3, 1, 4)
        q, k, v = qkv[0], qkv[1], qkv[2]
        phi = lambda t: torch.where(t > 0, t + 1, torch.exp(t)) + 1e-6
        pq, pk = phi(q), phi(k)
        kv = torch.einsum("bhsd,bhse->bhde", pk, v)
        z = torch.einsum("bhsd->bhd", pk)
        num = torch.einsum("bhqd,bhde->bhqe", pq, kv)
        den = torch.einsum("bhqd,bhd->bhq", pq, z)[..., None] + 1e-6
        o = num / den
        return (lambda x, *d: x.permute(*d))(o, 0, 2, 1, 3).reshape(B, S, D) @ wo

    def _B_ref(x, w1, w2):
        h = torch.einsum("bsd,df->bsf", x, w1)
        zero = torch.zeros_like(h)
        h = torch.maximum(h, zero)
        return torch.einsum("bsf,fd->bsd", h, w2)

    x = A_x
    g = _sigmoid((x * gate_w).sum(-1, keepdims=True))
    a = _A_ref(x, A_wqkv, A_wo)
    b = _B_ref(x, B_w1, B_w2)
    return g * a + (1 - g) * b
```

```asm
; @launch kernel=k1_kernel grid=(704,1,1) block=(256,1,1) lds=69632
; @launch kernel=k15_kernel grid=(352,1,1) block=(256,1,1) lds=4096
; @launch kernel=k2_kernel grid=(256,1,1) block=(256,1,1) lds=139264
; @launch kernel=k3_kernel grid=(576,1,1) block=(256,1,1) lds=0
.amdgcn_target "amdgcn-amd-amdhsa--gfx950"
.text
.globl k1_kernel
.p2align 8
.type k1_kernel,@function
k1_kernel:
    s_cmp_ge_u32 s2, 704
    s_cbranch_scc1 K1_END
    s_load_dwordx2 s[4:5], s[0:1], 0
    s_load_dwordx2 s[20:21], s[0:1], 8
    s_load_dwordx2 s[22:23], s[0:1], 32
    s_load_dwordx2 s[24:25], s[0:1], 72
    v_lshrrev_b32 v1, 6, v0
    s_nop 0
    v_readfirstlane_b32 s8, v1
    s_nop 1
    v_and_b32 v1, 63, v0
    v_lshrrev_b32 v16, 4, v1
    v_and_b32 v17, 15, v1
    v_lshrrev_b32 v18, 1, v17
    v_and_b32 v18, 7, v18
    v_lshrrev_b32 v19, 1, v16
    v_xor_b32 v18, v18, v19
    v_lshlrev_b32 v18, 4, v18
    v_and_b32 v19, 1, v16
    v_lshlrev_b32 v19, 3, v19
    v_add_u32 v18, v18, v19
    s_lshl_b32 s9, s8, 5
    v_add_u32 v19, s9, v17
    v_lshlrev_b32 v19, 7, v19
    v_add_u32 v18, v18, v19
    v_xor_b32 v11, 0, v18
    v_xor_b32 v12, 32, v18
    v_xor_b32 v13, 64, v18
    v_xor_b32 v14, 96, v18
    v_lshlrev_b32 v18, 2, v16
    v_lshrrev_b32 v19, 2, v17
    v_add_u32 v18, v18, v19
    v_mul_u32_u24 v18, 288, v18
    v_and_b32 v19, 3, v17
    v_lshlrev_b32 v19, 3, v19
    v_add_u32 v18, v18, v19
    v_add_u32 v15, 16384, v18
    v_add_u32 v200, 69632, v11
    v_add_u32 v201, 69632, v12
    v_add_u32 v202, 69632, v13
    v_add_u32 v203, 69632, v14
    v_add_u32 v204, 69632, v15
    v_mov_b32 v108, 0
    v_mov_b32 v109, 0
    v_mov_b32 v110, 0
    v_mov_b32 v111, 0
    v_mov_b32 v112, 0
    v_mov_b32 v113, 0
    v_mov_b32 v114, 0
    v_mov_b32 v115, 0
    v_mov_b32 v116, 0
    v_mov_b32 v117, 0
    v_mov_b32 v118, 0
    v_mov_b32 v119, 0
    v_mov_b32 v120, 0
    v_mov_b32 v121, 0
    v_mov_b32 v122, 0
    v_mov_b32 v123, 0
    v_mov_b32 v124, 0
    v_mov_b32 v125, 0
    v_mov_b32 v126, 0
    v_mov_b32 v127, 0
    v_mov_b32 v128, 0
    v_mov_b32 v129, 0
    v_mov_b32 v130, 0
    v_mov_b32 v131, 0
    v_mov_b32 v132, 0
    v_mov_b32 v133, 0
    v_mov_b32 v134, 0
    v_mov_b32 v135, 0
    v_mov_b32 v136, 0
    v_mov_b32 v137, 0
    v_mov_b32 v138, 0
    v_mov_b32 v139, 0
    v_mov_b32 v140, 0
    v_mov_b32 v141, 0
    v_mov_b32 v142, 0
    v_mov_b32 v143, 0
    v_mov_b32 v144, 0
    v_mov_b32 v145, 0
    v_mov_b32 v146, 0
    v_mov_b32 v147, 0
    v_mov_b32 v148, 0
    v_mov_b32 v149, 0
    v_mov_b32 v150, 0
    v_mov_b32 v151, 0
    v_mov_b32 v152, 0
    v_mov_b32 v153, 0
    v_mov_b32 v154, 0
    v_mov_b32 v155, 0
    v_mov_b32 v156, 0
    v_mov_b32 v157, 0
    v_mov_b32 v158, 0
    v_mov_b32 v159, 0
    v_mov_b32 v160, 0
    v_mov_b32 v161, 0
    v_mov_b32 v162, 0
    v_mov_b32 v163, 0
    v_mov_b32 v164, 0
    v_mov_b32 v165, 0
    v_mov_b32 v166, 0
    v_mov_b32 v167, 0
    v_mov_b32 v168, 0
    v_mov_b32 v169, 0
    v_mov_b32 v170, 0
    v_mov_b32 v171, 0
    v_mov_b32 v172, 0
    v_mov_b32 v173, 0
    v_mov_b32 v174, 0
    v_mov_b32 v175, 0
    v_mov_b32 v176, 0
    v_mov_b32 v177, 0
    v_mov_b32 v178, 0
    v_mov_b32 v179, 0
    s_waitcnt lgkmcnt(0)
    s_mov_b32 s34, s24
    s_mov_b32 s35, s25
    s_cmp_ge_u32 s2, 192
    s_cbranch_scc1 K1_H
    s_cmp_ge_u32 s2, 128
    s_cbranch_scc1 K1_Q
    s_lshr_b32 s15, s2, 3
    s_lshl_b32 s15, s15, 7
    s_and_b32 s16, s2, 7
    s_mul_i32 s12, s16, 144
    s_add_u32 s13, s12, 2160
    s_add_u32 s12, s12, 1152
    s_mov_b32 s17, 3456
    s_mov_b32 s18, 221184
    s_mov_b32 s6, s20
    s_mov_b32 s7, s21
    s_mov_b32 s19, 1152
    s_lshl_b32 s9, s8, 8
    s_add_u32 s9, s9, 0
    v_add_u32 v16, s9, v1
    v_lshrrev_b32 v17, 3, v16
    v_and_b32 v18, 7, v16
    v_lshrrev_b32 v19, 1, v17
    v_and_b32 v19, 7, v19
    v_xor_b32 v18, v18, v19
    v_lshlrev_b32 v18, 4, v18
    v_add_u32 v17, s15, v17
    v_mul_lo_u32 v17, v17, s19
    v_add_u32 v2, v17, v18
    s_lshl_b32 s9, s8, 8
    s_add_u32 s9, s9, 64
    v_add_u32 v16, s9, v1
    v_lshrrev_b32 v17, 3, v16
    v_and_b32 v18, 7, v16
    v_lshrrev_b32 v19, 1, v17
    v_and_b32 v19, 7, v19
    v_xor_b32 v18, v18, v19
    v_lshlrev_b32 v18, 4, v18
    v_add_u32 v17, s15, v17
    v_mul_lo_u32 v17, v17, s19
    v_add_u32 v3, v17, v18
    s_lshl_b32 s9, s8, 8
    s_add_u32 s9, s9, 128
    v_add_u32 v16, s9, v1
    v_lshrrev_b32 v17, 3, v16
    v_and_b32 v18, 7, v16
    v_lshrrev_b32 v19, 1, v17
    v_and_b32 v19, 7, v19
    v_xor_b32 v18, v18, v19
    v_lshlrev_b32 v18, 4, v18
    v_add_u32 v17, s15, v17
    v_mul_lo_u32 v17, v17, s19
    v_add_u32 v4, v17, v18
    s_lshl_b32 s9, s8, 8
    s_add_u32 s9, s9, 192
    v_add_u32 v16, s9, v1
    v_lshrrev_b32 v17, 3, v16
    v_and_b32 v18, 7, v16
    v_lshrrev_b32 v19, 1, v17
    v_and_b32 v19, 7, v19
    v_xor_b32 v18, v18, v19
    v_lshlrev_b32 v18, 4, v18
    v_add_u32 v17, s15, v17
    v_mul_lo_u32 v17, v17, s19
    v_add_u32 v5, v17, v18
    s_mul_i32 s9, s8, 288
    s_add_u32 s9, s9, 0
    v_add_u32 v16, s9, v1
    v_mul_u32_u24 v17, 3641, v16
    v_lshrrev_b32 v17, 16, v17
    v_mul_u32_u24 v18, 18, v17
    v_sub_u32 v18, v16, v18
    v_mul_lo_u32 v17, v17, s17
    v_cmp_gt_u32 vcc, 9, v18
    v_lshlrev_b32 v19, 4, v18
    v_add_u32 v17, v17, v19
    v_add_u32 v19, s12, v17
    v_add_u32 v18, s13, v17
    v_cndmask_b32 v6, v18, v19, vcc
    s_mul_i32 s9, s8, 288
    s_add_u32 s9, s9, 64
    v_add_u32 v16, s9, v1
    v_mul_u32_u24 v17, 3641, v16
    v_lshrrev_b32 v17, 16, v17
    v_mul_u32_u24 v18, 18, v17
    v_sub_u32 v18, v16, v18
    v_mul_lo_u32 v17, v17, s17
    v_cmp_gt_u32 vcc, 9, v18
    v_lshlrev_b32 v19, 4, v18
    v_add_u32 v17, v17, v19
    v_add_u32 v19, s12, v17
    v_add_u32 v18, s13, v17
    v_cndmask_b32 v7, v18, v19, vcc
    s_mul_i32 s9, s8, 288
    s_add_u32 s9, s9, 128
    v_add_u32 v16, s9, v1
    v_mul_u32_u24 v17, 3641, v16
    v_lshrrev_b32 v17, 16, v17
    v_mul_u32_u24 v18, 18, v17
    v_sub_u32 v18, v16, v18
    v_mul_lo_u32 v17, v17, s17
    v_cmp_gt_u32 vcc, 9, v18
    v_lshlrev_b32 v19, 4, v18
    v_add_u32 v17, v17, v19
    v_add_u32 v19, s12, v17
    v_add_u32 v18, s13, v17
    v_cndmask_b32 v8, v18, v19, vcc
    s_mul_i32 s9, s8, 288
    s_add_u32 s9, s9, 192
    v_add_u32 v16, s9, v1
    v_mul_u32_u24 v17, 3641, v16
    v_lshrrev_b32 v17, 16, v17
    v_mul_u32_u24 v18, 18, v17
    v_sub_u32 v18, v16, v18
    v_mul_lo_u32 v17, v17, s17
    v_cmp_gt_u32 vcc, 9, v18
    v_lshlrev_b32 v19, 4, v18
    v_add_u32 v17, v17, v19
    v_add_u32 v19, s12, v17
    v_add_u32 v18, s13, v17
    v_cndmask_b32 v9, v18, v19, vcc
    s_mul_i32 s9, s8, 288
    s_add_u32 s9, s9, 256
    v_add_u32 v16, s9, v1
    v_mul_u32_u24 v17, 3641, v16
    v_lshrrev_b32 v17, 16, v17
    v_mul_u32_u24 v18, 18, v17
    v_sub_u32 v18, v16, v18
    v_mul_lo_u32 v17, v17, s17
    v_cmp_gt_u32 vcc, 9, v18
    v_lshlrev_b32 v19, 4, v18
    v_add_u32 v17, v17, v19
    v_add_u32 v19, s12, v17
    v_add_u32 v18, s13, v17
    v_cndmask_b32 v10, v18, v19, vcc
    s_lshl_b32 s9, s8, 12
    s_add_u32 m0, s9, 0
    s_nop 0
    global_load_lds_dwordx4 v2, s[4:5]
    s_lshl_b32 s9, s8, 12
    s_add_u32 m0, s9, 1024
    s_nop 0
    global_load_lds_dwordx4 v3, s[4:5]
    s_lshl_b32 s9, s8, 12
    s_add_u32 m0, s9, 2048
    s_nop 0
    global_load_lds_dwordx4 v4, s[4:5]
    s_lshl_b32 s9, s8, 12
    s_add_u32 m0, s9, 3072
    s_nop 0
    global_load_lds_dwordx4 v5, s[4:5]
    s_mul_i32 s9, s8, 4608
    s_add_u32 m0, s9, 16384
    s_nop 0
    global_load_lds_dwordx4 v6, s[6:7]
    s_mul_i32 s9, s8, 4608
    s_add_u32 m0, s9, 17408
    s_nop 0
    global_load_lds_dwordx4 v7, s[6:7]
    s_mul_i32 s9, s8, 4608
    s_add_u32 m0, s9, 18432
    s_nop 0
    global_load_lds_dwordx4 v8, s[6:7]
    s_mul_i32 s9, s8, 4608
    s_add_u32 m0, s9, 19456
    s_nop 0
    global_load_lds_dwordx4 v9, s[6:7]
    s_mul_i32 s9, s8, 4608
    s_add_u32 m0, s9, 20480
    s_mov_b32 exec_hi, 0
    global_load_lds_dwordx4 v10, s[6:7]
    s_mov_b64 exec, -1
    s_add_u32 s4, s4, 128
    s_addc_u32 s5, s5, 0
    s_add_u32 s6, s6, s18
    s_addc_u32 s7, s7, 0
    s_lshl_b32 s9, s8, 12
    s_add_u32 m0, s9, 34816
    s_nop 0
    global_load_lds_dwordx4 v2, s[4:5]
    s_lshl_b32 s9, s8, 12
    s_add_u32 m0, s9, 35840
    s_nop 0
    global_load_lds_dwordx4 v3, s[4:5]
    s_lshl_b32 s9, s8, 12
    s_add_u32 m0, s9, 36864
    s_nop 0
    global_load_lds_dwordx4 v4, s[4:5]
    s_lshl_b32 s9, s8, 12
    s_add_u32 m0, s9, 37888
    s_nop 0
    global_load_lds_dwordx4 v5, s[4:5]
    s_mul_i32 s9, s8, 4608
    s_add_u32 m0, s9, 51200
    s_nop 0
    global_load_lds_dwordx4 v6, s[6:7]
    s_mul_i32 s9, s8, 4608
    s_add_u32 m0, s9, 52224
    s_nop 0
    global_load_lds_dwordx4 v7, s[6:7]
    s_mul_i32 s9, s8, 4608
    s_add_u32 m0, s9, 53248
    s_nop 0
    global_load_lds_dwordx4 v8, s[6:7]
    s_mul_i32 s9, s8, 4608
    s_add_u32 m0, s9, 54272
    s_nop 0
    global_load_lds_dwordx4 v9, s[6:7]
    s_mul_i32 s9, s8, 4608
    s_add_u32 m0, s9, 55296
    s_mov_b32 exec_hi, 0
    global_load_lds_dwordx4 v10, s[6:7]
    s_mov_b64 exec, -1
    s_waitcnt vmcnt(9)
    s_barrier
    ds_read_b64 v[20:21], v11 offset:0
    ds_read_b64 v[22:23], v12 offset:0
    ds_read_b64 v[24:25], v11 offset:2048
    ds_read_b64 v[26:27], v12 offset:2048
    ds_read_b64_tr_b16 v[36:37], v15 offset:0
    ds_read_b64_tr_b16 v[38:39], v15 offset:4608
    ds_read_b64_tr_b16 v[40:41], v15 offset:32
    ds_read_b64_tr_b16 v[42:43], v15 offset:4640
    ds_read_b64_tr_b16 v[44:45], v15 offset:64
    ds_read_b64_tr_b16 v[46:47], v15 offset:4672
    ds_read_b64_tr_b16 v[48:49], v15 offset:96
    ds_read_b64_tr_b16 v[50:51], v15 offset:4704
    ds_read_b64_tr_b16 v[52:53], v15 offset:128
    ds_read_b64_tr_b16 v[54:55], v15 offset:4736
    ds_read_b64_tr_b16 v[56:57], v15 offset:160
    ds_read_b64_tr_b16 v[58:59], v15 offset:4768
    ds_read_b64_tr_b16 v[60:61], v15 offset:192
    ds_read_b64_tr_b16 v[62:63], v15 offset:4800
    ds_read_b64_tr_b16 v[64:65], v15 offset:224
    ds_read_b64_tr_b16 v[66:67], v15 offset:4832
    ds_read_b64_tr_b16 v[68:69], v15 offset:256
    ds_read_b64_tr_b16 v[70:71], v15 offset:4864
    s_waitcnt lgkmcnt(15)
    v_mfma_f32_16x16x32_bf16 v[108:111], v[36:39], v[20:23], v[108:111]
    v_mfma_f32_16x16x32_bf16 v[144:147], v[36:39], v[24:27], v[144:147]
    ds_read_b64 v[28:29], v13 offset:0
    ds_read_b64 v[30:31], v14 offset:0
    ds_read_b64 v[32:33], v13 offset:2048
    s_waitcnt lgkmcnt(15)
    v_mfma_f32_16x16x32_bf16 v[112:115], v[40:43], v[20:23], v[112:115]
    v_mfma_f32_16x16x32_bf16 v[148:151], v[40:43], v[24:27], v[148:151]
    ds_read_b64 v[34:35], v14 offset:2048
    ds_read_b64_tr_b16 v[72:73], v15 offset:9216
    ds_read_b64_tr_b16 v[74:75], v15 offset:13824
    v_mfma_f32_16x16x32_bf16 v[116:119], v[44:47], v[20:23], v[116:119]
    v_mfma_f32_16x16x32_bf16 v[152:155], v[44:47], v[24:27], v[152:155]
    ds_read_b64_tr_b16 v[76:77], v15 offset:9248
    ds_read_b64_tr_b16 v[78:79], v15 offset:13856
    ds_read_b64_tr_b16 v[80:81], v15 offset:9280
    s_waitcnt lgkmcnt(15)
    v_mfma_f32_16x16x32_bf16 v[120:123], v[48:51], v[20:23], v[120:123]
    v_mfma_f32_16x16x32_bf16 v[156:159], v[48:51], v[24:27], v[156:159]
    ds_read_b64_tr_b16 v[82:83], v15 offset:13888
    ds_read_b64_tr_b16 v[84:85], v15 offset:9312
    ds_read_b64_tr_b16 v[86:87], v15 offset:13920
    v_mfma_f32_16x16x32_bf16 v[124:127], v[52:55], v[20:23], v[124:127]
    v_mfma_f32_16x16x32_bf16 v[160:163], v[52:55], v[24:27], v[160:163]
    ds_read_b64_tr_b16 v[88:89], v15 offset:9344
    ds_read_b64_tr_b16 v[90:91], v15 offset:13952
    ds_read_b64_tr_b16 v[92:93], v15 offset:9376
    v_mfma_f32_16x16x32_bf16 v[128:131], v[56:59], v[20:23], v[128:131]
    v_mfma_f32_16x16x32_bf16 v[164:167], v[56:59], v[24:27], v[164:167]
    ds_read_b64_tr_b16 v[94:95], v15 offset:13984
    ds_read_b64_tr_b16 v[96:97], v15 offset:9408
    ds_read_b64_tr_b16 v[98:99], v15 offset:14016
    s_waitcnt lgkmcnt(15)
    v_mfma_f32_16x16x32_bf16 v[132:135], v[60:63], v[20:23], v[132:135]
    v_mfma_f32_16x16x32_bf16 v[168:171], v[60:63], v[24:27], v[168:171]
    ds_read_b64_tr_b16 v[100:101], v15 offset:9440
    ds_read_b64_tr_b16 v[102:103], v15 offset:14048
    ds_read_b64_tr_b16 v[104:105], v15 offset:9472
    v_mfma_f32_16x16x32_bf16 v[136:139], v[64:67], v[20:23], v[136:139]
    v_mfma_f32_16x16x32_bf16 v[172:175], v[64:67], v[24:27], v[172:175]
    ds_read_b64_tr_b16 v[106:107], v15 offset:14080
    v_mfma_f32_16x16x32_bf16 v[140:143], v[68:71], v[20:23], v[140:143]
    v_mfma_f32_16x16x32_bf16 v[176:179], v[68:71], v[24:27], v[176:179]
    s_waitcnt lgkmcnt(0)
    s_waitcnt vmcnt(0)
    s_barrier
    s_add_u32 s4, s4, 128
    s_addc_u32 s5, s5, 0
    s_add_u32 s6, s6, s18
    s_addc_u32 s7, s7, 0
    s_lshl_b32 s9, s8, 12
    s_add_u32 m0, s9, 0
    s_nop 0
    global_load_lds_dwordx4 v2, s[4:5]
    s_lshl_b32 s9, s8, 12
    s_add_u32 m0, s9, 1024
    s_nop 0
    global_load_lds_dwordx4 v3, s[4:5]
    s_lshl_b32 s9, s8, 12
    s_add_u32 m0, s9, 2048
    s_nop 0
    global_load_lds_dwordx4 v4, s[4:5]
    s_lshl_b32 s9, s8, 12
    s_add_u32 m0, s9, 3072
    s_nop 0
    global_load_lds_dwordx4 v5, s[4:5]
    s_mul_i32 s9, s8, 4608
    s_add_u32 m0, s9, 16384
    s_nop 0
    global_load_lds_dwordx4 v6, s[6:7]
    s_mul_i32 s9, s8, 4608
    s_add_u32 m0, s9, 17408
    s_nop 0
    global_load_lds_dwordx4 v7, s[6:7]
    s_mul_i32 s9, s8, 4608
    s_add_u32 m0, s9, 18432
    s_nop 0
    global_load_lds_dwordx4 v8, s[6:7]
    s_mul_i32 s9, s8, 4608
    s_add_u32 m0, s9, 19456
    s_nop 0
    global_load_lds_dwordx4 v9, s[6:7]
    s_mul_i32 s9, s8, 4608
    s_add_u32 m0, s9, 20480
    s_mov_b32 exec_hi, 0
    global_load_lds_dwordx4 v10, s[6:7]
    s_mov_b64 exec, -1
    v_mfma_f32_16x16x32_bf16 v[108:111], v[72:75], v[28:31], v[108:111]
    v_mfma_f32_16x16x32_bf16 v[144:147], v[72:75], v[32:35], v[144:147]
    ds_read_b64 v[20:21], v11 offset:34816
    ds_read_b64 v[22:23], v12 offset:34816
    ds_read_b64 v[24:25], v11 offset:36864
    v_mfma_f32_16x16x32_bf16 v[112:115], v[76:79], v[28:31], v[112:115]
    v_mfma_f32_16x16x32_bf16 v[148:151], v[76:79], v[32:35], v[148:151]
    ds_read_b64 v[26:27], v12 offset:36864
    ds_read_b64_tr_b16 v[36:37], v15 offset:34816
    ds_read_b64_tr_b16 v[38:39], v15 offset:39424
    v_mfma_f32_16x16x32_bf16 v[116:119], v[80:83], v[28:31], v[116:119]
    v_mfma_f32_16x16x32_bf16 v[152:155], v[80:83], v[32:35], v[152:155]
    ds_read_b64_tr_b16 v[40:41], v15 offset:34848
    ds_read_b64_tr_b16 v[42:43], v15 offset:39456
    ds_read_b64_tr_b16 v[44:45], v15 offset:34880
    v_mfma_f32_16x16x32_bf16 v[120:123], v[84:87], v[28:31], v[120:123]
    v_mfma_f32_16x16x32_bf16 v[156:159], v[84:87], v[32:35], v[156:159]
    ds_read_b64_tr_b16 v[46:47], v15 offset:39488
    ds_read_b64_tr_b16 v[48:49], v15 offset:34912
    ds_read_b64_tr_b16 v[50:51], v15 offset:39520
    v_mfma_f32_16x16x32_bf16 v[124:127], v[88:91], v[28:31], v[124:127]
    v_mfma_f32_16x16x32_bf16 v[160:163], v[88:91], v[32:35], v[160:163]
    ds_read_b64_tr_b16 v[52:53], v15 offset:34944
    ds_read_b64_tr_b16 v[54:55], v15 offset:39552
    ds_read_b64_tr_b16 v[56:57], v15 offset:34976
    v_mfma_f32_16x16x32_bf16 v[128:131], v[92:95], v[28:31], v[128:131]
    v_mfma_f32_16x16x32_bf16 v[164:167], v[92:95], v[32:35], v[164:167]
    ds_read_b64_tr_b16 v[58:59], v15 offset:39584
    ds_read_b64_tr_b16 v[60:61], v15 offset:35008
    ds_read_b64_tr_b16 v[62:63], v15 offset:39616
    v_mfma_f32_16x16x32_bf16 v[132:135], v[96:99], v[28:31], v[132:135]
    v_mfma_f32_16x16x32_bf16 v[168:171], v[96:99], v[32:35], v[168:171]
    ds_read_b64_tr_b16 v[64:65], v15 offset:35040
    ds_read_b64_tr_b16 v[66:67], v15 offset:39648
    ds_read_b64_tr_b16 v[68:69], v15 offset:35072
    v_mfma_f32_16x16x32_bf16 v[136:139], v[100:103], v[28:31], v[136:139]
    v_mfma_f32_16x16x32_bf16 v[172:175], v[100:103], v[32:35], v[172:175]
    ds_read_b64_tr_b16 v[70:71], v15 offset:39680
    v_mfma_f32_16x16x32_bf16 v[140:143], v[104:107], v[28:31], v[140:143]
    v_mfma_f32_16x16x32_bf16 v[176:179], v[104:107], v[32:35], v[176:179]
    s_waitcnt lgkmcnt(15)
    v_mfma_f32_16x16x32_bf16 v[108:111], v[36:39], v[20:23], v[108:111]
    v_mfma_f32_16x16x32_bf16 v[144:147], v[36:39], v[24:27], v[144:147]
    ds_read_b64 v[28:29], v13 offset:34816
    ds_read_b64 v[30:31], v14 offset:34816
    ds_read_b64 v[32:33], v13 offset:36864
    s_waitcnt lgkmcnt(15)
    v_mfma_f32_16x16x32_bf16 v[112:115], v[40:43], v[20:23], v[112:115]
    v_mfma_f32_16x16x32_bf16 v[148:151], v[40:43], v[24:27], v[148:151]
    ds_read_b64 v[34:35], v14 offset:36864
    ds_read_b64_tr_b16 v[72:73], v15 offset:44032
    ds_read_b64_tr_b16 v[74:75], v15 offset:48640
    v_mfma_f32_16x16x32_bf16 v[116:119], v[44:47], v[20:23], v[116:119]
    v_mfma_f32_16x16x32_bf16 v[152:155], v[44:47], v[24:27], v[152:155]
    ds_read_b64_tr_b16 v[76:77], v15 offset:44064
    ds_read_b64_tr_b16 v[78:79], v15 offset:48672
    ds_read_b64_tr_b16 v[80:81], v15 offset:44096
    s_waitcnt lgkmcnt(15)
    v_mfma_f32_16x16x32_bf16 v[120:123], v[48:51], v[20:23], v[120:123]
    v_mfma_f32_16x16x32_bf16 v[156:159], v[48:51], v[24:27], v[156:159]
    ds_read_b64_tr_b16 v[82:83], v15 offset:48704
    ds_read_b64_tr_b16 v[84:85], v15 offset:44128
    ds_read_b64_tr_b16 v[86:87], v15 offset:48736
    v_mfma_f32_16x16x32_bf16 v[124:127], v[52:55], v[20:23], v[124:127]
    v_mfma_f32_16x16x32_bf16 v[160:163], v[52:55], v[24:27], v[160:163]
    ds_read_b64_tr_b16 v[88:89], v15 offset:44160
    ds_read_b64_tr_b16 v[90:91], v15 offset:48768
    ds_read_b64_tr_b16 v[92:93], v15 offset:44192
    v_mfma_f32_16x16x32_bf16 v[128:131], v[56:59], v[20:23], v[128:131]
    v_mfma_f32_16x16x32_bf16 v[164:167], v[56:59], v[24:27], v[164:167]
    ds_read_b64_tr_b16 v[94:95], v15 offset:48800
    ds_read_b64_tr_b16 v[96:97], v15 offset:44224
    ds_read_b64_tr_b16 v[98:99], v15 offset:48832
    s_waitcnt lgkmcnt(15)
    v_mfma_f32_16x16x32_bf16 v[132:135], v[60:63], v[20:23], v[132:135]
    v_mfma_f32_16x16x32_bf16 v[168:171], v[60:63], v[24:27], v[168:171]
    ds_read_b64_tr_b16 v[100:101], v15 offset:44256
    ds_read_b64_tr_b16 v[102:103], v15 offset:48864
    ds_read_b64_tr_b16 v[104:105], v15 offset:44288
    v_mfma_f32_16x16x32_bf16 v[136:139], v[64:67], v[20:23], v[136:139]
    v_mfma_f32_16x16x32_bf16 v[172:175], v[64:67], v[24:27], v[172:175]
    ds_read_b64_tr_b16 v[106:107], v15 offset:48896
    v_mfma_f32_16x16x32_bf16 v[140:143], v[68:71], v[20:23], v[140:143]
    v_mfma_f32_16x16x32_bf16 v[176:179], v[68:71], v[24:27], v[176:179]
    s_waitcnt lgkmcnt(0)
    s_waitcnt vmcnt(0)
    s_barrier
    s_add_u32 s4, s4, 128
    s_addc_u32 s5, s5, 0
    s_add_u32 s6, s6, s18
    s_addc_u32 s7, s7, 0
    s_lshl_b32 s9, s8, 12
    s_add_u32 m0, s9, 34816
    s_nop 0
    global_load_lds_dwordx4 v2, s[4:5]
    s_lshl_b32 s9, s8, 12
    s_add_u32 m0, s9, 35840
    s_nop 0
    global_load_lds_dwordx4 v3, s[4:5]
    s_lshl_b32 s9, s8, 12
    s_add_u32 m0, s9, 36864
    s_nop 0
    global_load_lds_dwordx4 v4, s[4:5]
    s_lshl_b32 s9, s8, 12
    s_add_u32 m0, s9, 37888
    s_nop 0
    global_load_lds_dwordx4 v5, s[4:5]
    s_mul_i32 s9, s8, 4608
    s_add_u32 m0, s9, 51200
    s_nop 0
    global_load_lds_dwordx4 v6, s[6:7]
    s_mul_i32 s9, s8, 4608
    s_add_u32 m0, s9, 52224
    s_nop 0
    global_load_lds_dwordx4 v7, s[6:7]
    s_mul_i32 s9, s8, 4608
    s_add_u32 m0, s9, 53248
    s_nop 0
    global_load_lds_dwordx4 v8, s[6:7]
    s_mul_i32 s9, s8, 4608
    s_add_u32 m0, s9, 54272
    s_nop 0
    global_load_lds_dwordx4 v9, s[6:7]
    s_mul_i32 s9, s8, 4608
    s_add_u32 m0, s9, 55296
    s_mov_b32 exec_hi, 0
    global_load_lds_dwordx4 v10, s[6:7]
    s_mov_b64 exec, -1
    v_mfma_f32_16x16x32_bf16 v[108:111], v[72:75], v[28:31], v[108:111]
    v_mfma_f32_16x16x32_bf16 v[144:147], v[72:75], v[32:35], v[144:147]
    ds_read_b64 v[20:21], v11 offset:0
    ds_read_b64 v[22:23], v12 offset:0
    ds_read_b64 v[24:25], v11 offset:2048
    v_mfma_f32_16x16x32_bf16 v[112:115], v[76:79], v[28:31], v[112:115]
    v_mfma_f32_16x16x32_bf16 v[148:151], v[76:79], v[32:35], v[148:151]
    ds_read_b64 v[26:27], v12 offset:2048
    ds_read_b64_tr_b16 v[36:37], v15 offset:0
    ds_read_b64_tr_b16 v[38:39], v15 offset:4608
    v_mfma_f32_16x16x32_bf16 v[116:119], v[80:83], v[28:31], v[116:119]
    v_mfma_f32_16x16x32_bf16 v[152:155], v[80:83], v[32:35], v[152:155]
    ds_read_b64_tr_b16 v[40:41], v15 offset:32
    ds_read_b64_tr_b16 v[42:43], v15 offset:4640
    ds_read_b64_tr_b16 v[44:45], v15 offset:64
    v_mfma_f32_16x16x32_bf16 v[120:123], v[84:87], v[28:31], v[120:123]
    v_mfma_f32_16x16x32_bf16 v[156:159], v[84:87], v[32:35], v[156:159]
    ds_read_b64_tr_b16 v[46:47], v15 offset:4672
    ds_read_b64_tr_b16 v[48:49], v15 offset:96
    ds_read_b64_tr_b16 v[50:51], v15 offset:4704
    v_mfma_f32_16x16x32_bf16 v[124:127], v[88:91], v[28:31], v[124:127]
    v_mfma_f32_16x16x32_bf16 v[160:163], v[88:91], v[32:35], v[160:163]
    ds_read_b64_tr_b16 v[52:53], v15 offset:128
    ds_read_b64_tr_b16 v[54:55], v15 offset:4736
    ds_read_b64_tr_b16 v[56:57], v15 offset:160
    v_mfma_f32_16x16x32_bf16 v[128:131], v[92:95], v[28:31], v[128:131]
    v_mfma_f32_16x16x32_bf16 v[164:167], v[92:95], v[32:35], v[164:167]
    ds_read_b64_tr_b16 v[58:59], v15 offset:4768
    ds_read_b64_tr_b16 v[60:61], v15 offset:192
    ds_read_b64_tr_b16 v[62:63], v15 offset:4800
    v_mfma_f32_16x16x32_bf16 v[132:135], v[96:99], v[28:31], v[132:135]
    v_mfma_f32_16x16x32_bf16 v[168:171], v[96:99], v[32:35], v[168:171]
    ds_read_b64_tr_b16 v[64:65], v15 offset:224
    ds_read_b64_tr_b16 v[66:67], v15 offset:4832
    ds_read_b64_tr_b16 v[68:69], v15 offset:256
    v_mfma_f32_16x16x32_bf16 v[136:139], v[100:103], v[28:31], v[136:139]
    v_mfma_f32_16x16x32_bf16 v[172:175], v[100:103], v[32:35], v[172:175]
    ds_read_b64_tr_b16 v[70:71], v15 offset:4864
    v_mfma_f32_16x16x32_bf16 v[140:143], v[104:107], v[28:31], v[140:143]
    v_mfma_f32_16x16x32_bf16 v[176:179], v[104:107], v[32:35], v[176:179]
    s_waitcnt lgkmcnt(15)
    v_mfma_f32_16x16x32_bf16 v[108:111], v[36:39], v[20:23], v[108:111]
    v_mfma_f32_16x16x32_bf16 v[144:147], v[36:39], v[24:27], v[144:147]
    ds_read_b64 v[28:29], v13 offset:0
    ds_read_b64 v[30:31], v14 offset:0
    ds_read_b64 v[32:33], v13 offset:2048
    s_waitcnt lgkmcnt(15)
    v_mfma_f32_16x16x32_bf16 v[112:115], v[40:43], v[20:23], v[112:115]
    v_mfma_f32_16x16x32_bf16 v[148:151], v[40:43], v[24:27], v[148:151]
    ds_read_b64 v[34:35], v14 offset:2048
    ds_read_b64_tr_b16 v[72:73], v15 offset:9216
    ds_read_b64_tr_b16 v[74:75], v15 offset:13824
    v_mfma_f32_16x16x32_bf16 v[116:119], v[44:47], v[20:23], v[116:119]
    v_mfma_f32_16x16x32_bf16 v[152:155], v[44:47], v[24:27], v[152:155]
    ds_read_b64_tr_b16 v[76:77], v15 offset:9248
    ds_read_b64_tr_b16 v[78:79], v15 offset:13856
    ds_read_b64_tr_b16 v[80:81], v15 offset:9280
    s_waitcnt lgkmcnt(15)
    v_mfma_f32_16x16x32_bf16 v[120:123], v[48:51], v[20:23], v[120:123]
    v_mfma_f32_16x16x32_bf16 v[156:159], v[48:51], v[24:27], v[156:159]
    ds_read_b64_tr_b16 v[82:83], v15 offset:13888
    ds_read_b64_tr_b16 v[84:85], v15 offset:9312
    ds_read_b64_tr_b16 v[86:87], v15 offset:13920
    v_mfma_f32_16x16x32_bf16 v[124:127], v[52:55], v[20:23], v[124:127]
    v_mfma_f32_16x16x32_bf16 v[160:163], v[52:55], v[24:27], v[160:163]
    ds_read_b64_tr_b16 v[88:89], v15 offset:9344
    ds_read_b64_tr_b16 v[90:91], v15 offset:13952
    ds_read_b64_tr_b16 v[92:93], v15 offset:9376
    v_mfma_f32_16x16x32_bf16 v[128:131], v[56:59], v[20:23], v[128:131]
    v_mfma_f32_16x16x32_bf16 v[164:167], v[56:59], v[24:27], v[164:167]
    ds_read_b64_tr_b16 v[94:95], v15 offset:13984
    ds_read_b64_tr_b16 v[96:97], v15 offset:9408
    ds_read_b64_tr_b16 v[98:99], v15 offset:14016
    s_waitcnt lgkmcnt(15)
    v_mfma_f32_16x16x32_bf16 v[132:135], v[60:63], v[20:23], v[132:135]
    v_mfma_f32_16x16x32_bf16 v[168:171], v[60:63], v[24:27], v[168:171]
    ds_read_b64_tr_b16 v[100:101], v15 offset:9440
    ds_read_b64_tr_b16 v[102:103], v15 offset:14048
    ds_read_b64_tr_b16 v[104:105], v15 offset:9472
    v_mfma_f32_16x16x32_bf16 v[136:139], v[64:67], v[20:23], v[136:139]
    v_mfma_f32_16x16x32_bf16 v[172:175], v[64:67], v[24:27], v[172:175]
    ds_read_b64_tr_b16 v[106:107], v15 offset:14080
    v_mfma_f32_16x16x32_bf16 v[140:143], v[68:71], v[20:23], v[140:143]
    v_mfma_f32_16x16x32_bf16 v[176:179], v[68:71], v[24:27], v[176:179]
    s_waitcnt lgkmcnt(0)
    s_waitcnt vmcnt(0)
    s_barrier
    s_add_u32 s4, s4, 128
    s_addc_u32 s5, s5, 0
    s_add_u32 s6, s6, s18
    s_addc_u32 s7, s7, 0
    s_lshl_b32 s9, s8, 12
    s_add_u32 m0, s9, 0
    s_nop 0
    global_load_lds_dwordx4 v2, s[4:5]
    s_lshl_b32 s9, s8, 12
    s_add_u32 m0, s9, 1024
    s_nop 0
    global_load_lds_dwordx4 v3, s[4:5]
    s_lshl_b32 s9, s8, 12
    s_add_u32 m0, s9, 2048
    s_nop 0
    global_load_lds_dwordx4 v4, s[4:5]
    s_lshl_b32 s9, s8, 12
    s_add_u32 m0, s9, 3072
    s_nop 0
    global_load_lds_dwordx4 v5, s[4:5]
    s_mul_i32 s9, s8, 4608
    s_add_u32 m0, s9, 16384
    s_nop 0
    global_load_lds_dwordx4 v6, s[6:7]
    s_mul_i32 s9, s8, 4608
    s_add_u32 m0, s9, 17408
    s_nop 0
    global_load_lds_dwordx4 v7, s[6:7]
    s_mul_i32 s9, s8, 4608
    s_add_u32 m0, s9, 18432
    s_nop 0
    global_load_lds_dwordx4 v8, s[6:7]
    s_mul_i32 s9, s8, 4608
    s_add_u32 m0, s9, 19456
    s_nop 0
    global_load_lds_dwordx4 v9, s[6:7]
    s_mul_i32 s9, s8, 4608
    s_add_u32 m0, s9, 20480
    s_mov_b32 exec_hi, 0
    global_load_lds_dwordx4 v10, s[6:7]
    s_mov_b64 exec, -1
    v_mfma_f32_16x16x32_bf16 v[108:111], v[72:75], v[28:31], v[108:111]
    v_mfma_f32_16x16x32_bf16 v[144:147], v[72:75], v[32:35], v[144:147]
    ds_read_b64 v[20:21], v11 offset:34816
    ds_read_b64 v[22:23], v12 offset:34816
    ds_read_b64 v[24:25], v11 offset:36864
    v_mfma_f32_16x16x32_bf16 v[112:115], v[76:79], v[28:31], v[112:115]
    v_mfma_f32_16x16x32_bf16 v[148:151], v[76:79], v[32:35], v[148:151]
    ds_read_b64 v[26:27], v12 offset:36864
    ds_read_b64_tr_b16 v[36:37], v15 offset:34816
    ds_read_b64_tr_b16 v[38:39], v15 offset:39424
    v_mfma_f32_16x16x32_bf16 v[116:119], v[80:83], v[28:31], v[116:119]
    v_mfma_f32_16x16x32_bf16 v[152:155], v[80:83], v[32:35], v[152:155]
    ds_read_b64_tr_b16 v[40:41], v15 offset:34848
    ds_read_b64_tr_b16 v[42:43], v15 offset:39456
    ds_read_b64_tr_b16 v[44:45], v15 offset:34880
    v_mfma_f32_16x16x32_bf16 v[120:123], v[84:87], v[28:31], v[120:123]
    v_mfma_f32_16x16x32_bf16 v[156:159], v[84:87], v[32:35], v[156:159]
    ds_read_b64_tr_b16 v[46:47], v15 offset:39488
    ds_read_b64_tr_b16 v[48:49], v15 offset:34912
    ds_read_b64_tr_b16 v[50:51], v15 offset:39520
    v_mfma_f32_16x16x32_bf16 v[124:127], v[88:91], v[28:31], v[124:127]
    v_mfma_f32_16x16x32_bf16 v[160:163], v[88:91], v[32:35], v[160:163]
    ds_read_b64_tr_b16 v[52:53], v15 offset:34944
    ds_read_b64_tr_b16 v[54:55], v15 offset:39552
    ds_read_b64_tr_b16 v[56:57], v15 offset:34976
    v_mfma_f32_16x16x32_bf16 v[128:131], v[92:95], v[28:31], v[128:131]
    v_mfma_f32_16x16x32_bf16 v[164:167], v[92:95], v[32:35], v[164:167]
    ds_read_b64_tr_b16 v[58:59], v15 offset:39584
    ds_read_b64_tr_b16 v[60:61], v15 offset:35008
    ds_read_b64_tr_b16 v[62:63], v15 offset:39616
    v_mfma_f32_16x16x32_bf16 v[132:135], v[96:99], v[28:31], v[132:135]
    v_mfma_f32_16x16x32_bf16 v[168:171], v[96:99], v[32:35], v[168:171]
    ds_read_b64_tr_b16 v[64:65], v15 offset:35040
    ds_read_b64_tr_b16 v[66:67], v15 offset:39648
    ds_read_b64_tr_b16 v[68:69], v15 offset:35072
    v_mfma_f32_16x16x32_bf16 v[136:139], v[100:103], v[28:31], v[136:139]
    v_mfma_f32_16x16x32_bf16 v[172:175], v[100:103], v[32:35], v[172:175]
    ds_read_b64_tr_b16 v[70:71], v15 offset:39680
    v_mfma_f32_16x16x32_bf16 v[140:143], v[104:107], v[28:31], v[140:143]
    v_mfma_f32_16x16x32_bf16 v[176:179], v[104:107], v[32:35], v[176:179]
    s_waitcnt lgkmcnt(15)
    v_mfma_f32_16x16x32_bf16 v[108:111], v[36:39], v[20:23], v[108:111]
    v_mfma_f32_16x16x32_bf16 v[144:147], v[36:39], v[24:27], v[144:147]
    ds_read_b64 v[28:29], v13 offset:34816
    ds_read_b64 v[30:31], v14 offset:34816
    ds_read_b64 v[32:33], v13 offset:36864
    s_waitcnt lgkmcnt(15)
    v_mfma_f32_16x16x32_bf16 v[112:115], v[40:43], v[20:23], v[112:115]
    v_mfma_f32_16x16x32_bf16 v[148:151], v[40:43], v[24:27], v[148:151]
    ds_read_b64 v[34:35], v14 offset:36864
    ds_read_b64_tr_b16 v[72:73], v15 offset:44032
    ds_read_b64_tr_b16 v[74:75], v15 offset:48640
    v_mfma_f32_16x16x32_bf16 v[116:119], v[44:47], v[20:23], v[116:119]
    v_mfma_f32_16x16x32_bf16 v[152:155], v[44:47], v[24:27], v[152:155]
    ds_read_b64_tr_b16 v[76:77], v15 offset:44064
    ds_read_b64_tr_b16 v[78:79], v15 offset:48672
    ds_read_b64_tr_b16 v[80:81], v15 offset:44096
    s_waitcnt lgkmcnt(15)
    v_mfma_f32_16x16x32_bf16 v[120:123], v[48:51], v[20:23], v[120:123]
    v_mfma_f32_16x16x32_bf16 v[156:159], v[48:51], v[24:27], v[156:159]
    ds_read_b64_tr_b16 v[82:83], v15 offset:48704
    ds_read_b64_tr_b16 v[84:85], v15 offset:44128
    ds_read_b64_tr_b16 v[86:87], v15 offset:48736
    v_mfma_f32_16x16x32_bf16 v[124:127], v[52:55], v[20:23], v[124:127]
    v_mfma_f32_16x16x32_bf16 v[160:163], v[52:55], v[24:27], v[160:163]
    ds_read_b64_tr_b16 v[88:89], v15 offset:44160
    ds_read_b64_tr_b16 v[90:91], v15 offset:48768
    ds_read_b64_tr_b16 v[92:93], v15 offset:44192
    v_mfma_f32_16x16x32_bf16 v[128:131], v[56:59], v[20:23], v[128:131]
    v_mfma_f32_16x16x32_bf16 v[164:167], v[56:59], v[24:27], v[164:167]
    ds_read_b64_tr_b16 v[94:95], v15 offset:48800
    ds_read_b64_tr_b16 v[96:97], v15 offset:44224
    ds_read_b64_tr_b16 v[98:99], v15 offset:48832
    s_waitcnt lgkmcnt(15)
    v_mfma_f32_16x16x32_bf16 v[132:135], v[60:63], v[20:23], v[132:135]
    v_mfma_f32_16x16x32_bf16 v[168:171], v[60:63], v[24:27], v[168:171]
    ds_read_b64_tr_b16 v[100:101], v15 offset:44256
    ds_read_b64_tr_b16 v[102:103], v15 offset:48864
    ds_read_b64_tr_b16 v[104:105], v15 offset:44288
    v_mfma_f32_16x16x32_bf16 v[136:139], v[64:67], v[20:23], v[136:139]
    v_mfma_f32_16x16x32_bf16 v[172:175], v[64:67], v[24:27], v[172:175]
    ds_read_b64_tr_b16 v[106:107], v15 offset:48896
    v_mfma_f32_16x16x32_bf16 v[140:143], v[68:71], v[20:23], v[140:143]
    v_mfma_f32_16x16x32_bf16 v[176:179], v[68:71], v[24:27], v[176:179]
    s_waitcnt lgkmcnt(0)
    s_waitcnt vmcnt(0)
    s_barrier
    s_add_u32 s4, s4, 128
    s_addc_u32 s5, s5, 0
    s_add_u32 s6, s6, s18
    s_addc_u32 s7, s7, 0
    s_lshl_b32 s9, s8, 12
    s_add_u32 m0, s9, 34816
    s_nop 0
    global_load_lds_dwordx4 v2, s[4:5]
    s_lshl_b32 s9, s8, 12
    s_add_u32 m0, s9, 35840
    s_nop 0
    global_load_lds_dwordx4 v3, s[4:5]
    s_lshl_b32 s9, s8, 12
    s_add_u32 m0, s9, 36864
    s_nop 0
    global_load_lds_dwordx4 v4, s[4:5]
    s_lshl_b32 s9, s8, 12
    s_add_u32 m0, s9, 37888
    s_nop 0
    global_load_lds_dwordx4 v5, s[4:5]
    s_mul_i32 s9, s8, 4608
    s_add_u32 m0, s9, 51200
    s_nop 0
    global_load_lds_dwordx4 v6, s[6:7]
    s_mul_i32 s9, s8, 4608
    s_add_u32 m0, s9, 52224
    s_nop 0
    global_load_lds_dwordx4 v7, s[6:7]
    s_mul_i32 s9, s8, 4608
    s_add_u32 m0, s9, 53248
    s_nop 0
    global_load_lds_dwordx4 v8, s[6:7]
    s_mul_i32 s9, s8, 4608
    s_add_u32 m0, s9, 54272
    s_nop 0
    global_load_lds_dwordx4 v9, s[6:7]
    s_mul_i32 s9, s8, 4608
    s_add_u32 m0, s9, 55296
    s_mov_b32 exec_hi, 0
    global_load_lds_dwordx4 v10, s[6:7]
    s_mov_b64 exec, -1
    v_mfma_f32_16x16x32_bf16 v[108:111], v[72:75], v[28:31], v[108:111]
    v_mfma_f32_16x16x32_bf16 v[144:147], v[72:75], v[32:35], v[144:147]
    ds_read_b64 v[20:21], v11 offset:0
    ds_read_b64 v[22:23], v12 offset:0
    ds_read_b64 v[24:25], v11 offset:2048
    v_mfma_f32_16x16x32_bf16 v[112:115], v[76:79], v[28:31], v[112:115]
    v_mfma_f32_16x16x32_bf16 v[148:151], v[76:79], v[32:35], v[148:151]
    ds_read_b64 v[26:27], v12 offset:2048
    ds_read_b64_tr_b16 v[36:37], v15 offset:0
    ds_read_b64_tr_b16 v[38:39], v15 offset:4608
    v_mfma_f32_16x16x32_bf16 v[116:119], v[80:83], v[28:31], v[116:119]
    v_mfma_f32_16x16x32_bf16 v[152:155], v[80:83], v[32:35], v[152:155]
    ds_read_b64_tr_b16 v[40:41], v15 offset:32
    ds_read_b64_tr_b16 v[42:43], v15 offset:4640
    ds_read_b64_tr_b16 v[44:45], v15 offset:64
    v_mfma_f32_16x16x32_bf16 v[120:123], v[84:87], v[28:31], v[120:123]
    v_mfma_f32_16x16x32_bf16 v[156:159], v[84:87], v[32:35], v[156:159]
    ds_read_b64_tr_b16 v[46:47], v15 offset:4672
    ds_read_b64_tr_b16 v[48:49], v15 offset:96
    ds_read_b64_tr_b16 v[50:51], v15 offset:4704
    v_mfma_f32_16x16x32_bf16 v[124:127], v[88:91], v[28:31], v[124:127]
    v_mfma_f32_16x16x32_bf16 v[160:163], v[88:91], v[32:35], v[160:163]
    ds_read_b64_tr_b16 v[52:53], v15 offset:128
    ds_read_b64_tr_b16 v[54:55], v15 offset:4736
    ds_read_b64_tr_b16 v[56:57], v15 offset:160
    v_mfma_f32_16x16x32_bf16 v[128:131], v[92:95], v[28:31], v[128:131]
    v_mfma_f32_16x16x32_bf16 v[164:167], v[92:95], v[32:35], v[164:167]
    ds_read_b64_tr_b16 v[58:59], v15 offset:4768
    ds_read_b64_tr_b16 v[60:61], v15 offset:192
    ds_read_b64_tr_b16 v[62:63], v15 offset:4800
    v_mfma_f32_16x16x32_bf16 v[132:135], v[96:99], v[28:31], v[132:135]
    v_mfma_f32_16x16x32_bf16 v[168:171], v[96:99], v[32:35], v[168:171]
    ds_read_b64_tr_b16 v[64:65], v15 offset:224
    ds_read_b64_tr_b16 v[66:67], v15 offset:4832
    ds_read_b64_tr_b16 v[68:69], v15 offset:256
    v_mfma_f32_16x16x32_bf16 v[136:139], v[100:103], v[28:31], v[136:139]
    v_mfma_f32_16x16x32_bf16 v[172:175], v[100:103], v[32:35], v[172:175]
    ds_read_b64_tr_b16 v[70:71], v15 offset:4864
    v_mfma_f32_16x16x32_bf16 v[140:143], v[104:107], v[28:31], v[140:143]
    v_mfma_f32_16x16x32_bf16 v[176:179], v[104:107], v[32:35], v[176:179]
    s_waitcnt lgkmcnt(15)
    v_mfma_f32_16x16x32_bf16 v[108:111], v[36:39], v[20:23], v[108:111]
    v_mfma_f32_16x16x32_bf16 v[144:147], v[36:39], v[24:27], v[144:147]
    ds_read_b64 v[28:29], v13 offset:0
    ds_read_b64 v[30:31], v14 offset:0
    ds_read_b64 v[32:33], v13 offset:2048
    s_waitcnt lgkmcnt(15)
    v_mfma_f32_16x16x32_bf16 v[112:115], v[40:43], v[20:23], v[112:115]
    v_mfma_f32_16x16x32_bf16 v[148:151], v[40:43], v[24:27], v[148:151]
    ds_read_b64 v[34:35], v14 offset:2048
    ds_read_b64_tr_b16 v[72:73], v15 offset:9216
    ds_read_b64_tr_b16 v[74:75], v15 offset:13824
    v_mfma_f32_16x16x32_bf16 v[116:119], v[44:47], v[20:23], v[116:119]
    v_mfma_f32_16x16x32_bf16 v[152:155], v[44:47], v[24:27], v[152:155]
    ds_read_b64_tr_b16 v[76:77], v15 offset:9248
    ds_read_b64_tr_b16 v[78:79], v15 offset:13856
    ds_read_b64_tr_b16 v[80:81], v15 offset:9280
    s_waitcnt lgkmcnt(15)
    v_mfma_f32_16x16x32_bf16 v[120:123], v[48:51], v[20:23], v[120:123]
    v_mfma_f32_16x16x32_bf16 v[156:159], v[48:51], v[24:27], v[156:159]
    ds_read_b64_tr_b16 v[82:83], v15 offset:13888
    ds_read_b64_tr_b16 v[84:85], v15 offset:9312
    ds_read_b64_tr_b16 v[86:87], v15 offset:13920
    v_mfma_f32_16x16x32_bf16 v[124:127], v[52:55], v[20:23], v[124:127]
    v_mfma_f32_16x16x32_bf16 v[160:163], v[52:55], v[24:27], v[160:163]
    ds_read_b64_tr_b16 v[88:89], v15 offset:9344
    ds_read_b64_tr_b16 v[90:91], v15 offset:13952
    ds_read_b64_tr_b16 v[92:93], v15 offset:9376
    v_mfma_f32_16x16x32_bf16 v[128:131], v[56:59], v[20:23], v[128:131]
    v_mfma_f32_16x16x32_bf16 v[164:167], v[56:59], v[24:27], v[164:167]
    ds_read_b64_tr_b16 v[94:95], v15 offset:13984
    ds_read_b64_tr_b16 v[96:97], v15 offset:9408
    ds_read_b64_tr_b16 v[98:99], v15 offset:14016
    s_waitcnt lgkmcnt(15)
    v_mfma_f32_16x16x32_bf16 v[132:135], v[60:63], v[20:23], v[132:135]
    v_mfma_f32_16x16x32_bf16 v[168:171], v[60:63], v[24:27], v[168:171]
    ds_read_b64_tr_b16 v[100:101], v15 offset:9440
    ds_read_b64_tr_b16 v[102:103], v15 offset:14048
    ds_read_b64_tr_b16 v[104:105], v15 offset:9472
    v_mfma_f32_16x16x32_bf16 v[136:139], v[64:67], v[20:23], v[136:139]
    v_mfma_f32_16x16x32_bf16 v[172:175], v[64:67], v[24:27], v[172:175]
    ds_read_b64_tr_b16 v[106:107], v15 offset:14080
    v_mfma_f32_16x16x32_bf16 v[140:143], v[68:71], v[20:23], v[140:143]
    v_mfma_f32_16x16x32_bf16 v[176:179], v[68:71], v[24:27], v[176:179]
    s_waitcnt lgkmcnt(0)
    s_waitcnt vmcnt(0)
    s_barrier
    s_add_u32 s4, s4, 128
    s_addc_u32 s5, s5, 0
    s_add_u32 s6, s6, s18
    s_addc_u32 s7, s7, 0
    s_lshl_b32 s9, s8, 12
    s_add_u32 m0, s9, 0
    s_nop 0
    global_load_lds_dwordx4 v2, s[4:5]
    s_lshl_b32 s9, s8, 12
    s_add_u32 m0, s9, 1024
    s_nop 0
    global_load_lds_dwordx4 v3, s[4:5]
    s_lshl_b32 s9, s8, 12
    s_add_u32 m0, s9, 2048
    s_nop 0
    global_load_lds_dwordx4 v4, s[4:5]
    s_lshl_b32 s9, s8, 12
    s_add_u32 m0, s9, 3072
    s_nop 0
    global_load_lds_dwordx4 v5, s[4:5]
    s_mul_i32 s9, s8, 4608
    s_add_u32 m0, s9, 16384
    s_nop 0
    global_load_lds_dwordx4 v6, s[6:7]
    s_mul_i32 s9, s8, 4608
    s_add_u32 m0, s9, 17408
    s_nop 0
    global_load_lds_dwordx4 v7, s[6:7]
    s_mul_i32 s9, s8, 4608
    s_add_u32 m0, s9, 18432
    s_nop 0
    global_load_lds_dwordx4 v8, s[6:7]
    s_mul_i32 s9, s8, 4608
    s_add_u32 m0, s9, 19456
    s_nop 0
    global_load_lds_dwordx4 v9, s[6:7]
    s_mul_i32 s9, s8, 4608
    s_add_u32 m0, s9, 20480
    s_mov_b32 exec_hi, 0
    global_load_lds_dwordx4 v10, s[6:7]
    s_mov_b64 exec, -1
    v_mfma_f32_16x16x32_bf16 v[108:111], v[72:75], v[28:31], v[108:111]
    v_mfma_f32_16x16x32_bf16 v[144:147], v[72:75], v[32:35], v[144:147]
    ds_read_b64 v[20:21], v11 offset:34816
    ds_read_b64 v[22:23], v12 offset:34816
    ds_read_b64 v[24:25], v11 offset:36864
    v_mfma_f32_16x16x32_bf16 v[112:115], v[76:79], v[28:31], v[112:115]
    v_mfma_f32_16x16x32_bf16 v[148:151], v[76:79], v[32:35], v[148:151]
    ds_read_b64 v[26:27], v12 offset:36864
    ds_read_b64_tr_b16 v[36:37], v15 offset:34816
    ds_read_b64_tr_b16 v[38:39], v15 offset:39424
    v_mfma_f32_16x16x32_bf16 v[116:119], v[80:83], v[28:31], v[116:119]
    v_mfma_f32_16x16x32_bf16 v[152:155], v[80:83], v[32:35], v[152:155]
    ds_read_b64_tr_b16 v[40:41], v15 offset:34848
    ds_read_b64_tr_b16 v[42:43], v15 offset:39456
    ds_read_b64_tr_b16 v[44:45], v15 offset:34880
    v_mfma_f32_16x16x32_bf16 v[120:123], v[84:87], v[28:31], v[120:123]
    v_mfma_f32_16x16x32_bf16 v[156:159], v[84:87], v[32:35], v[156:159]
    ds_read_b64_tr_b16 v[46:47], v15 offset:39488
    ds_read_b64_tr_b16 v[48:49], v15 offset:34912
    ds_read_b64_tr_b16 v[50:51], v15 offset:39520
    v_mfma_f32_16x16x32_bf16 v[124:127], v[88:91], v[28:31], v[124:127]
    v_mfma_f32_16x16x32_bf16 v[160:163], v[88:91], v[32:35], v[160:163]
    ds_read_b64_tr_b16 v[52:53], v15 offset:34944
    ds_read_b64_tr_b16 v[54:55], v15 offset:39552
    ds_read_b64_tr_b16 v[56:57], v15 offset:34976
    v_mfma_f32_16x16x32_bf16 v[128:131], v[92:95], v[28:31], v[128:131]
    v_mfma_f32_16x16x32_bf16 v[164:167], v[92:95], v[32:35], v[164:167]
    ds_read_b64_tr_b16 v[58:59], v15 offset:39584
    ds_read_b64_tr_b16 v[60:61], v15 offset:35008
    ds_read_b64_tr_b16 v[62:63], v15 offset:39616
    v_mfma_f32_16x16x32_bf16 v[132:135], v[96:99], v[28:31], v[132:135]
    v_mfma_f32_16x16x32_bf16 v[168:171], v[96:99], v[32:35], v[168:171]
    ds_read_b64_tr_b16 v[64:65], v15 offset:35040
    ds_read_b64_tr_b16 v[66:67], v15 offset:39648
    ds_read_b64_tr_b16 v[68:69], v15 offset:35072
    v_mfma_f32_16x16x32_bf16 v[136:139], v[100:103], v[28:31], v[136:139]
    v_mfma_f32_16x16x32_bf16 v[172:175], v[100:103], v[32:35], v[172:175]
    ds_read_b64_tr_b16 v[70:71], v15 offset:39680
    v_mfma_f32_16x16x32_bf16 v[140:143], v[104:107], v[28:31], v[140:143]
    v_mfma_f32_16x16x32_bf16 v[176:179], v[104:107], v[32:35], v[176:179]
    s_waitcnt lgkmcnt(15)
    v_mfma_f32_16x16x32_bf16 v[108:111], v[36:39], v[20:23], v[108:111]
    v_mfma_f32_16x16x32_bf16 v[144:147], v[36:39], v[24:27], v[144:147]
    ds_read_b64 v[28:29], v13 offset:34816
    ds_read_b64 v[30:31], v14 offset:34816
    ds_read_b64 v[32:33], v13 offset:36864
    s_waitcnt lgkmcnt(15)
    v_mfma_f32_16x16x32_bf16 v[112:115], v[40:43], v[20:23], v[112:115]
    v_mfma_f32_16x16x32_bf16 v[148:151], v[40:43], v[24:27], v[148:151]
    ds_read_b64 v[34:35], v14 offset:36864
    ds_read_b64_tr_b16 v[72:73], v15 offset:44032
    ds_read_b64_tr_b16 v[74:75], v15 offset:48640
    v_mfma_f32_16x16x32_bf16 v[116:119], v[44:47], v[20:23], v[116:119]
    v_mfma_f32_16x16x32_bf16 v[152:155], v[44:47], v[24:27], v[152:155]
    ds_read_b64_tr_b16 v[76:77], v15 offset:44064
    ds_read_b64_tr_b16 v[78:79], v15 offset:48672
    ds_read_b64_tr_b16 v[80:81], v15 offset:44096
    s_waitcnt lgkmcnt(15)
    v_mfma_f32_16x16x32_bf16 v[120:123], v[48:51], v[20:23], v[120:123]
    v_mfma_f32_16x16x32_bf16 v[156:159], v[48:51], v[24:27], v[156:159]
    ds_read_b64_tr_b16 v[82:83], v15 offset:48704
    ds_read_b64_tr_b16 v[84:85], v15 offset:44128
    ds_read_b64_tr_b16 v[86:87], v15 offset:48736
    v_mfma_f32_16x16x32_bf16 v[124:127], v[52:55], v[20:23], v[124:127]
    v_mfma_f32_16x16x32_bf16 v[160:163], v[52:55], v[24:27], v[160:163]
    ds_read_b64_tr_b16 v[88:89], v15 offset:44160
    ds_read_b64_tr_b16 v[90:91], v15 offset:48768
    ds_read_b64_tr_b16 v[92:93], v15 offset:44192
    v_mfma_f32_16x16x32_bf16 v[128:131], v[56:59], v[20:23], v[128:131]
    v_mfma_f32_16x16x32_bf16 v[164:167], v[56:59], v[24:27], v[164:167]
    ds_read_b64_tr_b16 v[94:95], v15 offset:48800
    ds_read_b64_tr_b16 v[96:97], v15 offset:44224
    ds_read_b64_tr_b16 v[98:99], v15 offset:48832
    s_waitcnt lgkmcnt(15)
    v_mfma_f32_16x16x32_bf16 v[132:135], v[60:63], v[20:23], v[132:135]
    v_mfma_f32_16x16x32_bf16 v[168:171], v[60:63], v[24:27], v[168:171]
    ds_read_b64_tr_b16 v[100:101], v15 offset:44256
    ds_read_b64_tr_b16 v[102:103], v15 offset:48864
    ds_read_b64_tr_b16 v[104:105], v15 offset:44288
    v_mfma_f32_16x16x32_bf16 v[136:139], v[64:67], v[20:23], v[136:139]
    v_mfma_f32_16x16x32_bf16 v[172:175], v[64:67], v[24:27], v[172:175]
    ds_read_b64_tr_b16 v[106:107], v15 offset:48896
    v_mfma_f32_16x16x32_bf16 v[140:143], v[68:71], v[20:23], v[140:143]
    v_mfma_f32_16x16x32_bf16 v[176:179], v[68:71], v[24:27], v[176:179]
    s_waitcnt lgkmcnt(0)
    s_waitcnt vmcnt(0)
    s_barrier
    s_add_u32 s4, s4, 128
    s_addc_u32 s5, s5, 0
    s_add_u32 s6, s6, s18
    s_addc_u32 s7, s7, 0
    s_lshl_b32 s9, s8, 12
    s_add_u32 m0, s9, 34816
    s_nop 0
    global_load_lds_dwordx4 v2, s[4:5]
    s_lshl_b32 s9, s8, 12
    s_add_u32 m0, s9, 35840
    s_nop 0
    global_load_lds_dwordx4 v3, s[4:5]
    s_lshl_b32 s9, s8, 12
    s_add_u32 m0, s9, 36864
    s_nop 0
    global_load_lds_dwordx4 v4, s[4:5]
    s_lshl_b32 s9, s8, 12
    s_add_u32 m0, s9, 37888
    s_nop 0
    global_load_lds_dwordx4 v5, s[4:5]
    s_mul_i32 s9, s8, 4608
    s_add_u32 m0, s9, 51200
    s_nop 0
    global_load_lds_dwordx4 v6, s[6:7]
    s_mul_i32 s9, s8, 4608
    s_add_u32 m0, s9, 52224
    s_nop 0
    global_load_lds_dwordx4 v7, s[6:7]
    s_mul_i32 s9, s8, 4608
    s_add_u32 m0, s9, 53248
    s_nop 0
    global_load_lds_dwordx4 v8, s[6:7]
    s_mul_i32 s9, s8, 4608
    s_add_u32 m0, s9, 54272
    s_nop 0
    global_load_lds_dwordx4 v9, s[6:7]
    s_mul_i32 s9, s8, 4608
    s_add_u32 m0, s9, 55296
    s_mov_b32 exec_hi, 0
    global_load_lds_dwordx4 v10, s[6:7]
    s_mov_b64 exec, -1
    v_mfma_f32_16x16x32_bf16 v[108:111], v[72:75], v[28:31], v[108:111]
    v_mfma_f32_16x16x32_bf16 v[144:147], v[72:75], v[32:35], v[144:147]
    ds_read_b64 v[20:21], v11 offset:0
    ds_read_b64 v[22:23], v12 offset:0
    ds_read_b64 v[24:25], v11 offset:2048
    v_mfma_f32_16x16x32_bf16 v[112:115], v[76:79], v[28:31], v[112:115]
    v_mfma_f32_16x16x32_bf16 v[148:151], v[76:79], v[32:35], v[148:151]
    ds_read_b64 v[26:27], v12 offset:2048
    ds_read_b64_tr_b16 v[36:37], v15 offset:0
    ds_read_b64_tr_b16 v[38:39], v15 offset:4608
    v_mfma_f32_16x16x32_bf16 v[116:119], v[80:83], v[28:31], v[116:119]
    v_mfma_f32_16x16x32_bf16 v[152:155], v[80:83], v[32:35], v[152:155]
    ds_read_b64_tr_b16 v[40:41], v15 offset:32
    ds_read_b64_tr_b16 v[42:43], v15 offset:4640
    ds_read_b64_tr_b16 v[44:45], v15 offset:64
    v_mfma_f32_16x16x32_bf16 v[120:123], v[84:87], v[28:31], v[120:123]
    v_mfma_f32_16x16x32_bf16 v[156:159], v[84:87], v[32:35], v[156:159]
    ds_read_b64_tr_b16 v[46:47], v15 offset:4672
    ds_read_b64_tr_b16 v[48:49], v15 offset:96
    ds_read_b64_tr_b16 v[50:51], v15 offset:4704
    v_mfma_f32_16x16x32_bf16 v[124:127], v[88:91], v[28:31], v[124:127]
    v_mfma_f32_16x16x32_bf16 v[160:163], v[88:91], v[32:35], v[160:163]
    ds_read_b64_tr_b16 v[52:53], v15 offset:128
    ds_read_b64_tr_b16 v[54:55], v15 offset:4736
    ds_read_b64_tr_b16 v[56:57], v15 offset:160
    v_mfma_f32_16x16x32_bf16 v[128:131], v[92:95], v[28:31], v[128:131]
    v_mfma_f32_16x16x32_bf16 v[164:167], v[92:95], v[32:35], v[164:167]
    ds_read_b64_tr_b16 v[58:59], v15 offset:4768
    ds_read_b64_tr_b16 v[60:61], v15 offset:192
    ds_read_b64_tr_b16 v[62:63], v15 offset:4800
    v_mfma_f32_16x16x32_bf16 v[132:135], v[96:99], v[28:31], v[132:135]
    v_mfma_f32_16x16x32_bf16 v[168:171], v[96:99], v[32:35], v[168:171]
    ds_read_b64_tr_b16 v[64:65], v15 offset:224
    ds_read_b64_tr_b16 v[66:67], v15 offset:4832
    ds_read_b64_tr_b16 v[68:69], v15 offset:256
    v_mfma_f32_16x16x32_bf16 v[136:139], v[100:103], v[28:31], v[136:139]
    v_mfma_f32_16x16x32_bf16 v[172:175], v[100:103], v[32:35], v[172:175]
    ds_read_b64_tr_b16 v[70:71], v15 offset:4864
    v_mfma_f32_16x16x32_bf16 v[140:143], v[104:107], v[28:31], v[140:143]
    v_mfma_f32_16x16x32_bf16 v[176:179], v[104:107], v[32:35], v[176:179]
    s_waitcnt lgkmcnt(15)
    v_mfma_f32_16x16x32_bf16 v[108:111], v[36:39], v[20:23], v[108:111]
    v_mfma_f32_16x16x32_bf16 v[144:147], v[36:39], v[24:27], v[144:147]
    ds_read_b64 v[28:29], v13 offset:0
    ds_read_b64 v[30:31], v14 offset:0
    ds_read_b64 v[32:33], v13 offset:2048
    s_waitcnt lgkmcnt(15)
    v_mfma_f32_16x16x32_bf16 v[112:115], v[40:43], v[20:23], v[112:115]
    v_mfma_f32_16x16x32_bf16 v[148:151], v[40:43], v[24:27], v[148:151]
    ds_read_b64 v[34:35], v14 offset:2048
    ds_read_b64_tr_b16 v[72:73], v15 offset:9216
    ds_read_b64_tr_b16 v[74:75], v15 offset:13824
    v_mfma_f32_16x16x32_bf16 v[116:119], v[44:47], v[20:23], v[116:119]
    v_mfma_f32_16x16x32_bf16 v[152:155], v[44:47], v[24:27], v[152:155]
    ds_read_b64_tr_b16 v[76:77], v15 offset:9248
    ds_read_b64_tr_b16 v[78:79], v15 offset:13856
    ds_read_b64_tr_b16 v[80:81], v15 offset:9280
    s_waitcnt lgkmcnt(15)
    v_mfma_f32_16x16x32_bf16 v[120:123], v[48:51], v[20:23], v[120:123]
    v_mfma_f32_16x16x32_bf16 v[156:159], v[48:51], v[24:27], v[156:159]
    ds_read_b64_tr_b16 v[82:83], v15 offset:13888
    ds_read_b64_tr_b16 v[84:85], v15 offset:9312
    ds_read_b64_tr_b16 v[86:87], v15 offset:13920
    v_mfma_f32_16x16x32_bf16 v[124:127], v[52:55], v[20:23], v[124:127]
    v_mfma_f32_16x16x32_bf16 v[160:163], v[52:55], v[24:27], v[160:163]
    ds_read_b64_tr_b16 v[88:89], v15 offset:9344
    ds_read_b64_tr_b16 v[90:91], v15 offset:13952
    ds_read_b64_tr_b16 v[92:93], v15 offset:9376
    v_mfma_f32_16x16x32_bf16 v[128:131], v[56:59], v[20:23], v[128:131]
    v_mfma_f32_16x16x32_bf16 v[164:167], v[56:59], v[24:27], v[164:167]
    ds_read_b64_tr_b16 v[94:95], v15 offset:13984
    ds_read_b64_tr_b16 v[96:97], v15 offset:9408
    ds_read_b64_tr_b16 v[98:99], v15 offset:14016
    s_waitcnt lgkmcnt(15)
    v_mfma_f32_16x16x32_bf16 v[132:135], v[60:63], v[20:23], v[132:135]
    v_mfma_f32_16x16x32_bf16 v[168:171], v[60:63], v[24:27], v[168:171]
    ds_read_b64_tr_b16 v[100:101], v15 offset:9440
    ds_read_b64_tr_b16 v[102:103], v15 offset:14048
    ds_read_b64_tr_b16 v[104:105], v15 offset:9472
    v_mfma_f32_16x16x32_bf16 v[136:139], v[64:67], v[20:23], v[136:139]
    v_mfma_f32_16x16x32_bf16 v[172:175], v[64:67], v[24:27], v[172:175]
    ds_read_b64_tr_b16 v[106:107], v15 offset:14080
    v_mfma_f32_16x16x32_bf16 v[140:143], v[68:71], v[20:23], v[140:143]
    v_mfma_f32_16x16x32_bf16 v[176:179], v[68:71], v[24:27], v[176:179]
    s_waitcnt lgkmcnt(0)
    s_waitcnt vmcnt(0)
    s_barrier
    s_add_u32 s4, s4, 128
    s_addc_u32 s5, s5, 0
    s_add_u32 s6, s6, s18
    s_addc_u32 s7, s7, 0
    s_lshl_b32 s9, s8, 12
    s_add_u32 m0, s9, 0
    s_nop 0
    global_load_lds_dwordx4 v2, s[4:5]
    s_lshl_b32 s9, s8, 12
    s_add_u32 m0, s9, 1024
    s_nop 0
    global_load_lds_dwordx4 v3, s[4:5]
    s_lshl_b32 s9, s8, 12
    s_add_u32 m0, s9, 2048
    s_nop 0
    global_load_lds_dwordx4 v4, s[4:5]
    s_lshl_b32 s9, s8, 12
    s_add_u32 m0, s9, 3072
    s_nop 0
    global_load_lds_dwordx4 v5, s[4:5]
    s_mul_i32 s9, s8, 4608
    s_add_u32 m0, s9, 16384
    s_nop 0
    global_load_lds_dwordx4 v6, s[6:7]
    s_mul_i32 s9, s8, 4608
    s_add_u32 m0, s9, 17408
    s_nop 0
    global_load_lds_dwordx4 v7, s[6:7]
    s_mul_i32 s9, s8, 4608
    s_add_u32 m0, s9, 18432
    s_nop 0
    global_load_lds_dwordx4 v8, s[6:7]
    s_mul_i32 s9, s8, 4608
    s_add_u32 m0, s9, 19456
    s_nop 0
    global_load_lds_dwordx4 v9, s[6:7]
    s_mul_i32 s9, s8, 4608
    s_add_u32 m0, s9, 20480
    s_mov_b32 exec_hi, 0
    global_load_lds_dwordx4 v10, s[6:7]
    s_mov_b64 exec, -1
    v_mfma_f32_16x16x32_bf16 v[108:111], v[72:75], v[28:31], v[108:111]
    v_mfma_f32_16x16x32_bf16 v[144:147], v[72:75], v[32:35], v[144:147]
    ds_read_b64 v[20:21], v11 offset:34816
    ds_read_b64 v[22:23], v12 offset:34816
    ds_read_b64 v[24:25], v11 offset:36864
    v_mfma_f32_16x16x32_bf16 v[112:115], v[76:79], v[28:31], v[112:115]
    v_mfma_f32_16x16x32_bf16 v[148:151], v[76:79], v[32:35], v[148:151]
    ds_read_b64 v[26:27], v12 offset:36864
    ds_read_b64_tr_b16 v[36:37], v15 offset:34816
    ds_read_b64_tr_b16 v[38:39], v15 offset:39424
    v_mfma_f32_16x16x32_bf16 v[116:119], v[80:83], v[28:31], v[116:119]
    v_mfma_f32_16x16x32_bf16 v[152:155], v[80:83], v[32:35], v[152:155]
    ds_read_b64_tr_b16 v[40:41], v15 offset:34848
    ds_read_b64_tr_b16 v[42:43], v15 offset:39456
    ds_read_b64_tr_b16 v[44:45], v15 offset:34880
    v_mfma_f32_16x16x32_bf16 v[120:123], v[84:87], v[28:31], v[120:123]
    v_mfma_f32_16x16x32_bf16 v[156:159], v[84:87], v[32:35], v[156:159]
    ds_read_b64_tr_b16 v[46:47], v15 offset:39488
    ds_read_b64_tr_b16 v[48:49], v15 offset:34912
    ds_read_b64_tr_b16 v[50:51], v15 offset:39520
    v_mfma_f32_16x16x32_bf16 v[124:127], v[88:91], v[28:31], v[124:127]
    v_mfma_f32_16x16x32_bf16 v[160:163], v[88:91], v[32:35], v[160:163]
    ds_read_b64_tr_b16 v[52:53], v15 offset:34944
    ds_read_b64_tr_b16 v[54:55], v15 offset:39552
    ds_read_b64_tr_b16 v[56:57], v15 offset:34976
    v_mfma_f32_16x16x32_bf16 v[128:131], v[92:95], v[28:31], v[128:131]
    v_mfma_f32_16x16x32_bf16 v[164:167], v[92:95], v[32:35], v[164:167]
    ds_read_b64_tr_b16 v[58:59], v15 offset:39584
    ds_read_b64_tr_b16 v[60:61], v15 offset:35008
    ds_read_b64_tr_b16 v[62:63], v15 offset:39616
    v_mfma_f32_16x16x32_bf16 v[132:135], v[96:99], v[28:31], v[132:135]
    v_mfma_f32_16x16x32_bf16 v[168:171], v[96:99], v[32:35], v[168:171]
    ds_read_b64_tr_b16 v[64:65], v15 offset:35040
    ds_read_b64_tr_b16 v[66:67], v15 offset:39648
    ds_read_b64_tr_b16 v[68:69], v15 offset:35072
    v_mfma_f32_16x16x32_bf16 v[136:139], v[100:103], v[28:31], v[136:139]
    v_mfma_f32_16x16x32_bf16 v[172:175], v[100:103], v[32:35], v[172:175]
    ds_read_b64_tr_b16 v[70:71], v15 offset:39680
    v_mfma_f32_16x16x32_bf16 v[140:143], v[104:107], v[28:31], v[140:143]
    v_mfma_f32_16x16x32_bf16 v[176:179], v[104:107], v[32:35], v[176:179]
    s_waitcnt lgkmcnt(15)
    v_mfma_f32_16x16x32_bf16 v[108:111], v[36:39], v[20:23], v[108:111]
    v_mfma_f32_16x16x32_bf16 v[144:147], v[36:39], v[24:27], v[144:147]
    ds_read_b64 v[28:29], v13 offset:34816
    ds_read_b64 v[30:31], v14 offset:34816
    ds_read_b64 v[32:33], v13 offset:36864
    s_waitcnt lgkmcnt(15)
    v_mfma_f32_16x16x32_bf16 v[112:115], v[40:43], v[20:23], v[112:115]
    v_mfma_f32_16x16x32_bf16 v[148:151], v[40:43], v[24:27], v[148:151]
    ds_read_b64 v[34:35], v14 offset:36864
    ds_read_b64_tr_b16 v[72:73], v15 offset:44032
    ds_read_b64_tr_b16 v[74:75], v15 offset:48640
    v_mfma_f32_16x16x32_bf16 v[116:119], v[44:47], v[20:23], v[116:119]
    v_mfma_f32_16x16x32_bf16 v[152:155], v[44:47], v[24:27], v[152:155]
    ds_read_b64_tr_b16 v[76:77], v15 offset:44064
    ds_read_b64_tr_b16 v[78:79], v15 offset:48672
    ds_read_b64_tr_b16 v[80:81], v15 offset:44096
    s_waitcnt lgkmcnt(15)
    v_mfma_f32_16x16x32_bf16 v[120:123], v[48:51], v[20:23], v[120:123]
    v_mfma_f32_16x16x32_bf16 v[156:159], v[48:51], v[24:27], v[156:159]
    ds_read_b64_tr_b16 v[82:83], v15 offset:48704
    ds_read_b64_tr_b16 v[84:85], v15 offset:44128
    ds_read_b64_tr_b16 v[86:87], v15 offset:48736
    v_mfma_f32_16x16x32_bf16 v[124:127], v[52:55], v[20:23], v[124:127]
    v_mfma_f32_16x16x32_bf16 v[160:163], v[52:55], v[24:27], v[160:163]
    ds_read_b64_tr_b16 v[88:89], v15 offset:44160
    ds_read_b64_tr_b16 v[90:91], v15 offset:48768
    ds_read_b64_tr_b16 v[92:93], v15 offset:44192
    v_mfma_f32_16x16x32_bf16 v[128:131], v[56:59], v[20:23], v[128:131]
    v_mfma_f32_16x16x32_bf16 v[164:167], v[56:59], v[24:27], v[164:167]
    ds_read_b64_tr_b16 v[94:95], v15 offset:48800
    ds_read_b64_tr_b16 v[96:97], v15 offset:44224
    ds_read_b64_tr_b16 v[98:99], v15 offset:48832
    s_waitcnt lgkmcnt(15)
    v_mfma_f32_16x16x32_bf16 v[132:135], v[60:63], v[20:23], v[132:135]
    v_mfma_f32_16x16x32_bf16 v[168:171], v[60:63], v[24:27], v[168:171]
    ds_read_b64_tr_b16 v[100:101], v15 offset:44256
    ds_read_b64_tr_b16 v[102:103], v15 offset:48864
    ds_read_b64_tr_b16 v[104:105], v15 offset:44288
    v_mfma_f32_16x16x32_bf16 v[136:139], v[64:67], v[20:23], v[136:139]
    v_mfma_f32_16x16x32_bf16 v[172:175], v[64:67], v[24:27], v[172:175]
    ds_read_b64_tr_b16 v[106:107], v15 offset:48896
    v_mfma_f32_16x16x32_bf16 v[140:143], v[68:71], v[20:23], v[140:143]
    v_mfma_f32_16x16x32_bf16 v[176:179], v[68:71], v[24:27], v[176:179]
    s_waitcnt lgkmcnt(0)
    s_waitcnt vmcnt(0)
    s_barrier
    v_mfma_f32_16x16x32_bf16 v[108:111], v[72:75], v[28:31], v[108:111]
    v_mfma_f32_16x16x32_bf16 v[144:147], v[72:75], v[32:35], v[144:147]
    ds_read_b64 v[20:21], v11 offset:0
    ds_read_b64 v[22:23], v12 offset:0
    ds_read_b64 v[24:25], v11 offset:2048
    v_mfma_f32_16x16x32_bf16 v[112:115], v[76:79], v[28:31], v[112:115]
    v_mfma_f32_16x16x32_bf16 v[148:151], v[76:79], v[32:35], v[148:151]
    ds_read_b64 v[26:27], v12 offset:2048
    ds_read_b64_tr_b16 v[36:37], v15 offset:0
    ds_read_b64_tr_b16 v[38:39], v15 offset:4608
    v_mfma_f32_16x16x32_bf16 v[116:119], v[80:83], v[28:31], v[116:119]
    v_mfma_f32_16x16x32_bf16 v[152:155], v[80:83], v[32:35], v[152:155]
    ds_read_b64_tr_b16 v[40:41], v15 offset:32
    ds_read_b64_tr_b16 v[42:43], v15 offset:4640
    ds_read_b64_tr_b16 v[44:45], v15 offset:64
    v_mfma_f32_16x16x32_bf16 v[120:123], v[84:87], v[28:31], v[120:123]
    v_mfma_f32_16x16x32_bf16 v[156:159], v[84:87], v[32:35], v[156:159]
    ds_read_b64_tr_b16 v[46:47], v15 offset:4672
    ds_read_b64_tr_b16 v[48:49], v15 offset:96
    ds_read_b64_tr_b16 v[50:51], v15 offset:4704
    v_mfma_f32_16x16x32_bf16 v[124:127], v[88:91], v[28:31], v[124:127]
    v_mfma_f32_16x16x32_bf16 v[160:163], v[88:91], v[32:35], v[160:163]
    ds_read_b64_tr_b16 v[52:53], v15 offset:128
    ds_read_b64_tr_b16 v[54:55], v15 offset:4736
    ds_read_b64_tr_b16 v[56:57], v15 offset:160
    v_mfma_f32_16x16x32_bf16 v[128:131], v[92:95], v[28:31], v[128:131]
    v_mfma_f32_16x16x32_bf16 v[164:167], v[92:95], v[32:35], v[164:167]
    ds_read_b64_tr_b16 v[58:59], v15 offset:4768
    ds_read_b64_tr_b16 v[60:61], v15 offset:192
    ds_read_b64_tr_b16 v[62:63], v15 offset:4800
    v_mfma_f32_16x16x32_bf16 v[132:135], v[96:99], v[28:31], v[132:135]
    v_mfma_f32_16x16x32_bf16 v[168:171], v[96:99], v[32:35], v[168:171]
    ds_read_b64_tr_b16 v[64:65], v15 offset:224
    ds_read_b64_tr_b16 v[66:67], v15 offset:4832
    ds_read_b64_tr_b16 v[68:69], v15 offset:256
    v_mfma_f32_16x16x32_bf16 v[136:139], v[100:103], v[28:31], v[136:139]
    v_mfma_f32_16x16x32_bf16 v[172:175], v[100:103], v[32:35], v[172:175]
    ds_read_b64_tr_b16 v[70:71], v15 offset:4864
    v_mfma_f32_16x16x32_bf16 v[140:143], v[104:107], v[28:31], v[140:143]
    v_mfma_f32_16x16x32_bf16 v[176:179], v[104:107], v[32:35], v[176:179]
    s_waitcnt lgkmcnt(15)
    v_mfma_f32_16x16x32_bf16 v[108:111], v[36:39], v[20:23], v[108:111]
    v_mfma_f32_16x16x32_bf16 v[144:147], v[36:39], v[24:27], v[144:147]
    ds_read_b64 v[28:29], v13 offset:0
    ds_read_b64 v[30:31], v14 offset:0
    ds_read_b64 v[32:33], v13 offset:2048
    s_waitcnt lgkmcnt(15)
    v_mfma_f32_16x16x32_bf16 v[112:115], v[40:43], v[20:23], v[112:115]
    v_mfma_f32_16x16x32_bf16 v[148:151], v[40:43], v[24:27], v[148:151]
    ds_read_b64 v[34:35], v14 offset:2048
    ds_read_b64_tr_b16 v[72:73], v15 offset:9216
    ds_read_b64_tr_b16 v[74:75], v15 offset:13824
    v_mfma_f32_16x16x32_bf16 v[116:119], v[44:47], v[20:23], v[116:119]
    v_mfma_f32_16x16x32_bf16 v[152:155], v[44:47], v[24:27], v[152:155]
    ds_read_b64_tr_b16 v[76:77], v15 offset:9248
    ds_read_b64_tr_b16 v[78:79], v15 offset:13856
    ds_read_b64_tr_b16 v[80:81], v15 offset:9280
    s_waitcnt lgkmcnt(15)
    v_mfma_f32_16x16x32_bf16 v[120:123], v[48:51], v[20:23], v[120:123]
    v_mfma_f32_16x16x32_bf16 v[156:159], v[48:51], v[24:27], v[156:159]
    ds_read_b64_tr_b16 v[82:83], v15 offset:13888
    ds_read_b64_tr_b16 v[84:85], v15 offset:9312
    ds_read_b64_tr_b16 v[86:87], v15 offset:13920
    v_mfma_f32_16x16x32_bf16 v[124:127], v[52:55], v[20:23], v[124:127]
    v_mfma_f32_16x16x32_bf16 v[160:163], v[52:55], v[24:27], v[160:163]
    ds_read_b64_tr_b16 v[88:89], v15 offset:9344
    ds_read_b64_tr_b16 v[90:91], v15 offset:13952
    ds_read_b64_tr_b16 v[92:93], v15 offset:9376
    v_mfma_f32_16x16x32_bf16 v[128:131], v[56:59], v[20:23], v[128:131]
    v_mfma_f32_16x16x32_bf16 v[164:167], v[56:59], v[24:27], v[164:167]
    ds_read_b64_tr_b16 v[94:95], v15 offset:13984
    ds_read_b64_tr_b16 v[96:97], v15 offset:9408
    ds_read_b64_tr_b16 v[98:99], v15 offset:14016
    s_waitcnt lgkmcnt(15)
    v_mfma_f32_16x16x32_bf16 v[132:135], v[60:63], v[20:23], v[132:135]
    v_mfma_f32_16x16x32_bf16 v[168:171], v[60:63], v[24:27], v[168:171]
    ds_read_b64_tr_b16 v[100:101], v15 offset:9440
    ds_read_b64_tr_b16 v[102:103], v15 offset:14048
    ds_read_b64_tr_b16 v[104:105], v15 offset:9472
    v_mfma_f32_16x16x32_bf16 v[136:139], v[64:67], v[20:23], v[136:139]
    v_mfma_f32_16x16x32_bf16 v[172:175], v[64:67], v[24:27], v[172:175]
    ds_read_b64_tr_b16 v[106:107], v15 offset:14080
    v_mfma_f32_16x16x32_bf16 v[140:143], v[68:71], v[20:23], v[140:143]
    v_mfma_f32_16x16x32_bf16 v[176:179], v[68:71], v[24:27], v[176:179]
    s_waitcnt lgkmcnt(15)
    v_mfma_f32_16x16x32_bf16 v[108:111], v[72:75], v[28:31], v[108:111]
    v_mfma_f32_16x16x32_bf16 v[144:147], v[72:75], v[32:35], v[144:147]
    s_waitcnt lgkmcnt(14)
    v_mfma_f32_16x16x32_bf16 v[112:115], v[76:79], v[28:31], v[112:115]
    v_mfma_f32_16x16x32_bf16 v[148:151], v[76:79], v[32:35], v[148:151]
    s_waitcnt lgkmcnt(12)
    v_mfma_f32_16x16x32_bf16 v[116:119], v[80:83], v[28:31], v[116:119]
    v_mfma_f32_16x16x32_bf16 v[152:155], v[80:83], v[32:35], v[152:155]
    s_waitcnt lgkmcnt(10)
    v_mfma_f32_16x16x32_bf16 v[120:123], v[84:87], v[28:31], v[120:123]
    v_mfma_f32_16x16x32_bf16 v[156:159], v[84:87], v[32:35], v[156:159]
    s_waitcnt lgkmcnt(8)
    v_mfma_f32_16x16x32_bf16 v[124:127], v[88:91], v[28:31], v[124:127]
    v_mfma_f32_16x16x32_bf16 v[160:163], v[88:91], v[32:35], v[160:163]
    s_waitcnt lgkmcnt(6)
    v_mfma_f32_16x16x32_bf16 v[128:131], v[92:95], v[28:31], v[128:131]
    v_mfma_f32_16x16x32_bf16 v[164:167], v[92:95], v[32:35], v[164:167]
    s_waitcnt lgkmcnt(4)
    v_mfma_f32_16x16x32_bf16 v[132:135], v[96:99], v[28:31], v[132:135]
    v_mfma_f32_16x16x32_bf16 v[168:171], v[96:99], v[32:35], v[168:171]
    s_waitcnt lgkmcnt(2)
    v_mfma_f32_16x16x32_bf16 v[136:139], v[100:103], v[28:31], v[136:139]
    v_mfma_f32_16x16x32_bf16 v[172:175], v[100:103], v[32:35], v[172:175]
    s_waitcnt lgkmcnt(0)
    v_mfma_f32_16x16x32_bf16 v[140:143], v[104:107], v[28:31], v[140:143]
    v_mfma_f32_16x16x32_bf16 v[176:179], v[104:107], v[32:35], v[176:179]
    s_nop 15
    s_barrier
    v_lshrrev_b32 v18, 4, v1
    v_and_b32 v19, 15, v1
    s_lshl_b32 s9, s8, 5
    v_add_u32 v19, s9, v19
    v_mul_u32_u24 v19, 288, v19
    v_lshlrev_b32 v16, 3, v18
    v_add_u32 v16, v16, v19
    v_cvt_pk_bf16_f32 v182, v108, v109
    v_cvt_pk_bf16_f32 v183, v110, v111
    v_lshlrev_b32 v184, 16, v182
    v_and_b32 v185, 0xffff0000, v182
    v_lshlrev_b32 v186, 16, v183
    v_and_b32 v187, 0xffff0000, v183
    v_mul_f32 v188, 0x3fb8aa3b, v184
    v_exp_f32 v188, v188
    v_add_f32 v189, 1.0, v184
    v_cmp_lt_f32 vcc, 0, v184
    s_nop 1
    v_cndmask_b32 v184, v188, v189, vcc
    v_mul_f32 v188, 0x3fb8aa3b, v185
    v_exp_f32 v188, v188
    v_add_f32 v189, 1.0, v185
    v_cmp_lt_f32 vcc, 0, v185
    s_nop 1
    v_cndmask_b32 v185, v188, v189, vcc
    v_mul_f32 v188, 0x3fb8aa3b, v186
    v_exp_f32 v188, v188
    v_add_f32 v189, 1.0, v186
    v_cmp_lt_f32 vcc, 0, v186
    s_nop 1
    v_cndmask_b32 v186, v188, v189, vcc
    v_mul_f32 v188, 0x3fb8aa3b, v187
    v_exp_f32 v188, v188
    v_add_f32 v189, 1.0, v187
    v_cmp_lt_f32 vcc, 0, v187
    s_nop 1
    v_cndmask_b32 v187, v188, v189, vcc
    v_cvt_pk_bf16_f32 v182, v184, v185
    v_cvt_pk_bf16_f32 v183, v186, v187
    v_lshlrev_b32 v184, 16, v182
    v_and_b32 v185, 0xffff0000, v182
    v_lshlrev_b32 v186, 16, v183
    v_and_b32 v187, 0xffff0000, v183
    v_add_f32 v184, 0x358637bd, v184
    v_add_f32 v185, 0x358637bd, v185
    v_add_f32 v186, 0x358637bd, v186
    v_add_f32 v187, 0x358637bd, v187
    v_cvt_pk_bf16_f32 v180, v184, v185
    v_cvt_pk_bf16_f32 v181, v186, v187
    ds_write_b64 v16, v[180:181] offset:0
    v_cvt_pk_bf16_f32 v182, v112, v113
    v_cvt_pk_bf16_f32 v183, v114, v115
    v_lshlrev_b32 v184, 16, v182
    v_and_b32 v185, 0xffff0000, v182
    v_lshlrev_b32 v186, 16, v183
    v_and_b32 v187, 0xffff0000, v183
    v_mul_f32 v188, 0x3fb8aa3b, v184
    v_exp_f32 v188, v188
    v_add_f32 v189, 1.0, v184
    v_cmp_lt_f32 vcc, 0, v184
    s_nop 1
    v_cndmask_b32 v184, v188, v189, vcc
    v_mul_f32 v188, 0x3fb8aa3b, v185
    v_exp_f32 v188, v188
    v_add_f32 v189, 1.0, v185
    v_cmp_lt_f32 vcc, 0, v185
    s_nop 1
    v_cndmask_b32 v185, v188, v189, vcc
    v_mul_f32 v188, 0x3fb8aa3b, v186
    v_exp_f32 v188, v188
    v_add_f32 v189, 1.0, v186
    v_cmp_lt_f32 vcc, 0, v186
    s_nop 1
    v_cndmask_b32 v186, v188, v189, vcc
    v_mul_f32 v188, 0x3fb8aa3b, v187
    v_exp_f32 v188, v188
    v_add_f32 v189, 1.0, v187
    v_cmp_lt_f32 vcc, 0, v187
    s_nop 1
    v_cndmask_b32 v187, v188, v189, vcc
    v_cvt_pk_bf16_f32 v182, v184, v185
    v_cvt_pk_bf16_f32 v183, v186, v187
    v_lshlrev_b32 v184, 16, v182
    v_and_b32 v185, 0xffff0000, v182
    v_lshlrev_b32 v186, 16, v183
    v_and_b32 v187, 0xffff0000, v183
    v_add_f32 v184, 0x358637bd, v184
    v_add_f32 v185, 0x358637bd, v185
    v_add_f32 v186, 0x358637bd, v186
    v_add_f32 v187, 0x358637bd, v187
    v_cvt_pk_bf16_f32 v180, v184, v185
    v_cvt_pk_bf16_f32 v181, v186, v187
    ds_write_b64 v16, v[180:181] offset:32
    v_cvt_pk_bf16_f32 v182, v116, v117
    v_cvt_pk_bf16_f32 v183, v118, v119
    v_lshlrev_b32 v184, 16, v182
    v_and_b32 v185, 0xffff0000, v182
    v_lshlrev_b32 v186, 16, v183
    v_and_b32 v187, 0xffff0000, v183
    v_mul_f32 v188, 0x3fb8aa3b, v184
    v_exp_f32 v188, v188
    v_add_f32 v189, 1.0, v184
    v_cmp_lt_f32 vcc, 0, v184
    s_nop 1
    v_cndmask_b32 v184, v188, v189, vcc
    v_mul_f32 v188, 0x3fb8aa3b, v185
    v_exp_f32 v188, v188
    v_add_f32 v189, 1.0, v185
    v_cmp_lt_f32 vcc, 0, v185
    s_nop 1
    v_cndmask_b32 v185, v188, v189, vcc
    v_mul_f32 v188, 0x3fb8aa3b, v186
    v_exp_f32 v188, v188
    v_add_f32 v189, 1.0, v186
    v_cmp_lt_f32 vcc, 0, v186
    s_nop 1
    v_cndmask_b32 v186, v188, v189, vcc
    v_mul_f32 v188, 0x3fb8aa3b, v187
    v_exp_f32 v188, v188
    v_add_f32 v189, 1.0, v187
    v_cmp_lt_f32 vcc, 0, v187
    s_nop 1
    v_cndmask_b32 v187, v188, v189, vcc
    v_cvt_pk_bf16_f32 v182, v184, v185
    v_cvt_pk_bf16_f32 v183, v186, v187
    v_lshlrev_b32 v184, 16, v182
    v_and_b32 v185, 0xffff0000, v182
    v_lshlrev_b32 v186, 16, v183
    v_and_b32 v187, 0xffff0000, v183
    v_add_f32 v184, 0x358637bd, v184
    v_add_f32 v185, 0x358637bd, v185
    v_add_f32 v186, 0x358637bd, v186
    v_add_f32 v187, 0x358637bd, v187
    v_cvt_pk_bf16_f32 v180, v184, v185
    v_cvt_pk_bf16_f32 v181, v186, v187
    ds_write_b64 v16, v[180:181] offset:64
    v_cvt_pk_bf16_f32 v182, v120, v121
    v_cvt_pk_bf16_f32 v183, v122, v123
    v_lshlrev_b32 v184, 16, v182
    v_and_b32 v185, 0xffff0000, v182
    v_lshlrev_b32 v186, 16, v183
    v_and_b32 v187, 0xffff0000, v183
    v_mul_f32 v188, 0x3fb8aa3b, v184
    v_exp_f32 v188, v188
    v_add_f32 v189, 1.0, v184
    v_cmp_lt_f32 vcc, 0, v184
    s_nop 1
    v_cndmask_b32 v184, v188, v189, vcc
    v_mul_f32 v188, 0x3fb8aa3b, v185
    v_exp_f32 v188, v188
    v_add_f32 v189, 1.0, v185
    v_cmp_lt_f32 vcc, 0, v185
    s_nop 1
    v_cndmask_b32 v185, v188, v189, vcc
    v_mul_f32 v188, 0x3fb8aa3b, v186
    v_exp_f32 v188, v188
    v_add_f32 v189, 1.0, v186
    v_cmp_lt_f32 vcc, 0, v186
    s_nop 1
    v_cndmask_b32 v186, v188, v189, vcc
    v_mul_f32 v188, 0x3fb8aa3b, v187
    v_exp_f32 v188, v188
    v_add_f32 v189, 1.0, v187
    v_cmp_lt_f32 vcc, 0, v187
    s_nop 1
    v_cndmask_b32 v187, v188, v189, vcc
    v_cvt_pk_bf16_f32 v182, v184, v185
    v_cvt_pk_bf16_f32 v183, v186, v187
    v_lshlrev_b32 v184, 16, v182
    v_and_b32 v185, 0xffff0000, v182
    v_lshlrev_b32 v186, 16, v183
    v_and_b32 v187, 0xffff0000, v183
    v_add_f32 v184, 0x358637bd, v184
    v_add_f32 v185, 0x358637bd, v185
    v_add_f32 v186, 0x358637bd, v186
    v_add_f32 v187, 0x358637bd, v187
    v_cvt_pk_bf16_f32 v180, v184, v185
    v_cvt_pk_bf16_f32 v181, v186, v187
    ds_write_b64 v16, v[180:181] offset:96
    v_cvt_pk_bf16_f32 v182, v124, v125
    v_cvt_pk_bf16_f32 v183, v126, v127
    v_lshlrev_b32 v184, 16, v182
    v_and_b32 v185, 0xffff0000, v182
    v_lshlrev_b32 v186, 16, v183
    v_and_b32 v187, 0xffff0000, v183
    v_mul_f32 v188, 0x3fb8aa3b, v184
    v_exp_f32 v188, v188
    v_add_f32 v189, 1.0, v184
    v_cmp_lt_f32 vcc, 0, v184
    s_nop 1
    v_cndmask_b32 v184, v188, v189, vcc
    v_mul_f32 v188, 0x3fb8aa3b, v185
    v_exp_f32 v188, v188
    v_add_f32 v189, 1.0, v185
    v_cmp_lt_f32 vcc, 0, v185
    s_nop 1
    v_cndmask_b32 v185, v188, v189, vcc
    v_mul_f32 v188, 0x3fb8aa3b, v186
    v_exp_f32 v188, v188
    v_add_f32 v189, 1.0, v186
    v_cmp_lt_f32 vcc, 0, v186
    s_nop 1
    v_cndmask_b32 v186, v188, v189, vcc
    v_mul_f32 v188, 0x3fb8aa3b, v187
    v_exp_f32 v188, v188
    v_add_f32 v189, 1.0, v187
    v_cmp_lt_f32 vcc, 0, v187
    s_nop 1
    v_cndmask_b32 v187, v188, v189, vcc
    v_cvt_pk_bf16_f32 v182, v184, v185
    v_cvt_pk_bf16_f32 v183, v186, v187
    v_lshlrev_b32 v184, 16, v182
    v_and_b32 v185, 0xffff0000, v182
    v_lshlrev_b32 v186, 16, v183
    v_and_b32 v187, 0xffff0000, v183
    v_add_f32 v184, 0x358637bd, v184
    v_add_f32 v185, 0x358637bd, v185
    v_add_f32 v186, 0x358637bd, v186
    v_add_f32 v187, 0x358637bd, v187
    v_cvt_pk_bf16_f32 v180, v184, v185
    v_cvt_pk_bf16_f32 v181, v186, v187
    v_cvt_pk_bf16_f32 v182, v124, v125
    v_cvt_pk_bf16_f32 v183, v126, v127
    v_cmp_gt_u32 vcc, 2, v18
    s_nop 1
    v_cndmask_b32 v180, v182, v180, vcc
    v_cndmask_b32 v181, v183, v181, vcc
    ds_write_b64 v16, v[180:181] offset:128
    v_cvt_pk_bf16_f32 v180, v128, v129
    v_cvt_pk_bf16_f32 v181, v130, v131
    ds_write_b64 v16, v[180:181] offset:160
    v_cvt_pk_bf16_f32 v180, v132, v133
    v_cvt_pk_bf16_f32 v181, v134, v135
    ds_write_b64 v16, v[180:181] offset:192
    v_cvt_pk_bf16_f32 v180, v136, v137
    v_cvt_pk_bf16_f32 v181, v138, v139
    ds_write_b64 v16, v[180:181] offset:224
    v_cvt_pk_bf16_f32 v180, v140, v141
    v_cvt_pk_bf16_f32 v181, v142, v143
    ds_write_b64 v16, v[180:181] offset:256
    v_cvt_pk_bf16_f32 v182, v144, v145
    v_cvt_pk_bf16_f32 v183, v146, v147
    v_lshlrev_b32 v184, 16, v182
    v_and_b32 v185, 0xffff0000, v182
    v_lshlrev_b32 v186, 16, v183
    v_and_b32 v187, 0xffff0000, v183
    v_mul_f32 v188, 0x3fb8aa3b, v184
    v_exp_f32 v188, v188
    v_add_f32 v189, 1.0, v184
    v_cmp_lt_f32 vcc, 0, v184
    s_nop 1
    v_cndmask_b32 v184, v188, v189, vcc
    v_mul_f32 v188, 0x3fb8aa3b, v185
    v_exp_f32 v188, v188
    v_add_f32 v189, 1.0, v185
    v_cmp_lt_f32 vcc, 0, v185
    s_nop 1
    v_cndmask_b32 v185, v188, v189, vcc
    v_mul_f32 v188, 0x3fb8aa3b, v186
    v_exp_f32 v188, v188
    v_add_f32 v189, 1.0, v186
    v_cmp_lt_f32 vcc, 0, v186
    s_nop 1
    v_cndmask_b32 v186, v188, v189, vcc
    v_mul_f32 v188, 0x3fb8aa3b, v187
    v_exp_f32 v188, v188
    v_add_f32 v189, 1.0, v187
    v_cmp_lt_f32 vcc, 0, v187
    s_nop 1
    v_cndmask_b32 v187, v188, v189, vcc
    v_cvt_pk_bf16_f32 v182, v184, v185
    v_cvt_pk_bf16_f32 v183, v186, v187
    v_lshlrev_b32 v184, 16, v182
    v_and_b32 v185, 0xffff0000, v182
    v_lshlrev_b32 v186, 16, v183
    v_and_b32 v187, 0xffff0000, v183
    v_add_f32 v184, 0x358637bd, v184
    v_add_f32 v185, 0x358637bd, v185
    v_add_f32 v186, 0x358637bd, v186
    v_add_f32 v187, 0x358637bd, v187
    v_cvt_pk_bf16_f32 v180, v184, v185
    v_cvt_pk_bf16_f32 v181, v186, v187
    ds_write_b64 v16, v[180:181] offset:4608
    v_cvt_pk_bf16_f32 v182, v148, v149
    v_cvt_pk_bf16_f32 v183, v150, v151
    v_lshlrev_b32 v184, 16, v182
    v_and_b32 v185, 0xffff0000, v182
    v_lshlrev_b32 v186, 16, v183
    v_and_b32 v187, 0xffff0000, v183
    v_mul_f32 v188, 0x3fb8aa3b, v184
    v_exp_f32 v188, v188
    v_add_f32 v189, 1.0, v184
    v_cmp_lt_f32 vcc, 0, v184
    s_nop 1
    v_cndmask_b32 v184, v188, v189, vcc
    v_mul_f32 v188, 0x3fb8aa3b, v185
    v_exp_f32 v188, v188
    v_add_f32 v189, 1.0, v185
    v_cmp_lt_f32 vcc, 0, v185
    s_nop 1
    v_cndmask_b32 v185, v188, v189, vcc
    v_mul_f32 v188, 0x3fb8aa3b, v186
    v_exp_f32 v188, v188
    v_add_f32 v189, 1.0, v186
    v_cmp_lt_f32 vcc, 0, v186
    s_nop 1
    v_cndmask_b32 v186, v188, v189, vcc
    v_mul_f32 v188, 0x3fb8aa3b, v187
    v_exp_f32 v188, v188
    v_add_f32 v189, 1.0, v187
    v_cmp_lt_f32 vcc, 0, v187
    s_nop 1
    v_cndmask_b32 v187, v188, v189, vcc
    v_cvt_pk_bf16_f32 v182, v184, v185
    v_cvt_pk_bf16_f32 v183, v186, v187
    v_lshlrev_b32 v184, 16, v182
    v_and_b32 v185, 0xffff0000, v182
    v_lshlrev_b32 v186, 16, v183
    v_and_b32 v187, 0xffff0000, v183
    v_add_f32 v184, 0x358637bd, v184
    v_add_f32 v185, 0x358637bd, v185
    v_add_f32 v186, 0x358637bd, v186
    v_add_f32 v187, 0x358637bd, v187
    v_cvt_pk_bf16_f32 v180, v184, v185
    v_cvt_pk_bf16_f32 v181, v186, v187
    ds_write_b64 v16, v[180:181] offset:4640
    v_cvt_pk_bf16_f32 v182, v152, v153
    v_cvt_pk_bf16_f32 v183, v154, v155
    v_lshlrev_b32 v184, 16, v182
    v_and_b32 v185, 0xffff0000, v182
    v_lshlrev_b32 v186, 16, v183
    v_and_b32 v187, 0xffff0000, v183
    v_mul_f32 v188, 0x3fb8aa3b, v184
    v_exp_f32 v188, v188
    v_add_f32 v189, 1.0, v184
    v_cmp_lt_f32 vcc, 0, v184
    s_nop 1
    v_cndmask_b32 v184, v188, v189, vcc
    v_mul_f32 v188, 0x3fb8aa3b, v185
    v_exp_f32 v188, v188
    v_add_f32 v189, 1.0, v185
    v_cmp_lt_f32 vcc, 0, v185
    s_nop 1
    v_cndmask_b32 v185, v188, v189, vcc
    v_mul_f32 v188, 0x3fb8aa3b, v186
    v_exp_f32 v188, v188
    v_add_f32 v189, 1.0, v186
    v_cmp_lt_f32 vcc, 0, v186
    s_nop 1
    v_cndmask_b32 v186, v188, v189, vcc
    v_mul_f32 v188, 0x3fb8aa3b, v187
    v_exp_f32 v188, v188
    v_add_f32 v189, 1.0, v187
    v_cmp_lt_f32 vcc, 0, v187
    s_nop 1
    v_cndmask_b32 v187, v188, v189, vcc
    v_cvt_pk_bf16_f32 v182, v184, v185
    v_cvt_pk_bf16_f32 v183, v186, v187
    v_lshlrev_b32 v184, 16, v182
    v_and_b32 v185, 0xffff0000, v182
    v_lshlrev_b32 v186, 16, v183
    v_and_b32 v187, 0xffff0000, v183
    v_add_f32 v184, 0x358637bd, v184
    v_add_f32 v185, 0x358637bd, v185
    v_add_f32 v186, 0x358637bd, v186
    v_add_f32 v187, 0x358637bd, v187
    v_cvt_pk_bf16_f32 v180, v184, v185
    v_cvt_pk_bf16_f32 v181, v186, v187
    ds_write_b64 v16, v[180:181] offset:4672
    v_cvt_pk_bf16_f32 v182, v156, v157
    v_cvt_pk_bf16_f32 v183, v158, v159
    v_lshlrev_b32 v184, 16, v182
    v_and_b32 v185, 0xffff0000, v182
    v_lshlrev_b32 v186, 16, v183
    v_and_b32 v187, 0xffff0000, v183
    v_mul_f32 v188, 0x3fb8aa3b, v184
    v_exp_f32 v188, v188
    v_add_f32 v189, 1.0, v184
    v_cmp_lt_f32 vcc, 0, v184
    s_nop 1
    v_cndmask_b32 v184, v188, v189, vcc
    v_mul_f32 v188, 0x3fb8aa3b, v185
    v_exp_f32 v188, v188
    v_add_f32 v189, 1.0, v185
    v_cmp_lt_f32 vcc, 0, v185
    s_nop 1
    v_cndmask_b32 v185, v188, v189, vcc
    v_mul_f32 v188, 0x3fb8aa3b, v186
    v_exp_f32 v188, v188
    v_add_f32 v189, 1.0, v186
    v_cmp_lt_f32 vcc, 0, v186
    s_nop 1
    v_cndmask_b32 v186, v188, v189, vcc
    v_mul_f32 v188, 0x3fb8aa3b, v187
    v_exp_f32 v188, v188
    v_add_f32 v189, 1.0, v187
    v_cmp_lt_f32 vcc, 0, v187
    s_nop 1
    v_cndmask_b32 v187, v188, v189, vcc
    v_cvt_pk_bf16_f32 v182, v184, v185
    v_cvt_pk_bf16_f32 v183, v186, v187
    v_lshlrev_b32 v184, 16, v182
    v_and_b32 v185, 0xffff0000, v182
    v_lshlrev_b32 v186, 16, v183
    v_and_b32 v187, 0xffff0000, v183
    v_add_f32 v184, 0x358637bd, v184
    v_add_f32 v185, 0x358637bd, v185
    v_add_f32 v186, 0x358637bd, v186
    v_add_f32 v187, 0x358637bd, v187
    v_cvt_pk_bf16_f32 v180, v184, v185
    v_cvt_pk_bf16_f32 v181, v186, v187
    ds_write_b64 v16, v[180:181] offset:4704
    v_cvt_pk_bf16_f32 v182, v160, v161
    v_cvt_pk_bf16_f32 v183, v162, v163
    v_lshlrev_b32 v184, 16, v182
    v_and_b32 v185, 0xffff0000, v182
    v_lshlrev_b32 v186, 16, v183
    v_and_b32 v187, 0xffff0000, v183
    v_mul_f32 v188, 0x3fb8aa3b, v184
    v_exp_f32 v188, v188
    v_add_f32 v189, 1.0, v184
    v_cmp_lt_f32 vcc, 0, v184
    s_nop 1
    v_cndmask_b32 v184, v188, v189, vcc
    v_mul_f32 v188, 0x3fb8aa3b, v185
    v_exp_f32 v188, v188
    v_add_f32 v189, 1.0, v185
    v_cmp_lt_f32 vcc, 0, v185
    s_nop 1
    v_cndmask_b32 v185, v188, v189, vcc
    v_mul_f32 v188, 0x3fb8aa3b, v186
    v_exp_f32 v188, v188
    v_add_f32 v189, 1.0, v186
    v_cmp_lt_f32 vcc, 0, v186
    s_nop 1
    v_cndmask_b32 v186, v188, v189, vcc
    v_mul_f32 v188, 0x3fb8aa3b, v187
    v_exp_f32 v188, v188
    v_add_f32 v189, 1.0, v187
    v_cmp_lt_f32 vcc, 0, v187
    s_nop 1
    v_cndmask_b32 v187, v188, v189, vcc
    v_cvt_pk_bf16_f32 v182, v184, v185
    v_cvt_pk_bf16_f32 v183, v186, v187
    v_lshlrev_b32 v184, 16, v182
    v_and_b32 v185, 0xffff0000, v182
    v_lshlrev_b32 v186, 16, v183
    v_and_b32 v187, 0xffff0000, v183
    v_add_f32 v184, 0x358637bd, v184
    v_add_f32 v185, 0x358637bd, v185
    v_add_f32 v186, 0x358637bd, v186
    v_add_f32 v187, 0x358637bd, v187
    v_cvt_pk_bf16_f32 v180, v184, v185
    v_cvt_pk_bf16_f32 v181, v186, v187
    v_cvt_pk_bf16_f32 v182, v160, v161
    v_cvt_pk_bf16_f32 v183, v162, v163
    v_cmp_gt_u32 vcc, 2, v18
    s_nop 1
    v_cndmask_b32 v180, v182, v180, vcc
    v_cndmask_b32 v181, v183, v181, vcc
    ds_write_b64 v16, v[180:181] offset:4736
    v_cvt_pk_bf16_f32 v180, v164, v165
    v_cvt_pk_bf16_f32 v181, v166, v167
    ds_write_b64 v16, v[180:181] offset:4768
    v_cvt_pk_bf16_f32 v180, v168, v169
    v_cvt_pk_bf16_f32 v181, v170, v171
    ds_write_b64 v16, v[180:181] offset:4800
    v_cvt_pk_bf16_f32 v180, v172, v173
    v_cvt_pk_bf16_f32 v181, v174, v175
    ds_write_b64 v16, v[180:181] offset:4832
    v_cvt_pk_bf16_f32 v180, v176, v177
    v_cvt_pk_bf16_f32 v181, v178, v179
    ds_write_b64 v16, v[180:181] offset:4864
    s_waitcnt lgkmcnt(0)
    s_barrier
    v_subrev_u32 v17, 16384, v15
    v_mov_b32 v188, 0x3f803f80
    v_mov_b32 v189, 0x3f803f80
    v_mov_b32 v190, 0x3f803f80
    v_mov_b32 v191, 0x3f803f80
    v_lshrrev_b32 v18, 4, v1
    v_and_b32 v19, 15, v1
    s_lshr_b32 s9, s15, 7
    s_lshl_b32 s9, s9, 3
    s_add_u32 s9, s9, s16
    s_mul_i32 s9, s9, 5472
    s_add_u32 s26, s24, s9
    s_addc_u32 s27, s25, 0
    s_add_u32 s26, s26, 23592960
    s_addc_u32 s27, s27, 0
    s_cmp_lg_u32 s8, 0
    s_cbranch_scc1 KVJ_1
    v_mov_b32 v200, 0
    v_mov_b32 v201, 0
    v_mov_b32 v202, 0
    v_mov_b32 v203, 0
    ds_read_b64_tr_b16 v[192:193], v17 offset:0
    ds_read_b64_tr_b16 v[194:195], v17 offset:4608
    ds_read_b64_tr_b16 v[196:197], v17 offset:128
    ds_read_b64_tr_b16 v[198:199], v17 offset:4736
    s_waitcnt lgkmcnt(0)
    v_mfma_f32_16x16x32_bf16 v[200:203], v[192:195], v[196:199], v[200:203]
    ds_read_b64_tr_b16 v[192:193], v17 offset:9216
    ds_read_b64_tr_b16 v[194:195], v17 offset:13824
    ds_read_b64_tr_b16 v[196:197], v17 offset:9344
    ds_read_b64_tr_b16 v[198:199], v17 offset:13952
    s_waitcnt lgkmcnt(0)
    v_mfma_f32_16x16x32_bf16 v[200:203], v[192:195], v[196:199], v[200:203]
    ds_read_b64_tr_b16 v[192:193], v17 offset:18432
    ds_read_b64_tr_b16 v[194:195], v17 offset:23040
    ds_read_b64_tr_b16 v[196:197], v17 offset:18560
    ds_read_b64_tr_b16 v[198:199], v17 offset:23168
    s_waitcnt lgkmcnt(0)
    v_mfma_f32_16x16x32_bf16 v[200:203], v[192:195], v[196:199], v[200:203]
    ds_read_b64_tr_b16 v[192:193], v17 offset:27648
    ds_read_b64_tr_b16 v[194:195], v17 offset:32256
    ds_read_b64_tr_b16 v[196:197], v17 offset:27776
    ds_read_b64_tr_b16 v[198:199], v17 offset:32384
    s_waitcnt lgkmcnt(0)
    v_mfma_f32_16x16x32_bf16 v[200:203], v[192:195], v[196:199], v[200:203]
    s_nop 9
    v_lshlrev_b32 v204, 2, v18
    v_add_u32 v204, 0, v204
    v_mul_u32_u24 v205, 3641, v204
    v_lshrrev_b32 v205, 16, v205
    v_mul_u32_u24 v206, 18, v205
    v_sub_u32 v206, v204, v206
    v_cmp_gt_u32 vcc, 72, v204
    s_mov_b64 s[28:29], vcc
    v_add_u32 v207, 64, v19
    v_subrev_u32 v207, 72, v207
    v_cmp_gt_u32 vcc, 72, v207
    s_and_b64 s[28:29], s[28:29], vcc
    v_mul_u32_u24 v208, 3641, v207
    v_lshrrev_b32 v208, 16, v208
    v_cmp_eq_u32 vcc, v208, v205
    s_and_b64 s[28:29], s[28:29], vcc
    v_mul_u32_u24 v208, 18, v205
    v_sub_u32 v207, v207, v208
    v_mul_u32_u24 v206, 18, v206
    v_add_u32 v206, v206, v207
    v_mul_u32_u24 v205, 342, v205
    v_add_u32 v206, v206, v205
    v_lshlrev_b32 v206, 2, v206
    s_and_saveexec_b64 s[30:31], s[28:29]
    s_cbranch_execz KVS_2
    global_store_dword v206, v200, s[26:27]
KVS_2:
    s_mov_b64 exec, s[30:31]
    v_lshlrev_b32 v204, 2, v18
    v_add_u32 v204, 1, v204
    v_mul_u32_u24 v205, 3641, v204
    v_lshrrev_b32 v205, 16, v205
    v_mul_u32_u24 v206, 18, v205
    v_sub_u32 v206, v204, v206
    v_cmp_gt_u32 vcc, 72, v204
    s_mov_b64 s[28:29], vcc
    v_add_u32 v207, 64, v19
    v_subrev_u32 v207, 72, v207
    v_cmp_gt_u32 vcc, 72, v207
    s_and_b64 s[28:29], s[28:29], vcc
    v_mul_u32_u24 v208, 3641, v207
    v_lshrrev_b32 v208, 16, v208
    v_cmp_eq_u32 vcc, v208, v205
    s_and_b64 s[28:29], s[28:29], vcc
    v_mul_u32_u24 v208, 18, v205
    v_sub_u32 v207, v207, v208
    v_mul_u32_u24 v206, 18, v206
    v_add_u32 v206, v206, v207
    v_mul_u32_u24 v205, 342, v205
    v_add_u32 v206, v206, v205
    v_lshlrev_b32 v206, 2, v206
    s_and_saveexec_b64 s[30:31], s[28:29]
    s_cbranch_execz KVS_3
    global_store_dword v206, v201, s[26:27]
KVS_3:
    s_mov_b64 exec, s[30:31]
    v_lshlrev_b32 v204, 2, v18
    v_add_u32 v204, 2, v204
    v_mul_u32_u24 v205, 3641, v204
    v_lshrrev_b32 v205, 16, v205
    v_mul_u32_u24 v206, 18, v205
    v_sub_u32 v206, v204, v206
    v_cmp_gt_u32 vcc, 72, v204
    s_mov_b64 s[28:29], vcc
    v_add_u32 v207, 64, v19
    v_subrev_u32 v207, 72, v207
    v_cmp_gt_u32 vcc, 72, v207
    s_and_b64 s[28:29], s[28:29], vcc
    v_mul_u32_u24 v208, 3641, v207
    v_lshrrev_b32 v208, 16, v208
    v_cmp_eq_u32 vcc, v208, v205
    s_and_b64 s[28:29], s[28:29], vcc
    v_mul_u32_u24 v208, 18, v205
    v_sub_u32 v207, v207, v208
    v_mul_u32_u24 v206, 18, v206
    v_add_u32 v206, v206, v207
    v_mul_u32_u24 v205, 342, v205
    v_add_u32 v206, v206, v205
    v_lshlrev_b32 v206, 2, v206
    s_and_saveexec_b64 s[30:31], s[28:29]
    s_cbranch_execz KVS_4
    global_store_dword v206, v202, s[26:27]
KVS_4:
    s_mov_b64 exec, s[30:31]
    v_lshlrev_b32 v204, 2, v18
    v_add_u32 v204, 3, v204
    v_mul_u32_u24 v205, 3641, v204
    v_lshrrev_b32 v205, 16, v205
    v_mul_u32_u24 v206, 18, v205
    v_sub_u32 v206, v204, v206
    v_cmp_gt_u32 vcc, 72, v204
    s_mov_b64 s[28:29], vcc
    v_add_u32 v207, 64, v19
    v_subrev_u32 v207, 72, v207
    v_cmp_gt_u32 vcc, 72, v207
    s_and_b64 s[28:29], s[28:29], vcc
    v_mul_u32_u24 v208, 3641, v207
    v_lshrrev_b32 v208, 16, v208
    v_cmp_eq_u32 vcc, v208, v205
    s_and_b64 s[28:29], s[28:29], vcc
    v_mul_u32_u24 v208, 18, v205
    v_sub_u32 v207, v207, v208
    v_mul_u32_u24 v206, 18, v206
    v_add_u32 v206, v206, v207
    v_mul_u32_u24 v205, 342, v205
    v_add_u32 v206, v206, v205
    v_lshlrev_b32 v206, 2, v206
    s_and_saveexec_b64 s[30:31], s[28:29]
    s_cbranch_execz KVS_5
    global_store_dword v206, v203, s[26:27]
KVS_5:
    s_mov_b64 exec, s[30:31]
    v_mov_b32 v200, 0
    v_mov_b32 v201, 0
    v_mov_b32 v202, 0
    v_mov_b32 v203, 0
    ds_read_b64_tr_b16 v[192:193], v17 offset:32
    ds_read_b64_tr_b16 v[194:195], v17 offset:4640
    ds_read_b64_tr_b16 v[196:197], v17 offset:192
    ds_read_b64_tr_b16 v[198:199], v17 offset:4800
    s_waitcnt lgkmcnt(0)
    v_mfma_f32_16x16x32_bf16 v[200:203], v[192:195], v[196:199], v[200:203]
    ds_read_b64_tr_b16 v[192:193], v17 offset:9248
    ds_read_b64_tr_b16 v[194:195], v17 offset:13856
    ds_read_b64_tr_b16 v[196:197], v17 offset:9408
    ds_read_b64_tr_b16 v[198:199], v17 offset:14016
    s_waitcnt lgkmcnt(0)
    v_mfma_f32_16x16x32_bf16 v[200:203], v[192:195], v[196:199], v[200:203]
    ds_read_b64_tr_b16 v[192:193], v17 offset:18464
    ds_read_b64_tr_b16 v[194:195], v17 offset:23072
    ds_read_b64_tr_b16 v[196:197], v17 offset:18624
    ds_read_b64_tr_b16 v[198:199], v17 offset:23232
    s_waitcnt lgkmcnt(0)
    v_mfma_f32_16x16x32_bf16 v[200:203], v[192:195], v[196:199], v[200:203]
    ds_read_b64_tr_b16 v[192:193], v17 offset:27680
    ds_read_b64_tr_b16 v[194:195], v17 offset:32288
    ds_read_b64_tr_b16 v[196:197], v17 offset:27840
    ds_read_b64_tr_b16 v[198:199], v17 offset:32448
    s_waitcnt lgkmcnt(0)
    v_mfma_f32_16x16x32_bf16 v[200:203], v[192:195], v[196:199], v[200:203]
    s_nop 9
    v_lshlrev_b32 v204, 2, v18
    v_add_u32 v204, 16, v204
    v_mul_u32_u24 v205, 3641, v204
    v_lshrrev_b32 v205, 16, v205
    v_mul_u32_u24 v206, 18, v205
    v_sub_u32 v206, v204, v206
    v_cmp_gt_u32 vcc, 72, v204
    s_mov_b64 s[28:29], vcc
    v_add_u32 v207, 96, v19
    v_subrev_u32 v207, 72, v207
    v_cmp_gt_u32 vcc, 72, v207
    s_and_b64 s[28:29], s[28:29], vcc
    v_mul_u32_u24 v208, 3641, v207
    v_lshrrev_b32 v208, 16, v208
    v_cmp_eq_u32 vcc, v208, v205
    s_and_b64 s[28:29], s[28:29], vcc
    v_mul_u32_u24 v208, 18, v205
    v_sub_u32 v207, v207, v208
    v_mul_u32_u24 v206, 18, v206
    v_add_u32 v206, v206, v207
    v_mul_u32_u24 v205, 342, v205
    v_add_u32 v206, v206, v205
    v_lshlrev_b32 v206, 2, v206
    s_and_saveexec_b64 s[30:31], s[28:29]
    s_cbranch_execz KVS_6
    global_store_dword v206, v200, s[26:27]
KVS_6:
    s_mov_b64 exec, s[30:31]
    v_lshlrev_b32 v204, 2, v18
    v_add_u32 v204, 17, v204
    v_mul_u32_u24 v205, 3641, v204
    v_lshrrev_b32 v205, 16, v205
    v_mul_u32_u24 v206, 18, v205
    v_sub_u32 v206, v204, v206
    v_cmp_gt_u32 vcc, 72, v204
    s_mov_b64 s[28:29], vcc
    v_add_u32 v207, 96, v19
    v_subrev_u32 v207, 72, v207
    v_cmp_gt_u32 vcc, 72, v207
    s_and_b64 s[28:29], s[28:29], vcc
    v_mul_u32_u24 v208, 3641, v207
    v_lshrrev_b32 v208, 16, v208
    v_cmp_eq_u32 vcc, v208, v205
    s_and_b64 s[28:29], s[28:29], vcc
    v_mul_u32_u24 v208, 18, v205
    v_sub_u32 v207, v207, v208
    v_mul_u32_u24 v206, 18, v206
    v_add_u32 v206, v206, v207
    v_mul_u32_u24 v205, 342, v205
    v_add_u32 v206, v206, v205
    v_lshlrev_b32 v206, 2, v206
    s_and_saveexec_b64 s[30:31], s[28:29]
    s_cbranch_execz KVS_7
    global_store_dword v206, v201, s[26:27]
KVS_7:
    s_mov_b64 exec, s[30:31]
    v_lshlrev_b32 v204, 2, v18
    v_add_u32 v204, 18, v204
    v_mul_u32_u24 v205, 3641, v204
    v_lshrrev_b32 v205, 16, v205
    v_mul_u32_u24 v206, 18, v205
    v_sub_u32 v206, v204, v206
    v_cmp_gt_u32 vcc, 72, v204
    s_mov_b64 s[28:29], vcc
    v_add_u32 v207, 96, v19
    v_subrev_u32 v207, 72, v207
    v_cmp_gt_u32 vcc, 72, v207
    s_and_b64 s[28:29], s[28:29], vcc
    v_mul_u32_u24 v208, 3641, v207
    v_lshrrev_b32 v208, 16, v208
    v_cmp_eq_u32 vcc, v208, v205
    s_and_b64 s[28:29], s[28:29], vcc
    v_mul_u32_u24 v208, 18, v205
    v_sub_u32 v207, v207, v208
    v_mul_u32_u24 v206, 18, v206
    v_add_u32 v206, v206, v207
    v_mul_u32_u24 v205, 342, v205
    v_add_u32 v206, v206, v205
    v_lshlrev_b32 v206, 2, v206
    s_and_saveexec_b64 s[30:31], s[28:29]
    s_cbranch_execz KVS_8
    global_store_dword v206, v202, s[26:27]
KVS_8:
    s_mov_b64 exec, s[30:31]
    v_lshlrev_b32 v204, 2, v18
    v_add_u32 v204, 19, v204
    v_mul_u32_u24 v205, 3641, v204
    v_lshrrev_b32 v205, 16, v205
    v_mul_u32_u24 v206, 18, v205
    v_sub_u32 v206, v204, v206
    v_cmp_gt_u32 vcc, 72, v204
    s_mov_b64 s[28:29], vcc
    v_add_u32 v207, 96, v19
    v_subrev_u32 v207, 72, v207
    v_cmp_gt_u32 vcc, 72, v207
    s_and_b64 s[28:29], s[28:29], vcc
    v_mul_u32_u24 v208, 3641, v207
    v_lshrrev_b32 v208, 16, v208
    v_cmp_eq_u32 vcc, v208, v205
    s_and_b64 s[28:29], s[28:29], vcc
    v_mul_u32_u24 v208, 18, v205
    v_sub_u32 v207, v207, v208
    v_mul_u32_u24 v206, 18, v206
    v_add_u32 v206, v206, v207
    v_mul_u32_u24 v205, 342, v205
    v_add_u32 v206, v206, v205
    v_lshlrev_b32 v206, 2, v206
    s_and_saveexec_b64 s[30:31], s[28:29]
    s_cbranch_execz KVS_9
    global_store_dword v206, v203, s[26:27]
KVS_9:
    s_mov_b64 exec, s[30:31]
    v_mov_b32 v200, 0
    v_mov_b32 v201, 0
    v_mov_b32 v202, 0
    v_mov_b32 v203, 0
    ds_read_b64_tr_b16 v[192:193], v17 offset:96
    ds_read_b64_tr_b16 v[194:195], v17 offset:4704
    ds_read_b64_tr_b16 v[196:197], v17 offset:192
    ds_read_b64_tr_b16 v[198:199], v17 offset:4800
    s_waitcnt lgkmcnt(0)
    v_mfma_f32_16x16x32_bf16 v[200:203], v[192:195], v[196:199], v[200:203]
    ds_read_b64_tr_b16 v[192:193], v17 offset:9312
    ds_read_b64_tr_b16 v[194:195], v17 offset:13920
    ds_read_b64_tr_b16 v[196:197], v17 offset:9408
    ds_read_b64_tr_b16 v[198:199], v17 offset:14016
    s_waitcnt lgkmcnt(0)
    v_mfma_f32_16x16x32_bf16 v[200:203], v[192:195], v[196:199], v[200:203]
    ds_read_b64_tr_b16 v[192:193], v17 offset:18528
    ds_read_b64_tr_b16 v[194:195], v17 offset:23136
    ds_read_b64_tr_b16 v[196:197], v17 offset:18624
    ds_read_b64_tr_b16 v[198:199], v17 offset:23232
    s_waitcnt lgkmcnt(0)
    v_mfma_f32_16x16x32_bf16 v[200:203], v[192:195], v[196:199], v[200:203]
    ds_read_b64_tr_b16 v[192:193], v17 offset:27744
    ds_read_b64_tr_b16 v[194:195], v17 offset:32352
    ds_read_b64_tr_b16 v[196:197], v17 offset:27840
    ds_read_b64_tr_b16 v[198:199], v17 offset:32448
    s_waitcnt lgkmcnt(0)
    v_mfma_f32_16x16x32_bf16 v[200:203], v[192:195], v[196:199], v[200:203]
    s_nop 9
    v_lshlrev_b32 v204, 2, v18
    v_add_u32 v204, 48, v204
    v_mul_u32_u24 v205, 3641, v204
    v_lshrrev_b32 v205, 16, v205
    v_mul_u32_u24 v206, 18, v205
    v_sub_u32 v206, v204, v206
    v_cmp_gt_u32 vcc, 72, v204
    s_mov_b64 s[28:29], vcc
    v_add_u32 v207, 96, v19
    v_subrev_u32 v207, 72, v207
    v_cmp_gt_u32 vcc, 72, v207
    s_and_b64 s[28:29], s[28:29], vcc
    v_mul_u32_u24 v208, 3641, v207
    v_lshrrev_b32 v208, 16, v208
    v_cmp_eq_u32 vcc, v208, v205
    s_and_b64 s[28:29], s[28:29], vcc
    v_mul_u32_u24 v208, 18, v205
    v_sub_u32 v207, v207, v208
    v_mul_u32_u24 v206, 18, v206
    v_add_u32 v206, v206, v207
    v_mul_u32_u24 v205, 342, v205
    v_add_u32 v206, v206, v205
    v_lshlrev_b32 v206, 2, v206
    s_and_saveexec_b64 s[30:31], s[28:29]
    s_cbranch_execz KVS_10
    global_store_dword v206, v200, s[26:27]
KVS_10:
    s_mov_b64 exec, s[30:31]
    v_lshlrev_b32 v204, 2, v18
    v_add_u32 v204, 49, v204
    v_mul_u32_u24 v205, 3641, v204
    v_lshrrev_b32 v205, 16, v205
    v_mul_u32_u24 v206, 18, v205
    v_sub_u32 v206, v204, v206
    v_cmp_gt_u32 vcc, 72, v204
    s_mov_b64 s[28:29], vcc
    v_add_u32 v207, 96, v19
    v_subrev_u32 v207, 72, v207
    v_cmp_gt_u32 vcc, 72, v207
    s_and_b64 s[28:29], s[28:29], vcc
    v_mul_u32_u24 v208, 3641, v207
    v_lshrrev_b32 v208, 16, v208
    v_cmp_eq_u32 vcc, v208, v205
    s_and_b64 s[28:29], s[28:29], vcc
    v_mul_u32_u24 v208, 18, v205
    v_sub_u32 v207, v207, v208
    v_mul_u32_u24 v206, 18, v206
    v_add_u32 v206, v206, v207
    v_mul_u32_u24 v205, 342, v205
    v_add_u32 v206, v206, v205
    v_lshlrev_b32 v206, 2, v206
    s_and_saveexec_b64 s[30:31], s[28:29]
    s_cbranch_execz KVS_11
    global_store_dword v206, v201, s[26:27]
KVS_11:
    s_mov_b64 exec, s[30:31]
    v_lshlrev_b32 v204, 2, v18
    v_add_u32 v204, 50, v204
    v_mul_u32_u24 v205, 3641, v204
    v_lshrrev_b32 v205, 16, v205
    v_mul_u32_u24 v206, 18, v205
    v_sub_u32 v206, v204, v206
    v_cmp_gt_u32 vcc, 72, v204
    s_mov_b64 s[28:29], vcc
    v_add_u32 v207, 96, v19
    v_subrev_u32 v207, 72, v207
    v_cmp_gt_u32 vcc, 72, v207
    s_and_b64 s[28:29], s[28:29], vcc
    v_mul_u32_u24 v208, 3641, v207
    v_lshrrev_b32 v208, 16, v208
    v_cmp_eq_u32 vcc, v208, v205
    s_and_b64 s[28:29], s[28:29], vcc
    v_mul_u32_u24 v208, 18, v205
    v_sub_u32 v207, v207, v208
    v_mul_u32_u24 v206, 18, v206
    v_add_u32 v206, v206, v207
    v_mul_u32_u24 v205, 342, v205
    v_add_u32 v206, v206, v205
    v_lshlrev_b32 v206, 2, v206
    s_and_saveexec_b64 s[30:31], s[28:29]
    s_cbranch_execz KVS_12
    global_store_dword v206, v202, s[26:27]
KVS_12:
    s_mov_b64 exec, s[30:31]
    v_lshlrev_b32 v204, 2, v18
    v_add_u32 v204, 51, v204
    v_mul_u32_u24 v205, 3641, v204
    v_lshrrev_b32 v205, 16, v205
    v_mul_u32_u24 v206, 18, v205
    v_sub_u32 v206, v204, v206
    v_cmp_gt_u32 vcc, 72, v204
    s_mov_b64 s[28:29], vcc
    v_add_u32 v207, 96, v19
    v_subrev_u32 v207, 72, v207
    v_cmp_gt_u32 vcc, 72, v207
    s_and_b64 s[28:29], s[28:29], vcc
    v_mul_u32_u24 v208, 3641, v207
    v_lshrrev_b32 v208, 16, v208
    v_cmp_eq_u32 vcc, v208, v205
    s_and_b64 s[28:29], s[28:29], vcc
    v_mul_u32_u24 v208, 18, v205
    v_sub_u32 v207, v207, v208
    v_mul_u32_u24 v206, 18, v206
    v_add_u32 v206, v206, v207
    v_mul_u32_u24 v205, 342, v205
    v_add_u32 v206, v206, v205
    v_lshlrev_b32 v206, 2, v206
    s_and_saveexec_b64 s[30:31], s[28:29]
    s_cbranch_execz KVS_13
    global_store_dword v206, v203, s[26:27]
KVS_13:
    s_mov_b64 exec, s[30:31]
    v_mov_b32 v200, 0
    v_mov_b32 v201, 0
    v_mov_b32 v202, 0
    v_mov_b32 v203, 0
    ds_read_b64_tr_b16 v[192:193], v17 offset:128
    ds_read_b64_tr_b16 v[194:195], v17 offset:4736
    ds_read_b64_tr_b16 v[196:197], v17 offset:256
    ds_read_b64_tr_b16 v[198:199], v17 offset:4864
    s_waitcnt lgkmcnt(0)
    v_mfma_f32_16x16x32_bf16 v[200:203], v[192:195], v[196:199], v[200:203]
    ds_read_b64_tr_b16 v[192:193], v17 offset:9344
    ds_read_b64_tr_b16 v[194:195], v17 offset:13952
    ds_read_b64_tr_b16 v[196:197], v17 offset:9472
    ds_read_b64_tr_b16 v[198:199], v17 offset:14080
    s_waitcnt lgkmcnt(0)
    v_mfma_f32_16x16x32_bf16 v[200:203], v[192:195], v[196:199], v[200:203]
    ds_read_b64_tr_b16 v[192:193], v17 offset:18560
    ds_read_b64_tr_b16 v[194:195], v17 offset:23168
    ds_read_b64_tr_b16 v[196:197], v17 offset:18688
    ds_read_b64_tr_b16 v[198:199], v17 offset:23296
    s_waitcnt lgkmcnt(0)
    v_mfma_f32_16x16x32_bf16 v[200:203], v[192:195], v[196:199], v[200:203]
    ds_read_b64_tr_b16 v[192:193], v17 offset:27776
    ds_read_b64_tr_b16 v[194:195], v17 offset:32384
    ds_read_b64_tr_b16 v[196:197], v17 offset:27904
    ds_read_b64_tr_b16 v[198:199], v17 offset:32512
    s_waitcnt lgkmcnt(0)
    v_mfma_f32_16x16x32_bf16 v[200:203], v[192:195], v[196:199], v[200:203]
    s_nop 9
    v_lshlrev_b32 v204, 2, v18
    v_add_u32 v204, 64, v204
    v_mul_u32_u24 v205, 3641, v204
    v_lshrrev_b32 v205, 16, v205
    v_mul_u32_u24 v206, 18, v205
    v_sub_u32 v206, v204, v206
    v_cmp_gt_u32 vcc, 72, v204
    s_mov_b64 s[28:29], vcc
    v_add_u32 v207, 128, v19
    v_subrev_u32 v207, 72, v207
    v_cmp_gt_u32 vcc, 72, v207
    s_and_b64 s[28:29], s[28:29], vcc
    v_mul_u32_u24 v208, 3641, v207
    v_lshrrev_b32 v208, 16, v208
    v_cmp_eq_u32 vcc, v208, v205
    s_and_b64 s[28:29], s[28:29], vcc
    v_mul_u32_u24 v208, 18, v205
    v_sub_u32 v207, v207, v208
    v_mul_u32_u24 v206, 18, v206
    v_add_u32 v206, v206, v207
    v_mul_u32_u24 v205, 342, v205
    v_add_u32 v206, v206, v205
    v_lshlrev_b32 v206, 2, v206
    s_and_saveexec_b64 s[30:31], s[28:29]
    s_cbranch_execz KVS_14
    global_store_dword v206, v200, s[26:27]
KVS_14:
    s_mov_b64 exec, s[30:31]
    v_lshlrev_b32 v204, 2, v18
    v_add_u32 v204, 65, v204
    v_mul_u32_u24 v205, 3641, v204
    v_lshrrev_b32 v205, 16, v205
    v_mul_u32_u24 v206, 18, v205
    v_sub_u32 v206, v204, v206
    v_cmp_gt_u32 vcc, 72, v204
    s_mov_b64 s[28:29], vcc
    v_add_u32 v207, 128, v19
    v_subrev_u32 v207, 72, v207
    v_cmp_gt_u32 vcc, 72, v207
    s_and_b64 s[28:29], s[28:29], vcc
    v_mul_u32_u24 v208, 3641, v207
    v_lshrrev_b32 v208, 16, v208
    v_cmp_eq_u32 vcc, v208, v205
    s_and_b64 s[28:29], s[28:29], vcc
    v_mul_u32_u24 v208, 18, v205
    v_sub_u32 v207, v207, v208
    v_mul_u32_u24 v206, 18, v206
    v_add_u32 v206, v206, v207
    v_mul_u32_u24 v205, 342, v205
    v_add_u32 v206, v206, v205
    v_lshlrev_b32 v206, 2, v206
    s_and_saveexec_b64 s[30:31], s[28:29]
    s_cbranch_execz KVS_15
    global_store_dword v206, v201, s[26:27]
KVS_15:
    s_mov_b64 exec, s[30:31]
    v_lshlrev_b32 v204, 2, v18
    v_add_u32 v204, 66, v204
    v_mul_u32_u24 v205, 3641, v204
    v_lshrrev_b32 v205, 16, v205
    v_mul_u32_u24 v206, 18, v205
    v_sub_u32 v206, v204, v206
    v_cmp_gt_u32 vcc, 72, v204
    s_mov_b64 s[28:29], vcc
    v_add_u32 v207, 128, v19
    v_subrev_u32 v207, 72, v207
    v_cmp_gt_u32 vcc, 72, v207
    s_and_b64 s[28:29], s[28:29], vcc
    v_mul_u32_u24 v208, 3641, v207
    v_lshrrev_b32 v208, 16, v208
    v_cmp_eq_u32 vcc, v208, v205
    s_and_b64 s[28:29], s[28:29], vcc
    v_mul_u32_u24 v208, 18, v205
    v_sub_u32 v207, v207, v208
    v_mul_u32_u24 v206, 18, v206
    v_add_u32 v206, v206, v207
    v_mul_u32_u24 v205, 342, v205
    v_add_u32 v206, v206, v205
    v_lshlrev_b32 v206, 2, v206
    s_and_saveexec_b64 s[30:31], s[28:29]
    s_cbranch_execz KVS_16
    global_store_dword v206, v202, s[26:27]
KVS_16:
    s_mov_b64 exec, s[30:31]
    v_lshlrev_b32 v204, 2, v18
    v_add_u32 v204, 67, v204
    v_mul_u32_u24 v205, 3641, v204
    v_lshrrev_b32 v205, 16, v205
    v_mul_u32_u24 v206, 18, v205
    v_sub_u32 v206, v204, v206
    v_cmp_gt_u32 vcc, 72, v204
    s_mov_b64 s[28:29], vcc
    v_add_u32 v207, 128, v19
    v_subrev_u32 v207, 72, v207
    v_cmp_gt_u32 vcc, 72, v207
    s_and_b64 s[28:29], s[28:29], vcc
    v_mul_u32_u24 v208, 3641, v207
    v_lshrrev_b32 v208, 16, v208
    v_cmp_eq_u32 vcc, v208, v205
    s_and_b64 s[28:29], s[28:29], vcc
    v_mul_u32_u24 v208, 18, v205
    v_sub_u32 v207, v207, v208
    v_mul_u32_u24 v206, 18, v206
    v_add_u32 v206, v206, v207
    v_mul_u32_u24 v205, 342, v205
    v_add_u32 v206, v206, v205
    v_lshlrev_b32 v206, 2, v206
    s_and_saveexec_b64 s[30:31], s[28:29]
    s_cbranch_execz KVS_17
    global_store_dword v206, v203, s[26:27]
KVS_17:
    s_mov_b64 exec, s[30:31]
    v_mov_b32 v200, 0
    v_mov_b32 v201, 0
    v_mov_b32 v202, 0
    v_mov_b32 v203, 0
    ds_read_b64_tr_b16 v[192:193], v17 offset:96
    ds_read_b64_tr_b16 v[194:195], v17 offset:4704
    s_waitcnt lgkmcnt(0)
    v_mfma_f32_16x16x32_bf16 v[200:203], v[192:195], v[188:191], v[200:203]
    ds_read_b64_tr_b16 v[192:193], v17 offset:9312
    ds_read_b64_tr_b16 v[194:195], v17 offset:13920
    s_waitcnt lgkmcnt(0)
    v_mfma_f32_16x16x32_bf16 v[200:203], v[192:195], v[188:191], v[200:203]
    ds_read_b64_tr_b16 v[192:193], v17 offset:18528
    ds_read_b64_tr_b16 v[194:195], v17 offset:23136
    s_waitcnt lgkmcnt(0)
    v_mfma_f32_16x16x32_bf16 v[200:203], v[192:195], v[188:191], v[200:203]
    ds_read_b64_tr_b16 v[192:193], v17 offset:27744
    ds_read_b64_tr_b16 v[194:195], v17 offset:32352
    s_waitcnt lgkmcnt(0)
    v_mfma_f32_16x16x32_bf16 v[200:203], v[192:195], v[188:191], v[200:203]
    s_nop 9
    v_lshlrev_b32 v204, 2, v18
    v_add_u32 v204, 48, v204
    v_mul_u32_u24 v205, 3641, v204
    v_lshrrev_b32 v205, 16, v205
    v_mul_u32_u24 v206, 18, v205
    v_sub_u32 v206, v204, v206
    v_cmp_gt_u32 vcc, 72, v204
    s_mov_b64 s[28:29], vcc
    v_cmp_eq_u32 vcc, 0, v19
    s_and_b64 s[28:29], s[28:29], vcc
    v_add_u32 v206, 324, v206
    v_mul_u32_u24 v205, 342, v205
    v_add_u32 v206, v206, v205
    v_lshlrev_b32 v206, 2, v206
    s_and_saveexec_b64 s[30:31], s[28:29]
    s_cbranch_execz KVS_18
    global_store_dword v206, v200, s[26:27]
KVS_18:
    s_mov_b64 exec, s[30:31]
    v_lshlrev_b32 v204, 2, v18
    v_add_u32 v204, 49, v204
    v_mul_u32_u24 v205, 3641, v204
    v_lshrrev_b32 v205, 16, v205
    v_mul_u32_u24 v206, 18, v205
    v_sub_u32 v206, v204, v206
    v_cmp_gt_u32 vcc, 72, v204
    s_mov_b64 s[28:29], vcc
    v_cmp_eq_u32 vcc, 0, v19
    s_and_b64 s[28:29], s[28:29], vcc
    v_add_u32 v206, 324, v206
    v_mul_u32_u24 v205, 342, v205
    v_add_u32 v206, v206, v205
    v_lshlrev_b32 v206, 2, v206
    s_and_saveexec_b64 s[30:31], s[28:29]
    s_cbranch_execz KVS_19
    global_store_dword v206, v201, s[26:27]
KVS_19:
    s_mov_b64 exec, s[30:31]
    v_lshlrev_b32 v204, 2, v18
    v_add_u32 v204, 50, v204
    v_mul_u32_u24 v205, 3641, v204
    v_lshrrev_b32 v205, 16, v205
    v_mul_u32_u24 v206, 18, v205
    v_sub_u32 v206, v204, v206
    v_cmp_gt_u32 vcc, 72, v204
    s_mov_b64 s[28:29], vcc
    v_cmp_eq_u32 vcc, 0, v19
    s_and_b64 s[28:29], s[28:29], vcc
    v_add_u32 v206, 324, v206
    v_mul_u32_u24 v205, 342, v205
    v_add_u32 v206, v206, v205
    v_lshlrev_b32 v206, 2, v206
    s_and_saveexec_b64 s[30:31], s[28:29]
    s_cbranch_execz KVS_20
    global_store_dword v206, v202, s[26:27]
KVS_20:
    s_mov_b64 exec, s[30:31]
    v_lshlrev_b32 v204, 2, v18
    v_add_u32 v204, 51, v204
    v_mul_u32_u24 v205, 3641, v204
    v_lshrrev_b32 v205, 16, v205
    v_mul_u32_u24 v206, 18, v205
    v_sub_u32 v206, v204, v206
    v_cmp_gt_u32 vcc, 72, v204
    s_mov_b64 s[28:29], vcc
    v_cmp_eq_u32 vcc, 0, v19
    s_and_b64 s[28:29], s[28:29], vcc
    v_add_u32 v206, 324, v206
    v_mul_u32_u24 v205, 342, v205
    v_add_u32 v206, v206, v205
    v_lshlrev_b32 v206, 2, v206
    s_and_saveexec_b64 s[30:31], s[28:29]
    s_cbranch_execz KVS_21
    global_store_dword v206, v203, s[26:27]
KVS_21:
    s_mov_b64 exec, s[30:31]
KVJ_1:
    s_cmp_lg_u32 s8, 1
    s_cbranch_scc1 KVJ_22
    v_mov_b32 v200, 0
    v_mov_b32 v201, 0
    v_mov_b32 v202, 0
    v_mov_b32 v203, 0
    ds_read_b64_tr_b16 v[192:193], v17 offset:0
    ds_read_b64_tr_b16 v[194:195], v17 offset:4608
    ds_read_b64_tr_b16 v[196:197], v17 offset:160
    ds_read_b64_tr_b16 v[198:199], v17 offset:4768
    s_waitcnt lgkmcnt(0)
    v_mfma_f32_16x16x32_bf16 v[200:203], v[192:195], v[196:199], v[200:203]
    ds_read_b64_tr_b16 v[192:193], v17 offset:9216
    ds_read_b64_tr_b16 v[194:195], v17 offset:13824
    ds_read_b64_tr_b16 v[196:197], v17 offset:9376
    ds_read_b64_tr_b16 v[198:199], v17 offset:13984
    s_waitcnt lgkmcnt(0)
    v_mfma_f32_16x16x32_bf16 v[200:203], v[192:195], v[196:199], v[200:203]
    ds_read_b64_tr_b16 v[192:193], v17 offset:18432
    ds_read_b64_tr_b16 v[194:195], v17 offset:23040
    ds_read_b64_tr_b16 v[196:197], v17 offset:18592
    ds_read_b64_tr_b16 v[198:199], v17 offset:23200
    s_waitcnt lgkmcnt(0)
    v_mfma_f32_16x16x32_bf16 v[200:203], v[192:195], v[196:199], v[200:203]
    ds_read_b64_tr_b16 v[192:193], v17 offset:27648
    ds_read_b64_tr_b16 v[194:195], v17 offset:32256
    ds_read_b64_tr_b16 v[196:197], v17 offset:27808
    ds_read_b64_tr_b16 v[198:199], v17 offset:32416
    s_waitcnt lgkmcnt(0)
    v_mfma_f32_16x16x32_bf16 v[200:203], v[192:195], v[196:199], v[200:203]
    s_nop 9
    v_lshlrev_b32 v204, 2, v18
    v_add_u32 v204, 0, v204
    v_mul_u32_u24 v205, 3641, v204
    v_lshrrev_b32 v205, 16, v205
    v_mul_u32_u24 v206, 18, v205
    v_sub_u32 v206, v204, v206
    v_cmp_gt_u32 vcc, 72, v204
    s_mov_b64 s[28:29], vcc
    v_add_u32 v207, 80, v19
    v_subrev_u32 v207, 72, v207
    v_cmp_gt_u32 vcc, 72, v207
    s_and_b64 s[28:29], s[28:29], vcc
    v_mul_u32_u24 v208, 3641, v207
    v_lshrrev_b32 v208, 16, v208
    v_cmp_eq_u32 vcc, v208, v205
    s_and_b64 s[28:29], s[28:29], vcc
    v_mul_u32_u24 v208, 18, v205
    v_sub_u32 v207, v207, v208
    v_mul_u32_u24 v206, 18, v206
    v_add_u32 v206, v206, v207
    v_mul_u32_u24 v205, 342, v205
    v_add_u32 v206, v206, v205
    v_lshlrev_b32 v206, 2, v206
    s_and_saveexec_b64 s[30:31], s[28:29]
    s_cbranch_execz KVS_23
    global_store_dword v206, v200, s[26:27]
KVS_23:
    s_mov_b64 exec, s[30:31]
    v_lshlrev_b32 v204, 2, v18
    v_add_u32 v204, 1, v204
    v_mul_u32_u24 v205, 3641, v204
    v_lshrrev_b32 v205, 16, v205
    v_mul_u32_u24 v206, 18, v205
    v_sub_u32 v206, v204, v206
    v_cmp_gt_u32 vcc, 72, v204
    s_mov_b64 s[28:29], vcc
    v_add_u32 v207, 80, v19
    v_subrev_u32 v207, 72, v207
    v_cmp_gt_u32 vcc, 72, v207
    s_and_b64 s[28:29], s[28:29], vcc
    v_mul_u32_u24 v208, 3641, v207
    v_lshrrev_b32 v208, 16, v208
    v_cmp_eq_u32 vcc, v208, v205
    s_and_b64 s[28:29], s[28:29], vcc
    v_mul_u32_u24 v208, 18, v205
    v_sub_u32 v207, v207, v208
    v_mul_u32_u24 v206, 18, v206
    v_add_u32 v206, v206, v207
    v_mul_u32_u24 v205, 342, v205
    v_add_u32 v206, v206, v205
    v_lshlrev_b32 v206, 2, v206
    s_and_saveexec_b64 s[30:31], s[28:29]
    s_cbranch_execz KVS_24
    global_store_dword v206, v201, s[26:27]
KVS_24:
    s_mov_b64 exec, s[30:31]
    v_lshlrev_b32 v204, 2, v18
    v_add_u32 v204, 2, v204
    v_mul_u32_u24 v205, 3641, v204
    v_lshrrev_b32 v205, 16, v205
    v_mul_u32_u24 v206, 18, v205
    v_sub_u32 v206, v204, v206
    v_cmp_gt_u32 vcc, 72, v204
    s_mov_b64 s[28:29], vcc
    v_add_u32 v207, 80, v19
    v_subrev_u32 v207, 72, v207
    v_cmp_gt_u32 vcc, 72, v207
    s_and_b64 s[28:29], s[28:29], vcc
    v_mul_u32_u24 v208, 3641, v207
    v_lshrrev_b32 v208, 16, v208
    v_cmp_eq_u32 vcc, v208, v205
    s_and_b64 s[28:29], s[28:29], vcc
    v_mul_u32_u24 v208, 18, v205
    v_sub_u32 v207, v207, v208
    v_mul_u32_u24 v206, 18, v206
    v_add_u32 v206, v206, v207
    v_mul_u32_u24 v205, 342, v205
    v_add_u32 v206, v206, v205
    v_lshlrev_b32 v206, 2, v206
    s_and_saveexec_b64 s[30:31], s[28:29]
    s_cbranch_execz KVS_25
    global_store_dword v206, v202, s[26:27]
KVS_25:
    s_mov_b64 exec, s[30:31]
    v_lshlrev_b32 v204, 2, v18
    v_add_u32 v204, 3, v204
    v_mul_u32_u24 v205, 3641, v204
    v_lshrrev_b32 v205, 16, v205
    v_mul_u32_u24 v206, 18, v205
    v_sub_u32 v206, v204, v206
    v_cmp_gt_u32 vcc, 72, v204
    s_mov_b64 s[28:29], vcc
    v_add_u32 v207, 80, v19
    v_subrev_u32 v207, 72, v207
    v_cmp_gt_u32 vcc, 72, v207
    s_and_b64 s[28:29], s[28:29], vcc
    v_mul_u32_u24 v208, 3641, v207
    v_lshrrev_b32 v208, 16, v208
    v_cmp_eq_u32 vcc, v208, v205
    s_and_b64 s[28:29], s[28:29], vcc
    v_mul_u32_u24 v208, 18, v205
    v_sub_u32 v207, v207, v208
    v_mul_u32_u24 v206, 18, v206
    v_add_u32 v206, v206, v207
    v_mul_u32_u24 v205, 342, v205
    v_add_u32 v206, v206, v205
    v_lshlrev_b32 v206, 2, v206
    s_and_saveexec_b64 s[30:31], s[28:29]
    s_cbranch_execz KVS_26
    global_store_dword v206, v203, s[26:27]
KVS_26:
    s_mov_b64 exec, s[30:31]
    v_mov_b32 v200, 0
    v_mov_b32 v201, 0
    v_mov_b32 v202, 0
    v_mov_b32 v203, 0
    ds_read_b64_tr_b16 v[192:193], v17 offset:64
    ds_read_b64_tr_b16 v[194:195], v17 offset:4672
    ds_read_b64_tr_b16 v[196:197], v17 offset:160
    ds_read_b64_tr_b16 v[198:199], v17 offset:4768
    s_waitcnt lgkmcnt(0)
    v_mfma_f32_16x16x32_bf16 v[200:203], v[192:195], v[196:199], v[200:203]
    ds_read_b64_tr_b16 v[192:193], v17 offset:9280
    ds_read_b64_tr_b16 v[194:195], v17 offset:13888
    ds_read_b64_tr_b16 v[196:197], v17 offset:9376
    ds_read_b64_tr_b16 v[198:199], v17 offset:13984
    s_waitcnt lgkmcnt(0)
    v_mfma_f32_16x16x32_bf16 v[200:203], v[192:195], v[196:199], v[200:203]
    ds_read_b64_tr_b16 v[192:193], v17 offset:18496
    ds_read_b64_tr_b16 v[194:195], v17 offset:23104
    ds_read_b64_tr_b16 v[196:197], v17 offset:18592
    ds_read_b64_tr_b16 v[198:199], v17 offset:23200
    s_waitcnt lgkmcnt(0)
    v_mfma_f32_16x16x32_bf16 v[200:203], v[192:195], v[196:199], v[200:203]
    ds_read_b64_tr_b16 v[192:193], v17 offset:27712
    ds_read_b64_tr_b16 v[194:195], v17 offset:32320
    ds_read_b64_tr_b16 v[196:197], v17 offset:27808
    ds_read_b64_tr_b16 v[198:199], v17 offset:32416
    s_waitcnt lgkmcnt(0)
    v_mfma_f32_16x16x32_bf16 v[200:203], v[192:195], v[196:199], v[200:203]
    s_nop 9
    v_lshlrev_b32 v204, 2, v18
    v_add_u32 v204, 32, v204
    v_mul_u32_u24 v205, 3641, v204
    v_lshrrev_b32 v205, 16, v205
    v_mul_u32_u24 v206, 18, v205
    v_sub_u32 v206, v204, v206
    v_cmp_gt_u32 vcc, 72, v204
    s_mov_b64 s[28:29], vcc
    v_add_u32 v207, 80, v19
    v_subrev_u32 v207, 72, v207
    v_cmp_gt_u32 vcc, 72, v207
    s_and_b64 s[28:29], s[28:29], vcc
    v_mul_u32_u24 v208, 3641, v207
    v_lshrrev_b32 v208, 16, v208
    v_cmp_eq_u32 vcc, v208, v205
    s_and_b64 s[28:29], s[28:29], vcc
    v_mul_u32_u24 v208, 18, v205
    v_sub_u32 v207, v207, v208
    v_mul_u32_u24 v206, 18, v206
    v_add_u32 v206, v206, v207
    v_mul_u32_u24 v205, 342, v205
    v_add_u32 v206, v206, v205
    v_lshlrev_b32 v206, 2, v206
    s_and_saveexec_b64 s[30:31], s[28:29]
    s_cbranch_execz KVS_27
    global_store_dword v206, v200, s[26:27]
KVS_27:
    s_mov_b64 exec, s[30:31]
    v_lshlrev_b32 v204, 2, v18
    v_add_u32 v204, 33, v204
    v_mul_u32_u24 v205, 3641, v204
    v_lshrrev_b32 v205, 16, v205
    v_mul_u32_u24 v206, 18, v205
    v_sub_u32 v206, v204, v206
    v_cmp_gt_u32 vcc, 72, v204
    s_mov_b64 s[28:29], vcc
    v_add_u32 v207, 80, v19
    v_subrev_u32 v207, 72, v207
    v_cmp_gt_u32 vcc, 72, v207
    s_and_b64 s[28:29], s[28:29], vcc
    v_mul_u32_u24 v208, 3641, v207
    v_lshrrev_b32 v208, 16, v208
    v_cmp_eq_u32 vcc, v208, v205
    s_and_b64 s[28:29], s[28:29], vcc
    v_mul_u32_u24 v208, 18, v205
    v_sub_u32 v207, v207, v208
    v_mul_u32_u24 v206, 18, v206
    v_add_u32 v206, v206, v207
    v_mul_u32_u24 v205, 342, v205
    v_add_u32 v206, v206, v205
    v_lshlrev_b32 v206, 2, v206
    s_and_saveexec_b64 s[30:31], s[28:29]
    s_cbranch_execz KVS_28
    global_store_dword v206, v201, s[26:27]
KVS_28:
    s_mov_b64 exec, s[30:31]
    v_lshlrev_b32 v204, 2, v18
    v_add_u32 v204, 34, v204
    v_mul_u32_u24 v205, 3641, v204
    v_lshrrev_b32 v205, 16, v205
    v_mul_u32_u24 v206, 18, v205
    v_sub_u32 v206, v204, v206
    v_cmp_gt_u32 vcc, 72, v204
    s_mov_b64 s[28:29], vcc
    v_add_u32 v207, 80, v19
    v_subrev_u32 v207, 72, v207
    v_cmp_gt_u32 vcc, 72, v207
    s_and_b64 s[28:29], s[28:29], vcc
    v_mul_u32_u24 v208, 3641, v207
    v_lshrrev_b32 v208, 16, v208
    v_cmp_eq_u32 vcc, v208, v205
    s_and_b64 s[28:29], s[28:29], vcc
    v_mul_u32_u24 v208, 18, v205
    v_sub_u32 v207, v207, v208
    v_mul_u32_u24 v206, 18, v206
    v_add_u32 v206, v206, v207
    v_mul_u32_u24 v205, 342, v205
    v_add_u32 v206, v206, v205
    v_lshlrev_b32 v206, 2, v206
    s_and_saveexec_b64 s[30:31], s[28:29]
    s_cbranch_execz KVS_29
    global_store_dword v206, v202, s[26:27]
KVS_29:
    s_mov_b64 exec, s[30:31]
    v_lshlrev_b32 v204, 2, v18
    v_add_u32 v204, 35, v204
    v_mul_u32_u24 v205, 3641, v204
    v_lshrrev_b32 v205, 16, v205
    v_mul_u32_u24 v206, 18, v205
    v_sub_u32 v206, v204, v206
    v_cmp_gt_u32 vcc, 72, v204
    s_mov_b64 s[28:29], vcc
    v_add_u32 v207, 80, v19
    v_subrev_u32 v207, 72, v207
    v_cmp_gt_u32 vcc, 72, v207
    s_and_b64 s[28:29], s[28:29], vcc
    v_mul_u32_u24 v208, 3641, v207
    v_lshrrev_b32 v208, 16, v208
    v_cmp_eq_u32 vcc, v208, v205
    s_and_b64 s[28:29], s[28:29], vcc
    v_mul_u32_u24 v208, 18, v205
    v_sub_u32 v207, v207, v208
    v_mul_u32_u24 v206, 18, v206
    v_add_u32 v206, v206, v207
    v_mul_u32_u24 v205, 342, v205
    v_add_u32 v206, v206, v205
    v_lshlrev_b32 v206, 2, v206
    s_and_saveexec_b64 s[30:31], s[28:29]
    s_cbranch_execz KVS_30
    global_store_dword v206, v203, s[26:27]
KVS_30:
    s_mov_b64 exec, s[30:31]
    v_mov_b32 v200, 0
    v_mov_b32 v201, 0
    v_mov_b32 v202, 0
    v_mov_b32 v203, 0
    ds_read_b64_tr_b16 v[192:193], v17 offset:96
    ds_read_b64_tr_b16 v[194:195], v17 offset:4704
    ds_read_b64_tr_b16 v[196:197], v17 offset:224
    ds_read_b64_tr_b16 v[198:199], v17 offset:4832
    s_waitcnt lgkmcnt(0)
    v_mfma_f32_16x16x32_bf16 v[200:203], v[192:195], v[196:199], v[200:203]
    ds_read_b64_tr_b16 v[192:193], v17 offset:9312
    ds_read_b64_tr_b16 v[194:195], v17 offset:13920
    ds_read_b64_tr_b16 v[196:197], v17 offset:9440
    ds_read_b64_tr_b16 v[198:199], v17 offset:14048
    s_waitcnt lgkmcnt(0)
    v_mfma_f32_16x16x32_bf16 v[200:203], v[192:195], v[196:199], v[200:203]
    ds_read_b64_tr_b16 v[192:193], v17 offset:18528
    ds_read_b64_tr_b16 v[194:195], v17 offset:23136
    ds_read_b64_tr_b16 v[196:197], v17 offset:18656
    ds_read_b64_tr_b16 v[198:199], v17 offset:23264
    s_waitcnt lgkmcnt(0)
    v_mfma_f32_16x16x32_bf16 v[200:203], v[192:195], v[196:199], v[200:203]
    ds_read_b64_tr_b16 v[192:193], v17 offset:27744
    ds_read_b64_tr_b16 v[194:195], v17 offset:32352
    ds_read_b64_tr_b16 v[196:197], v17 offset:27872
    ds_read_b64_tr_b16 v[198:199], v17 offset:32480
    s_waitcnt lgkmcnt(0)
    v_mfma_f32_16x16x32_bf16 v[200:203], v[192:195], v[196:199], v[200:203]
    s_nop 9
    v_lshlrev_b32 v204, 2, v18
    v_add_u32 v204, 48, v204
    v_mul_u32_u24 v205, 3641, v204
    v_lshrrev_b32 v205, 16, v205
    v_mul_u32_u24 v206, 18, v205
    v_sub_u32 v206, v204, v206
    v_cmp_gt_u32 vcc, 72, v204
    s_mov_b64 s[28:29], vcc
    v_add_u32 v207, 112, v19
    v_subrev_u32 v207, 72, v207
    v_cmp_gt_u32 vcc, 72, v207
    s_and_b64 s[28:29], s[28:29], vcc
    v_mul_u32_u24 v208, 3641, v207
    v_lshrrev_b32 v208, 16, v208
    v_cmp_eq_u32 vcc, v208, v205
    s_and_b64 s[28:29], s[28:29], vcc
    v_mul_u32_u24 v208, 18, v205
    v_sub_u32 v207, v207, v208
    v_mul_u32_u24 v206, 18, v206
    v_add_u32 v206, v206, v207
    v_mul_u32_u24 v205, 342, v205
    v_add_u32 v206, v206, v205
    v_lshlrev_b32 v206, 2, v206
    s_and_saveexec_b64 s[30:31], s[28:29]
    s_cbranch_execz KVS_31
    global_store_dword v206, v200, s[26:27]
KVS_31:
    s_mov_b64 exec, s[30:31]
    v_lshlrev_b32 v204, 2, v18
    v_add_u32 v204, 49, v204
    v_mul_u32_u24 v205, 3641, v204
    v_lshrrev_b32 v205, 16, v205
    v_mul_u32_u24 v206, 18, v205
    v_sub_u32 v206, v204, v206
    v_cmp_gt_u32 vcc, 72, v204
    s_mov_b64 s[28:29], vcc
    v_add_u32 v207, 112, v19
    v_subrev_u32 v207, 72, v207
    v_cmp_gt_u32 vcc, 72, v207
    s_and_b64 s[28:29], s[28:29], vcc
    v_mul_u32_u24 v208, 3641, v207
    v_lshrrev_b32 v208, 16, v208
    v_cmp_eq_u32 vcc, v208, v205
    s_and_b64 s[28:29], s[28:29], vcc
    v_mul_u32_u24 v208, 18, v205
    v_sub_u32 v207, v207, v208
    v_mul_u32_u24 v206, 18, v206
    v_add_u32 v206, v206, v207
    v_mul_u32_u24 v205, 342, v205
    v_add_u32 v206, v206, v205
    v_lshlrev_b32 v206, 2, v206
    s_and_saveexec_b64 s[30:31], s[28:29]
    s_cbranch_execz KVS_32
    global_store_dword v206, v201, s[26:27]
KVS_32:
    s_mov_b64 exec, s[30:31]
    v_lshlrev_b32 v204, 2, v18
    v_add_u32 v204, 50, v204
    v_mul_u32_u24 v205, 3641, v204
    v_lshrrev_b32 v205, 16, v205
    v_mul_u32_u24 v206, 18, v205
    v_sub_u32 v206, v204, v206
    v_cmp_gt_u32 vcc, 72, v204
    s_mov_b64 s[28:29], vcc
    v_add_u32 v207, 112, v19
    v_subrev_u32 v207, 72, v207
    v_cmp_gt_u32 vcc, 72, v207
    s_and_b64 s[28:29], s[28:29], vcc
    v_mul_u32_u24 v208, 3641, v207
    v_lshrrev_b32 v208, 16, v208
    v_cmp_eq_u32 vcc, v208, v205
    s_and_b64 s[28:29], s[28:29], vcc
    v_mul_u32_u24 v208, 18, v205
    v_sub_u32 v207, v207, v208
    v_mul_u32_u24 v206, 18, v206
    v_add_u32 v206, v206, v207
    v_mul_u32_u24 v205, 342, v205
    v_add_u32 v206, v206, v205
    v_lshlrev_b32 v206, 2, v206
    s_and_saveexec_b64 s[30:31], s[28:29]
    s_cbranch_execz KVS_33
    global_store_dword v206, v202, s[26:27]
KVS_33:
    s_mov_b64 exec, s[30:31]
    v_lshlrev_b32 v204, 2, v18
    v_add_u32 v204, 51, v204
    v_mul_u32_u24 v205, 3641, v204
    v_lshrrev_b32 v205, 16, v205
    v_mul_u32_u24 v206, 18, v205
    v_sub_u32 v206, v204, v206
    v_cmp_gt_u32 vcc, 72, v204
    s_mov_b64 s[28:29], vcc
    v_add_u32 v207, 112, v19
    v_subrev_u32 v207, 72, v207
    v_cmp_gt_u32 vcc, 72, v207
    s_and_b64 s[28:29], s[28:29], vcc
    v_mul_u32_u24 v208, 3641, v207
    v_lshrrev_b32 v208, 16, v208
    v_cmp_eq_u32 vcc, v208, v205
    s_and_b64 s[28:29], s[28:29], vcc
    v_mul_u32_u24 v208, 18, v205
    v_sub_u32 v207, v207, v208
    v_mul_u32_u24 v206, 18, v206
    v_add_u32 v206, v206, v207
    v_mul_u32_u24 v205, 342, v205
    v_add_u32 v206, v206, v205
    v_lshlrev_b32 v206, 2, v206
    s_and_saveexec_b64 s[30:31], s[28:29]
    s_cbranch_execz KVS_34
    global_store_dword v206, v203, s[26:27]
KVS_34:
    s_mov_b64 exec, s[30:31]
    v_mov_b32 v200, 0
    v_mov_b32 v201, 0
    v_mov_b32 v202, 0
    v_mov_b32 v203, 0
    ds_read_b64_tr_b16 v[192:193], v17 offset:0
    ds_read_b64_tr_b16 v[194:195], v17 offset:4608
    s_waitcnt lgkmcnt(0)
    v_mfma_f32_16x16x32_bf16 v[200:203], v[192:195], v[188:191], v[200:203]
    ds_read_b64_tr_b16 v[192:193], v17 offset:9216
    ds_read_b64_tr_b16 v[194:195], v17 offset:13824
    s_waitcnt lgkmcnt(0)
    v_mfma_f32_16x16x32_bf16 v[200:203], v[192:195], v[188:191], v[200:203]
    ds_read_b64_tr_b16 v[192:193], v17 offset:18432
    ds_read_b64_tr_b16 v[194:195], v17 offset:23040
    s_waitcnt lgkmcnt(0)
    v_mfma_f32_16x16x32_bf16 v[200:203], v[192:195], v[188:191], v[200:203]
    ds_read_b64_tr_b16 v[192:193], v17 offset:27648
    ds_read_b64_tr_b16 v[194:195], v17 offset:32256
    s_waitcnt lgkmcnt(0)
    v_mfma_f32_16x16x32_bf16 v[200:203], v[192:195], v[188:191], v[200:203]
    s_nop 9
    v_lshlrev_b32 v204, 2, v18
    v_add_u32 v204, 0, v204
    v_mul_u32_u24 v205, 3641, v204
    v_lshrrev_b32 v205, 16, v205
    v_mul_u32_u24 v206, 18, v205
    v_sub_u32 v206, v204, v206
    v_cmp_gt_u32 vcc, 72, v204
    s_mov_b64 s[28:29], vcc
    v_cmp_eq_u32 vcc, 0, v19
    s_and_b64 s[28:29], s[28:29], vcc
    v_add_u32 v206, 324, v206
    v_mul_u32_u24 v205, 342, v205
    v_add_u32 v206, v206, v205
    v_lshlrev_b32 v206, 2, v206
    s_and_saveexec_b64 s[30:31], s[28:29]
    s_cbranch_execz KVS_35
    global_store_dword v206, v200, s[26:27]
KVS_35:
    s_mov_b64 exec, s[30:31]
    v_lshlrev_b32 v204, 2, v18
    v_add_u32 v204, 1, v204
    v_mul_u32_u24 v205, 3641, v204
    v_lshrrev_b32 v205, 16, v205
    v_mul_u32_u24 v206, 18, v205
    v_sub_u32 v206, v204, v206
    v_cmp_gt_u32 vcc, 72, v204
    s_mov_b64 s[28:29], vcc
    v_cmp_eq_u32 vcc, 0, v19
    s_and_b64 s[28:29], s[28:29], vcc
    v_add_u32 v206, 324, v206
    v_mul_u32_u24 v205, 342, v205
    v_add_u32 v206, v206, v205
    v_lshlrev_b32 v206, 2, v206
    s_and_saveexec_b64 s[30:31], s[28:29]
    s_cbranch_execz KVS_36
    global_store_dword v206, v201, s[26:27]
KVS_36:
    s_mov_b64 exec, s[30:31]
    v_lshlrev_b32 v204, 2, v18
    v_add_u32 v204, 2, v204
    v_mul_u32_u24 v205, 3641, v204
    v_lshrrev_b32 v205, 16, v205
    v_mul_u32_u24 v206, 18, v205
    v_sub_u32 v206, v204, v206
    v_cmp_gt_u32 vcc, 72, v204
    s_mov_b64 s[28:29], vcc
    v_cmp_eq_u32 vcc, 0, v19
    s_and_b64 s[28:29], s[28:29], vcc
    v_add_u32 v206, 324, v206
    v_mul_u32_u24 v205, 342, v205
    v_add_u32 v206, v206, v205
    v_lshlrev_b32 v206, 2, v206
    s_and_saveexec_b64 s[30:31], s[28:29]
    s_cbranch_execz KVS_37
    global_store_dword v206, v202, s[26:27]
KVS_37:
    s_mov_b64 exec, s[30:31]
    v_lshlrev_b32 v204, 2, v18
    v_add_u32 v204, 3, v204
    v_mul_u32_u24 v205, 3641, v204
    v_lshrrev_b32 v205, 16, v205
    v_mul_u32_u24 v206, 18, v205
    v_sub_u32 v206, v204, v206
    v_cmp_gt_u32 vcc, 72, v204
    s_mov_b64 s[28:29], vcc
    v_cmp_eq_u32 vcc, 0, v19
    s_and_b64 s[28:29], s[28:29], vcc
    v_add_u32 v206, 324, v206
    v_mul_u32_u24 v205, 342, v205
    v_add_u32 v206, v206, v205
    v_lshlrev_b32 v206, 2, v206
    s_and_saveexec_b64 s[30:31], s[28:29]
    s_cbranch_execz KVS_38
    global_store_dword v206, v203, s[26:27]
KVS_38:
    s_mov_b64 exec, s[30:31]
    v_mov_b32 v200, 0
    v_mov_b32 v201, 0
    v_mov_b32 v202, 0
    v_mov_b32 v203, 0
    ds_read_b64_tr_b16 v[192:193], v17 offset:128
    ds_read_b64_tr_b16 v[194:195], v17 offset:4736
    s_waitcnt lgkmcnt(0)
    v_mfma_f32_16x16x32_bf16 v[200:203], v[192:195], v[188:191], v[200:203]
    ds_read_b64_tr_b16 v[192:193], v17 offset:9344
    ds_read_b64_tr_b16 v[194:195], v17 offset:13952
    s_waitcnt lgkmcnt(0)
    v_mfma_f32_16x16x32_bf16 v[200:203], v[192:195], v[188:191], v[200:203]
    ds_read_b64_tr_b16 v[192:193], v17 offset:18560
    ds_read_b64_tr_b16 v[194:195], v17 offset:23168
    s_waitcnt lgkmcnt(0)
    v_mfma_f32_16x16x32_bf16 v[200:203], v[192:195], v[188:191], v[200:203]
    ds_read_b64_tr_b16 v[192:193], v17 offset:27776
    ds_read_b64_tr_b16 v[194:195], v17 offset:32384
    s_waitcnt lgkmcnt(0)
    v_mfma_f32_16x16x32_bf16 v[200:203], v[192:195], v[188:191], v[200:203]
    s_nop 9
    v_lshlrev_b32 v204, 2, v18
    v_add_u32 v204, 64, v204
    v_mul_u32_u24 v205, 3641, v204
    v_lshrrev_b32 v205, 16, v205
    v_mul_u32_u24 v206, 18, v205
    v_sub_u32 v206, v204, v206
    v_cmp_gt_u32 vcc, 72, v204
    s_mov_b64 s[28:29], vcc
    v_cmp_eq_u32 vcc, 0, v19
    s_and_b64 s[28:29], s[28:29], vcc
    v_add_u32 v206, 324, v206
    v_mul_u32_u24 v205, 342, v205
    v_add_u32 v206, v206, v205
    v_lshlrev_b32 v206, 2, v206
    s_and_saveexec_b64 s[30:31], s[28:29]
    s_cbranch_execz KVS_39
    global_store_dword v206, v200, s[26:27]
KVS_39:
    s_mov_b64 exec, s[30:31]
    v_lshlrev_b32 v204, 2, v18
    v_add_u32 v204, 65, v204
    v_mul_u32_u24 v205, 3641, v204
    v_lshrrev_b32 v205, 16, v205
    v_mul_u32_u24 v206, 18, v205
    v_sub_u32 v206, v204, v206
    v_cmp_gt_u32 vcc, 72, v204
    s_mov_b64 s[28:29], vcc
    v_cmp_eq_u32 vcc, 0, v19
    s_and_b64 s[28:29], s[28:29], vcc
    v_add_u32 v206, 324, v206
    v_mul_u32_u24 v205, 342, v205
    v_add_u32 v206, v206, v205
    v_lshlrev_b32 v206, 2, v206
    s_and_saveexec_b64 s[30:31], s[28:29]
    s_cbranch_execz KVS_40
    global_store_dword v206, v201, s[26:27]
KVS_40:
    s_mov_b64 exec, s[30:31]
    v_lshlrev_b32 v204, 2, v18
    v_add_u32 v204, 66, v204
    v_mul_u32_u24 v205, 3641, v204
    v_lshrrev_b32 v205, 16, v205
    v_mul_u32_u24 v206, 18, v205
    v_sub_u32 v206, v204, v206
    v_cmp_gt_u32 vcc, 72, v204
    s_mov_b64 s[28:29], vcc
    v_cmp_eq_u32 vcc, 0, v19
    s_and_b64 s[28:29], s[28:29], vcc
    v_add_u32 v206, 324, v206
    v_mul_u32_u24 v205, 342, v205
    v_add_u32 v206, v206, v205
    v_lshlrev_b32 v206, 2, v206
    s_and_saveexec_b64 s[30:31], s[28:29]
    s_cbranch_execz KVS_41
    global_store_dword v206, v202, s[26:27]
KVS_41:
    s_mov_b64 exec, s[30:31]
    v_lshlrev_b32 v204, 2, v18
    v_add_u32 v204, 67, v204
    v_mul_u32_u24 v205, 3641, v204
    v_lshrrev_b32 v205, 16, v205
    v_mul_u32_u24 v206, 18, v205
    v_sub_u32 v206, v204, v206
    v_cmp_gt_u32 vcc, 72, v204
    s_mov_b64 s[28:29], vcc
    v_cmp_eq_u32 vcc, 0, v19
    s_and_b64 s[28:29], s[28:29], vcc
    v_add_u32 v206, 324, v206
    v_mul_u32_u24 v205, 342, v205
    v_add_u32 v206, v206, v205
    v_lshlrev_b32 v206, 2, v206
    s_and_saveexec_b64 s[30:31], s[28:29]
    s_cbranch_execz KVS_42
    global_store_dword v206, v203, s[26:27]
KVS_42:
    s_mov_b64 exec, s[30:31]
KVJ_22:
    s_cmp_lg_u32 s8, 2
    s_cbranch_scc1 KVJ_43
    v_mov_b32 v200, 0
    v_mov_b32 v201, 0
    v_mov_b32 v202, 0
    v_mov_b32 v203, 0
    ds_read_b64_tr_b16 v[192:193], v17 offset:32
    ds_read_b64_tr_b16 v[194:195], v17 offset:4640
    ds_read_b64_tr_b16 v[196:197], v17 offset:128
    ds_read_b64_tr_b16 v[198:199], v17 offset:4736
    s_waitcnt lgkmcnt(0)
    v_mfma_f32_16x16x32_bf16 v[200:203], v[192:195], v[196:199], v[200:203]
    ds_read_b64_tr_b16 v[192:193], v17 offset:9248
    ds_read_b64_tr_b16 v[194:195], v17 offset:13856
    ds_read_b64_tr_b16 v[196:197], v17 offset:9344
    ds_read_b64_tr_b16 v[198:199], v17 offset:13952
    s_waitcnt lgkmcnt(0)
    v_mfma_f32_16x16x32_bf16 v[200:203], v[192:195], v[196:199], v[200:203]
    ds_read_b64_tr_b16 v[192:193], v17 offset:18464
    ds_read_b64_tr_b16 v[194:195], v17 offset:23072
    ds_read_b64_tr_b16 v[196:197], v17 offset:18560
    ds_read_b64_tr_b16 v[198:199], v17 offset:23168
    s_waitcnt lgkmcnt(0)
    v_mfma_f32_16x16x32_bf16 v[200:203], v[192:195], v[196:199], v[200:203]
    ds_read_b64_tr_b16 v[192:193], v17 offset:27680
    ds_read_b64_tr_b16 v[194:195], v17 offset:32288
    ds_read_b64_tr_b16 v[196:197], v17 offset:27776
    ds_read_b64_tr_b16 v[198:199], v17 offset:32384
    s_waitcnt lgkmcnt(0)
    v_mfma_f32_16x16x32_bf16 v[200:203], v[192:195], v[196:199], v[200:203]
    s_nop 9
    v_lshlrev_b32 v204, 2, v18
    v_add_u32 v204, 16, v204
    v_mul_u32_u24 v205, 3641, v204
    v_lshrrev_b32 v205, 16, v205
    v_mul_u32_u24 v206, 18, v205
    v_sub_u32 v206, v204, v206
    v_cmp_gt_u32 vcc, 72, v204
    s_mov_b64 s[28:29], vcc
    v_add_u32 v207, 64, v19
    v_subrev_u32 v207, 72, v207
    v_cmp_gt_u32 vcc, 72, v207
    s_and_b64 s[28:29], s[28:29], vcc
    v_mul_u32_u24 v208, 3641, v207
    v_lshrrev_b32 v208, 16, v208
    v_cmp_eq_u32 vcc, v208, v205
    s_and_b64 s[28:29], s[28:29], vcc
    v_mul_u32_u24 v208, 18, v205
    v_sub_u32 v207, v207, v208
    v_mul_u32_u24 v206, 18, v206
    v_add_u32 v206, v206, v207
    v_mul_u32_u24 v205, 342, v205
    v_add_u32 v206, v206, v205
    v_lshlrev_b32 v206, 2, v206
    s_and_saveexec_b64 s[30:31], s[28:29]
    s_cbranch_execz KVS_44
    global_store_dword v206, v200, s[26:27]
KVS_44:
    s_mov_b64 exec, s[30:31]
    v_lshlrev_b32 v204, 2, v18
    v_add_u32 v204, 17, v204
    v_mul_u32_u24 v205, 3641, v204
    v_lshrrev_b32 v205, 16, v205
    v_mul_u32_u24 v206, 18, v205
    v_sub_u32 v206, v204, v206
    v_cmp_gt_u32 vcc, 72, v204
    s_mov_b64 s[28:29], vcc
    v_add_u32 v207, 64, v19
    v_subrev_u32 v207, 72, v207
    v_cmp_gt_u32 vcc, 72, v207
    s_and_b64 s[28:29], s[28:29], vcc
    v_mul_u32_u24 v208, 3641, v207
    v_lshrrev_b32 v208, 16, v208
    v_cmp_eq_u32 vcc, v208, v205
    s_and_b64 s[28:29], s[28:29], vcc
    v_mul_u32_u24 v208, 18, v205
    v_sub_u32 v207, v207, v208
    v_mul_u32_u24 v206, 18, v206
    v_add_u32 v206, v206, v207
    v_mul_u32_u24 v205, 342, v205
    v_add_u32 v206, v206, v205
    v_lshlrev_b32 v206, 2, v206
    s_and_saveexec_b64 s[30:31], s[28:29]
    s_cbranch_execz KVS_45
    global_store_dword v206, v201, s[26:27]
KVS_45:
    s_mov_b64 exec, s[30:31]
    v_lshlrev_b32 v204, 2, v18
    v_add_u32 v204, 18, v204
    v_mul_u32_u24 v205, 3641, v204
    v_lshrrev_b32 v205, 16, v205
    v_mul_u32_u24 v206, 18, v205
    v_sub_u32 v206, v204, v206
    v_cmp_gt_u32 vcc, 72, v204
    s_mov_b64 s[28:29], vcc
    v_add_u32 v207, 64, v19
    v_subrev_u32 v207, 72, v207
    v_cmp_gt_u32 vcc, 72, v207
    s_and_b64 s[28:29], s[28:29], vcc
    v_mul_u32_u24 v208, 3641, v207
    v_lshrrev_b32 v208, 16, v208
    v_cmp_eq_u32 vcc, v208, v205
    s_and_b64 s[28:29], s[28:29], vcc
    v_mul_u32_u24 v208, 18, v205
    v_sub_u32 v207, v207, v208
    v_mul_u32_u24 v206, 18, v206
    v_add_u32 v206, v206, v207
    v_mul_u32_u24 v205, 342, v205
    v_add_u32 v206, v206, v205
    v_lshlrev_b32 v206, 2, v206
    s_and_saveexec_b64 s[30:31], s[28:29]
    s_cbranch_execz KVS_46
    global_store_dword v206, v202, s[26:27]
KVS_46:
    s_mov_b64 exec, s[30:31]
    v_lshlrev_b32 v204, 2, v18
    v_add_u32 v204, 19, v204
    v_mul_u32_u24 v205, 3641, v204
    v_lshrrev_b32 v205, 16, v205
    v_mul_u32_u24 v206, 18, v205
    v_sub_u32 v206, v204, v206
    v_cmp_gt_u32 vcc, 72, v204
    s_mov_b64 s[28:29], vcc
    v_add_u32 v207, 64, v19
    v_subrev_u32 v207, 72, v207
    v_cmp_gt_u32 vcc, 72, v207
    s_and_b64 s[28:29], s[28:29], vcc
    v_mul_u32_u24 v208, 3641, v207
    v_lshrrev_b32 v208, 16, v208
    v_cmp_eq_u32 vcc, v208, v205
    s_and_b64 s[28:29], s[28:29], vcc
    v_mul_u32_u24 v208, 18, v205
    v_sub_u32 v207, v207, v208
    v_mul_u32_u24 v206, 18, v206
    v_add_u32 v206, v206, v207
    v_mul_u32_u24 v205, 342, v205
    v_add_u32 v206, v206, v205
    v_lshlrev_b32 v206, 2, v206
    s_and_saveexec_b64 s[30:31], s[28:29]
    s_cbranch_execz KVS_47
    global_store_dword v206, v203, s[26:27]
KVS_47:
    s_mov_b64 exec, s[30:31]
    v_mov_b32 v200, 0
    v_mov_b32 v201, 0
    v_mov_b32 v202, 0
    v_mov_b32 v203, 0
    ds_read_b64_tr_b16 v[192:193], v17 offset:64
    ds_read_b64_tr_b16 v[194:195], v17 offset:4672
    ds_read_b64_tr_b16 v[196:197], v17 offset:192
    ds_read_b64_tr_b16 v[198:199], v17 offset:4800
    s_waitcnt lgkmcnt(0)
    v_mfma_f32_16x16x32_bf16 v[200:203], v[192:195], v[196:199], v[200:203]
    ds_read_b64_tr_b16 v[192:193], v17 offset:9280
    ds_read_b64_tr_b16 v[194:195], v17 offset:13888
    ds_read_b64_tr_b16 v[196:197], v17 offset:9408
    ds_read_b64_tr_b16 v[198:199], v17 offset:14016
    s_waitcnt lgkmcnt(0)
    v_mfma_f32_16x16x32_bf16 v[200:203], v[192:195], v[196:199], v[200:203]
    ds_read_b64_tr_b16 v[192:193], v17 offset:18496
    ds_read_b64_tr_b16 v[194:195], v17 offset:23104
    ds_read_b64_tr_b16 v[196:197], v17 offset:18624
    ds_read_b64_tr_b16 v[198:199], v17 offset:23232
    s_waitcnt lgkmcnt(0)
    v_mfma_f32_16x16x32_bf16 v[200:203], v[192:195], v[196:199], v[200:203]
    ds_read_b64_tr_b16 v[192:193], v17 offset:27712
    ds_read_b64_tr_b16 v[194:195], v17 offset:32320
    ds_read_b64_tr_b16 v[196:197], v17 offset:27840
    ds_read_b64_tr_b16 v[198:199], v17 offset:32448
    s_waitcnt lgkmcnt(0)
    v_mfma_f32_16x16x32_bf16 v[200:203], v[192:195], v[196:199], v[200:203]
    s_nop 9
    v_lshlrev_b32 v204, 2, v18
    v_add_u32 v204, 32, v204
    v_mul_u32_u24 v205, 3641, v204
    v_lshrrev_b32 v205, 16, v205
    v_mul_u32_u24 v206, 18, v205
    v_sub_u32 v206, v204, v206
    v_cmp_gt_u32 vcc, 72, v204
    s_mov_b64 s[28:29], vcc
    v_add_u32 v207, 96, v19
    v_subrev_u32 v207, 72, v207
    v_cmp_gt_u32 vcc, 72, v207
    s_and_b64 s[28:29], s[28:29], vcc
    v_mul_u32_u24 v208, 3641, v207
    v_lshrrev_b32 v208, 16, v208
    v_cmp_eq_u32 vcc, v208, v205
    s_and_b64 s[28:29], s[28:29], vcc
    v_mul_u32_u24 v208, 18, v205
    v_sub_u32 v207, v207, v208
    v_mul_u32_u24 v206, 18, v206
    v_add_u32 v206, v206, v207
    v_mul_u32_u24 v205, 342, v205
    v_add_u32 v206, v206, v205
    v_lshlrev_b32 v206, 2, v206
    s_and_saveexec_b64 s[30:31], s[28:29]
    s_cbranch_execz KVS_48
    global_store_dword v206, v200, s[26:27]
KVS_48:
    s_mov_b64 exec, s[30:31]
    v_lshlrev_b32 v204, 2, v18
    v_add_u32 v204, 33, v204
    v_mul_u32_u24 v205, 3641, v204
    v_lshrrev_b32 v205, 16, v205
    v_mul_u32_u24 v206, 18, v205
    v_sub_u32 v206, v204, v206
    v_cmp_gt_u32 vcc, 72, v204
    s_mov_b64 s[28:29], vcc
    v_add_u32 v207, 96, v19
    v_subrev_u32 v207, 72, v207
    v_cmp_gt_u32 vcc, 72, v207
    s_and_b64 s[28:29], s[28:29], vcc
    v_mul_u32_u24 v208, 3641, v207
    v_lshrrev_b32 v208, 16, v208
    v_cmp_eq_u32 vcc, v208, v205
    s_and_b64 s[28:29], s[28:29], vcc
    v_mul_u32_u24 v208, 18, v205
    v_sub_u32 v207, v207, v208
    v_mul_u32_u24 v206, 18, v206
    v_add_u32 v206, v206, v207
    v_mul_u32_u24 v205, 342, v205
    v_add_u32 v206, v206, v205
    v_lshlrev_b32 v206, 2, v206
    s_and_saveexec_b64 s[30:31], s[28:29]
    s_cbranch_execz KVS_49
    global_store_dword v206, v201, s[26:27]
KVS_49:
    s_mov_b64 exec, s[30:31]
    v_lshlrev_b32 v204, 2, v18
    v_add_u32 v204, 34, v204
    v_mul_u32_u24 v205, 3641, v204
    v_lshrrev_b32 v205, 16, v205
    v_mul_u32_u24 v206, 18, v205
    v_sub_u32 v206, v204, v206
    v_cmp_gt_u32 vcc, 72, v204
    s_mov_b64 s[28:29], vcc
    v_add_u32 v207, 96, v19
    v_subrev_u32 v207, 72, v207
    v_cmp_gt_u32 vcc, 72, v207
    s_and_b64 s[28:29], s[28:29], vcc
    v_mul_u32_u24 v208, 3641, v207
    v_lshrrev_b32 v208, 16, v208
    v_cmp_eq_u32 vcc, v208, v205
    s_and_b64 s[28:29], s[28:29], vcc
    v_mul_u32_u24 v208, 18, v205
    v_sub_u32 v207, v207, v208
    v_mul_u32_u24 v206, 18, v206
    v_add_u32 v206, v206, v207
    v_mul_u32_u24 v205, 342, v205
    v_add_u32 v206, v206, v205
    v_lshlrev_b32 v206, 2, v206
    s_and_saveexec_b64 s[30:31], s[28:29]
    s_cbranch_execz KVS_50
    global_store_dword v206, v202, s[26:27]
KVS_50:
    s_mov_b64 exec, s[30:31]
    v_lshlrev_b32 v204, 2, v18
    v_add_u32 v204, 35, v204
    v_mul_u32_u24 v205, 3641, v204
    v_lshrrev_b32 v205, 16, v205
    v_mul_u32_u24 v206, 18, v205
    v_sub_u32 v206, v204, v206
    v_cmp_gt_u32 vcc, 72, v204
    s_mov_b64 s[28:29], vcc
    v_add_u32 v207, 96, v19
    v_subrev_u32 v207, 72, v207
    v_cmp_gt_u32 vcc, 72, v207
    s_and_b64 s[28:29], s[28:29], vcc
    v_mul_u32_u24 v208, 3641, v207
    v_lshrrev_b32 v208, 16, v208
    v_cmp_eq_u32 vcc, v208, v205
    s_and_b64 s[28:29], s[28:29], vcc
    v_mul_u32_u24 v208, 18, v205
    v_sub_u32 v207, v207, v208
    v_mul_u32_u24 v206, 18, v206
    v_add_u32 v206, v206, v207
    v_mul_u32_u24 v205, 342, v205
    v_add_u32 v206, v206, v205
    v_lshlrev_b32 v206, 2, v206
    s_and_saveexec_b64 s[30:31], s[28:29]
    s_cbranch_execz KVS_51
    global_store_dword v206, v203, s[26:27]
KVS_51:
    s_mov_b64 exec, s[30:31]
    v_mov_b32 v200, 0
    v_mov_b32 v201, 0
    v_mov_b32 v202, 0
    v_mov_b32 v203, 0
    ds_read_b64_tr_b16 v[192:193], v17 offset:96
    ds_read_b64_tr_b16 v[194:195], v17 offset:4704
    ds_read_b64_tr_b16 v[196:197], v17 offset:256
    ds_read_b64_tr_b16 v[198:199], v17 offset:4864
    s_waitcnt lgkmcnt(0)
    v_mfma_f32_16x16x32_bf16 v[200:203], v[192:195], v[196:199], v[200:203]
    ds_read_b64_tr_b16 v[192:193], v17 offset:9312
    ds_read_b64_tr_b16 v[194:195], v17 offset:13920
    ds_read_b64_tr_b16 v[196:197], v17 offset:9472
    ds_read_b64_tr_b16 v[198:199], v17 offset:14080
    s_waitcnt lgkmcnt(0)
    v_mfma_f32_16x16x32_bf16 v[200:203], v[192:195], v[196:199], v[200:203]
    ds_read_b64_tr_b16 v[192:193], v17 offset:18528
    ds_read_b64_tr_b16 v[194:195], v17 offset:23136
    ds_read_b64_tr_b16 v[196:197], v17 offset:18688
    ds_read_b64_tr_b16 v[198:199], v17 offset:23296
    s_waitcnt lgkmcnt(0)
    v_mfma_f32_16x16x32_bf16 v[200:203], v[192:195], v[196:199], v[200:203]
    ds_read_b64_tr_b16 v[192:193], v17 offset:27744
    ds_read_b64_tr_b16 v[194:195], v17 offset:32352
    ds_read_b64_tr_b16 v[196:197], v17 offset:27904
    ds_read_b64_tr_b16 v[198:199], v17 offset:32512
    s_waitcnt lgkmcnt(0)
    v_mfma_f32_16x16x32_bf16 v[200:203], v[192:195], v[196:199], v[200:203]
    s_nop 9
    v_lshlrev_b32 v204, 2, v18
    v_add_u32 v204, 48, v204
    v_mul_u32_u24 v205, 3641, v204
    v_lshrrev_b32 v205, 16, v205
    v_mul_u32_u24 v206, 18, v205
    v_sub_u32 v206, v204, v206
    v_cmp_gt_u32 vcc, 72, v204
    s_mov_b64 s[28:29], vcc
    v_add_u32 v207, 128, v19
    v_subrev_u32 v207, 72, v207
    v_cmp_gt_u32 vcc, 72, v207
    s_and_b64 s[28:29], s[28:29], vcc
    v_mul_u32_u24 v208, 3641, v207
    v_lshrrev_b32 v208, 16, v208
    v_cmp_eq_u32 vcc, v208, v205
    s_and_b64 s[28:29], s[28:29], vcc
    v_mul_u32_u24 v208, 18, v205
    v_sub_u32 v207, v207, v208
    v_mul_u32_u24 v206, 18, v206
    v_add_u32 v206, v206, v207
    v_mul_u32_u24 v205, 342, v205
    v_add_u32 v206, v206, v205
    v_lshlrev_b32 v206, 2, v206
    s_and_saveexec_b64 s[30:31], s[28:29]
    s_cbranch_execz KVS_52
    global_store_dword v206, v200, s[26:27]
KVS_52:
    s_mov_b64 exec, s[30:31]
    v_lshlrev_b32 v204, 2, v18
    v_add_u32 v204, 49, v204
    v_mul_u32_u24 v205, 3641, v204
    v_lshrrev_b32 v205, 16, v205
    v_mul_u32_u24 v206, 18, v205
    v_sub_u32 v206, v204, v206
    v_cmp_gt_u32 vcc, 72, v204
    s_mov_b64 s[28:29], vcc
    v_add_u32 v207, 128, v19
    v_subrev_u32 v207, 72, v207
    v_cmp_gt_u32 vcc, 72, v207
    s_and_b64 s[28:29], s[28:29], vcc
    v_mul_u32_u24 v208, 3641, v207
    v_lshrrev_b32 v208, 16, v208
    v_cmp_eq_u32 vcc, v208, v205
    s_and_b64 s[28:29], s[28:29], vcc
    v_mul_u32_u24 v208, 18, v205
    v_sub_u32 v207, v207, v208
    v_mul_u32_u24 v206, 18, v206
    v_add_u32 v206, v206, v207
    v_mul_u32_u24 v205, 342, v205
    v_add_u32 v206, v206, v205
    v_lshlrev_b32 v206, 2, v206
    s_and_saveexec_b64 s[30:31], s[28:29]
    s_cbranch_execz KVS_53
    global_store_dword v206, v201, s[26:27]
KVS_53:
    s_mov_b64 exec, s[30:31]
    v_lshlrev_b32 v204, 2, v18
    v_add_u32 v204, 50, v204
    v_mul_u32_u24 v205, 3641, v204
    v_lshrrev_b32 v205, 16, v205
    v_mul_u32_u24 v206, 18, v205
    v_sub_u32 v206, v204, v206
    v_cmp_gt_u32 vcc, 72, v204
    s_mov_b64 s[28:29], vcc
    v_add_u32 v207, 128, v19
    v_subrev_u32 v207, 72, v207
    v_cmp_gt_u32 vcc, 72, v207
    s_and_b64 s[28:29], s[28:29], vcc
    v_mul_u32_u24 v208, 3641, v207
    v_lshrrev_b32 v208, 16, v208
    v_cmp_eq_u32 vcc, v208, v205
    s_and_b64 s[28:29], s[28:29], vcc
    v_mul_u32_u24 v208, 18, v205
    v_sub_u32 v207, v207, v208
    v_mul_u32_u24 v206, 18, v206
    v_add_u32 v206, v206, v207
    v_mul_u32_u24 v205, 342, v205
    v_add_u32 v206, v206, v205
    v_lshlrev_b32 v206, 2, v206
    s_and_saveexec_b64 s[30:31], s[28:29]
    s_cbranch_execz KVS_54
    global_store_dword v206, v202, s[26:27]
KVS_54:
    s_mov_b64 exec, s[30:31]
    v_lshlrev_b32 v204, 2, v18
    v_add_u32 v204, 51, v204
    v_mul_u32_u24 v205, 3641, v204
    v_lshrrev_b32 v205, 16, v205
    v_mul_u32_u24 v206, 18, v205
    v_sub_u32 v206, v204, v206
    v_cmp_gt_u32 vcc, 72, v204
    s_mov_b64 s[28:29], vcc
    v_add_u32 v207, 128, v19
    v_subrev_u32 v207, 72, v207
    v_cmp_gt_u32 vcc, 72, v207
    s_and_b64 s[28:29], s[28:29], vcc
    v_mul_u32_u24 v208, 3641, v207
    v_lshrrev_b32 v208, 16, v208
    v_cmp_eq_u32 vcc, v208, v205
    s_and_b64 s[28:29], s[28:29], vcc
    v_mul_u32_u24 v208, 18, v205
    v_sub_u32 v207, v207, v208
    v_mul_u32_u24 v206, 18, v206
    v_add_u32 v206, v206, v207
    v_mul_u32_u24 v205, 342, v205
    v_add_u32 v206, v206, v205
    v_lshlrev_b32 v206, 2, v206
    s_and_saveexec_b64 s[30:31], s[28:29]
    s_cbranch_execz KVS_55
    global_store_dword v206, v203, s[26:27]
KVS_55:
    s_mov_b64 exec, s[30:31]
    v_mov_b32 v200, 0
    v_mov_b32 v201, 0
    v_mov_b32 v202, 0
    v_mov_b32 v203, 0
    ds_read_b64_tr_b16 v[192:193], v17 offset:32
    ds_read_b64_tr_b16 v[194:195], v17 offset:4640
    s_waitcnt lgkmcnt(0)
    v_mfma_f32_16x16x32_bf16 v[200:203], v[192:195], v[188:191], v[200:203]
    ds_read_b64_tr_b16 v[192:193], v17 offset:9248
    ds_read_b64_tr_b16 v[194:195], v17 offset:13856
    s_waitcnt lgkmcnt(0)
    v_mfma_f32_16x16x32_bf16 v[200:203], v[192:195], v[188:191], v[200:203]
    ds_read_b64_tr_b16 v[192:193], v17 offset:18464
    ds_read_b64_tr_b16 v[194:195], v17 offset:23072
    s_waitcnt lgkmcnt(0)
    v_mfma_f32_16x16x32_bf16 v[200:203], v[192:195], v[188:191], v[200:203]
    ds_read_b64_tr_b16 v[192:193], v17 offset:27680
    ds_read_b64_tr_b16 v[194:195], v17 offset:32288
    s_waitcnt lgkmcnt(0)
    v_mfma_f32_16x16x32_bf16 v[200:203], v[192:195], v[188:191], v[200:203]
    s_nop 9
    v_lshlrev_b32 v204, 2, v18
    v_add_u32 v204, 16, v204
    v_mul_u32_u24 v205, 3641, v204
    v_lshrrev_b32 v205, 16, v205
    v_mul_u32_u24 v206, 18, v205
    v_sub_u32 v206, v204, v206
    v_cmp_gt_u32 vcc, 72, v204
    s_mov_b64 s[28:29], vcc
    v_cmp_eq_u32 vcc, 0, v19
    s_and_b64 s[28:29], s[28:29], vcc
    v_add_u32 v206, 324, v206
    v_mul_u32_u24 v205, 342, v205
    v_add_u32 v206, v206, v205
    v_lshlrev_b32 v206, 2, v206
    s_and_saveexec_b64 s[30:31], s[28:29]
    s_cbranch_execz KVS_56
    global_store_dword v206, v200, s[26:27]
KVS_56:
    s_mov_b64 exec, s[30:31]
    v_lshlrev_b32 v204, 2, v18
    v_add_u32 v204, 17, v204
    v_mul_u32_u24 v205, 3641, v204
    v_lshrrev_b32 v205, 16, v205
    v_mul_u32_u24 v206, 18, v205
    v_sub_u32 v206, v204, v206
    v_cmp_gt_u32 vcc, 72, v204
    s_mov_b64 s[28:29], vcc
    v_cmp_eq_u32 vcc, 0, v19
    s_and_b64 s[28:29], s[28:29], vcc
    v_add_u32 v206, 324, v206
    v_mul_u32_u24 v205, 342, v205
    v_add_u32 v206, v206, v205
    v_lshlrev_b32 v206, 2, v206
    s_and_saveexec_b64 s[30:31], s[28:29]
    s_cbranch_execz KVS_57
    global_store_dword v206, v201, s[26:27]
KVS_57:
    s_mov_b64 exec, s[30:31]
    v_lshlrev_b32 v204, 2, v18
    v_add_u32 v204, 18, v204
    v_mul_u32_u24 v205, 3641, v204
    v_lshrrev_b32 v205, 16, v205
    v_mul_u32_u24 v206, 18, v205
    v_sub_u32 v206, v204, v206
    v_cmp_gt_u32 vcc, 72, v204
    s_mov_b64 s[28:29], vcc
    v_cmp_eq_u32 vcc, 0, v19
    s_and_b64 s[28:29], s[28:29], vcc
    v_add_u32 v206, 324, v206
    v_mul_u32_u24 v205, 342, v205
    v_add_u32 v206, v206, v205
    v_lshlrev_b32 v206, 2, v206
    s_and_saveexec_b64 s[30:31], s[28:29]
    s_cbranch_execz KVS_58
    global_store_dword v206, v202, s[26:27]
KVS_58:
    s_mov_b64 exec, s[30:31]
    v_lshlrev_b32 v204, 2, v18
    v_add_u32 v204, 19, v204
    v_mul_u32_u24 v205, 3641, v204
    v_lshrrev_b32 v205, 16, v205
    v_mul_u32_u24 v206, 18, v205
    v_sub_u32 v206, v204, v206
    v_cmp_gt_u32 vcc, 72, v204
    s_mov_b64 s[28:29], vcc
    v_cmp_eq_u32 vcc, 0, v19
    s_and_b64 s[28:29], s[28:29], vcc
    v_add_u32 v206, 324, v206
    v_mul_u32_u24 v205, 342, v205
    v_add_u32 v206, v206, v205
    v_lshlrev_b32 v206, 2, v206
    s_and_saveexec_b64 s[30:31], s[28:29]
    s_cbranch_execz KVS_59
    global_store_dword v206, v203, s[26:27]
KVS_59:
    s_mov_b64 exec, s[30:31]
KVJ_43:
    s_cmp_lg_u32 s8, 3
    s_cbranch_scc1 KVJ_60
    v_mov_b32 v200, 0
    v_mov_b32 v201, 0
    v_mov_b32 v202, 0
    v_mov_b32 v203, 0
    ds_read_b64_tr_b16 v[192:193], v17 offset:32
    ds_read_b64_tr_b16 v[194:195], v17 offset:4640
    ds_read_b64_tr_b16 v[196:197], v17 offset:160
    ds_read_b64_tr_b16 v[198:199], v17 offset:4768
    s_waitcnt lgkmcnt(0)
    v_mfma_f32_16x16x32_bf16 v[200:203], v[192:195], v[196:199], v[200:203]
    ds_read_b64_tr_b16 v[192:193], v17 offset:9248
    ds_read_b64_tr_b16 v[194:195], v17 offset:13856
    ds_read_b64_tr_b16 v[196:197], v17 offset:9376
    ds_read_b64_tr_b16 v[198:199], v17 offset:13984
    s_waitcnt lgkmcnt(0)
    v_mfma_f32_16x16x32_bf16 v[200:203], v[192:195], v[196:199], v[200:203]
    ds_read_b64_tr_b16 v[192:193], v17 offset:18464
    ds_read_b64_tr_b16 v[194:195], v17 offset:23072
    ds_read_b64_tr_b16 v[196:197], v17 offset:18592
    ds_read_b64_tr_b16 v[198:199], v17 offset:23200
    s_waitcnt lgkmcnt(0)
    v_mfma_f32_16x16x32_bf16 v[200:203], v[192:195], v[196:199], v[200:203]
    ds_read_b64_tr_b16 v[192:193], v17 offset:27680
    ds_read_b64_tr_b16 v[194:195], v17 offset:32288
    ds_read_b64_tr_b16 v[196:197], v17 offset:27808
    ds_read_b64_tr_b16 v[198:199], v17 offset:32416
    s_waitcnt lgkmcnt(0)
    v_mfma_f32_16x16x32_bf16 v[200:203], v[192:195], v[196:199], v[200:203]
    s_nop 9
    v_lshlrev_b32 v204, 2, v18
    v_add_u32 v204, 16, v204
    v_mul_u32_u24 v205, 3641, v204
    v_lshrrev_b32 v205, 16, v205
    v_mul_u32_u24 v206, 18, v205
    v_sub_u32 v206, v204, v206
    v_cmp_gt_u32 vcc, 72, v204
    s_mov_b64 s[28:29], vcc
    v_add_u32 v207, 80, v19
    v_subrev_u32 v207, 72, v207
    v_cmp_gt_u32 vcc, 72, v207
    s_and_b64 s[28:29], s[28:29], vcc
    v_mul_u32_u24 v208, 3641, v207
    v_lshrrev_b32 v208, 16, v208
    v_cmp_eq_u32 vcc, v208, v205
    s_and_b64 s[28:29], s[28:29], vcc
    v_mul_u32_u24 v208, 18, v205
    v_sub_u32 v207, v207, v208
    v_mul_u32_u24 v206, 18, v206
    v_add_u32 v206, v206, v207
    v_mul_u32_u24 v205, 342, v205
    v_add_u32 v206, v206, v205
    v_lshlrev_b32 v206, 2, v206
    s_and_saveexec_b64 s[30:31], s[28:29]
    s_cbranch_execz KVS_61
    global_store_dword v206, v200, s[26:27]
KVS_61:
    s_mov_b64 exec, s[30:31]
    v_lshlrev_b32 v204, 2, v18
    v_add_u32 v204, 17, v204
    v_mul_u32_u24 v205, 3641, v204
    v_lshrrev_b32 v205, 16, v205
    v_mul_u32_u24 v206, 18, v205
    v_sub_u32 v206, v204, v206
    v_cmp_gt_u32 vcc, 72, v204
    s_mov_b64 s[28:29], vcc
    v_add_u32 v207, 80, v19
    v_subrev_u32 v207, 72, v207
    v_cmp_gt_u32 vcc, 72, v207
    s_and_b64 s[28:29], s[28:29], vcc
    v_mul_u32_u24 v208, 3641, v207
    v_lshrrev_b32 v208, 16, v208
    v_cmp_eq_u32 vcc, v208, v205
    s_and_b64 s[28:29], s[28:29], vcc
    v_mul_u32_u24 v208, 18, v205
    v_sub_u32 v207, v207, v208
    v_mul_u32_u24 v206, 18, v206
    v_add_u32 v206, v206, v207
    v_mul_u32_u24 v205, 342, v205
    v_add_u32 v206, v206, v205
    v_lshlrev_b32 v206, 2, v206
    s_and_saveexec_b64 s[30:31], s[28:29]
    s_cbranch_execz KVS_62
    global_store_dword v206, v201, s[26:27]
KVS_62:
    s_mov_b64 exec, s[30:31]
    v_lshlrev_b32 v204, 2, v18
    v_add_u32 v204, 18, v204
    v_mul_u32_u24 v205, 3641, v204
    v_lshrrev_b32 v205, 16, v205
    v_mul_u32_u24 v206, 18, v205
    v_sub_u32 v206, v204, v206
    v_cmp_gt_u32 vcc, 72, v204
    s_mov_b64 s[28:29], vcc
    v_add_u32 v207, 80, v19
    v_subrev_u32 v207, 72, v207
    v_cmp_gt_u32 vcc, 72, v207
    s_and_b64 s[28:29], s[28:29], vcc
    v_mul_u32_u24 v208, 3641, v207
    v_lshrrev_b32 v208, 16, v208
    v_cmp_eq_u32 vcc, v208, v205
    s_and_b64 s[28:29], s[28:29], vcc
    v_mul_u32_u24 v208, 18, v205
    v_sub_u32 v207, v207, v208
    v_mul_u32_u24 v206, 18, v206
    v_add_u32 v206, v206, v207
    v_mul_u32_u24 v205, 342, v205
    v_add_u32 v206, v206, v205
    v_lshlrev_b32 v206, 2, v206
    s_and_saveexec_b64 s[30:31], s[28:29]
    s_cbranch_execz KVS_63
    global_store_dword v206, v202, s[26:27]
KVS_63:
    s_mov_b64 exec, s[30:31]
    v_lshlrev_b32 v204, 2, v18
    v_add_u32 v204, 19, v204
    v_mul_u32_u24 v205, 3641, v204
    v_lshrrev_b32 v205, 16, v205
    v_mul_u32_u24 v206, 18, v205
    v_sub_u32 v206, v204, v206
    v_cmp_gt_u32 vcc, 72, v204
    s_mov_b64 s[28:29], vcc
    v_add_u32 v207, 80, v19
    v_subrev_u32 v207, 72, v207
    v_cmp_gt_u32 vcc, 72, v207
    s_and_b64 s[28:29], s[28:29], vcc
    v_mul_u32_u24 v208, 3641, v207
    v_lshrrev_b32 v208, 16, v208
    v_cmp_eq_u32 vcc, v208, v205
    s_and_b64 s[28:29], s[28:29], vcc
    v_mul_u32_u24 v208, 18, v205
    v_sub_u32 v207, v207, v208
    v_mul_u32_u24 v206, 18, v206
    v_add_u32 v206, v206, v207
    v_mul_u32_u24 v205, 342, v205
    v_add_u32 v206, v206, v205
    v_lshlrev_b32 v206, 2, v206
    s_and_saveexec_b64 s[30:31], s[28:29]
    s_cbranch_execz KVS_64
    global_store_dword v206, v203, s[26:27]
KVS_64:
    s_mov_b64 exec, s[30:31]
    v_mov_b32 v200, 0
    v_mov_b32 v201, 0
    v_mov_b32 v202, 0
    v_mov_b32 v203, 0
    ds_read_b64_tr_b16 v[192:193], v17 offset:64
    ds_read_b64_tr_b16 v[194:195], v17 offset:4672
    ds_read_b64_tr_b16 v[196:197], v17 offset:224
    ds_read_b64_tr_b16 v[198:199], v17 offset:4832
    s_waitcnt lgkmcnt(0)
    v_mfma_f32_16x16x32_bf16 v[200:203], v[192:195], v[196:199], v[200:203]
    ds_read_b64_tr_b16 v[192:193], v17 offset:9280
    ds_read_b64_tr_b16 v[194:195], v17 offset:13888
    ds_read_b64_tr_b16 v[196:197], v17 offset:9440
    ds_read_b64_tr_b16 v[198:199], v17 offset:14048
    s_waitcnt lgkmcnt(0)
    v_mfma_f32_16x16x32_bf16 v[200:203], v[192:195], v[196:199], v[200:203]
    ds_read_b64_tr_b16 v[192:193], v17 offset:18496
    ds_read_b64_tr_b16 v[194:195], v17 offset:23104
    ds_read_b64_tr_b16 v[196:197], v17 offset:18656
    ds_read_b64_tr_b16 v[198:199], v17 offset:23264
    s_waitcnt lgkmcnt(0)
    v_mfma_f32_16x16x32_bf16 v[200:203], v[192:195], v[196:199], v[200:203]
    ds_read_b64_tr_b16 v[192:193], v17 offset:27712
    ds_read_b64_tr_b16 v[194:195], v17 offset:32320
    ds_read_b64_tr_b16 v[196:197], v17 offset:27872
    ds_read_b64_tr_b16 v[198:199], v17 offset:32480
    s_waitcnt lgkmcnt(0)
    v_mfma_f32_16x16x32_bf16 v[200:203], v[192:195], v[196:199], v[200:203]
    s_nop 9
    v_lshlrev_b32 v204, 2, v18
    v_add_u32 v204, 32, v204
    v_mul_u32_u24 v205, 3641, v204
    v_lshrrev_b32 v205, 16, v205
    v_mul_u32_u24 v206, 18, v205
    v_sub_u32 v206, v204, v206
    v_cmp_gt_u32 vcc, 72, v204
    s_mov_b64 s[28:29], vcc
    v_add_u32 v207, 112, v19
    v_subrev_u32 v207, 72, v207
    v_cmp_gt_u32 vcc, 72, v207
    s_and_b64 s[28:29], s[28:29], vcc
    v_mul_u32_u24 v208, 3641, v207
    v_lshrrev_b32 v208, 16, v208
    v_cmp_eq_u32 vcc, v208, v205
    s_and_b64 s[28:29], s[28:29], vcc
    v_mul_u32_u24 v208, 18, v205
    v_sub_u32 v207, v207, v208
    v_mul_u32_u24 v206, 18, v206
    v_add_u32 v206, v206, v207
    v_mul_u32_u24 v205, 342, v205
    v_add_u32 v206, v206, v205
    v_lshlrev_b32 v206, 2, v206
    s_and_saveexec_b64 s[30:31], s[28:29]
    s_cbranch_execz KVS_65
    global_store_dword v206, v200, s[26:27]
KVS_65:
    s_mov_b64 exec, s[30:31]
    v_lshlrev_b32 v204, 2, v18
    v_add_u32 v204, 33, v204
    v_mul_u32_u24 v205, 3641, v204
    v_lshrrev_b32 v205, 16, v205
    v_mul_u32_u24 v206, 18, v205
    v_sub_u32 v206, v204, v206
    v_cmp_gt_u32 vcc, 72, v204
    s_mov_b64 s[28:29], vcc
    v_add_u32 v207, 112, v19
    v_subrev_u32 v207, 72, v207
    v_cmp_gt_u32 vcc, 72, v207
    s_and_b64 s[28:29], s[28:29], vcc
    v_mul_u32_u24 v208, 3641, v207
    v_lshrrev_b32 v208, 16, v208
    v_cmp_eq_u32 vcc, v208, v205
    s_and_b64 s[28:29], s[28:29], vcc
    v_mul_u32_u24 v208, 18, v205
    v_sub_u32 v207, v207, v208
    v_mul_u32_u24 v206, 18, v206
    v_add_u32 v206, v206, v207
    v_mul_u32_u24 v205, 342, v205
    v_add_u32 v206, v206, v205
    v_lshlrev_b32 v206, 2, v206
    s_and_saveexec_b64 s[30:31], s[28:29]
    s_cbranch_execz KVS_66
    global_store_dword v206, v201, s[26:27]
KVS_66:
    s_mov_b64 exec, s[30:31]
    v_lshlrev_b32 v204, 2, v18
    v_add_u32 v204, 34, v204
    v_mul_u32_u24 v205, 3641, v204
    v_lshrrev_b32 v205, 16, v205
    v_mul_u32_u24 v206, 18, v205
    v_sub_u32 v206, v204, v206
    v_cmp_gt_u32 vcc, 72, v204
    s_mov_b64 s[28:29], vcc
    v_add_u32 v207, 112, v19
    v_subrev_u32 v207, 72, v207
    v_cmp_gt_u32 vcc, 72, v207
    s_and_b64 s[28:29], s[28:29], vcc
    v_mul_u32_u24 v208, 3641, v207
    v_lshrrev_b32 v208, 16, v208
    v_cmp_eq_u32 vcc, v208, v205
    s_and_b64 s[28:29], s[28:29], vcc
    v_mul_u32_u24 v208, 18, v205
    v_sub_u32 v207, v207, v208
    v_mul_u32_u24 v206, 18, v206
    v_add_u32 v206, v206, v207
    v_mul_u32_u24 v205, 342, v205
    v_add_u32 v206, v206, v205
    v_lshlrev_b32 v206, 2, v206
    s_and_saveexec_b64 s[30:31], s[28:29]
    s_cbranch_execz KVS_67
    global_store_dword v206, v202, s[26:27]
KVS_67:
    s_mov_b64 exec, s[30:31]
    v_lshlrev_b32 v204, 2, v18
    v_add_u32 v204, 35, v204
    v_mul_u32_u24 v205, 3641, v204
    v_lshrrev_b32 v205, 16, v205
    v_mul_u32_u24 v206, 18, v205
    v_sub_u32 v206, v204, v206
    v_cmp_gt_u32 vcc, 72, v204
    s_mov_b64 s[28:29], vcc
    v_add_u32 v207, 112, v19
    v_subrev_u32 v207, 72, v207
    v_cmp_gt_u32 vcc, 72, v207
    s_and_b64 s[28:29], s[28:29], vcc
    v_mul_u32_u24 v208, 3641, v207
    v_lshrrev_b32 v208, 16, v208
    v_cmp_eq_u32 vcc, v208, v205
    s_and_b64 s[28:29], s[28:29], vcc
    v_mul_u32_u24 v208, 18, v205
    v_sub_u32 v207, v207, v208
    v_mul_u32_u24 v206, 18, v206
    v_add_u32 v206, v206, v207
    v_mul_u32_u24 v205, 342, v205
    v_add_u32 v206, v206, v205
    v_lshlrev_b32 v206, 2, v206
    s_and_saveexec_b64 s[30:31], s[28:29]
    s_cbranch_execz KVS_68
    global_store_dword v206, v203, s[26:27]
KVS_68:
    s_mov_b64 exec, s[30:31]
    v_mov_b32 v200, 0
    v_mov_b32 v201, 0
    v_mov_b32 v202, 0
    v_mov_b32 v203, 0
    ds_read_b64_tr_b16 v[192:193], v17 offset:128
    ds_read_b64_tr_b16 v[194:195], v17 offset:4736
    ds_read_b64_tr_b16 v[196:197], v17 offset:224
    ds_read_b64_tr_b16 v[198:199], v17 offset:4832
    s_waitcnt lgkmcnt(0)
    v_mfma_f32_16x16x32_bf16 v[200:203], v[192:195], v[196:199], v[200:203]
    ds_read_b64_tr_b16 v[192:193], v17 offset:9344
    ds_read_b64_tr_b16 v[194:195], v17 offset:13952
    ds_read_b64_tr_b16 v[196:197], v17 offset:9440
    ds_read_b64_tr_b16 v[198:199], v17 offset:14048
    s_waitcnt lgkmcnt(0)
    v_mfma_f32_16x16x32_bf16 v[200:203], v[192:195], v[196:199], v[200:203]
    ds_read_b64_tr_b16 v[192:193], v17 offset:18560
    ds_read_b64_tr_b16 v[194:195], v17 offset:23168
    ds_read_b64_tr_b16 v[196:197], v17 offset:18656
    ds_read_b64_tr_b16 v[198:199], v17 offset:23264
    s_waitcnt lgkmcnt(0)
    v_mfma_f32_16x16x32_bf16 v[200:203], v[192:195], v[196:199], v[200:203]
    ds_read_b64_tr_b16 v[192:193], v17 offset:27776
    ds_read_b64_tr_b16 v[194:195], v17 offset:32384
    ds_read_b64_tr_b16 v[196:197], v17 offset:27872
    ds_read_b64_tr_b16 v[198:199], v17 offset:32480
    s_waitcnt lgkmcnt(0)
    v_mfma_f32_16x16x32_bf16 v[200:203], v[192:195], v[196:199], v[200:203]
    s_nop 9
    v_lshlrev_b32 v204, 2, v18
    v_add_u32 v204, 64, v204
    v_mul_u32_u24 v205, 3641, v204
    v_lshrrev_b32 v205, 16, v205
    v_mul_u32_u24 v206, 18, v205
    v_sub_u32 v206, v204, v206
    v_cmp_gt_u32 vcc, 72, v204
    s_mov_b64 s[28:29], vcc
    v_add_u32 v207, 112, v19
    v_subrev_u32 v207, 72, v207
    v_cmp_gt_u32 vcc, 72, v207
    s_and_b64 s[28:29], s[28:29], vcc
    v_mul_u32_u24 v208, 3641, v207
    v_lshrrev_b32 v208, 16, v208
    v_cmp_eq_u32 vcc, v208, v205
    s_and_b64 s[28:29], s[28:29], vcc
    v_mul_u32_u24 v208, 18, v205
    v_sub_u32 v207, v207, v208
    v_mul_u32_u24 v206, 18, v206
    v_add_u32 v206, v206, v207
    v_mul_u32_u24 v205, 342, v205
    v_add_u32 v206, v206, v205
    v_lshlrev_b32 v206, 2, v206
    s_and_saveexec_b64 s[30:31], s[28:29]
    s_cbranch_execz KVS_69
    global_store_dword v206, v200, s[26:27]
KVS_69:
    s_mov_b64 exec, s[30:31]
    v_lshlrev_b32 v204, 2, v18
    v_add_u32 v204, 65, v204
    v_mul_u32_u24 v205, 3641, v204
    v_lshrrev_b32 v205, 16, v205
    v_mul_u32_u24 v206, 18, v205
    v_sub_u32 v206, v204, v206
    v_cmp_gt_u32 vcc, 72, v204
    s_mov_b64 s[28:29], vcc
    v_add_u32 v207, 112, v19
    v_subrev_u32 v207, 72, v207
    v_cmp_gt_u32 vcc, 72, v207
    s_and_b64 s[28:29], s[28:29], vcc
    v_mul_u32_u24 v208, 3641, v207
    v_lshrrev_b32 v208, 16, v208
    v_cmp_eq_u32 vcc, v208, v205
    s_and_b64 s[28:29], s[28:29], vcc
    v_mul_u32_u24 v208, 18, v205
    v_sub_u32 v207, v207, v208
    v_mul_u32_u24 v206, 18, v206
    v_add_u32 v206, v206, v207
    v_mul_u32_u24 v205, 342, v205
    v_add_u32 v206, v206, v205
    v_lshlrev_b32 v206, 2, v206
    s_and_saveexec_b64 s[30:31], s[28:29]
    s_cbranch_execz KVS_70
    global_store_dword v206, v201, s[26:27]
KVS_70:
    s_mov_b64 exec, s[30:31]
    v_lshlrev_b32 v204, 2, v18
    v_add_u32 v204, 66, v204
    v_mul_u32_u24 v205, 3641, v204
    v_lshrrev_b32 v205, 16, v205
    v_mul_u32_u24 v206, 18, v205
    v_sub_u32 v206, v204, v206
    v_cmp_gt_u32 vcc, 72, v204
    s_mov_b64 s[28:29], vcc
    v_add_u32 v207, 112, v19
    v_subrev_u32 v207, 72, v207
    v_cmp_gt_u32 vcc, 72, v207
    s_and_b64 s[28:29], s[28:29], vcc
    v_mul_u32_u24 v208, 3641, v207
    v_lshrrev_b32 v208, 16, v208
    v_cmp_eq_u32 vcc, v208, v205
    s_and_b64 s[28:29], s[28:29], vcc
    v_mul_u32_u24 v208, 18, v205
    v_sub_u32 v207, v207, v208
    v_mul_u32_u24 v206, 18, v206
    v_add_u32 v206, v206, v207
    v_mul_u32_u24 v205, 342, v205
    v_add_u32 v206, v206, v205
    v_lshlrev_b32 v206, 2, v206
    s_and_saveexec_b64 s[30:31], s[28:29]
    s_cbranch_execz KVS_71
    global_store_dword v206, v202, s[26:27]
KVS_71:
    s_mov_b64 exec, s[30:31]
    v_lshlrev_b32 v204, 2, v18
    v_add_u32 v204, 67, v204
    v_mul_u32_u24 v205, 3641, v204
    v_lshrrev_b32 v205, 16, v205
    v_mul_u32_u24 v206, 18, v205
    v_sub_u32 v206, v204, v206
    v_cmp_gt_u32 vcc, 72, v204
    s_mov_b64 s[28:29], vcc
    v_add_u32 v207, 112, v19
    v_subrev_u32 v207, 72, v207
    v_cmp_gt_u32 vcc, 72, v207
    s_and_b64 s[28:29], s[28:29], vcc
    v_mul_u32_u24 v208, 3641, v207
    v_lshrrev_b32 v208, 16, v208
    v_cmp_eq_u32 vcc, v208, v205
    s_and_b64 s[28:29], s[28:29], vcc
    v_mul_u32_u24 v208, 18, v205
    v_sub_u32 v207, v207, v208
    v_mul_u32_u24 v206, 18, v206
    v_add_u32 v206, v206, v207
    v_mul_u32_u24 v205, 342, v205
    v_add_u32 v206, v206, v205
    v_lshlrev_b32 v206, 2, v206
    s_and_saveexec_b64 s[30:31], s[28:29]
    s_cbranch_execz KVS_72
    global_store_dword v206, v203, s[26:27]
KVS_72:
    s_mov_b64 exec, s[30:31]
    v_mov_b32 v200, 0
    v_mov_b32 v201, 0
    v_mov_b32 v202, 0
    v_mov_b32 v203, 0
    ds_read_b64_tr_b16 v[192:193], v17 offset:64
    ds_read_b64_tr_b16 v[194:195], v17 offset:4672
    s_waitcnt lgkmcnt(0)
    v_mfma_f32_16x16x32_bf16 v[200:203], v[192:195], v[188:191], v[200:203]
    ds_read_b64_tr_b16 v[192:193], v17 offset:9280
    ds_read_b64_tr_b16 v[194:195], v17 offset:13888
    s_waitcnt lgkmcnt(0)
    v_mfma_f32_16x16x32_bf16 v[200:203], v[192:195], v[188:191], v[200:203]
    ds_read_b64_tr_b16 v[192:193], v17 offset:18496
    ds_read_b64_tr_b16 v[194:195], v17 offset:23104
    s_waitcnt lgkmcnt(0)
    v_mfma_f32_16x16x32_bf16 v[200:203], v[192:195], v[188:191], v[200:203]
    ds_read_b64_tr_b16 v[192:193], v17 offset:27712
    ds_read_b64_tr_b16 v[194:195], v17 offset:32320
    s_waitcnt lgkmcnt(0)
    v_mfma_f32_16x16x32_bf16 v[200:203], v[192:195], v[188:191], v[200:203]
    s_nop 9
    v_lshlrev_b32 v204, 2, v18
    v_add_u32 v204, 32, v204
    v_mul_u32_u24 v205, 3641, v204
    v_lshrrev_b32 v205, 16, v205
    v_mul_u32_u24 v206, 18, v205
    v_sub_u32 v206, v204, v206
    v_cmp_gt_u32 vcc, 72, v204
    s_mov_b64 s[28:29], vcc
    v_cmp_eq_u32 vcc, 0, v19
    s_and_b64 s[28:29], s[28:29], vcc
    v_add_u32 v206, 324, v206
    v_mul_u32_u24 v205, 342, v205
    v_add_u32 v206, v206, v205
    v_lshlrev_b32 v206, 2, v206
    s_and_saveexec_b64 s[30:31], s[28:29]
    s_cbranch_execz KVS_73
    global_store_dword v206, v200, s[26:27]
KVS_73:
    s_mov_b64 exec, s[30:31]
    v_lshlrev_b32 v204, 2, v18
    v_add_u32 v204, 33, v204
    v_mul_u32_u24 v205, 3641, v204
    v_lshrrev_b32 v205, 16, v205
    v_mul_u32_u24 v206, 18, v205
    v_sub_u32 v206, v204, v206
    v_cmp_gt_u32 vcc, 72, v204
    s_mov_b64 s[28:29], vcc
    v_cmp_eq_u32 vcc, 0, v19
    s_and_b64 s[28:29], s[28:29], vcc
    v_add_u32 v206, 324, v206
    v_mul_u32_u24 v205, 342, v205
    v_add_u32 v206, v206, v205
    v_lshlrev_b32 v206, 2, v206
    s_and_saveexec_b64 s[30:31], s[28:29]
    s_cbranch_execz KVS_74
    global_store_dword v206, v201, s[26:27]
KVS_74:
    s_mov_b64 exec, s[30:31]
    v_lshlrev_b32 v204, 2, v18
    v_add_u32 v204, 34, v204
    v_mul_u32_u24 v205, 3641, v204
    v_lshrrev_b32 v205, 16, v205
    v_mul_u32_u24 v206, 18, v205
    v_sub_u32 v206, v204, v206
    v_cmp_gt_u32 vcc, 72, v204
    s_mov_b64 s[28:29], vcc
    v_cmp_eq_u32 vcc, 0, v19
    s_and_b64 s[28:29], s[28:29], vcc
    v_add_u32 v206, 324, v206
    v_mul_u32_u24 v205, 342, v205
    v_add_u32 v206, v206, v205
    v_lshlrev_b32 v206, 2, v206
    s_and_saveexec_b64 s[30:31], s[28:29]
    s_cbranch_execz KVS_75
    global_store_dword v206, v202, s[26:27]
KVS_75:
    s_mov_b64 exec, s[30:31]
    v_lshlrev_b32 v204, 2, v18
    v_add_u32 v204, 35, v204
    v_mul_u32_u24 v205, 3641, v204
    v_lshrrev_b32 v205, 16, v205
    v_mul_u32_u24 v206, 18, v205
    v_sub_u32 v206, v204, v206
    v_cmp_gt_u32 vcc, 72, v204
    s_mov_b64 s[28:29], vcc
    v_cmp_eq_u32 vcc, 0, v19
    s_and_b64 s[28:29], s[28:29], vcc
    v_add_u32 v206, 324, v206
    v_mul_u32_u24 v205, 342, v205
    v_add_u32 v206, v206, v205
    v_lshlrev_b32 v206, 2, v206
    s_and_saveexec_b64 s[30:31], s[28:29]
    s_cbranch_execz KVS_76
    global_store_dword v206, v203, s[26:27]
KVS_76:
    s_mov_b64 exec, s[30:31]
KVJ_60:
    s_branch K1_END
K1_Q:
    s_sub_u32 s16, s2, 128
    s_lshr_b32 s15, s16, 2
    s_lshl_b32 s15, s15, 7
    s_and_b32 s16, s16, 3
    s_mul_i32 s12, s16, 288
    s_mov_b32 s17, 3456
    s_mov_b32 s18, 221184
    s_mov_b32 s6, s20
    s_mov_b32 s7, s21
    s_mov_b32 s19, 1152
    s_lshl_b32 s9, s8, 8
    s_add_u32 s9, s9, 0
    v_add_u32 v16, s9, v1
    v_lshrrev_b32 v17, 3, v16
    v_and_b32 v18, 7, v16
    v_lshrrev_b32 v19, 1, v17
    v_and_b32 v19, 7, v19
    v_xor_b32 v18, v18, v19
    v_lshlrev_b32 v18, 4, v18
    v_add_u32 v17, s15, v17
    v_mul_lo_u32 v17, v17, s19
    v_add_u32 v2, v17, v18
    s_lshl_b32 s9, s8, 8
    s_add_u32 s9, s9, 64
    v_add_u32 v16, s9, v1
    v_lshrrev_b32 v17, 3, v16
    v_and_b32 v18, 7, v16
    v_lshrrev_b32 v19, 1, v17
    v_and_b32 v19, 7, v19
    v_xor_b32 v18, v18, v19
    v_lshlrev_b32 v18, 4, v18
    v_add_u32 v17, s15, v17
    v_mul_lo_u32 v17, v17, s19
    v_add_u32 v3, v17, v18
    s_lshl_b32 s9, s8, 8
    s_add_u32 s9, s9, 128
    v_add_u32 v16, s9, v1
    v_lshrrev_b32 v17, 3, v16
    v_and_b32 v18, 7, v16
    v_lshrrev_b32 v19, 1, v17
    v_and_b32 v19, 7, v19
    v_xor_b32 v18, v18, v19
    v_lshlrev_b32 v18, 4, v18
    v_add_u32 v17, s15, v17
    v_mul_lo_u32 v17, v17, s19
    v_add_u32 v4, v17, v18
    s_lshl_b32 s9, s8, 8
    s_add_u32 s9, s9, 192
    v_add_u32 v16, s9, v1
    v_lshrrev_b32 v17, 3, v16
    v_and_b32 v18, 7, v16
    v_lshrrev_b32 v19, 1, v17
    v_and_b32 v19, 7, v19
    v_xor_b32 v18, v18, v19
    v_lshlrev_b32 v18, 4, v18
    v_add_u32 v17, s15, v17
    v_mul_lo_u32 v17, v17, s19
    v_add_u32 v5, v17, v18
    s_mul_i32 s9, s8, 288
    s_add_u32 s9, s9, 0
    v_add_u32 v16, s9, v1
    v_mul_u32_u24 v17, 3641, v16
    v_lshrrev_b32 v17, 16, v17
    v_mul_u32_u24 v18, 18, v17
    v_sub_u32 v18, v16, v18
    v_mul_lo_u32 v17, v17, s17
    v_lshlrev_b32 v18, 4, v18
    v_add_u32 v17, v17, v18
    v_add_u32 v6, s12, v17
    s_mul_i32 s9, s8, 288
    s_add_u32 s9, s9, 64
    v_add_u32 v16, s9, v1
    v_mul_u32_u24 v17, 3641, v16
    v_lshrrev_b32 v17, 16, v17
    v_mul_u32_u24 v18, 18, v17
    v_sub_u32 v18, v16, v18
    v_mul_lo_u32 v17, v17, s17
    v_lshlrev_b32 v18, 4, v18
    v_add_u32 v17, v17, v18
    v_add_u32 v7, s12, v17
    s_mul_i32 s9, s8, 288
    s_add_u32 s9, s9, 128
    v_add_u32 v16, s9, v1
    v_mul_u32_u24 v17, 3641, v16
    v_lshrrev_b32 v17, 16, v17
    v_mul_u32_u24 v18, 18, v17
    v_sub_u32 v18, v16, v18
    v_mul_lo_u32 v17, v17, s17
    v_lshlrev_b32 v18, 4, v18
    v_add_u32 v17, v17, v18
    v_add_u32 v8, s12, v17
    s_mul_i32 s9, s8, 288
    s_add_u32 s9, s9, 192
    v_add_u32 v16, s9, v1
    v_mul_u32_u24 v17, 3641, v16
    v_lshrrev_b32 v17, 16, v17
    v_mul_u32_u24 v18, 18, v17
    v_sub_u32 v18, v16, v18
    v_mul_lo_u32 v17, v17, s17
    v_lshlrev_b32 v18, 4, v18
    v_add_u32 v17, v17, v18
    v_add_u32 v9, s12, v17
    s_mul_i32 s9, s8, 288
    s_add_u32 s9, s9, 256
    v_add_u32 v16, s9, v1
    v_mul_u32_u24 v17, 3641, v16
    v_lshrrev_b32 v17, 16, v17
    v_mul_u32_u24 v18, 18, v17
    v_sub_u32 v18, v16, v18
    v_mul_lo_u32 v17, v17, s17
    v_lshlrev_b32 v18, 4, v18
    v_add_u32 v17, v17, v18
    v_add_u32 v10, s12, v17
    s_lshl_b32 s9, s8, 12
    s_add_u32 m0, s9, 0
    s_nop 0
    global_load_lds_dwordx4 v2, s[4:5]
    s_lshl_b32 s9, s8, 12
    s_add_u32 m0, s9, 1024
    s_nop 0
    global_load_lds_dwordx4 v3, s[4:5]
    s_lshl_b32 s9, s8, 12
    s_add_u32 m0, s9, 2048
    s_nop 0
    global_load_lds_dwordx4 v4, s[4:5]
    s_lshl_b32 s9, s8, 12
    s_add_u32 m0, s9, 3072
    s_nop 0
    global_load_lds_dwordx4 v5, s[4:5]
    s_mul_i32 s9, s8, 4608
    s_add_u32 m0, s9, 16384
    s_nop 0
    global_load_lds_dwordx4 v6, s[6:7]
    s_mul_i32 s9, s8, 4608
    s_add_u32 m0, s9, 17408
    s_nop 0
    global_load_lds_dwordx4 v7, s[6:7]
    s_mul_i32 s9, s8, 4608
    s_add_u32 m0, s9, 18432
    s_nop 0
    global_load_lds_dwordx4 v8, s[6:7]
    s_mul_i32 s9, s8, 4608
    s_add_u32 m0, s9, 19456
    s_nop 0
    global_load_lds_dwordx4 v9, s[6:7]
    s_mul_i32 s9, s8, 4608
    s_add_u32 m0, s9, 20480
    s_mov_b32 exec_hi, 0
    global_load_lds_dwordx4 v10, s[6:7]
    s_mov_b64 exec, -1
    s_add_u32 s4, s4, 128
    s_addc_u32 s5, s5, 0
    s_add_u32 s6, s6, s18
    s_addc_u32 s7, s7, 0
    s_lshl_b32 s9, s8, 12
    s_add_u32 m0, s9, 34816
    s_nop 0
    global_load_lds_dwordx4 v2, s[4:5]
    s_lshl_b32 s9, s8, 12
    s_add_u32 m0, s9, 35840
    s_nop 0
    global_load_lds_dwordx4 v3, s[4:5]
    s_lshl_b32 s9, s8, 12
    s_add_u32 m0, s9, 36864
    s_nop 0
    global_load_lds_dwordx4 v4, s[4:5]
    s_lshl_b32 s9, s8, 12
    s_add_u32 m0, s9, 37888
    s_nop 0
    global_load_lds_dwordx4 v5, s[4:5]
    s_mul_i32 s9, s8, 4608
    s_add_u32 m0, s9, 51200
    s_nop 0
    global_load_lds_dwordx4 v6, s[6:7]
    s_mul_i32 s9, s8, 4608
    s_add_u32 m0, s9, 52224
    s_nop 0
    global_load_lds_dwordx4 v7, s[6:7]
    s_mul_i32 s9, s8, 4608
    s_add_u32 m0, s9, 53248
    s_nop 0
    global_load_lds_dwordx4 v8, s[6:7]
    s_mul_i32 s9, s8, 4608
    s_add_u32 m0, s9, 54272
    s_nop 0
    global_load_lds_dwordx4 v9, s[6:7]
    s_mul_i32 s9, s8, 4608
    s_add_u32 m0, s9, 55296
    s_mov_b32 exec_hi, 0
    global_load_lds_dwordx4 v10, s[6:7]
    s_mov_b64 exec, -1
    s_waitcnt vmcnt(9)
    s_barrier
    ds_read_b64 v[20:21], v11 offset:0
    ds_read_b64 v[22:23], v12 offset:0
    ds_read_b64 v[24:25], v11 offset:2048
    ds_read_b64 v[26:27], v12 offset:2048
    ds_read_b64_tr_b16 v[36:37], v15 offset:0
    ds_read_b64_tr_b16 v[38:39], v15 offset:4608
    ds_read_b64_tr_b16 v[40:41], v15 offset:32
    ds_read_b64_tr_b16 v[42:43], v15 offset:4640
    ds_read_b64_tr_b16 v[44:45], v15 offset:64
    ds_read_b64_tr_b16 v[46:47], v15 offset:4672
    ds_read_b64_tr_b16 v[48:49], v15 offset:96
    ds_read_b64_tr_b16 v[50:51], v15 offset:4704
    ds_read_b64_tr_b16 v[52:53], v15 offset:128
    ds_read_b64_tr_b16 v[54:55], v15 offset:4736
    ds_read_b64_tr_b16 v[56:57], v15 offset:160
    ds_read_b64_tr_b16 v[58:59], v15 offset:4768
    ds_read_b64_tr_b16 v[60:61], v15 offset:192
    ds_read_b64_tr_b16 v[62:63], v15 offset:4800
    ds_read_b64_tr_b16 v[64:65], v15 offset:224
    ds_read_b64_tr_b16 v[66:67], v15 offset:4832
    ds_read_b64_tr_b16 v[68:69], v15 offset:256
    ds_read_b64_tr_b16 v[70:71], v15 offset:4864
    s_waitcnt lgkmcnt(15)
    v_mfma_f32_16x16x32_bf16 v[108:111], v[36:39], v[20:23], v[108:111]
    v_mfma_f32_16x16x32_bf16 v[144:147], v[36:39], v[24:27], v[144:147]
    ds_read_b64 v[28:29], v13 offset:0
    ds_read_b64 v[30:31], v14 offset:0
    ds_read_b64 v[32:33], v13 offset:2048
    s_waitcnt lgkmcnt(15)
    v_mfma_f32_16x16x32_bf16 v[112:115], v[40:43], v[20:23], v[112:115]
    v_mfma_f32_16x16x32_bf16 v[148:151], v[40:43], v[24:27], v[148:151]
    ds_read_b64 v[34:35], v14 offset:2048
    ds_read_b64_tr_b16 v[72:73], v15 offset:9216
    ds_read_b64_tr_b16 v[74:75], v15 offset:13824
    v_mfma_f32_16x16x32_bf16 v[116:119], v[44:47], v[20:23], v[116:119]
    v_mfma_f32_16x16x32_bf16 v[152:155], v[44:47], v[24:27], v[152:155]
    ds_read_b64_tr_b16 v[76:77], v15 offset:9248
    ds_read_b64_tr_b16 v[78:79], v15 offset:13856
    ds_read_b64_tr_b16 v[80:81], v15 offset:9280
    s_waitcnt lgkmcnt(15)
    v_mfma_f32_16x16x32_bf16 v[120:123], v[48:51], v[20:23], v[120:123]
    v_mfma_f32_16x16x32_bf16 v[156:159], v[48:51], v[24:27], v[156:159]
    ds_read_b64_tr_b16 v[82:83], v15 offset:13888
    ds_read_b64_tr_b16 v[84:85], v15 offset:9312
    ds_read_b64_tr_b16 v[86:87], v15 offset:13920
    v_mfma_f32_16x16x32_bf16 v[124:127], v[52:55], v[20:23], v[124:127]
    v_mfma_f32_16x16x32_bf16 v[160:163], v[52:55], v[24:27], v[160:163]
    ds_read_b64_tr_b16 v[88:89], v15 offset:9344
    ds_read_b64_tr_b16 v[90:91], v15 offset:13952
    ds_read_b64_tr_b16 v[92:93], v15 offset:9376
    v_mfma_f32_16x16x32_bf16 v[128:131], v[56:59], v[20:23], v[128:131]
    v_mfma_f32_16x16x32_bf16 v[164:167], v[56:59], v[24:27], v[164:167]
    ds_read_b64_tr_b16 v[94:95], v15 offset:13984
    ds_read_b64_tr_b16 v[96:97], v15 offset:9408
    ds_read_b64_tr_b16 v[98:99], v15 offset:14016
    s_waitcnt lgkmcnt(15)
    v_mfma_f32_16x16x32_bf16 v[132:135], v[60:63], v[20:23], v[132:135]
    v_mfma_f32_16x16x32_bf16 v[168:171], v[60:63], v[24:27], v[168:171]
    ds_read_b64_tr_b16 v[100:101], v15 offset:9440
    ds_read_b64_tr_b16 v[102:103], v15 offset:14048
    ds_read_b64_tr_b16 v[104:105], v15 offset:9472
    v_mfma_f32_16x16x32_bf16 v[136:139], v[64:67], v[20:23], v[136:139]
    v_mfma_f32_16x16x32_bf16 v[172:175], v[64:67], v[24:27], v[172:175]
    ds_read_b64_tr_b16 v[106:107], v15 offset:14080
    v_mfma_f32_16x16x32_bf16 v[140:143], v[68:71], v[20:23], v[140:143]
    v_mfma_f32_16x16x32_bf16 v[176:179], v[68:71], v[24:27], v[176:179]
    s_waitcnt lgkmcnt(0)
    s_waitcnt vmcnt(0)
    s_barrier
    s_add_u32 s4, s4, 128
    s_addc_u32 s5, s5, 0
    s_add_u32 s6, s6, s18
    s_addc_u32 s7, s7, 0
    s_lshl_b32 s9, s8, 12
    s_add_u32 m0, s9, 0
    s_nop 0
    global_load_lds_dwordx4 v2, s[4:5]
    s_lshl_b32 s9, s8, 12
    s_add_u32 m0, s9, 1024
    s_nop 0
    global_load_lds_dwordx4 v3, s[4:5]
    s_lshl_b32 s9, s8, 12
    s_add_u32 m0, s9, 2048
    s_nop 0
    global_load_lds_dwordx4 v4, s[4:5]
    s_lshl_b32 s9, s8, 12
    s_add_u32 m0, s9, 3072
    s_nop 0
    global_load_lds_dwordx4 v5, s[4:5]
    s_mul_i32 s9, s8, 4608
    s_add_u32 m0, s9, 16384
    s_nop 0
    global_load_lds_dwordx4 v6, s[6:7]
    s_mul_i32 s9, s8, 4608
    s_add_u32 m0, s9, 17408
    s_nop 0
    global_load_lds_dwordx4 v7, s[6:7]
    s_mul_i32 s9, s8, 4608
    s_add_u32 m0, s9, 18432
    s_nop 0
    global_load_lds_dwordx4 v8, s[6:7]
    s_mul_i32 s9, s8, 4608
    s_add_u32 m0, s9, 19456
    s_nop 0
    global_load_lds_dwordx4 v9, s[6:7]
    s_mul_i32 s9, s8, 4608
    s_add_u32 m0, s9, 20480
    s_mov_b32 exec_hi, 0
    global_load_lds_dwordx4 v10, s[6:7]
    s_mov_b64 exec, -1
    v_mfma_f32_16x16x32_bf16 v[108:111], v[72:75], v[28:31], v[108:111]
    v_mfma_f32_16x16x32_bf16 v[144:147], v[72:75], v[32:35], v[144:147]
    ds_read_b64 v[20:21], v11 offset:34816
    ds_read_b64 v[22:23], v12 offset:34816
    ds_read_b64 v[24:25], v11 offset:36864
    v_mfma_f32_16x16x32_bf16 v[112:115], v[76:79], v[28:31], v[112:115]
    v_mfma_f32_16x16x32_bf16 v[148:151], v[76:79], v[32:35], v[148:151]
    ds_read_b64 v[26:27], v12 offset:36864
    ds_read_b64_tr_b16 v[36:37], v15 offset:34816
    ds_read_b64_tr_b16 v[38:39], v15 offset:39424
    v_mfma_f32_16x16x32_bf16 v[116:119], v[80:83], v[28:31], v[116:119]
    v_mfma_f32_16x16x32_bf16 v[152:155], v[80:83], v[32:35], v[152:155]
    ds_read_b64_tr_b16 v[40:41], v15 offset:34848
    ds_read_b64_tr_b16 v[42:43], v15 offset:39456
    ds_read_b64_tr_b16 v[44:45], v15 offset:34880
    v_mfma_f32_16x16x32_bf16 v[120:123], v[84:87], v[28:31], v[120:123]
    v_mfma_f32_16x16x32_bf16 v[156:159], v[84:87], v[32:35], v[156:159]
    ds_read_b64_tr_b16 v[46:47], v15 offset:39488
    ds_read_b64_tr_b16 v[48:49], v15 offset:34912
    ds_read_b64_tr_b16 v[50:51], v15 offset:39520
    v_mfma_f32_16x16x32_bf16 v[124:127], v[88:91], v[28:31], v[124:127]
    v_mfma_f32_16x16x32_bf16 v[160:163], v[88:91], v[32:35], v[160:163]
    ds_read_b64_tr_b16 v[52:53], v15 offset:34944
    ds_read_b64_tr_b16 v[54:55], v15 offset:39552
    ds_read_b64_tr_b16 v[56:57], v15 offset:34976
    v_mfma_f32_16x16x32_bf16 v[128:131], v[92:95], v[28:31], v[128:131]
    v_mfma_f32_16x16x32_bf16 v[164:167], v[92:95], v[32:35], v[164:167]
    ds_read_b64_tr_b16 v[58:59], v15 offset:39584
    ds_read_b64_tr_b16 v[60:61], v15 offset:35008
    ds_read_b64_tr_b16 v[62:63], v15 offset:39616
    v_mfma_f32_16x16x32_bf16 v[132:135], v[96:99], v[28:31], v[132:135]
    v_mfma_f32_16x16x32_bf16 v[168:171], v[96:99], v[32:35], v[168:171]
    ds_read_b64_tr_b16 v[64:65], v15 offset:35040
    ds_read_b64_tr_b16 v[66:67], v15 offset:39648
    ds_read_b64_tr_b16 v[68:69], v15 offset:35072
    v_mfma_f32_16x16x32_bf16 v[136:139], v[100:103], v[28:31], v[136:139]
    v_mfma_f32_16x16x32_bf16 v[172:175], v[100:103], v[32:35], v[172:175]
    ds_read_b64_tr_b16 v[70:71], v15 offset:39680
    v_mfma_f32_16x16x32_bf16 v[140:143], v[104:107], v[28:31], v[140:143]
    v_mfma_f32_16x16x32_bf16 v[176:179], v[104:107], v[32:35], v[176:179]
    s_waitcnt lgkmcnt(15)
    v_mfma_f32_16x16x32_bf16 v[108:111], v[36:39], v[20:23], v[108:111]
    v_mfma_f32_16x16x32_bf16 v[144:147], v[36:39], v[24:27], v[144:147]
    ds_read_b64 v[28:29], v13 offset:34816
    ds_read_b64 v[30:31], v14 offset:34816
    ds_read_b64 v[32:33], v13 offset:36864
    s_waitcnt lgkmcnt(15)
    v_mfma_f32_16x16x32_bf16 v[112:115], v[40:43], v[20:23], v[112:115]
    v_mfma_f32_16x16x32_bf16 v[148:151], v[40:43], v[24:27], v[148:151]
    ds_read_b64 v[34:35], v14 offset:36864
    ds_read_b64_tr_b16 v[72:73], v15 offset:44032
    ds_read_b64_tr_b16 v[74:75], v15 offset:48640
    v_mfma_f32_16x16x32_bf16 v[116:119], v[44:47], v[20:23], v[116:119]
    v_mfma_f32_16x16x32_bf16 v[152:155], v[44:47], v[24:27], v[152:155]
    ds_read_b64_tr_b16 v[76:77], v15 offset:44064
    ds_read_b64_tr_b16 v[78:79], v15 offset:48672
    ds_read_b64_tr_b16 v[80:81], v15 offset:44096
    s_waitcnt lgkmcnt(15)
    v_mfma_f32_16x16x32_bf16 v[120:123], v[48:51], v[20:23], v[120:123]
    v_mfma_f32_16x16x32_bf16 v[156:159], v[48:51], v[24:27], v[156:159]
    ds_read_b64_tr_b16 v[82:83], v15 offset:48704
    ds_read_b64_tr_b16 v[84:85], v15 offset:44128
    ds_read_b64_tr_b16 v[86:87], v15 offset:48736
    v_mfma_f32_16x16x32_bf16 v[124:127], v[52:55], v[20:23], v[124:127]
    v_mfma_f32_16x16x32_bf16 v[160:163], v[52:55], v[24:27], v[160:163]
    ds_read_b64_tr_b16 v[88:89], v15 offset:44160
    ds_read_b64_tr_b16 v[90:91], v15 offset:48768
    ds_read_b64_tr_b16 v[92:93], v15 offset:44192
    v_mfma_f32_16x16x32_bf16 v[128:131], v[56:59], v[20:23], v[128:131]
    v_mfma_f32_16x16x32_bf16 v[164:167], v[56:59], v[24:27], v[164:167]
    ds_read_b64_tr_b16 v[94:95], v15 offset:48800
    ds_read_b64_tr_b16 v[96:97], v15 offset:44224
    ds_read_b64_tr_b16 v[98:99], v15 offset:48832
    s_waitcnt lgkmcnt(15)
    v_mfma_f32_16x16x32_bf16 v[132:135], v[60:63], v[20:23], v[132:135]
    v_mfma_f32_16x16x32_bf16 v[168:171], v[60:63], v[24:27], v[168:171]
    ds_read_b64_tr_b16 v[100:101], v15 offset:44256
    ds_read_b64_tr_b16 v[102:103], v15 offset:48864
    ds_read_b64_tr_b16 v[104:105], v15 offset:44288
    v_mfma_f32_16x16x32_bf16 v[136:139], v[64:67], v[20:23], v[136:139]
    v_mfma_f32_16x16x32_bf16 v[172:175], v[64:67], v[24:27], v[172:175]
    ds_read_b64_tr_b16 v[106:107], v15 offset:48896
    v_mfma_f32_16x16x32_bf16 v[140:143], v[68:71], v[20:23], v[140:143]
    v_mfma_f32_16x16x32_bf16 v[176:179], v[68:71], v[24:27], v[176:179]
    s_waitcnt lgkmcnt(0)
    s_waitcnt vmcnt(0)
    s_barrier
    s_add_u32 s4, s4, 128
    s_addc_u32 s5, s5, 0
    s_add_u32 s6, s6, s18
    s_addc_u32 s7, s7, 0
    s_lshl_b32 s9, s8, 12
    s_add_u32 m0, s9, 34816
    s_nop 0
    global_load_lds_dwordx4 v2, s[4:5]
    s_lshl_b32 s9, s8, 12
    s_add_u32 m0, s9, 35840
    s_nop 0
    global_load_lds_dwordx4 v3, s[4:5]
    s_lshl_b32 s9, s8, 12
    s_add_u32 m0, s9, 36864
    s_nop 0
    global_load_lds_dwordx4 v4, s[4:5]
    s_lshl_b32 s9, s8, 12
    s_add_u32 m0, s9, 37888
    s_nop 0
    global_load_lds_dwordx4 v5, s[4:5]
    s_mul_i32 s9, s8, 4608
    s_add_u32 m0, s9, 51200
    s_nop 0
    global_load_lds_dwordx4 v6, s[6:7]
    s_mul_i32 s9, s8, 4608
    s_add_u32 m0, s9, 52224
    s_nop 0
    global_load_lds_dwordx4 v7, s[6:7]
    s_mul_i32 s9, s8, 4608
    s_add_u32 m0, s9, 53248
    s_nop 0
    global_load_lds_dwordx4 v8, s[6:7]
    s_mul_i32 s9, s8, 4608
    s_add_u32 m0, s9, 54272
    s_nop 0
    global_load_lds_dwordx4 v9, s[6:7]
    s_mul_i32 s9, s8, 4608
    s_add_u32 m0, s9, 55296
    s_mov_b32 exec_hi, 0
    global_load_lds_dwordx4 v10, s[6:7]
    s_mov_b64 exec, -1
    v_mfma_f32_16x16x32_bf16 v[108:111], v[72:75], v[28:31], v[108:111]
    v_mfma_f32_16x16x32_bf16 v[144:147], v[72:75], v[32:35], v[144:147]
    ds_read_b64 v[20:21], v11 offset:0
    ds_read_b64 v[22:23], v12 offset:0
    ds_read_b64 v[24:25], v11 offset:2048
    v_mfma_f32_16x16x32_bf16 v[112:115], v[76:79], v[28:31], v[112:115]
    v_mfma_f32_16x16x32_bf16 v[148:151], v[76:79], v[32:35], v[148:151]
    ds_read_b64 v[26:27], v12 offset:2048
    ds_read_b64_tr_b16 v[36:37], v15 offset:0
    ds_read_b64_tr_b16 v[38:39], v15 offset:4608
    v_mfma_f32_16x16x32_bf16 v[116:119], v[80:83], v[28:31], v[116:119]
    v_mfma_f32_16x16x32_bf16 v[152:155], v[80:83], v[32:35], v[152:155]
    ds_read_b64_tr_b16 v[40:41], v15 offset:32
    ds_read_b64_tr_b16 v[42:43], v15 offset:4640
    ds_read_b64_tr_b16 v[44:45], v15 offset:64
    v_mfma_f32_16x16x32_bf16 v[120:123], v[84:87], v[28:31], v[120:123]
    v_mfma_f32_16x16x32_bf16 v[156:159], v[84:87], v[32:35], v[156:159]
    ds_read_b64_tr_b16 v[46:47], v15 offset:4672
    ds_read_b64_tr_b16 v[48:49], v15 offset:96
    ds_read_b64_tr_b16 v[50:51], v15 offset:4704
    v_mfma_f32_16x16x32_bf16 v[124:127], v[88:91], v[28:31], v[124:127]
    v_mfma_f32_16x16x32_bf16 v[160:163], v[88:91], v[32:35], v[160:163]
    ds_read_b64_tr_b16 v[52:53], v15 offset:128
    ds_read_b64_tr_b16 v[54:55], v15 offset:4736
    ds_read_b64_tr_b16 v[56:57], v15 offset:160
    v_mfma_f32_16x16x32_bf16 v[128:131], v[92:95], v[28:31], v[128:131]
    v_mfma_f32_16x16x32_bf16 v[164:167], v[92:95], v[32:35], v[164:167]
    ds_read_b64_tr_b16 v[58:59], v15 offset:4768
    ds_read_b64_tr_b16 v[60:61], v15 offset:192
    ds_read_b64_tr_b16 v[62:63], v15 offset:4800
    v_mfma_f32_16x16x32_bf16 v[132:135], v[96:99], v[28:31], v[132:135]
    v_mfma_f32_16x16x32_bf16 v[168:171], v[96:99], v[32:35], v[168:171]
    ds_read_b64_tr_b16 v[64:65], v15 offset:224
    ds_read_b64_tr_b16 v[66:67], v15 offset:4832
    ds_read_b64_tr_b16 v[68:69], v15 offset:256
    v_mfma_f32_16x16x32_bf16 v[136:139], v[100:103], v[28:31], v[136:139]
    v_mfma_f32_16x16x32_bf16 v[172:175], v[100:103], v[32:35], v[172:175]
    ds_read_b64_tr_b16 v[70:71], v15 offset:4864
    v_mfma_f32_16x16x32_bf16 v[140:143], v[104:107], v[28:31], v[140:143]
    v_mfma_f32_16x16x32_bf16 v[176:179], v[104:107], v[32:35], v[176:179]
    s_waitcnt lgkmcnt(15)
    v_mfma_f32_16x16x32_bf16 v[108:111], v[36:39], v[20:23], v[108:111]
    v_mfma_f32_16x16x32_bf16 v[144:147], v[36:39], v[24:27], v[144:147]
    ds_read_b64 v[28:29], v13 offset:0
    ds_read_b64 v[30:31], v14 offset:0
    ds_read_b64 v[32:33], v13 offset:2048
    s_waitcnt lgkmcnt(15)
    v_mfma_f32_16x16x32_bf16 v[112:115], v[40:43], v[20:23], v[112:115]
    v_mfma_f32_16x16x32_bf16 v[148:151], v[40:43], v[24:27], v[148:151]
    ds_read_b64 v[34:35], v14 offset:2048
    ds_read_b64_tr_b16 v[72:73], v15 offset:9216
    ds_read_b64_tr_b16 v[74:75], v15 offset:13824
    v_mfma_f32_16x16x32_bf16 v[116:119], v[44:47], v[20:23], v[116:119]
    v_mfma_f32_16x16x32_bf16 v[152:155], v[44:47], v[24:27], v[152:155]
    ds_read_b64_tr_b16 v[76:77], v15 offset:9248
    ds_read_b64_tr_b16 v[78:79], v15 offset:13856
    ds_read_b64_tr_b16 v[80:81], v15 offset:9280
    s_waitcnt lgkmcnt(15)
    v_mfma_f32_16x16x32_bf16 v[120:123], v[48:51], v[20:23], v[120:123]
    v_mfma_f32_16x16x32_bf16 v[156:159], v[48:51], v[24:27], v[156:159]
    ds_read_b64_tr_b16 v[82:83], v15 offset:13888
    ds_read_b64_tr_b16 v[84:85], v15 offset:9312
    ds_read_b64_tr_b16 v[86:87], v15 offset:13920
    v_mfma_f32_16x16x32_bf16 v[124:127], v[52:55], v[20:23], v[124:127]
    v_mfma_f32_16x16x32_bf16 v[160:163], v[52:55], v[24:27], v[160:163]
    ds_read_b64_tr_b16 v[88:89], v15 offset:9344
    ds_read_b64_tr_b16 v[90:91], v15 offset:13952
    ds_read_b64_tr_b16 v[92:93], v15 offset:9376
    v_mfma_f32_16x16x32_bf16 v[128:131], v[56:59], v[20:23], v[128:131]
    v_mfma_f32_16x16x32_bf16 v[164:167], v[56:59], v[24:27], v[164:167]
    ds_read_b64_tr_b16 v[94:95], v15 offset:13984
    ds_read_b64_tr_b16 v[96:97], v15 offset:9408
    ds_read_b64_tr_b16 v[98:99], v15 offset:14016
    s_waitcnt lgkmcnt(15)
    v_mfma_f32_16x16x32_bf16 v[132:135], v[60:63], v[20:23], v[132:135]
    v_mfma_f32_16x16x32_bf16 v[168:171], v[60:63], v[24:27], v[168:171]
    ds_read_b64_tr_b16 v[100:101], v15 offset:9440
    ds_read_b64_tr_b16 v[102:103], v15 offset:14048
    ds_read_b64_tr_b16 v[104:105], v15 offset:9472
    v_mfma_f32_16x16x32_bf16 v[136:139], v[64:67], v[20:23], v[136:139]
    v_mfma_f32_16x16x32_bf16 v[172:175], v[64:67], v[24:27], v[172:175]
    ds_read_b64_tr_b16 v[106:107], v15 offset:14080
    v_mfma_f32_16x16x32_bf16 v[140:143], v[68:71], v[20:23], v[140:143]
    v_mfma_f32_16x16x32_bf16 v[176:179], v[68:71], v[24:27], v[176:179]
    s_waitcnt lgkmcnt(0)
    s_waitcnt vmcnt(0)
    s_barrier
    s_add_u32 s4, s4, 128
    s_addc_u32 s5, s5, 0
    s_add_u32 s6, s6, s18
    s_addc_u32 s7, s7, 0
    s_lshl_b32 s9, s8, 12
    s_add_u32 m0, s9, 0
    s_nop 0
    global_load_lds_dwordx4 v2, s[4:5]
    s_lshl_b32 s9, s8, 12
    s_add_u32 m0, s9, 1024
    s_nop 0
    global_load_lds_dwordx4 v3, s[4:5]
    s_lshl_b32 s9, s8, 12
    s_add_u32 m0, s9, 2048
    s_nop 0
    global_load_lds_dwordx4 v4, s[4:5]
    s_lshl_b32 s9, s8, 12
    s_add_u32 m0, s9, 3072
    s_nop 0
    global_load_lds_dwordx4 v5, s[4:5]
    s_mul_i32 s9, s8, 4608
    s_add_u32 m0, s9, 16384
    s_nop 0
    global_load_lds_dwordx4 v6, s[6:7]
    s_mul_i32 s9, s8, 4608
    s_add_u32 m0, s9, 17408
    s_nop 0
    global_load_lds_dwordx4 v7, s[6:7]
    s_mul_i32 s9, s8, 4608
    s_add_u32 m0, s9, 18432
    s_nop 0
    global_load_lds_dwordx4 v8, s[6:7]
    s_mul_i32 s9, s8, 4608
    s_add_u32 m0, s9, 19456
    s_nop 0
    global_load_lds_dwordx4 v9, s[6:7]
    s_mul_i32 s9, s8, 4608
    s_add_u32 m0, s9, 20480
    s_mov_b32 exec_hi, 0
    global_load_lds_dwordx4 v10, s[6:7]
    s_mov_b64 exec, -1
    v_mfma_f32_16x16x32_bf16 v[108:111], v[72:75], v[28:31], v[108:111]
    v_mfma_f32_16x16x32_bf16 v[144:147], v[72:75], v[32:35], v[144:147]
    ds_read_b64 v[20:21], v11 offset:34816
    ds_read_b64 v[22:23], v12 offset:34816
    ds_read_b64 v[24:25], v11 offset:36864
    v_mfma_f32_16x16x32_bf16 v[112:115], v[76:79], v[28:31], v[112:115]
    v_mfma_f32_16x16x32_bf16 v[148:151], v[76:79], v[32:35], v[148:151]
    ds_read_b64 v[26:27], v12 offset:36864
    ds_read_b64_tr_b16 v[36:37], v15 offset:34816
    ds_read_b64_tr_b16 v[38:39], v15 offset:39424
    v_mfma_f32_16x16x32_bf16 v[116:119], v[80:83], v[28:31], v[116:119]
    v_mfma_f32_16x16x32_bf16 v[152:155], v[80:83], v[32:35], v[152:155]
    ds_read_b64_tr_b16 v[40:41], v15 offset:34848
    ds_read_b64_tr_b16 v[42:43], v15 offset:39456
    ds_read_b64_tr_b16 v[44:45], v15 offset:34880
    v_mfma_f32_16x16x32_bf16 v[120:123], v[84:87], v[28:31], v[120:123]
    v_mfma_f32_16x16x32_bf16 v[156:159], v[84:87], v[32:35], v[156:159]
    ds_read_b64_tr_b16 v[46:47], v15 offset:39488
    ds_read_b64_tr_b16 v[48:49], v15 offset:34912
    ds_read_b64_tr_b16 v[50:51], v15 offset:39520
    v_mfma_f32_16x16x32_bf16 v[124:127], v[88:91], v[28:31], v[124:127]
    v_mfma_f32_16x16x32_bf16 v[160:163], v[88:91], v[32:35], v[160:163]
    ds_read_b64_tr_b16 v[52:53], v15 offset:34944
    ds_read_b64_tr_b16 v[54:55], v15 offset:39552
    ds_read_b64_tr_b16 v[56:57], v15 offset:34976
    v_mfma_f32_16x16x32_bf16 v[128:131], v[92:95], v[28:31], v[128:131]
    v_mfma_f32_16x16x32_bf16 v[164:167], v[92:95], v[32:35], v[164:167]
    ds_read_b64_tr_b16 v[58:59], v15 offset:39584
    ds_read_b64_tr_b16 v[60:61], v15 offset:35008
    ds_read_b64_tr_b16 v[62:63], v15 offset:39616
    v_mfma_f32_16x16x32_bf16 v[132:135], v[96:99], v[28:31], v[132:135]
    v_mfma_f32_16x16x32_bf16 v[168:171], v[96:99], v[32:35], v[168:171]
    ds_read_b64_tr_b16 v[64:65], v15 offset:35040
    ds_read_b64_tr_b16 v[66:67], v15 offset:39648
    ds_read_b64_tr_b16 v[68:69], v15 offset:35072
    v_mfma_f32_16x16x32_bf16 v[136:139], v[100:103], v[28:31], v[136:139]
    v_mfma_f32_16x16x32_bf16 v[172:175], v[100:103], v[32:35], v[172:175]
    ds_read_b64_tr_b16 v[70:71], v15 offset:39680
    v_mfma_f32_16x16x32_bf16 v[140:143], v[104:107], v[28:31], v[140:143]
    v_mfma_f32_16x16x32_bf16 v[176:179], v[104:107], v[32:35], v[176:179]
    s_waitcnt lgkmcnt(15)
    v_mfma_f32_16x16x32_bf16 v[108:111], v[36:39], v[20:23], v[108:111]
    v_mfma_f32_16x16x32_bf16 v[144:147], v[36:39], v[24:27], v[144:147]
    ds_read_b64 v[28:29], v13 offset:34816
    ds_read_b64 v[30:31], v14 offset:34816
    ds_read_b64 v[32:33], v13 offset:36864
    s_waitcnt lgkmcnt(15)
    v_mfma_f32_16x16x32_bf16 v[112:115], v[40:43], v[20:23], v[112:115]
    v_mfma_f32_16x16x32_bf16 v[148:151], v[40:43], v[24:27], v[148:151]
    ds_read_b64 v[34:35], v14 offset:36864
    ds_read_b64_tr_b16 v[72:73], v15 offset:44032
    ds_read_b64_tr_b16 v[74:75], v15 offset:48640
    v_mfma_f32_16x16x32_bf16 v[116:119], v[44:47], v[20:23], v[116:119]
    v_mfma_f32_16x16x32_bf16 v[152:155], v[44:47], v[24:27], v[152:155]
    ds_read_b64_tr_b16 v[76:77], v15 offset:44064
    ds_read_b64_tr_b16 v[78:79], v15 offset:48672
    ds_read_b64_tr_b16 v[80:81], v15 offset:44096
    s_waitcnt lgkmcnt(15)
    v_mfma_f32_16x16x32_bf16 v[120:123], v[48:51], v[20:23], v[120:123]
    v_mfma_f32_16x16x32_bf16 v[156:159], v[48:51], v[24:27], v[156:159]
    ds_read_b64_tr_b16 v[82:83], v15 offset:48704
    ds_read_b64_tr_b16 v[84:85], v15 offset:44128
    ds_read_b64_tr_b16 v[86:87], v15 offset:48736
    v_mfma_f32_16x16x32_bf16 v[124:127], v[52:55], v[20:23], v[124:127]
    v_mfma_f32_16x16x32_bf16 v[160:163], v[52:55], v[24:27], v[160:163]
    ds_read_b64_tr_b16 v[88:89], v15 offset:44160
    ds_read_b64_tr_b16 v[90:91], v15 offset:48768
    ds_read_b64_tr_b16 v[92:93], v15 offset:44192
    v_mfma_f32_16x16x32_bf16 v[128:131], v[56:59], v[20:23], v[128:131]
    v_mfma_f32_16x16x32_bf16 v[164:167], v[56:59], v[24:27], v[164:167]
    ds_read_b64_tr_b16 v[94:95], v15 offset:48800
    ds_read_b64_tr_b16 v[96:97], v15 offset:44224
    ds_read_b64_tr_b16 v[98:99], v15 offset:48832
    s_waitcnt lgkmcnt(15)
    v_mfma_f32_16x16x32_bf16 v[132:135], v[60:63], v[20:23], v[132:135]
    v_mfma_f32_16x16x32_bf16 v[168:171], v[60:63], v[24:27], v[168:171]
    ds_read_b64_tr_b16 v[100:101], v15 offset:44256
    ds_read_b64_tr_b16 v[102:103], v15 offset:48864
    ds_read_b64_tr_b16 v[104:105], v15 offset:44288
    v_mfma_f32_16x16x32_bf16 v[136:139], v[64:67], v[20:23], v[136:139]
    v_mfma_f32_16x16x32_bf16 v[172:175], v[64:67], v[24:27], v[172:175]
    ds_read_b64_tr_b16 v[106:107], v15 offset:48896
    v_mfma_f32_16x16x32_bf16 v[140:143], v[68:71], v[20:23], v[140:143]
    v_mfma_f32_16x16x32_bf16 v[176:179], v[68:71], v[24:27], v[176:179]
    s_waitcnt lgkmcnt(0)
    s_waitcnt vmcnt(0)
    s_barrier
    s_add_u32 s4, s4, 128
    s_addc_u32 s5, s5, 0
    s_add_u32 s6, s6, s18
    s_addc_u32 s7, s7, 0
    s_lshl_b32 s9, s8, 12
    s_add_u32 m0, s9, 34816
    s_nop 0
    global_load_lds_dwordx4 v2, s[4:5]
    s_lshl_b32 s9, s8, 12
    s_add_u32 m0, s9, 35840
    s_nop 0
    global_load_lds_dwordx4 v3, s[4:5]
    s_lshl_b32 s9, s8, 12
    s_add_u32 m0, s9, 36864
    s_nop 0
    global_load_lds_dwordx4 v4, s[4:5]
    s_lshl_b32 s9, s8, 12
    s_add_u32 m0, s9, 37888
    s_nop 0
    global_load_lds_dwordx4 v5, s[4:5]
    s_mul_i32 s9, s8, 4608
    s_add_u32 m0, s9, 51200
    s_nop 0
    global_load_lds_dwordx4 v6, s[6:7]
    s_mul_i32 s9, s8, 4608
    s_add_u32 m0, s9, 52224
    s_nop 0
    global_load_lds_dwordx4 v7, s[6:7]
    s_mul_i32 s9, s8, 4608
    s_add_u32 m0, s9, 53248
    s_nop 0
    global_load_lds_dwordx4 v8, s[6:7]
    s_mul_i32 s9, s8, 4608
    s_add_u32 m0, s9, 54272
    s_nop 0
    global_load_lds_dwordx4 v9, s[6:7]
    s_mul_i32 s9, s8, 4608
    s_add_u32 m0, s9, 55296
    s_mov_b32 exec_hi, 0
    global_load_lds_dwordx4 v10, s[6:7]
    s_mov_b64 exec, -1
    v_mfma_f32_16x16x32_bf16 v[108:111], v[72:75], v[28:31], v[108:111]
    v_mfma_f32_16x16x32_bf16 v[144:147], v[72:75], v[32:35], v[144:147]
    ds_read_b64 v[20:21], v11 offset:0
    ds_read_b64 v[22:23], v12 offset:0
    ds_read_b64 v[24:25], v11 offset:2048
    v_mfma_f32_16x16x32_bf16 v[112:115], v[76:79], v[28:31], v[112:115]
    v_mfma_f32_16x16x32_bf16 v[148:151], v[76:79], v[32:35], v[148:151]
    ds_read_b64 v[26:27], v12 offset:2048
    ds_read_b64_tr_b16 v[36:37], v15 offset:0
    ds_read_b64_tr_b16 v[38:39], v15 offset:4608
    v_mfma_f32_16x16x32_bf16 v[116:119], v[80:83], v[28:31], v[116:119]
    v_mfma_f32_16x16x32_bf16 v[152:155], v[80:83], v[32:35], v[152:155]
    ds_read_b64_tr_b16 v[40:41], v15 offset:32
    ds_read_b64_tr_b16 v[42:43], v15 offset:4640
    ds_read_b64_tr_b16 v[44:45], v15 offset:64
    v_mfma_f32_16x16x32_bf16 v[120:123], v[84:87], v[28:31], v[120:123]
    v_mfma_f32_16x16x32_bf16 v[156:159], v[84:87], v[32:35], v[156:159]
    ds_read_b64_tr_b16 v[46:47], v15 offset:4672
    ds_read_b64_tr_b16 v[48:49], v15 offset:96
    ds_read_b64_tr_b16 v[50:51], v15 offset:4704
    v_mfma_f32_16x16x32_bf16 v[124:127], v[88:91], v[28:31], v[124:127]
    v_mfma_f32_16x16x32_bf16 v[160:163], v[88:91], v[32:35], v[160:163]
    ds_read_b64_tr_b16 v[52:53], v15 offset:128
    ds_read_b64_tr_b16 v[54:55], v15 offset:4736
    ds_read_b64_tr_b16 v[56:57], v15 offset:160
    v_mfma_f32_16x16x32_bf16 v[128:131], v[92:95], v[28:31], v[128:131]
    v_mfma_f32_16x16x32_bf16 v[164:167], v[92:95], v[32:35], v[164:167]
    ds_read_b64_tr_b16 v[58:59], v15 offset:4768
    ds_read_b64_tr_b16 v[60:61], v15 offset:192
    ds_read_b64_tr_b16 v[62:63], v15 offset:4800
    v_mfma_f32_16x16x32_bf16 v[132:135], v[96:99], v[28:31], v[132:135]
    v_mfma_f32_16x16x32_bf16 v[168:171], v[96:99], v[32:35], v[168:171]
    ds_read_b64_tr_b16 v[64:65], v15 offset:224
    ds_read_b64_tr_b16 v[66:67], v15 offset:4832
    ds_read_b64_tr_b16 v[68:69], v15 offset:256
    v_mfma_f32_16x16x32_bf16 v[136:139], v[100:103], v[28:31], v[136:139]
    v_mfma_f32_16x16x32_bf16 v[172:175], v[100:103], v[32:35], v[172:175]
    ds_read_b64_tr_b16 v[70:71], v15 offset:4864
    v_mfma_f32_16x16x32_bf16 v[140:143], v[104:107], v[28:31], v[140:143]
    v_mfma_f32_16x16x32_bf16 v[176:179], v[104:107], v[32:35], v[176:179]
    s_waitcnt lgkmcnt(15)
    v_mfma_f32_16x16x32_bf16 v[108:111], v[36:39], v[20:23], v[108:111]
    v_mfma_f32_16x16x32_bf16 v[144:147], v[36:39], v[24:27], v[144:147]
    ds_read_b64 v[28:29], v13 offset:0
    ds_read_b64 v[30:31], v14 offset:0
    ds_read_b64 v[32:33], v13 offset:2048
    s_waitcnt lgkmcnt(15)
    v_mfma_f32_16x16x32_bf16 v[112:115], v[40:43], v[20:23], v[112:115]
    v_mfma_f32_16x16x32_bf16 v[148:151], v[40:43], v[24:27], v[148:151]
    ds_read_b64 v[34:35], v14 offset:2048
    ds_read_b64_tr_b16 v[72:73], v15 offset:9216
    ds_read_b64_tr_b16 v[74:75], v15 offset:13824
    v_mfma_f32_16x16x32_bf16 v[116:119], v[44:47], v[20:23], v[116:119]
    v_mfma_f32_16x16x32_bf16 v[152:155], v[44:47], v[24:27], v[152:155]
    ds_read_b64_tr_b16 v[76:77], v15 offset:9248
    ds_read_b64_tr_b16 v[78:79], v15 offset:13856
    ds_read_b64_tr_b16 v[80:81], v15 offset:9280
    s_waitcnt lgkmcnt(15)
    v_mfma_f32_16x16x32_bf16 v[120:123], v[48:51], v[20:23], v[120:123]
    v_mfma_f32_16x16x32_bf16 v[156:159], v[48:51], v[24:27], v[156:159]
    ds_read_b64_tr_b16 v[82:83], v15 offset:13888
    ds_read_b64_tr_b16 v[84:85], v15 offset:9312
    ds_read_b64_tr_b16 v[86:87], v15 offset:13920
    v_mfma_f32_16x16x32_bf16 v[124:127], v[52:55], v[20:23], v[124:127]
    v_mfma_f32_16x16x32_bf16 v[160:163], v[52:55], v[24:27], v[160:163]
    ds_read_b64_tr_b16 v[88:89], v15 offset:9344
    ds_read_b64_tr_b16 v[90:91], v15 offset:13952
    ds_read_b64_tr_b16 v[92:93], v15 offset:9376
    v_mfma_f32_16x16x32_bf16 v[128:131], v[56:59], v[20:23], v[128:131]
    v_mfma_f32_16x16x32_bf16 v[164:167], v[56:59], v[24:27], v[164:167]
    ds_read_b64_tr_b16 v[94:95], v15 offset:13984
    ds_read_b64_tr_b16 v[96:97], v15 offset:9408
    ds_read_b64_tr_b16 v[98:99], v15 offset:14016
    s_waitcnt lgkmcnt(15)
    v_mfma_f32_16x16x32_bf16 v[132:135], v[60:63], v[20:23], v[132:135]
    v_mfma_f32_16x16x32_bf16 v[168:171], v[60:63], v[24:27], v[168:171]
    ds_read_b64_tr_b16 v[100:101], v15 offset:9440
    ds_read_b64_tr_b16 v[102:103], v15 offset:14048
    ds_read_b64_tr_b16 v[104:105], v15 offset:9472
    v_mfma_f32_16x16x32_bf16 v[136:139], v[64:67], v[20:23], v[136:139]
    v_mfma_f32_16x16x32_bf16 v[172:175], v[64:67], v[24:27], v[172:175]
    ds_read_b64_tr_b16 v[106:107], v15 offset:14080
    v_mfma_f32_16x16x32_bf16 v[140:143], v[68:71], v[20:23], v[140:143]
    v_mfma_f32_16x16x32_bf16 v[176:179], v[68:71], v[24:27], v[176:179]
    s_waitcnt lgkmcnt(0)
    s_waitcnt vmcnt(0)
    s_barrier
    s_add_u32 s4, s4, 128
    s_addc_u32 s5, s5, 0
    s_add_u32 s6, s6, s18
    s_addc_u32 s7, s7, 0
    s_lshl_b32 s9, s8, 12
    s_add_u32 m0, s9, 0
    s_nop 0
    global_load_lds_dwordx4 v2, s[4:5]
    s_lshl_b32 s9, s8, 12
    s_add_u32 m0, s9, 1024
    s_nop 0
    global_load_lds_dwordx4 v3, s[4:5]
    s_lshl_b32 s9, s8, 12
    s_add_u32 m0, s9, 2048
    s_nop 0
    global_load_lds_dwordx4 v4, s[4:5]
    s_lshl_b32 s9, s8, 12
    s_add_u32 m0, s9, 3072
    s_nop 0
    global_load_lds_dwordx4 v5, s[4:5]
    s_mul_i32 s9, s8, 4608
    s_add_u32 m0, s9, 16384
    s_nop 0
    global_load_lds_dwordx4 v6, s[6:7]
    s_mul_i32 s9, s8, 4608
    s_add_u32 m0, s9, 17408
    s_nop 0
    global_load_lds_dwordx4 v7, s[6:7]
    s_mul_i32 s9, s8, 4608
    s_add_u32 m0, s9, 18432
    s_nop 0
    global_load_lds_dwordx4 v8, s[6:7]
    s_mul_i32 s9, s8, 4608
    s_add_u32 m0, s9, 19456
    s_nop 0
    global_load_lds_dwordx4 v9, s[6:7]
    s_mul_i32 s9, s8, 4608
    s_add_u32 m0, s9, 20480
    s_mov_b32 exec_hi, 0
    global_load_lds_dwordx4 v10, s[6:7]
    s_mov_b64 exec, -1
    v_mfma_f32_16x16x32_bf16 v[108:111], v[72:75], v[28:31], v[108:111]
    v_mfma_f32_16x16x32_bf16 v[144:147], v[72:75], v[32:35], v[144:147]
    ds_read_b64 v[20:21], v11 offset:34816
    ds_read_b64 v[22:23], v12 offset:34816
    ds_read_b64 v[24:25], v11 offset:36864
    v_mfma_f32_16x16x32_bf16 v[112:115], v[76:79], v[28:31], v[112:115]
    v_mfma_f32_16x16x32_bf16 v[148:151], v[76:79], v[32:35], v[148:151]
    ds_read_b64 v[26:27], v12 offset:36864
    ds_read_b64_tr_b16 v[36:37], v15 offset:34816
    ds_read_b64_tr_b16 v[38:39], v15 offset:39424
    v_mfma_f32_16x16x32_bf16 v[116:119], v[80:83], v[28:31], v[116:119]
    v_mfma_f32_16x16x32_bf16 v[152:155], v[80:83], v[32:35], v[152:155]
    ds_read_b64_tr_b16 v[40:41], v15 offset:34848
    ds_read_b64_tr_b16 v[42:43], v15 offset:39456
    ds_read_b64_tr_b16 v[44:45], v15 offset:34880
    v_mfma_f32_16x16x32_bf16 v[120:123], v[84:87], v[28:31], v[120:123]
    v_mfma_f32_16x16x32_bf16 v[156:159], v[84:87], v[32:35], v[156:159]
    ds_read_b64_tr_b16 v[46:47], v15 offset:39488
    ds_read_b64_tr_b16 v[48:49], v15 offset:34912
    ds_read_b64_tr_b16 v[50:51], v15 offset:39520
    v_mfma_f32_16x16x32_bf16 v[124:127], v[88:91], v[28:31], v[124:127]
    v_mfma_f32_16x16x32_bf16 v[160:163], v[88:91], v[32:35], v[160:163]
    ds_read_b64_tr_b16 v[52:53], v15 offset:34944
    ds_read_b64_tr_b16 v[54:55], v15 offset:39552
    ds_read_b64_tr_b16 v[56:57], v15 offset:34976
    v_mfma_f32_16x16x32_bf16 v[128:131], v[92:95], v[28:31], v[128:131]
    v_mfma_f32_16x16x32_bf16 v[164:167], v[92:95], v[32:35], v[164:167]
    ds_read_b64_tr_b16 v[58:59], v15 offset:39584
    ds_read_b64_tr_b16 v[60:61], v15 offset:35008
    ds_read_b64_tr_b16 v[62:63], v15 offset:39616
    v_mfma_f32_16x16x32_bf16 v[132:135], v[96:99], v[28:31], v[132:135]
    v_mfma_f32_16x16x32_bf16 v[168:171], v[96:99], v[32:35], v[168:171]
    ds_read_b64_tr_b16 v[64:65], v15 offset:35040
    ds_read_b64_tr_b16 v[66:67], v15 offset:39648
    ds_read_b64_tr_b16 v[68:69], v15 offset:35072
    v_mfma_f32_16x16x32_bf16 v[136:139], v[100:103], v[28:31], v[136:139]
    v_mfma_f32_16x16x32_bf16 v[172:175], v[100:103], v[32:35], v[172:175]
    ds_read_b64_tr_b16 v[70:71], v15 offset:39680
    v_mfma_f32_16x16x32_bf16 v[140:143], v[104:107], v[28:31], v[140:143]
    v_mfma_f32_16x16x32_bf16 v[176:179], v[104:107], v[32:35], v[176:179]
    s_waitcnt lgkmcnt(15)
    v_mfma_f32_16x16x32_bf16 v[108:111], v[36:39], v[20:23], v[108:111]
    v_mfma_f32_16x16x32_bf16 v[144:147], v[36:39], v[24:27], v[144:147]
    ds_read_b64 v[28:29], v13 offset:34816
    ds_read_b64 v[30:31], v14 offset:34816
    ds_read_b64 v[32:33], v13 offset:36864
    s_waitcnt lgkmcnt(15)
    v_mfma_f32_16x16x32_bf16 v[112:115], v[40:43], v[20:23], v[112:115]
    v_mfma_f32_16x16x32_bf16 v[148:151], v[40:43], v[24:27], v[148:151]
    ds_read_b64 v[34:35], v14 offset:36864
    ds_read_b64_tr_b16 v[72:73], v15 offset:44032
    ds_read_b64_tr_b16 v[74:75], v15 offset:48640
    v_mfma_f32_16x16x32_bf16 v[116:119], v[44:47], v[20:23], v[116:119]
    v_mfma_f32_16x16x32_bf16 v[152:155], v[44:47], v[24:27], v[152:155]
    ds_read_b64_tr_b16 v[76:77], v15 offset:44064
    ds_read_b64_tr_b16 v[78:79], v15 offset:48672
    ds_read_b64_tr_b16 v[80:81], v15 offset:44096
    s_waitcnt lgkmcnt(15)
    v_mfma_f32_16x16x32_bf16 v[120:123], v[48:51], v[20:23], v[120:123]
    v_mfma_f32_16x16x32_bf16 v[156:159], v[48:51], v[24:27], v[156:159]
    ds_read_b64_tr_b16 v[82:83], v15 offset:48704
    ds_read_b64_tr_b16 v[84:85], v15 offset:44128
    ds_read_b64_tr_b16 v[86:87], v15 offset:48736
    v_mfma_f32_16x16x32_bf16 v[124:127], v[52:55], v[20:23], v[124:127]
    v_mfma_f32_16x16x32_bf16 v[160:163], v[52:55], v[24:27], v[160:163]
    ds_read_b64_tr_b16 v[88:89], v15 offset:44160
    ds_read_b64_tr_b16 v[90:91], v15 offset:48768
    ds_read_b64_tr_b16 v[92:93], v15 offset:44192
    v_mfma_f32_16x16x32_bf16 v[128:131], v[56:59], v[20:23], v[128:131]
    v_mfma_f32_16x16x32_bf16 v[164:167], v[56:59], v[24:27], v[164:167]
    ds_read_b64_tr_b16 v[94:95], v15 offset:48800
    ds_read_b64_tr_b16 v[96:97], v15 offset:44224
    ds_read_b64_tr_b16 v[98:99], v15 offset:48832
    s_waitcnt lgkmcnt(15)
    v_mfma_f32_16x16x32_bf16 v[132:135], v[60:63], v[20:23], v[132:135]
    v_mfma_f32_16x16x32_bf16 v[168:171], v[60:63], v[24:27], v[168:171]
    ds_read_b64_tr_b16 v[100:101], v15 offset:44256
    ds_read_b64_tr_b16 v[102:103], v15 offset:48864
    ds_read_b64_tr_b16 v[104:105], v15 offset:44288
    v_mfma_f32_16x16x32_bf16 v[136:139], v[64:67], v[20:23], v[136:139]
    v_mfma_f32_16x16x32_bf16 v[172:175], v[64:67], v[24:27], v[172:175]
    ds_read_b64_tr_b16 v[106:107], v15 offset:48896
    v_mfma_f32_16x16x32_bf16 v[140:143], v[68:71], v[20:23], v[140:143]
    v_mfma_f32_16x16x32_bf16 v[176:179], v[68:71], v[24:27], v[176:179]
    s_waitcnt lgkmcnt(0)
    s_waitcnt vmcnt(0)
    s_barrier
    s_add_u32 s4, s4, 128
    s_addc_u32 s5, s5, 0
    s_add_u32 s6, s6, s18
    s_addc_u32 s7, s7, 0
    s_lshl_b32 s9, s8, 12
    s_add_u32 m0, s9, 34816
    s_nop 0
    global_load_lds_dwordx4 v2, s[4:5]
    s_lshl_b32 s9, s8, 12
    s_add_u32 m0, s9, 35840
    s_nop 0
    global_load_lds_dwordx4 v3, s[4:5]
    s_lshl_b32 s9, s8, 12
    s_add_u32 m0, s9, 36864
    s_nop 0
    global_load_lds_dwordx4 v4, s[4:5]
    s_lshl_b32 s9, s8, 12
    s_add_u32 m0, s9, 37888
    s_nop 0
    global_load_lds_dwordx4 v5, s[4:5]
    s_mul_i32 s9, s8, 4608
    s_add_u32 m0, s9, 51200
    s_nop 0
    global_load_lds_dwordx4 v6, s[6:7]
    s_mul_i32 s9, s8, 4608
    s_add_u32 m0, s9, 52224
    s_nop 0
    global_load_lds_dwordx4 v7, s[6:7]
    s_mul_i32 s9, s8, 4608
    s_add_u32 m0, s9, 53248
    s_nop 0
    global_load_lds_dwordx4 v8, s[6:7]
    s_mul_i32 s9, s8, 4608
    s_add_u32 m0, s9, 54272
    s_nop 0
    global_load_lds_dwordx4 v9, s[6:7]
    s_mul_i32 s9, s8, 4608
    s_add_u32 m0, s9, 55296
    s_mov_b32 exec_hi, 0
    global_load_lds_dwordx4 v10, s[6:7]
    s_mov_b64 exec, -1
    v_mfma_f32_16x16x32_bf16 v[108:111], v[72:75], v[28:31], v[108:111]
    v_mfma_f32_16x16x32_bf16 v[144:147], v[72:75], v[32:35], v[144:147]
    ds_read_b64 v[20:21], v11 offset:0
    ds_read_b64 v[22:23], v12 offset:0
    ds_read_b64 v[24:25], v11 offset:2048
    v_mfma_f32_16x16x32_bf16 v[112:115], v[76:79], v[28:31], v[112:115]
    v_mfma_f32_16x16x32_bf16 v[148:151], v[76:79], v[32:35], v[148:151]
    ds_read_b64 v[26:27], v12 offset:2048
    ds_read_b64_tr_b16 v[36:37], v15 offset:0
    ds_read_b64_tr_b16 v[38:39], v15 offset:4608
    v_mfma_f32_16x16x32_bf16 v[116:119], v[80:83], v[28:31], v[116:119]
    v_mfma_f32_16x16x32_bf16 v[152:155], v[80:83], v[32:35], v[152:155]
    ds_read_b64_tr_b16 v[40:41], v15 offset:32
    ds_read_b64_tr_b16 v[42:43], v15 offset:4640
    ds_read_b64_tr_b16 v[44:45], v15 offset:64
    v_mfma_f32_16x16x32_bf16 v[120:123], v[84:87], v[28:31], v[120:123]
    v_mfma_f32_16x16x32_bf16 v[156:159], v[84:87], v[32:35], v[156:159]
    ds_read_b64_tr_b16 v[46:47], v15 offset:4672
    ds_read_b64_tr_b16 v[48:49], v15 offset:96
    ds_read_b64_tr_b16 v[50:51], v15 offset:4704
    v_mfma_f32_16x16x32_bf16 v[124:127], v[88:91], v[28:31], v[124:127]
    v_mfma_f32_16x16x32_bf16 v[160:163], v[88:91], v[32:35], v[160:163]
    ds_read_b64_tr_b16 v[52:53], v15 offset:128
    ds_read_b64_tr_b16 v[54:55], v15 offset:4736
    ds_read_b64_tr_b16 v[56:57], v15 offset:160
    v_mfma_f32_16x16x32_bf16 v[128:131], v[92:95], v[28:31], v[128:131]
    v_mfma_f32_16x16x32_bf16 v[164:167], v[92:95], v[32:35], v[164:167]
    ds_read_b64_tr_b16 v[58:59], v15 offset:4768
    ds_read_b64_tr_b16 v[60:61], v15 offset:192
    ds_read_b64_tr_b16 v[62:63], v15 offset:4800
    v_mfma_f32_16x16x32_bf16 v[132:135], v[96:99], v[28:31], v[132:135]
    v_mfma_f32_16x16x32_bf16 v[168:171], v[96:99], v[32:35], v[168:171]
    ds_read_b64_tr_b16 v[64:65], v15 offset:224
    ds_read_b64_tr_b16 v[66:67], v15 offset:4832
    ds_read_b64_tr_b16 v[68:69], v15 offset:256
    v_mfma_f32_16x16x32_bf16 v[136:139], v[100:103], v[28:31], v[136:139]
    v_mfma_f32_16x16x32_bf16 v[172:175], v[100:103], v[32:35], v[172:175]
    ds_read_b64_tr_b16 v[70:71], v15 offset:4864
    v_mfma_f32_16x16x32_bf16 v[140:143], v[104:107], v[28:31], v[140:143]
    v_mfma_f32_16x16x32_bf16 v[176:179], v[104:107], v[32:35], v[176:179]
    s_waitcnt lgkmcnt(15)
    v_mfma_f32_16x16x32_bf16 v[108:111], v[36:39], v[20:23], v[108:111]
    v_mfma_f32_16x16x32_bf16 v[144:147], v[36:39], v[24:27], v[144:147]
    ds_read_b64 v[28:29], v13 offset:0
    ds_read_b64 v[30:31], v14 offset:0
    ds_read_b64 v[32:33], v13 offset:2048
    s_waitcnt lgkmcnt(15)
    v_mfma_f32_16x16x32_bf16 v[112:115], v[40:43], v[20:23], v[112:115]
    v_mfma_f32_16x16x32_bf16 v[148:151], v[40:43], v[24:27], v[148:151]
    ds_read_b64 v[34:35], v14 offset:2048
    ds_read_b64_tr_b16 v[72:73], v15 offset:9216
    ds_read_b64_tr_b16 v[74:75], v15 offset:13824
    v_mfma_f32_16x16x32_bf16 v[116:119], v[44:47], v[20:23], v[116:119]
    v_mfma_f32_16x16x32_bf16 v[152:155], v[44:47], v[24:27], v[152:155]
    ds_read_b64_tr_b16 v[76:77], v15 offset:9248
    ds_read_b64_tr_b16 v[78:79], v15 offset:13856
    ds_read_b64_tr_b16 v[80:81], v15 offset:9280
    s_waitcnt lgkmcnt(15)
    v_mfma_f32_16x16x32_bf16 v[120:123], v[48:51], v[20:23], v[120:123]
    v_mfma_f32_16x16x32_bf16 v[156:159], v[48:51], v[24:27], v[156:159]
    ds_read_b64_tr_b16 v[82:83], v15 offset:13888
    ds_read_b64_tr_b16 v[84:85], v15 offset:9312
    ds_read_b64_tr_b16 v[86:87], v15 offset:13920
    v_mfma_f32_16x16x32_bf16 v[124:127], v[52:55], v[20:23], v[124:127]
    v_mfma_f32_16x16x32_bf16 v[160:163], v[52:55], v[24:27], v[160:163]
    ds_read_b64_tr_b16 v[88:89], v15 offset:9344
    ds_read_b64_tr_b16 v[90:91], v15 offset:13952
    ds_read_b64_tr_b16 v[92:93], v15 offset:9376
    v_mfma_f32_16x16x32_bf16 v[128:131], v[56:59], v[20:23], v[128:131]
    v_mfma_f32_16x16x32_bf16 v[164:167], v[56:59], v[24:27], v[164:167]
    ds_read_b64_tr_b16 v[94:95], v15 offset:13984
    ds_read_b64_tr_b16 v[96:97], v15 offset:9408
    ds_read_b64_tr_b16 v[98:99], v15 offset:14016
    s_waitcnt lgkmcnt(15)
    v_mfma_f32_16x16x32_bf16 v[132:135], v[60:63], v[20:23], v[132:135]
    v_mfma_f32_16x16x32_bf16 v[168:171], v[60:63], v[24:27], v[168:171]
    ds_read_b64_tr_b16 v[100:101], v15 offset:9440
    ds_read_b64_tr_b16 v[102:103], v15 offset:14048
    ds_read_b64_tr_b16 v[104:105], v15 offset:9472
    v_mfma_f32_16x16x32_bf16 v[136:139], v[64:67], v[20:23], v[136:139]
    v_mfma_f32_16x16x32_bf16 v[172:175], v[64:67], v[24:27], v[172:175]
    ds_read_b64_tr_b16 v[106:107], v15 offset:14080
    v_mfma_f32_16x16x32_bf16 v[140:143], v[68:71], v[20:23], v[140:143]
    v_mfma_f32_16x16x32_bf16 v[176:179], v[68:71], v[24:27], v[176:179]
    s_waitcnt lgkmcnt(0)
    s_waitcnt vmcnt(0)
    s_barrier
    s_add_u32 s4, s4, 128
    s_addc_u32 s5, s5, 0
    s_add_u32 s6, s6, s18
    s_addc_u32 s7, s7, 0
    s_lshl_b32 s9, s8, 12
    s_add_u32 m0, s9, 0
    s_nop 0
    global_load_lds_dwordx4 v2, s[4:5]
    s_lshl_b32 s9, s8, 12
    s_add_u32 m0, s9, 1024
    s_nop 0
    global_load_lds_dwordx4 v3, s[4:5]
    s_lshl_b32 s9, s8, 12
    s_add_u32 m0, s9, 2048
    s_nop 0
    global_load_lds_dwordx4 v4, s[4:5]
    s_lshl_b32 s9, s8, 12
    s_add_u32 m0, s9, 3072
    s_nop 0
    global_load_lds_dwordx4 v5, s[4:5]
    s_mul_i32 s9, s8, 4608
    s_add_u32 m0, s9, 16384
    s_nop 0
    global_load_lds_dwordx4 v6, s[6:7]
    s_mul_i32 s9, s8, 4608
    s_add_u32 m0, s9, 17408
    s_nop 0
    global_load_lds_dwordx4 v7, s[6:7]
    s_mul_i32 s9, s8, 4608
    s_add_u32 m0, s9, 18432
    s_nop 0
    global_load_lds_dwordx4 v8, s[6:7]
    s_mul_i32 s9, s8, 4608
    s_add_u32 m0, s9, 19456
    s_nop 0
    global_load_lds_dwordx4 v9, s[6:7]
    s_mul_i32 s9, s8, 4608
    s_add_u32 m0, s9, 20480
    s_mov_b32 exec_hi, 0
    global_load_lds_dwordx4 v10, s[6:7]
    s_mov_b64 exec, -1
    v_mfma_f32_16x16x32_bf16 v[108:111], v[72:75], v[28:31], v[108:111]
    v_mfma_f32_16x16x32_bf16 v[144:147], v[72:75], v[32:35], v[144:147]
    ds_read_b64 v[20:21], v11 offset:34816
    ds_read_b64 v[22:23], v12 offset:34816
    ds_read_b64 v[24:25], v11 offset:36864
    v_mfma_f32_16x16x32_bf16 v[112:115], v[76:79], v[28:31], v[112:115]
    v_mfma_f32_16x16x32_bf16 v[148:151], v[76:79], v[32:35], v[148:151]
    ds_read_b64 v[26:27], v12 offset:36864
    ds_read_b64_tr_b16 v[36:37], v15 offset:34816
    ds_read_b64_tr_b16 v[38:39], v15 offset:39424
    v_mfma_f32_16x16x32_bf16 v[116:119], v[80:83], v[28:31], v[116:119]
    v_mfma_f32_16x16x32_bf16 v[152:155], v[80:83], v[32:35], v[152:155]
    ds_read_b64_tr_b16 v[40:41], v15 offset:34848
    ds_read_b64_tr_b16 v[42:43], v15 offset:39456
    ds_read_b64_tr_b16 v[44:45], v15 offset:34880
    v_mfma_f32_16x16x32_bf16 v[120:123], v[84:87], v[28:31], v[120:123]
    v_mfma_f32_16x16x32_bf16 v[156:159], v[84:87], v[32:35], v[156:159]
    ds_read_b64_tr_b16 v[46:47], v15 offset:39488
    ds_read_b64_tr_b16 v[48:49], v15 offset:34912
    ds_read_b64_tr_b16 v[50:51], v15 offset:39520
    v_mfma_f32_16x16x32_bf16 v[124:127], v[88:91], v[28:31], v[124:127]
    v_mfma_f32_16x16x32_bf16 v[160:163], v[88:91], v[32:35], v[160:163]
    ds_read_b64_tr_b16 v[52:53], v15 offset:34944
    ds_read_b64_tr_b16 v[54:55], v15 offset:39552
    ds_read_b64_tr_b16 v[56:57], v15 offset:34976
    v_mfma_f32_16x16x32_bf16 v[128:131], v[92:95], v[28:31], v[128:131]
    v_mfma_f32_16x16x32_bf16 v[164:167], v[92:95], v[32:35], v[164:167]
    ds_read_b64_tr_b16 v[58:59], v15 offset:39584
    ds_read_b64_tr_b16 v[60:61], v15 offset:35008
    ds_read_b64_tr_b16 v[62:63], v15 offset:39616
    v_mfma_f32_16x16x32_bf16 v[132:135], v[96:99], v[28:31], v[132:135]
    v_mfma_f32_16x16x32_bf16 v[168:171], v[96:99], v[32:35], v[168:171]
    ds_read_b64_tr_b16 v[64:65], v15 offset:35040
    ds_read_b64_tr_b16 v[66:67], v15 offset:39648
    ds_read_b64_tr_b16 v[68:69], v15 offset:35072
    v_mfma_f32_16x16x32_bf16 v[136:139], v[100:103], v[28:31], v[136:139]
    v_mfma_f32_16x16x32_bf16 v[172:175], v[100:103], v[32:35], v[172:175]
    ds_read_b64_tr_b16 v[70:71], v15 offset:39680
    v_mfma_f32_16x16x32_bf16 v[140:143], v[104:107], v[28:31], v[140:143]
    v_mfma_f32_16x16x32_bf16 v[176:179], v[104:107], v[32:35], v[176:179]
    s_waitcnt lgkmcnt(15)
    v_mfma_f32_16x16x32_bf16 v[108:111], v[36:39], v[20:23], v[108:111]
    v_mfma_f32_16x16x32_bf16 v[144:147], v[36:39], v[24:27], v[144:147]
    ds_read_b64 v[28:29], v13 offset:34816
    ds_read_b64 v[30:31], v14 offset:34816
    ds_read_b64 v[32:33], v13 offset:36864
    s_waitcnt lgkmcnt(15)
    v_mfma_f32_16x16x32_bf16 v[112:115], v[40:43], v[20:23], v[112:115]
    v_mfma_f32_16x16x32_bf16 v[148:151], v[40:43], v[24:27], v[148:151]
    ds_read_b64 v[34:35], v14 offset:36864
    ds_read_b64_tr_b16 v[72:73], v15 offset:44032
    ds_read_b64_tr_b16 v[74:75], v15 offset:48640
    v_mfma_f32_16x16x32_bf16 v[116:119], v[44:47], v[20:23], v[116:119]
    v_mfma_f32_16x16x32_bf16 v[152:155], v[44:47], v[24:27], v[152:155]
    ds_read_b64_tr_b16 v[76:77], v15 offset:44064
    ds_read_b64_tr_b16 v[78:79], v15 offset:48672
    ds_read_b64_tr_b16 v[80:81], v15 offset:44096
    s_waitcnt lgkmcnt(15)
    v_mfma_f32_16x16x32_bf16 v[120:123], v[48:51], v[20:23], v[120:123]
    v_mfma_f32_16x16x32_bf16 v[156:159], v[48:51], v[24:27], v[156:159]
    ds_read_b64_tr_b16 v[82:83], v15 offset:48704
    ds_read_b64_tr_b16 v[84:85], v15 offset:44128
    ds_read_b64_tr_b16 v[86:87], v15 offset:48736
    v_mfma_f32_16x16x32_bf16 v[124:127], v[52:55], v[20:23], v[124:127]
    v_mfma_f32_16x16x32_bf16 v[160:163], v[52:55], v[24:27], v[160:163]
    ds_read_b64_tr_b16 v[88:89], v15 offset:44160
    ds_read_b64_tr_b16 v[90:91], v15 offset:48768
    ds_read_b64_tr_b16 v[92:93], v15 offset:44192
    v_mfma_f32_16x16x32_bf16 v[128:131], v[56:59], v[20:23], v[128:131]
    v_mfma_f32_16x16x32_bf16 v[164:167], v[56:59], v[24:27], v[164:167]
    ds_read_b64_tr_b16 v[94:95], v15 offset:48800
    ds_read_b64_tr_b16 v[96:97], v15 offset:44224
    ds_read_b64_tr_b16 v[98:99], v15 offset:48832
    s_waitcnt lgkmcnt(15)
    v_mfma_f32_16x16x32_bf16 v[132:135], v[60:63], v[20:23], v[132:135]
    v_mfma_f32_16x16x32_bf16 v[168:171], v[60:63], v[24:27], v[168:171]
    ds_read_b64_tr_b16 v[100:101], v15 offset:44256
    ds_read_b64_tr_b16 v[102:103], v15 offset:48864
    ds_read_b64_tr_b16 v[104:105], v15 offset:44288
    v_mfma_f32_16x16x32_bf16 v[136:139], v[64:67], v[20:23], v[136:139]
    v_mfma_f32_16x16x32_bf16 v[172:175], v[64:67], v[24:27], v[172:175]
    ds_read_b64_tr_b16 v[106:107], v15 offset:48896
    v_mfma_f32_16x16x32_bf16 v[140:143], v[68:71], v[20:23], v[140:143]
    v_mfma_f32_16x16x32_bf16 v[176:179], v[68:71], v[24:27], v[176:179]
    s_waitcnt lgkmcnt(0)
    s_waitcnt vmcnt(0)
    s_barrier
    v_mfma_f32_16x16x32_bf16 v[108:111], v[72:75], v[28:31], v[108:111]
    v_mfma_f32_16x16x32_bf16 v[144:147], v[72:75], v[32:35], v[144:147]
    ds_read_b64 v[20:21], v11 offset:0
    ds_read_b64 v[22:23], v12 offset:0
    ds_read_b64 v[24:25], v11 offset:2048
    v_mfma_f32_16x16x32_bf16 v[112:115], v[76:79], v[28:31], v[112:115]
    v_mfma_f32_16x16x32_bf16 v[148:151], v[76:79], v[32:35], v[148:151]
    ds_read_b64 v[26:27], v12 offset:2048
    ds_read_b64_tr_b16 v[36:37], v15 offset:0
    ds_read_b64_tr_b16 v[38:39], v15 offset:4608
    v_mfma_f32_16x16x32_bf16 v[116:119], v[80:83], v[28:31], v[116:119]
    v_mfma_f32_16x16x32_bf16 v[152:155], v[80:83], v[32:35], v[152:155]
    ds_read_b64_tr_b16 v[40:41], v15 offset:32
    ds_read_b64_tr_b16 v[42:43], v15 offset:4640
    ds_read_b64_tr_b16 v[44:45], v15 offset:64
    v_mfma_f32_16x16x32_bf16 v[120:123], v[84:87], v[28:31], v[120:123]
    v_mfma_f32_16x16x32_bf16 v[156:159], v[84:87], v[32:35], v[156:159]
    ds_read_b64_tr_b16 v[46:47], v15 offset:4672
    ds_read_b64_tr_b16 v[48:49], v15 offset:96
    ds_read_b64_tr_b16 v[50:51], v15 offset:4704
    v_mfma_f32_16x16x32_bf16 v[124:127], v[88:91], v[28:31], v[124:127]
    v_mfma_f32_16x16x32_bf16 v[160:163], v[88:91], v[32:35], v[160:163]
    ds_read_b64_tr_b16 v[52:53], v15 offset:128
    ds_read_b64_tr_b16 v[54:55], v15 offset:4736
    ds_read_b64_tr_b16 v[56:57], v15 offset:160
    v_mfma_f32_16x16x32_bf16 v[128:131], v[92:95], v[28:31], v[128:131]
    v_mfma_f32_16x16x32_bf16 v[164:167], v[92:95], v[32:35], v[164:167]
    ds_read_b64_tr_b16 v[58:59], v15 offset:4768
    ds_read_b64_tr_b16 v[60:61], v15 offset:192
    ds_read_b64_tr_b16 v[62:63], v15 offset:4800
    v_mfma_f32_16x16x32_bf16 v[132:135], v[96:99], v[28:31], v[132:135]
    v_mfma_f32_16x16x32_bf16 v[168:171], v[96:99], v[32:35], v[168:171]
    ds_read_b64_tr_b16 v[64:65], v15 offset:224
    ds_read_b64_tr_b16 v[66:67], v15 offset:4832
    ds_read_b64_tr_b16 v[68:69], v15 offset:256
    v_mfma_f32_16x16x32_bf16 v[136:139], v[100:103], v[28:31], v[136:139]
    v_mfma_f32_16x16x32_bf16 v[172:175], v[100:103], v[32:35], v[172:175]
    ds_read_b64_tr_b16 v[70:71], v15 offset:4864
    v_mfma_f32_16x16x32_bf16 v[140:143], v[104:107], v[28:31], v[140:143]
    v_mfma_f32_16x16x32_bf16 v[176:179], v[104:107], v[32:35], v[176:179]
    s_waitcnt lgkmcnt(15)
    v_mfma_f32_16x16x32_bf16 v[108:111], v[36:39], v[20:23], v[108:111]
    v_mfma_f32_16x16x32_bf16 v[144:147], v[36:39], v[24:27], v[144:147]
    ds_read_b64 v[28:29], v13 offset:0
    ds_read_b64 v[30:31], v14 offset:0
    ds_read_b64 v[32:33], v13 offset:2048
    s_waitcnt lgkmcnt(15)
    v_mfma_f32_16x16x32_bf16 v[112:115], v[40:43], v[20:23], v[112:115]
    v_mfma_f32_16x16x32_bf16 v[148:151], v[40:43], v[24:27], v[148:151]
    ds_read_b64 v[34:35], v14 offset:2048
    ds_read_b64_tr_b16 v[72:73], v15 offset:9216
    ds_read_b64_tr_b16 v[74:75], v15 offset:13824
    v_mfma_f32_16x16x32_bf16 v[116:119], v[44:47], v[20:23], v[116:119]
    v_mfma_f32_16x16x32_bf16 v[152:155], v[44:47], v[24:27], v[152:155]
    ds_read_b64_tr_b16 v[76:77], v15 offset:9248
    ds_read_b64_tr_b16 v[78:79], v15 offset:13856
    ds_read_b64_tr_b16 v[80:81], v15 offset:9280
    s_waitcnt lgkmcnt(15)
    v_mfma_f32_16x16x32_bf16 v[120:123], v[48:51], v[20:23], v[120:123]
    v_mfma_f32_16x16x32_bf16 v[156:159], v[48:51], v[24:27], v[156:159]
    ds_read_b64_tr_b16 v[82:83], v15 offset:13888
    ds_read_b64_tr_b16 v[84:85], v15 offset:9312
    ds_read_b64_tr_b16 v[86:87], v15 offset:13920
    v_mfma_f32_16x16x32_bf16 v[124:127], v[52:55], v[20:23], v[124:127]
    v_mfma_f32_16x16x32_bf16 v[160:163], v[52:55], v[24:27], v[160:163]
    ds_read_b64_tr_b16 v[88:89], v15 offset:9344
    ds_read_b64_tr_b16 v[90:91], v15 offset:13952
    ds_read_b64_tr_b16 v[92:93], v15 offset:9376
    v_mfma_f32_16x16x32_bf16 v[128:131], v[56:59], v[20:23], v[128:131]
    v_mfma_f32_16x16x32_bf16 v[164:167], v[56:59], v[24:27], v[164:167]
    ds_read_b64_tr_b16 v[94:95], v15 offset:13984
    ds_read_b64_tr_b16 v[96:97], v15 offset:9408
    ds_read_b64_tr_b16 v[98:99], v15 offset:14016
    s_waitcnt lgkmcnt(15)
    v_mfma_f32_16x16x32_bf16 v[132:135], v[60:63], v[20:23], v[132:135]
    v_mfma_f32_16x16x32_bf16 v[168:171], v[60:63], v[24:27], v[168:171]
    ds_read_b64_tr_b16 v[100:101], v15 offset:9440
    ds_read_b64_tr_b16 v[102:103], v15 offset:14048
    ds_read_b64_tr_b16 v[104:105], v15 offset:9472
    v_mfma_f32_16x16x32_bf16 v[136:139], v[64:67], v[20:23], v[136:139]
    v_mfma_f32_16x16x32_bf16 v[172:175], v[64:67], v[24:27], v[172:175]
    ds_read_b64_tr_b16 v[106:107], v15 offset:14080
    v_mfma_f32_16x16x32_bf16 v[140:143], v[68:71], v[20:23], v[140:143]
    v_mfma_f32_16x16x32_bf16 v[176:179], v[68:71], v[24:27], v[176:179]
    s_waitcnt lgkmcnt(15)
    v_mfma_f32_16x16x32_bf16 v[108:111], v[72:75], v[28:31], v[108:111]
    v_mfma_f32_16x16x32_bf16 v[144:147], v[72:75], v[32:35], v[144:147]
    s_waitcnt lgkmcnt(14)
    v_mfma_f32_16x16x32_bf16 v[112:115], v[76:79], v[28:31], v[112:115]
    v_mfma_f32_16x16x32_bf16 v[148:151], v[76:79], v[32:35], v[148:151]
    s_waitcnt lgkmcnt(12)
    v_mfma_f32_16x16x32_bf16 v[116:119], v[80:83], v[28:31], v[116:119]
    v_mfma_f32_16x16x32_bf16 v[152:155], v[80:83], v[32:35], v[152:155]
    s_waitcnt lgkmcnt(10)
    v_mfma_f32_16x16x32_bf16 v[120:123], v[84:87], v[28:31], v[120:123]
    v_mfma_f32_16x16x32_bf16 v[156:159], v[84:87], v[32:35], v[156:159]
    s_waitcnt lgkmcnt(8)
    v_mfma_f32_16x16x32_bf16 v[124:127], v[88:91], v[28:31], v[124:127]
    v_mfma_f32_16x16x32_bf16 v[160:163], v[88:91], v[32:35], v[160:163]
    s_waitcnt lgkmcnt(6)
    v_mfma_f32_16x16x32_bf16 v[128:131], v[92:95], v[28:31], v[128:131]
    v_mfma_f32_16x16x32_bf16 v[164:167], v[92:95], v[32:35], v[164:167]
    s_waitcnt lgkmcnt(4)
    v_mfma_f32_16x16x32_bf16 v[132:135], v[96:99], v[28:31], v[132:135]
    v_mfma_f32_16x16x32_bf16 v[168:171], v[96:99], v[32:35], v[168:171]
    s_waitcnt lgkmcnt(2)
    v_mfma_f32_16x16x32_bf16 v[136:139], v[100:103], v[28:31], v[136:139]
    v_mfma_f32_16x16x32_bf16 v[172:175], v[100:103], v[32:35], v[172:175]
    s_waitcnt lgkmcnt(0)
    v_mfma_f32_16x16x32_bf16 v[140:143], v[104:107], v[28:31], v[140:143]
    v_mfma_f32_16x16x32_bf16 v[176:179], v[104:107], v[32:35], v[176:179]
    s_nop 15
    v_lshrrev_b32 v18, 4, v1
    v_and_b32 v19, 15, v1
    s_lshl_b32 s9, s8, 5
    s_add_u32 s9, s9, s15
    v_add_u32 v19, s9, v19
    s_mov_b32 s14, 1152
    v_mul_lo_u32 v19, v19, s14
    v_mul_u32_u24 v18, 8, v18
    v_add_u32 v19, v19, v18
    v_add_u32 v16, s12, v19
    v_add_u32 v17, 18432, v16
    s_add_u32 s24, s24, 18874368
    s_addc_u32 s25, s25, 0
    v_cvt_pk_bf16_f32 v182, v108, v109
    v_cvt_pk_bf16_f32 v183, v110, v111
    v_lshlrev_b32 v184, 16, v182
    v_and_b32 v185, 0xffff0000, v182
    v_lshlrev_b32 v186, 16, v183
    v_and_b32 v187, 0xffff0000, v183
    v_mul_f32 v188, 0x3fb8aa3b, v184
    v_exp_f32 v188, v188
    v_add_f32 v189, 1.0, v184
    v_cmp_lt_f32 vcc, 0, v184
    s_nop 1
    v_cndmask_b32 v184, v188, v189, vcc
    v_mul_f32 v188, 0x3fb8aa3b, v185
    v_exp_f32 v188, v188
    v_add_f32 v189, 1.0, v185
    v_cmp_lt_f32 vcc, 0, v185
    s_nop 1
    v_cndmask_b32 v185, v188, v189, vcc
    v_mul_f32 v188, 0x3fb8aa3b, v186
    v_exp_f32 v188, v188
    v_add_f32 v189, 1.0, v186
    v_cmp_lt_f32 vcc, 0, v186
    s_nop 1
    v_cndmask_b32 v186, v188, v189, vcc
    v_mul_f32 v188, 0x3fb8aa3b, v187
    v_exp_f32 v188, v188
    v_add_f32 v189, 1.0, v187
    v_cmp_lt_f32 vcc, 0, v187
    s_nop 1
    v_cndmask_b32 v187, v188, v189, vcc
    v_cvt_pk_bf16_f32 v182, v184, v185
    v_cvt_pk_bf16_f32 v183, v186, v187
    v_lshlrev_b32 v184, 16, v182
    v_and_b32 v185, 0xffff0000, v182
    v_lshlrev_b32 v186, 16, v183
    v_and_b32 v187, 0xffff0000, v183
    v_add_f32 v184, 0x358637bd, v184
    v_add_f32 v185, 0x358637bd, v185
    v_add_f32 v186, 0x358637bd, v186
    v_add_f32 v187, 0x358637bd, v187
    v_cvt_pk_bf16_f32 v180, v184, v185
    v_cvt_pk_bf16_f32 v181, v186, v187
    global_store_dwordx2 v16, v[180:181], s[24:25] offset:0
    s_nop 1
    v_cvt_pk_bf16_f32 v182, v112, v113
    v_cvt_pk_bf16_f32 v183, v114, v115
    v_lshlrev_b32 v184, 16, v182
    v_and_b32 v185, 0xffff0000, v182
    v_lshlrev_b32 v186, 16, v183
    v_and_b32 v187, 0xffff0000, v183
    v_mul_f32 v188, 0x3fb8aa3b, v184
    v_exp_f32 v188, v188
    v_add_f32 v189, 1.0, v184
    v_cmp_lt_f32 vcc, 0, v184
    s_nop 1
    v_cndmask_b32 v184, v188, v189, vcc
    v_mul_f32 v188, 0x3fb8aa3b, v185
    v_exp_f32 v188, v188
    v_add_f32 v189, 1.0, v185
    v_cmp_lt_f32 vcc, 0, v185
    s_nop 1
    v_cndmask_b32 v185, v188, v189, vcc
    v_mul_f32 v188, 0x3fb8aa3b, v186
    v_exp_f32 v188, v188
    v_add_f32 v189, 1.0, v186
    v_cmp_lt_f32 vcc, 0, v186
    s_nop 1
    v_cndmask_b32 v186, v188, v189, vcc
    v_mul_f32 v188, 0x3fb8aa3b, v187
    v_exp_f32 v188, v188
    v_add_f32 v189, 1.0, v187
    v_cmp_lt_f32 vcc, 0, v187
    s_nop 1
    v_cndmask_b32 v187, v188, v189, vcc
    v_cvt_pk_bf16_f32 v182, v184, v185
    v_cvt_pk_bf16_f32 v183, v186, v187
    v_lshlrev_b32 v184, 16, v182
    v_and_b32 v185, 0xffff0000, v182
    v_lshlrev_b32 v186, 16, v183
    v_and_b32 v187, 0xffff0000, v183
    v_add_f32 v184, 0x358637bd, v184
    v_add_f32 v185, 0x358637bd, v185
    v_add_f32 v186, 0x358637bd, v186
    v_add_f32 v187, 0x358637bd, v187
    v_cvt_pk_bf16_f32 v180, v184, v185
    v_cvt_pk_bf16_f32 v181, v186, v187
    global_store_dwordx2 v16, v[180:181], s[24:25] offset:32
    s_nop 1
    v_cvt_pk_bf16_f32 v182, v116, v117
    v_cvt_pk_bf16_f32 v183, v118, v119
    v_lshlrev_b32 v184, 16, v182
    v_and_b32 v185, 0xffff0000, v182
    v_lshlrev_b32 v186, 16, v183
    v_and_b32 v187, 0xffff0000, v183
    v_mul_f32 v188, 0x3fb8aa3b, v184
    v_exp_f32 v188, v188
    v_add_f32 v189, 1.0, v184
    v_cmp_lt_f32 vcc, 0, v184
    s_nop 1
    v_cndmask_b32 v184, v188, v189, vcc
    v_mul_f32 v188, 0x3fb8aa3b, v185
    v_exp_f32 v188, v188
    v_add_f32 v189, 1.0, v185
    v_cmp_lt_f32 vcc, 0, v185
    s_nop 1
    v_cndmask_b32 v185, v188, v189, vcc
    v_mul_f32 v188, 0x3fb8aa3b, v186
    v_exp_f32 v188, v188
    v_add_f32 v189, 1.0, v186
    v_cmp_lt_f32 vcc, 0, v186
    s_nop 1
    v_cndmask_b32 v186, v188, v189, vcc
    v_mul_f32 v188, 0x3fb8aa3b, v187
    v_exp_f32 v188, v188
    v_add_f32 v189, 1.0, v187
    v_cmp_lt_f32 vcc, 0, v187
    s_nop 1
    v_cndmask_b32 v187, v188, v189, vcc
    v_cvt_pk_bf16_f32 v182, v184, v185
    v_cvt_pk_bf16_f32 v183, v186, v187
    v_lshlrev_b32 v184, 16, v182
    v_and_b32 v185, 0xffff0000, v182
    v_lshlrev_b32 v186, 16, v183
    v_and_b32 v187, 0xffff0000, v183
    v_add_f32 v184, 0x358637bd, v184
    v_add_f32 v185, 0x358637bd, v185
    v_add_f32 v186, 0x358637bd, v186
    v_add_f32 v187, 0x358637bd, v187
    v_cvt_pk_bf16_f32 v180, v184, v185
    v_cvt_pk_bf16_f32 v181, v186, v187
    global_store_dwordx2 v16, v[180:181], s[24:25] offset:64
    s_nop 1
    v_cvt_pk_bf16_f32 v182, v120, v121
    v_cvt_pk_bf16_f32 v183, v122, v123
    v_lshlrev_b32 v184, 16, v182
    v_and_b32 v185, 0xffff0000, v182
    v_lshlrev_b32 v186, 16, v183
    v_and_b32 v187, 0xffff0000, v183
    v_mul_f32 v188, 0x3fb8aa3b, v184
    v_exp_f32 v188, v188
    v_add_f32 v189, 1.0, v184
    v_cmp_lt_f32 vcc, 0, v184
    s_nop 1
    v_cndmask_b32 v184, v188, v189, vcc
    v_mul_f32 v188, 0x3fb8aa3b, v185
    v_exp_f32 v188, v188
    v_add_f32 v189, 1.0, v185
    v_cmp_lt_f32 vcc, 0, v185
    s_nop 1
    v_cndmask_b32 v185, v188, v189, vcc
    v_mul_f32 v188, 0x3fb8aa3b, v186
    v_exp_f32 v188, v188
    v_add_f32 v189, 1.0, v186
    v_cmp_lt_f32 vcc, 0, v186
    s_nop 1
    v_cndmask_b32 v186, v188, v189, vcc
    v_mul_f32 v188, 0x3fb8aa3b, v187
    v_exp_f32 v188, v188
    v_add_f32 v189, 1.0, v187
    v_cmp_lt_f32 vcc, 0, v187
    s_nop 1
    v_cndmask_b32 v187, v188, v189, vcc
    v_cvt_pk_bf16_f32 v182, v184, v185
    v_cvt_pk_bf16_f32 v183, v186, v187
    v_lshlrev_b32 v184, 16, v182
    v_and_b32 v185, 0xffff0000, v182
    v_lshlrev_b32 v186, 16, v183
    v_and_b32 v187, 0xffff0000, v183
    v_add_f32 v184, 0x358637bd, v184
    v_add_f32 v185, 0x358637bd, v185
    v_add_f32 v186, 0x358637bd, v186
    v_add_f32 v187, 0x358637bd, v187
    v_cvt_pk_bf16_f32 v180, v184, v185
    v_cvt_pk_bf16_f32 v181, v186, v187
    global_store_dwordx2 v16, v[180:181], s[24:25] offset:96
    s_nop 1
    v_cvt_pk_bf16_f32 v182, v124, v125
    v_cvt_pk_bf16_f32 v183, v126, v127
    v_lshlrev_b32 v184, 16, v182
    v_and_b32 v185, 0xffff0000, v182
    v_lshlrev_b32 v186, 16, v183
    v_and_b32 v187, 0xffff0000, v183
    v_mul_f32 v188, 0x3fb8aa3b, v184
    v_exp_f32 v188, v188
    v_add_f32 v189, 1.0, v184
    v_cmp_lt_f32 vcc, 0, v184
    s_nop 1
    v_cndmask_b32 v184, v188, v189, vcc
    v_mul_f32 v188, 0x3fb8aa3b, v185
    v_exp_f32 v188, v188
    v_add_f32 v189, 1.0, v185
    v_cmp_lt_f32 vcc, 0, v185
    s_nop 1
    v_cndmask_b32 v185, v188, v189, vcc
    v_mul_f32 v188, 0x3fb8aa3b, v186
    v_exp_f32 v188, v188
    v_add_f32 v189, 1.0, v186
    v_cmp_lt_f32 vcc, 0, v186
    s_nop 1
    v_cndmask_b32 v186, v188, v189, vcc
    v_mul_f32 v188, 0x3fb8aa3b, v187
    v_exp_f32 v188, v188
    v_add_f32 v189, 1.0, v187
    v_cmp_lt_f32 vcc, 0, v187
    s_nop 1
    v_cndmask_b32 v187, v188, v189, vcc
    v_cvt_pk_bf16_f32 v182, v184, v185
    v_cvt_pk_bf16_f32 v183, v186, v187
    v_lshlrev_b32 v184, 16, v182
    v_and_b32 v185, 0xffff0000, v182
    v_lshlrev_b32 v186, 16, v183
    v_and_b32 v187, 0xffff0000, v183
    v_add_f32 v184, 0x358637bd, v184
    v_add_f32 v185, 0x358637bd, v185
    v_add_f32 v186, 0x358637bd, v186
    v_add_f32 v187, 0x358637bd, v187
    v_cvt_pk_bf16_f32 v180, v184, v185
    v_cvt_pk_bf16_f32 v181, v186, v187
    global_store_dwordx2 v16, v[180:181], s[24:25] offset:128
    s_nop 1
    v_cvt_pk_bf16_f32 v182, v128, v129
    v_cvt_pk_bf16_f32 v183, v130, v131
    v_lshlrev_b32 v184, 16, v182
    v_and_b32 v185, 0xffff0000, v182
    v_lshlrev_b32 v186, 16, v183
    v_and_b32 v187, 0xffff0000, v183
    v_mul_f32 v188, 0x3fb8aa3b, v184
    v_exp_f32 v188, v188
    v_add_f32 v189, 1.0, v184
    v_cmp_lt_f32 vcc, 0, v184
    s_nop 1
    v_cndmask_b32 v184, v188, v189, vcc
    v_mul_f32 v188, 0x3fb8aa3b, v185
    v_exp_f32 v188, v188
    v_add_f32 v189, 1.0, v185
    v_cmp_lt_f32 vcc, 0, v185
    s_nop 1
    v_cndmask_b32 v185, v188, v189, vcc
    v_mul_f32 v188, 0x3fb8aa3b, v186
    v_exp_f32 v188, v188
    v_add_f32 v189, 1.0, v186
    v_cmp_lt_f32 vcc, 0, v186
    s_nop 1
    v_cndmask_b32 v186, v188, v189, vcc
    v_mul_f32 v188, 0x3fb8aa3b, v187
    v_exp_f32 v188, v188
    v_add_f32 v189, 1.0, v187
    v_cmp_lt_f32 vcc, 0, v187
    s_nop 1
    v_cndmask_b32 v187, v188, v189, vcc
    v_cvt_pk_bf16_f32 v182, v184, v185
    v_cvt_pk_bf16_f32 v183, v186, v187
    v_lshlrev_b32 v184, 16, v182
    v_and_b32 v185, 0xffff0000, v182
    v_lshlrev_b32 v186, 16, v183
    v_and_b32 v187, 0xffff0000, v183
    v_add_f32 v184, 0x358637bd, v184
    v_add_f32 v185, 0x358637bd, v185
    v_add_f32 v186, 0x358637bd, v186
    v_add_f32 v187, 0x358637bd, v187
    v_cvt_pk_bf16_f32 v180, v184, v185
    v_cvt_pk_bf16_f32 v181, v186, v187
    global_store_dwordx2 v16, v[180:181], s[24:25] offset:160
    s_nop 1
    v_cvt_pk_bf16_f32 v182, v132, v133
    v_cvt_pk_bf16_f32 v183, v134, v135
    v_lshlrev_b32 v184, 16, v182
    v_and_b32 v185, 0xffff0000, v182
    v_lshlrev_b32 v186, 16, v183
    v_and_b32 v187, 0xffff0000, v183
    v_mul_f32 v188, 0x3fb8aa3b, v184
    v_exp_f32 v188, v188
    v_add_f32 v189, 1.0, v184
    v_cmp_lt_f32 vcc, 0, v184
    s_nop 1
    v_cndmask_b32 v184, v188, v189, vcc
    v_mul_f32 v188, 0x3fb8aa3b, v185
    v_exp_f32 v188, v188
    v_add_f32 v189, 1.0, v185
    v_cmp_lt_f32 vcc, 0, v185
    s_nop 1
    v_cndmask_b32 v185, v188, v189, vcc
    v_mul_f32 v188, 0x3fb8aa3b, v186
    v_exp_f32 v188, v188
    v_add_f32 v189, 1.0, v186
    v_cmp_lt_f32 vcc, 0, v186
    s_nop 1
    v_cndmask_b32 v186, v188, v189, vcc
    v_mul_f32 v188, 0x3fb8aa3b, v187
    v_exp_f32 v188, v188
    v_add_f32 v189, 1.0, v187
    v_cmp_lt_f32 vcc, 0, v187
    s_nop 1
    v_cndmask_b32 v187, v188, v189, vcc
    v_cvt_pk_bf16_f32 v182, v184, v185
    v_cvt_pk_bf16_f32 v183, v186, v187
    v_lshlrev_b32 v184, 16, v182
    v_and_b32 v185, 0xffff0000, v182
    v_lshlrev_b32 v186, 16, v183
    v_and_b32 v187, 0xffff0000, v183
    v_add_f32 v184, 0x358637bd, v184
    v_add_f32 v185, 0x358637bd, v185
    v_add_f32 v186, 0x358637bd, v186
    v_add_f32 v187, 0x358637bd, v187
    v_cvt_pk_bf16_f32 v180, v184, v185
    v_cvt_pk_bf16_f32 v181, v186, v187
    global_store_dwordx2 v16, v[180:181], s[24:25] offset:192
    s_nop 1
    v_cvt_pk_bf16_f32 v182, v136, v137
    v_cvt_pk_bf16_f32 v183, v138, v139
    v_lshlrev_b32 v184, 16, v182
    v_and_b32 v185, 0xffff0000, v182
    v_lshlrev_b32 v186, 16, v183
    v_and_b32 v187, 0xffff0000, v183
    v_mul_f32 v188, 0x3fb8aa3b, v184
    v_exp_f32 v188, v188
    v_add_f32 v189, 1.0, v184
    v_cmp_lt_f32 vcc, 0, v184
    s_nop 1
    v_cndmask_b32 v184, v188, v189, vcc
    v_mul_f32 v188, 0x3fb8aa3b, v185
    v_exp_f32 v188, v188
    v_add_f32 v189, 1.0, v185
    v_cmp_lt_f32 vcc, 0, v185
    s_nop 1
    v_cndmask_b32 v185, v188, v189, vcc
    v_mul_f32 v188, 0x3fb8aa3b, v186
    v_exp_f32 v188, v188
    v_add_f32 v189, 1.0, v186
    v_cmp_lt_f32 vcc, 0, v186
    s_nop 1
    v_cndmask_b32 v186, v188, v189, vcc
    v_mul_f32 v188, 0x3fb8aa3b, v187
    v_exp_f32 v188, v188
    v_add_f32 v189, 1.0, v187
    v_cmp_lt_f32 vcc, 0, v187
    s_nop 1
    v_cndmask_b32 v187, v188, v189, vcc
    v_cvt_pk_bf16_f32 v182, v184, v185
    v_cvt_pk_bf16_f32 v183, v186, v187
    v_lshlrev_b32 v184, 16, v182
    v_and_b32 v185, 0xffff0000, v182
    v_lshlrev_b32 v186, 16, v183
    v_and_b32 v187, 0xffff0000, v183
    v_add_f32 v184, 0x358637bd, v184
    v_add_f32 v185, 0x358637bd, v185
    v_add_f32 v186, 0x358637bd, v186
    v_add_f32 v187, 0x358637bd, v187
    v_cvt_pk_bf16_f32 v180, v184, v185
    v_cvt_pk_bf16_f32 v181, v186, v187
    global_store_dwordx2 v16, v[180:181], s[24:25] offset:224
    s_nop 1
    v_cvt_pk_bf16_f32 v182, v140, v141
    v_cvt_pk_bf16_f32 v183, v142, v143
    v_lshlrev_b32 v184, 16, v182
    v_and_b32 v185, 0xffff0000, v182
    v_lshlrev_b32 v186, 16, v183
    v_and_b32 v187, 0xffff0000, v183
    v_mul_f32 v188, 0x3fb8aa3b, v184
    v_exp_f32 v188, v188
    v_add_f32 v189, 1.0, v184
    v_cmp_lt_f32 vcc, 0, v184
    s_nop 1
    v_cndmask_b32 v184, v188, v189, vcc
    v_mul_f32 v188, 0x3fb8aa3b, v185
    v_exp_f32 v188, v188
    v_add_f32 v189, 1.0, v185
    v_cmp_lt_f32 vcc, 0, v185
    s_nop 1
    v_cndmask_b32 v185, v188, v189, vcc
    v_mul_f32 v188, 0x3fb8aa3b, v186
    v_exp_f32 v188, v188
    v_add_f32 v189, 1.0, v186
    v_cmp_lt_f32 vcc, 0, v186
    s_nop 1
    v_cndmask_b32 v186, v188, v189, vcc
    v_mul_f32 v188, 0x3fb8aa3b, v187
    v_exp_f32 v188, v188
    v_add_f32 v189, 1.0, v187
    v_cmp_lt_f32 vcc, 0, v187
    s_nop 1
    v_cndmask_b32 v187, v188, v189, vcc
    v_cvt_pk_bf16_f32 v182, v184, v185
    v_cvt_pk_bf16_f32 v183, v186, v187
    v_lshlrev_b32 v184, 16, v182
    v_and_b32 v185, 0xffff0000, v182
    v_lshlrev_b32 v186, 16, v183
    v_and_b32 v187, 0xffff0000, v183
    v_add_f32 v184, 0x358637bd, v184
    v_add_f32 v185, 0x358637bd, v185
    v_add_f32 v186, 0x358637bd, v186
    v_add_f32 v187, 0x358637bd, v187
    v_cvt_pk_bf16_f32 v180, v184, v185
    v_cvt_pk_bf16_f32 v181, v186, v187
    global_store_dwordx2 v16, v[180:181], s[24:25] offset:256
    s_nop 1
    v_cvt_pk_bf16_f32 v182, v144, v145
    v_cvt_pk_bf16_f32 v183, v146, v147
    v_lshlrev_b32 v184, 16, v182
    v_and_b32 v185, 0xffff0000, v182
    v_lshlrev_b32 v186, 16, v183
    v_and_b32 v187, 0xffff0000, v183
    v_mul_f32 v188, 0x3fb8aa3b, v184
    v_exp_f32 v188, v188
    v_add_f32 v189, 1.0, v184
    v_cmp_lt_f32 vcc, 0, v184
    s_nop 1
    v_cndmask_b32 v184, v188, v189, vcc
    v_mul_f32 v188, 0x3fb8aa3b, v185
    v_exp_f32 v188, v188
    v_add_f32 v189, 1.0, v185
    v_cmp_lt_f32 vcc, 0, v185
    s_nop 1
    v_cndmask_b32 v185, v188, v189, vcc
    v_mul_f32 v188, 0x3fb8aa3b, v186
    v_exp_f32 v188, v188
    v_add_f32 v189, 1.0, v186
    v_cmp_lt_f32 vcc, 0, v186
    s_nop 1
    v_cndmask_b32 v186, v188, v189, vcc
    v_mul_f32 v188, 0x3fb8aa3b, v187
    v_exp_f32 v188, v188
    v_add_f32 v189, 1.0, v187
    v_cmp_lt_f32 vcc, 0, v187
    s_nop 1
    v_cndmask_b32 v187, v188, v189, vcc
    v_cvt_pk_bf16_f32 v182, v184, v185
    v_cvt_pk_bf16_f32 v183, v186, v187
    v_lshlrev_b32 v184, 16, v182
    v_and_b32 v185, 0xffff0000, v182
    v_lshlrev_b32 v186, 16, v183
    v_and_b32 v187, 0xffff0000, v183
    v_add_f32 v184, 0x358637bd, v184
    v_add_f32 v185, 0x358637bd, v185
    v_add_f32 v186, 0x358637bd, v186
    v_add_f32 v187, 0x358637bd, v187
    v_cvt_pk_bf16_f32 v180, v184, v185
    v_cvt_pk_bf16_f32 v181, v186, v187
    global_store_dwordx2 v17, v[180:181], s[24:25] offset:0
    s_nop 1
    v_cvt_pk_bf16_f32 v182, v148, v149
    v_cvt_pk_bf16_f32 v183, v150, v151
    v_lshlrev_b32 v184, 16, v182
    v_and_b32 v185, 0xffff0000, v182
    v_lshlrev_b32 v186, 16, v183
    v_and_b32 v187, 0xffff0000, v183
    v_mul_f32 v188, 0x3fb8aa3b, v184
    v_exp_f32 v188, v188
    v_add_f32 v189, 1.0, v184
    v_cmp_lt_f32 vcc, 0, v184
    s_nop 1
    v_cndmask_b32 v184, v188, v189, vcc
    v_mul_f32 v188, 0x3fb8aa3b, v185
    v_exp_f32 v188, v188
    v_add_f32 v189, 1.0, v185
    v_cmp_lt_f32 vcc, 0, v185
    s_nop 1
    v_cndmask_b32 v185, v188, v189, vcc
    v_mul_f32 v188, 0x3fb8aa3b, v186
    v_exp_f32 v188, v188
    v_add_f32 v189, 1.0, v186
    v_cmp_lt_f32 vcc, 0, v186
    s_nop 1
    v_cndmask_b32 v186, v188, v189, vcc
    v_mul_f32 v188, 0x3fb8aa3b, v187
    v_exp_f32 v188, v188
    v_add_f32 v189, 1.0, v187
    v_cmp_lt_f32 vcc, 0, v187
    s_nop 1
    v_cndmask_b32 v187, v188, v189, vcc
    v_cvt_pk_bf16_f32 v182, v184, v185
    v_cvt_pk_bf16_f32 v183, v186, v187
    v_lshlrev_b32 v184, 16, v182
    v_and_b32 v185, 0xffff0000, v182
    v_lshlrev_b32 v186, 16, v183
    v_and_b32 v187, 0xffff0000, v183
    v_add_f32 v184, 0x358637bd, v184
    v_add_f32 v185, 0x358637bd, v185
    v_add_f32 v186, 0x358637bd, v186
    v_add_f32 v187, 0x358637bd, v187
    v_cvt_pk_bf16_f32 v180, v184, v185
    v_cvt_pk_bf16_f32 v181, v186, v187
    global_store_dwordx2 v17, v[180:181], s[24:25] offset:32
    s_nop 1
    v_cvt_pk_bf16_f32 v182, v152, v153
    v_cvt_pk_bf16_f32 v183, v154, v155
    v_lshlrev_b32 v184, 16, v182
    v_and_b32 v185, 0xffff0000, v182
    v_lshlrev_b32 v186, 16, v183
    v_and_b32 v187, 0xffff0000, v183
    v_mul_f32 v188, 0x3fb8aa3b, v184
    v_exp_f32 v188, v188
    v_add_f32 v189, 1.0, v184
    v_cmp_lt_f32 vcc, 0, v184
    s_nop 1
    v_cndmask_b32 v184, v188, v189, vcc
    v_mul_f32 v188, 0x3fb8aa3b, v185
    v_exp_f32 v188, v188
    v_add_f32 v189, 1.0, v185
    v_cmp_lt_f32 vcc, 0, v185
    s_nop 1
    v_cndmask_b32 v185, v188, v189, vcc
    v_mul_f32 v188, 0x3fb8aa3b, v186
    v_exp_f32 v188, v188
    v_add_f32 v189, 1.0, v186
    v_cmp_lt_f32 vcc, 0, v186
    s_nop 1
    v_cndmask_b32 v186, v188, v189, vcc
    v_mul_f32 v188, 0x3fb8aa3b, v187
    v_exp_f32 v188, v188
    v_add_f32 v189, 1.0, v187
    v_cmp_lt_f32 vcc, 0, v187
    s_nop 1
    v_cndmask_b32 v187, v188, v189, vcc
    v_cvt_pk_bf16_f32 v182, v184, v185
    v_cvt_pk_bf16_f32 v183, v186, v187
    v_lshlrev_b32 v184, 16, v182
    v_and_b32 v185, 0xffff0000, v182
    v_lshlrev_b32 v186, 16, v183
    v_and_b32 v187, 0xffff0000, v183
    v_add_f32 v184, 0x358637bd, v184
    v_add_f32 v185, 0x358637bd, v185
    v_add_f32 v186, 0x358637bd, v186
    v_add_f32 v187, 0x358637bd, v187
    v_cvt_pk_bf16_f32 v180, v184, v185
    v_cvt_pk_bf16_f32 v181, v186, v187
    global_store_dwordx2 v17, v[180:181], s[24:25] offset:64
    s_nop 1
    v_cvt_pk_bf16_f32 v182, v156, v157
    v_cvt_pk_bf16_f32 v183, v158, v159
    v_lshlrev_b32 v184, 16, v182
    v_and_b32 v185, 0xffff0000, v182
    v_lshlrev_b32 v186, 16, v183
    v_and_b32 v187, 0xffff0000, v183
    v_mul_f32 v188, 0x3fb8aa3b, v184
    v_exp_f32 v188, v188
    v_add_f32 v189, 1.0, v184
    v_cmp_lt_f32 vcc, 0, v184
    s_nop 1
    v_cndmask_b32 v184, v188, v189, vcc
    v_mul_f32 v188, 0x3fb8aa3b, v185
    v_exp_f32 v188, v188
    v_add_f32 v189, 1.0, v185
    v_cmp_lt_f32 vcc, 0, v185
    s_nop 1
    v_cndmask_b32 v185, v188, v189, vcc
    v_mul_f32 v188, 0x3fb8aa3b, v186
    v_exp_f32 v188, v188
    v_add_f32 v189, 1.0, v186
    v_cmp_lt_f32 vcc, 0, v186
    s_nop 1
    v_cndmask_b32 v186, v188, v189, vcc
    v_mul_f32 v188, 0x3fb8aa3b, v187
    v_exp_f32 v188, v188
    v_add_f32 v189, 1.0, v187
    v_cmp_lt_f32 vcc, 0, v187
    s_nop 1
    v_cndmask_b32 v187, v188, v189, vcc
    v_cvt_pk_bf16_f32 v182, v184, v185
    v_cvt_pk_bf16_f32 v183, v186, v187
    v_lshlrev_b32 v184, 16, v182
    v_and_b32 v185, 0xffff0000, v182
    v_lshlrev_b32 v186, 16, v183
    v_and_b32 v187, 0xffff0000, v183
    v_add_f32 v184, 0x358637bd, v184
    v_add_f32 v185, 0x358637bd, v185
    v_add_f32 v186, 0x358637bd, v186
    v_add_f32 v187, 0x358637bd, v187
    v_cvt_pk_bf16_f32 v180, v184, v185
    v_cvt_pk_bf16_f32 v181, v186, v187
    global_store_dwordx2 v17, v[180:181], s[24:25] offset:96
    s_nop 1
    v_cvt_pk_bf16_f32 v182, v160, v161
    v_cvt_pk_bf16_f32 v183, v162, v163
    v_lshlrev_b32 v184, 16, v182
    v_and_b32 v185, 0xffff0000, v182
    v_lshlrev_b32 v186, 16, v183
    v_and_b32 v187, 0xffff0000, v183
    v_mul_f32 v188, 0x3fb8aa3b, v184
    v_exp_f32 v188, v188
    v_add_f32 v189, 1.0, v184
    v_cmp_lt_f32 vcc, 0, v184
    s_nop 1
    v_cndmask_b32 v184, v188, v189, vcc
    v_mul_f32 v188, 0x3fb8aa3b, v185
    v_exp_f32 v188, v188
    v_add_f32 v189, 1.0, v185
    v_cmp_lt_f32 vcc, 0, v185
    s_nop 1
    v_cndmask_b32 v185, v188, v189, vcc
    v_mul_f32 v188, 0x3fb8aa3b, v186
    v_exp_f32 v188, v188
    v_add_f32 v189, 1.0, v186
    v_cmp_lt_f32 vcc, 0, v186
    s_nop 1
    v_cndmask_b32 v186, v188, v189, vcc
    v_mul_f32 v188, 0x3fb8aa3b, v187
    v_exp_f32 v188, v188
    v_add_f32 v189, 1.0, v187
    v_cmp_lt_f32 vcc, 0, v187
    s_nop 1
    v_cndmask_b32 v187, v188, v189, vcc
    v_cvt_pk_bf16_f32 v182, v184, v185
    v_cvt_pk_bf16_f32 v183, v186, v187
    v_lshlrev_b32 v184, 16, v182
    v_and_b32 v185, 0xffff0000, v182
    v_lshlrev_b32 v186, 16, v183
    v_and_b32 v187, 0xffff0000, v183
    v_add_f32 v184, 0x358637bd, v184
    v_add_f32 v185, 0x358637bd, v185
    v_add_f32 v186, 0x358637bd, v186
    v_add_f32 v187, 0x358637bd, v187
    v_cvt_pk_bf16_f32 v180, v184, v185
    v_cvt_pk_bf16_f32 v181, v186, v187
    global_store_dwordx2 v17, v[180:181], s[24:25] offset:128
    s_nop 1
    v_cvt_pk_bf16_f32 v182, v164, v165
    v_cvt_pk_bf16_f32 v183, v166, v167
    v_lshlrev_b32 v184, 16, v182
    v_and_b32 v185, 0xffff0000, v182
    v_lshlrev_b32 v186, 16, v183
    v_and_b32 v187, 0xffff0000, v183
    v_mul_f32 v188, 0x3fb8aa3b, v184
    v_exp_f32 v188, v188
    v_add_f32 v189, 1.0, v184
    v_cmp_lt_f32 vcc, 0, v184
    s_nop 1
    v_cndmask_b32 v184, v188, v189, vcc
    v_mul_f32 v188, 0x3fb8aa3b, v185
    v_exp_f32 v188, v188
    v_add_f32 v189, 1.0, v185
    v_cmp_lt_f32 vcc, 0, v185
    s_nop 1
    v_cndmask_b32 v185, v188, v189, vcc
    v_mul_f32 v188, 0x3fb8aa3b, v186
    v_exp_f32 v188, v188
    v_add_f32 v189, 1.0, v186
    v_cmp_lt_f32 vcc, 0, v186
    s_nop 1
    v_cndmask_b32 v186, v188, v189, vcc
    v_mul_f32 v188, 0x3fb8aa3b, v187
    v_exp_f32 v188, v188
    v_add_f32 v189, 1.0, v187
    v_cmp_lt_f32 vcc, 0, v187
    s_nop 1
    v_cndmask_b32 v187, v188, v189, vcc
    v_cvt_pk_bf16_f32 v182, v184, v185
    v_cvt_pk_bf16_f32 v183, v186, v187
    v_lshlrev_b32 v184, 16, v182
    v_and_b32 v185, 0xffff0000, v182
    v_lshlrev_b32 v186, 16, v183
    v_and_b32 v187, 0xffff0000, v183
    v_add_f32 v184, 0x358637bd, v184
    v_add_f32 v185, 0x358637bd, v185
    v_add_f32 v186, 0x358637bd, v186
    v_add_f32 v187, 0x358637bd, v187
    v_cvt_pk_bf16_f32 v180, v184, v185
    v_cvt_pk_bf16_f32 v181, v186, v187
    global_store_dwordx2 v17, v[180:181], s[24:25] offset:160
    s_nop 1
    v_cvt_pk_bf16_f32 v182, v168, v169
    v_cvt_pk_bf16_f32 v183, v170, v171
    v_lshlrev_b32 v184, 16, v182
    v_and_b32 v185, 0xffff0000, v182
    v_lshlrev_b32 v186, 16, v183
    v_and_b32 v187, 0xffff0000, v183
    v_mul_f32 v188, 0x3fb8aa3b, v184
    v_exp_f32 v188, v188
    v_add_f32 v189, 1.0, v184
    v_cmp_lt_f32 vcc, 0, v184
    s_nop 1
    v_cndmask_b32 v184, v188, v189, vcc
    v_mul_f32 v188, 0x3fb8aa3b, v185
    v_exp_f32 v188, v188
    v_add_f32 v189, 1.0, v185
    v_cmp_lt_f32 vcc, 0, v185
    s_nop 1
    v_cndmask_b32 v185, v188, v189, vcc
    v_mul_f32 v188, 0x3fb8aa3b, v186
    v_exp_f32 v188, v188
    v_add_f32 v189, 1.0, v186
    v_cmp_lt_f32 vcc, 0, v186
    s_nop 1
    v_cndmask_b32 v186, v188, v189, vcc
    v_mul_f32 v188, 0x3fb8aa3b, v187
    v_exp_f32 v188, v188
    v_add_f32 v189, 1.0, v187
    v_cmp_lt_f32 vcc, 0, v187
    s_nop 1
    v_cndmask_b32 v187, v188, v189, vcc
    v_cvt_pk_bf16_f32 v182, v184, v185
    v_cvt_pk_bf16_f32 v183, v186, v187
    v_lshlrev_b32 v184, 16, v182
    v_and_b32 v185, 0xffff0000, v182
    v_lshlrev_b32 v186, 16, v183
    v_and_b32 v187, 0xffff0000, v183
    v_add_f32 v184, 0x358637bd, v184
    v_add_f32 v185, 0x358637bd, v185
    v_add_f32 v186, 0x358637bd, v186
    v_add_f32 v187, 0x358637bd, v187
    v_cvt_pk_bf16_f32 v180, v184, v185
    v_cvt_pk_bf16_f32 v181, v186, v187
    global_store_dwordx2 v17, v[180:181], s[24:25] offset:192
    s_nop 1
    v_cvt_pk_bf16_f32 v182, v172, v173
    v_cvt_pk_bf16_f32 v183, v174, v175
    v_lshlrev_b32 v184, 16, v182
    v_and_b32 v185, 0xffff0000, v182
    v_lshlrev_b32 v186, 16, v183
    v_and_b32 v187, 0xffff0000, v183
    v_mul_f32 v188, 0x3fb8aa3b, v184
    v_exp_f32 v188, v188
    v_add_f32 v189, 1.0, v184
    v_cmp_lt_f32 vcc, 0, v184
    s_nop 1
    v_cndmask_b32 v184, v188, v189, vcc
    v_mul_f32 v188, 0x3fb8aa3b, v185
    v_exp_f32 v188, v188
    v_add_f32 v189, 1.0, v185
    v_cmp_lt_f32 vcc, 0, v185
    s_nop 1
    v_cndmask_b32 v185, v188, v189, vcc
    v_mul_f32 v188, 0x3fb8aa3b, v186
    v_exp_f32 v188, v188
    v_add_f32 v189, 1.0, v186
    v_cmp_lt_f32 vcc, 0, v186
    s_nop 1
    v_cndmask_b32 v186, v188, v189, vcc
    v_mul_f32 v188, 0x3fb8aa3b, v187
    v_exp_f32 v188, v188
    v_add_f32 v189, 1.0, v187
    v_cmp_lt_f32 vcc, 0, v187
    s_nop 1
    v_cndmask_b32 v187, v188, v189, vcc
    v_cvt_pk_bf16_f32 v182, v184, v185
    v_cvt_pk_bf16_f32 v183, v186, v187
    v_lshlrev_b32 v184, 16, v182
    v_and_b32 v185, 0xffff0000, v182
    v_lshlrev_b32 v186, 16, v183
    v_and_b32 v187, 0xffff0000, v183
    v_add_f32 v184, 0x358637bd, v184
    v_add_f32 v185, 0x358637bd, v185
    v_add_f32 v186, 0x358637bd, v186
    v_add_f32 v187, 0x358637bd, v187
    v_cvt_pk_bf16_f32 v180, v184, v185
    v_cvt_pk_bf16_f32 v181, v186, v187
    global_store_dwordx2 v17, v[180:181], s[24:25] offset:224
    s_nop 1
    v_cvt_pk_bf16_f32 v182, v176, v177
    v_cvt_pk_bf16_f32 v183, v178, v179
    v_lshlrev_b32 v184, 16, v182
    v_and_b32 v185, 0xffff0000, v182
    v_lshlrev_b32 v186, 16, v183
    v_and_b32 v187, 0xffff0000, v183
    v_mul_f32 v188, 0x3fb8aa3b, v184
    v_exp_f32 v188, v188
    v_add_f32 v189, 1.0, v184
    v_cmp_lt_f32 vcc, 0, v184
    s_nop 1
    v_cndmask_b32 v184, v188, v189, vcc
    v_mul_f32 v188, 0x3fb8aa3b, v185
    v_exp_f32 v188, v188
    v_add_f32 v189, 1.0, v185
    v_cmp_lt_f32 vcc, 0, v185
    s_nop 1
    v_cndmask_b32 v185, v188, v189, vcc
    v_mul_f32 v188, 0x3fb8aa3b, v186
    v_exp_f32 v188, v188
    v_add_f32 v189, 1.0, v186
    v_cmp_lt_f32 vcc, 0, v186
    s_nop 1
    v_cndmask_b32 v186, v188, v189, vcc
    v_mul_f32 v188, 0x3fb8aa3b, v187
    v_exp_f32 v188, v188
    v_add_f32 v189, 1.0, v187
    v_cmp_lt_f32 vcc, 0, v187
    s_nop 1
    v_cndmask_b32 v187, v188, v189, vcc
    v_cvt_pk_bf16_f32 v182, v184, v185
    v_cvt_pk_bf16_f32 v183, v186, v187
    v_lshlrev_b32 v184, 16, v182
    v_and_b32 v185, 0xffff0000, v182
    v_lshlrev_b32 v186, 16, v183
    v_and_b32 v187, 0xffff0000, v183
    v_add_f32 v184, 0x358637bd, v184
    v_add_f32 v185, 0x358637bd, v185
    v_add_f32 v186, 0x358637bd, v186
    v_add_f32 v187, 0x358637bd, v187
    v_cvt_pk_bf16_f32 v180, v184, v185
    v_cvt_pk_bf16_f32 v181, v186, v187
    global_store_dwordx2 v17, v[180:181], s[24:25] offset:256
    s_nop 1
    s_branch K1_END
K1_H:
    s_sub_u32 s16, s2, 192
    s_lshr_b32 s15, s16, 5
    s_lshl_b32 s15, s15, 7
    s_and_b32 s12, s16, 7
    s_lshl_b32 s12, s12, 2
    s_lshr_b32 s13, s16, 3
    s_and_b32 s13, s13, 3
    s_add_u32 s12, s12, s13
    s_mul_i32 s12, s12, 288
    s_mov_b32 s17, 9216
    s_mov_b32 s18, 589824
    s_mov_b32 s6, s22
    s_mov_b32 s7, s23
    s_mov_b32 s19, 1152
    s_lshl_b32 s9, s8, 8
    s_add_u32 s9, s9, 0
    v_add_u32 v16, s9, v1
    v_lshrrev_b32 v17, 3, v16
    v_and_b32 v18, 7, v16
    v_lshrrev_b32 v19, 1, v17
    v_and_b32 v19, 7, v19
    v_xor_b32 v18, v18, v19
    v_lshlrev_b32 v18, 4, v18
    v_add_u32 v17, s15, v17
    v_mul_lo_u32 v17, v17, s19
    v_add_u32 v2, v17, v18
    s_lshl_b32 s9, s8, 8
    s_add_u32 s9, s9, 64
    v_add_u32 v16, s9, v1
    v_lshrrev_b32 v17, 3, v16
    v_and_b32 v18, 7, v16
    v_lshrrev_b32 v19, 1, v17
    v_and_b32 v19, 7, v19
    v_xor_b32 v18, v18, v19
    v_lshlrev_b32 v18, 4, v18
    v_add_u32 v17, s15, v17
    v_mul_lo_u32 v17, v17, s19
    v_add_u32 v3, v17, v18
    s_lshl_b32 s9, s8, 8
    s_add_u32 s9, s9, 128
    v_add_u32 v16, s9, v1
    v_lshrrev_b32 v17, 3, v16
    v_and_b32 v18, 7, v16
    v_lshrrev_b32 v19, 1, v17
    v_and_b32 v19, 7, v19
    v_xor_b32 v18, v18, v19
    v_lshlrev_b32 v18, 4, v18
    v_add_u32 v17, s15, v17
    v_mul_lo_u32 v17, v17, s19
    v_add_u32 v4, v17, v18
    s_lshl_b32 s9, s8, 8
    s_add_u32 s9, s9, 192
    v_add_u32 v16, s9, v1
    v_lshrrev_b32 v17, 3, v16
    v_and_b32 v18, 7, v16
    v_lshrrev_b32 v19, 1, v17
    v_and_b32 v19, 7, v19
    v_xor_b32 v18, v18, v19
    v_lshlrev_b32 v18, 4, v18
    v_add_u32 v17, s15, v17
    v_mul_lo_u32 v17, v17, s19
    v_add_u32 v5, v17, v18
    s_mul_i32 s9, s8, 288
    s_add_u32 s9, s9, 0
    v_add_u32 v16, s9, v1
    v_mul_u32_u24 v17, 3641, v16
    v_lshrrev_b32 v17, 16, v17
    v_mul_u32_u24 v18, 18, v17
    v_sub_u32 v18, v16, v18
    v_mul_lo_u32 v17, v17, s17
    v_lshlrev_b32 v18, 4, v18
    v_add_u32 v17, v17, v18
    v_add_u32 v6, s12, v17
    s_mul_i32 s9, s8, 288
    s_add_u32 s9, s9, 64
    v_add_u32 v16, s9, v1
    v_mul_u32_u24 v17, 3641, v16
    v_lshrrev_b32 v17, 16, v17
    v_mul_u32_u24 v18, 18, v17
    v_sub_u32 v18, v16, v18
    v_mul_lo_u32 v17, v17, s17
    v_lshlrev_b32 v18, 4, v18
    v_add_u32 v17, v17, v18
    v_add_u32 v7, s12, v17
    s_mul_i32 s9, s8, 288
    s_add_u32 s9, s9, 128
    v_add_u32 v16, s9, v1
    v_mul_u32_u24 v17, 3641, v16
    v_lshrrev_b32 v17, 16, v17
    v_mul_u32_u24 v18, 18, v17
    v_sub_u32 v18, v16, v18
    v_mul_lo_u32 v17, v17, s17
    v_lshlrev_b32 v18, 4, v18
    v_add_u32 v17, v17, v18
    v_add_u32 v8, s12, v17
    s_mul_i32 s9, s8, 288
    s_add_u32 s9, s9, 192
    v_add_u32 v16, s9, v1
    v_mul_u32_u24 v17, 3641, v16
    v_lshrrev_b32 v17, 16, v17
    v_mul_u32_u24 v18, 18, v17
    v_sub_u32 v18, v16, v18
    v_mul_lo_u32 v17, v17, s17
    v_lshlrev_b32 v18, 4, v18
    v_add_u32 v17, v17, v18
    v_add_u32 v9, s12, v17
    s_mul_i32 s9, s8, 288
    s_add_u32 s9, s9, 256
    v_add_u32 v16, s9, v1
    v_mul_u32_u24 v17, 3641, v16
    v_lshrrev_b32 v17, 16, v17
    v_mul_u32_u24 v18, 18, v17
    v_sub_u32 v18, v16, v18
    v_mul_lo_u32 v17, v17, s17
    v_lshlrev_b32 v18, 4, v18
    v_add_u32 v17, v17, v18
    v_add_u32 v10, s12, v17
    s_lshl_b32 s9, s8, 12
    s_add_u32 m0, s9, 0
    s_nop 0
    global_load_lds_dwordx4 v2, s[4:5]
    s_lshl_b32 s9, s8, 12
    s_add_u32 m0, s9, 1024
    s_nop 0
    global_load_lds_dwordx4 v3, s[4:5]
    s_lshl_b32 s9, s8, 12
    s_add_u32 m0, s9, 2048
    s_nop 0
    global_load_lds_dwordx4 v4, s[4:5]
    s_lshl_b32 s9, s8, 12
    s_add_u32 m0, s9, 3072
    s_nop 0
    global_load_lds_dwordx4 v5, s[4:5]
    s_mul_i32 s9, s8, 4608
    s_add_u32 m0, s9, 16384
    s_nop 0
    global_load_lds_dwordx4 v6, s[6:7]
    s_mul_i32 s9, s8, 4608
    s_add_u32 m0, s9, 17408
    s_nop 0
    global_load_lds_dwordx4 v7, s[6:7]
    s_mul_i32 s9, s8, 4608
    s_add_u32 m0, s9, 18432
    s_nop 0
    global_load_lds_dwordx4 v8, s[6:7]
    s_mul_i32 s9, s8, 4608
    s_add_u32 m0, s9, 19456
    s_nop 0
    global_load_lds_dwordx4 v9, s[6:7]
    s_mul_i32 s9, s8, 4608
    s_add_u32 m0, s9, 20480
    s_mov_b32 exec_hi, 0
    global_load_lds_dwordx4 v10, s[6:7]
    s_mov_b64 exec, -1
    s_add_u32 s4, s4, 128
    s_addc_u32 s5, s5, 0
    s_add_u32 s6, s6, s18
    s_addc_u32 s7, s7, 0
    s_lshl_b32 s9, s8, 12
    s_add_u32 m0, s9, 34816
    s_nop 0
    global_load_lds_dwordx4 v2, s[4:5]
    s_lshl_b32 s9, s8, 12
    s_add_u32 m0, s9, 35840
    s_nop 0
    global_load_lds_dwordx4 v3, s[4:5]
    s_lshl_b32 s9, s8, 12
    s_add_u32 m0, s9, 36864
    s_nop 0
    global_load_lds_dwordx4 v4, s[4:5]
    s_lshl_b32 s9, s8, 12
    s_add_u32 m0, s9, 37888
    s_nop 0
    global_load_lds_dwordx4 v5, s[4:5]
    s_mul_i32 s9, s8, 4608
    s_add_u32 m0, s9, 51200
    s_nop 0
    global_load_lds_dwordx4 v6, s[6:7]
    s_mul_i32 s9, s8, 4608
    s_add_u32 m0, s9, 52224
    s_nop 0
    global_load_lds_dwordx4 v7, s[6:7]
    s_mul_i32 s9, s8, 4608
    s_add_u32 m0, s9, 53248
    s_nop 0
    global_load_lds_dwordx4 v8, s[6:7]
    s_mul_i32 s9, s8, 4608
    s_add_u32 m0, s9, 54272
    s_nop 0
    global_load_lds_dwordx4 v9, s[6:7]
    s_mul_i32 s9, s8, 4608
    s_add_u32 m0, s9, 55296
    s_mov_b32 exec_hi, 0
    global_load_lds_dwordx4 v10, s[6:7]
    s_mov_b64 exec, -1
    s_waitcnt vmcnt(9)
    s_barrier
    ds_read_b64 v[20:21], v11 offset:0
    ds_read_b64 v[22:23], v12 offset:0
    ds_read_b64 v[24:25], v11 offset:2048
    ds_read_b64 v[26:27], v12 offset:2048
    ds_read_b64_tr_b16 v[36:37], v15 offset:0
    ds_read_b64_tr_b16 v[38:39], v15 offset:4608
    ds_read_b64_tr_b16 v[40:41], v15 offset:32
    ds_read_b64_tr_b16 v[42:43], v15 offset:4640
    ds_read_b64_tr_b16 v[44:45], v15 offset:64
    ds_read_b64_tr_b16 v[46:47], v15 offset:4672
    ds_read_b64_tr_b16 v[48:49], v15 offset:96
    ds_read_b64_tr_b16 v[50:51], v15 offset:4704
    ds_read_b64_tr_b16 v[52:53], v15 offset:128
    ds_read_b64_tr_b16 v[54:55], v15 offset:4736
    ds_read_b64_tr_b16 v[56:57], v15 offset:160
    ds_read_b64_tr_b16 v[58:59], v15 offset:4768
    ds_read_b64_tr_b16 v[60:61], v15 offset:192
    ds_read_b64_tr_b16 v[62:63], v15 offset:4800
    ds_read_b64_tr_b16 v[64:65], v15 offset:224
    ds_read_b64_tr_b16 v[66:67], v15 offset:4832
    ds_read_b64_tr_b16 v[68:69], v15 offset:256
    ds_read_b64_tr_b16 v[70:71], v15 offset:4864
    s_waitcnt lgkmcnt(15)
    v_mfma_f32_16x16x32_bf16 v[108:111], v[36:39], v[20:23], v[108:111]
    v_mfma_f32_16x16x32_bf16 v[144:147], v[36:39], v[24:27], v[144:147]
    ds_read_b64 v[28:29], v13 offset:0
    ds_read_b64 v[30:31], v14 offset:0
    ds_read_b64 v[32:33], v13 offset:2048
    s_waitcnt lgkmcnt(15)
    v_mfma_f32_16x16x32_bf16 v[112:115], v[40:43], v[20:23], v[112:115]
    v_mfma_f32_16x16x32_bf16 v[148:151], v[40:43], v[24:27], v[148:151]
    ds_read_b64 v[34:35], v14 offset:2048
    ds_read_b64_tr_b16 v[72:73], v15 offset:9216
    ds_read_b64_tr_b16 v[74:75], v15 offset:13824
    v_mfma_f32_16x16x32_bf16 v[116:119], v[44:47], v[20:23], v[116:119]
    v_mfma_f32_16x16x32_bf16 v[152:155], v[44:47], v[24:27], v[152:155]
    ds_read_b64_tr_b16 v[76:77], v15 offset:9248
    ds_read_b64_tr_b16 v[78:79], v15 offset:13856
    ds_read_b64_tr_b16 v[80:81], v15 offset:9280
    s_waitcnt lgkmcnt(15)
    v_mfma_f32_16x16x32_bf16 v[120:123], v[48:51], v[20:23], v[120:123]
    v_mfma_f32_16x16x32_bf16 v[156:159], v[48:51], v[24:27], v[156:159]
    ds_read_b64_tr_b16 v[82:83], v15 offset:13888
    ds_read_b64_tr_b16 v[84:85], v15 offset:9312
    ds_read_b64_tr_b16 v[86:87], v15 offset:13920
    v_mfma_f32_16x16x32_bf16 v[124:127], v[52:55], v[20:23], v[124:127]
    v_mfma_f32_16x16x32_bf16 v[160:163], v[52:55], v[24:27], v[160:163]
    ds_read_b64_tr_b16 v[88:89], v15 offset:9344
    ds_read_b64_tr_b16 v[90:91], v15 offset:13952
    ds_read_b64_tr_b16 v[92:93], v15 offset:9376
    v_mfma_f32_16x16x32_bf16 v[128:131], v[56:59], v[20:23], v[128:131]
    v_mfma_f32_16x16x32_bf16 v[164:167], v[56:59], v[24:27], v[164:167]
    ds_read_b64_tr_b16 v[94:95], v15 offset:13984
    ds_read_b64_tr_b16 v[96:97], v15 offset:9408
    ds_read_b64_tr_b16 v[98:99], v15 offset:14016
    s_waitcnt lgkmcnt(15)
    v_mfma_f32_16x16x32_bf16 v[132:135], v[60:63], v[20:23], v[132:135]
    v_mfma_f32_16x16x32_bf16 v[168:171], v[60:63], v[24:27], v[168:171]
    ds_read_b64_tr_b16 v[100:101], v15 offset:9440
    ds_read_b64_tr_b16 v[102:103], v15 offset:14048
    ds_read_b64_tr_b16 v[104:105], v15 offset:9472
    v_mfma_f32_16x16x32_bf16 v[136:139], v[64:67], v[20:23], v[136:139]
    v_mfma_f32_16x16x32_bf16 v[172:175], v[64:67], v[24:27], v[172:175]
    ds_read_b64_tr_b16 v[106:107], v15 offset:14080
    v_mfma_f32_16x16x32_bf16 v[140:143], v[68:71], v[20:23], v[140:143]
    v_mfma_f32_16x16x32_bf16 v[176:179], v[68:71], v[24:27], v[176:179]
    s_waitcnt lgkmcnt(0)
    s_waitcnt vmcnt(0)
    s_barrier
    s_add_u32 s4, s4, 128
    s_addc_u32 s5, s5, 0
    s_add_u32 s6, s6, s18
    s_addc_u32 s7, s7, 0
    s_lshl_b32 s9, s8, 12
    s_add_u32 m0, s9, 0
    s_nop 0
    global_load_lds_dwordx4 v2, s[4:5]
    s_lshl_b32 s9, s8, 12
    s_add_u32 m0, s9, 1024
    s_nop 0
    global_load_lds_dwordx4 v3, s[4:5]
    s_lshl_b32 s9, s8, 12
    s_add_u32 m0, s9, 2048
    s_nop 0
    global_load_lds_dwordx4 v4, s[4:5]
    s_lshl_b32 s9, s8, 12
    s_add_u32 m0, s9, 3072
    s_nop 0
    global_load_lds_dwordx4 v5, s[4:5]
    s_mul_i32 s9, s8, 4608
    s_add_u32 m0, s9, 16384
    s_nop 0
    global_load_lds_dwordx4 v6, s[6:7]
    s_mul_i32 s9, s8, 4608
    s_add_u32 m0, s9, 17408
    s_nop 0
    global_load_lds_dwordx4 v7, s[6:7]
    s_mul_i32 s9, s8, 4608
    s_add_u32 m0, s9, 18432
    s_nop 0
    global_load_lds_dwordx4 v8, s[6:7]
    s_mul_i32 s9, s8, 4608
    s_add_u32 m0, s9, 19456
    s_nop 0
    global_load_lds_dwordx4 v9, s[6:7]
    s_mul_i32 s9, s8, 4608
    s_add_u32 m0, s9, 20480
    s_mov_b32 exec_hi, 0
    global_load_lds_dwordx4 v10, s[6:7]
    s_mov_b64 exec, -1
    v_mfma_f32_16x16x32_bf16 v[108:111], v[72:75], v[28:31], v[108:111]
    v_mfma_f32_16x16x32_bf16 v[144:147], v[72:75], v[32:35], v[144:147]
    ds_read_b64 v[20:21], v11 offset:34816
    ds_read_b64 v[22:23], v12 offset:34816
    ds_read_b64 v[24:25], v11 offset:36864
    v_mfma_f32_16x16x32_bf16 v[112:115], v[76:79], v[28:31], v[112:115]
    v_mfma_f32_16x16x32_bf16 v[148:151], v[76:79], v[32:35], v[148:151]
    ds_read_b64 v[26:27], v12 offset:36864
    ds_read_b64_tr_b16 v[36:37], v15 offset:34816
    ds_read_b64_tr_b16 v[38:39], v15 offset:39424
    v_mfma_f32_16x16x32_bf16 v[116:119], v[80:83], v[28:31], v[116:119]
    v_mfma_f32_16x16x32_bf16 v[152:155], v[80:83], v[32:35], v[152:155]
    ds_read_b64_tr_b16 v[40:41], v15 offset:34848
    ds_read_b64_tr_b16 v[42:43], v15 offset:39456
    ds_read_b64_tr_b16 v[44:45], v15 offset:34880
    v_mfma_f32_16x16x32_bf16 v[120:123], v[84:87], v[28:31], v[120:123]
    v_mfma_f32_16x16x32_bf16 v[156:159], v[84:87], v[32:35], v[156:159]
    ds_read_b64_tr_b16 v[46:47], v15 offset:39488
    ds_read_b64_tr_b16 v[48:49], v15 offset:34912
    ds_read_b64_tr_b16 v[50:51], v15 offset:39520
    v_mfma_f32_16x16x32_bf16 v[124:127], v[88:91], v[28:31], v[124:127]
    v_mfma_f32_16x16x32_bf16 v[160:163], v[88:91], v[32:35], v[160:163]
    ds_read_b64_tr_b16 v[52:53], v15 offset:34944
    ds_read_b64_tr_b16 v[54:55], v15 offset:39552
    ds_read_b64_tr_b16 v[56:57], v15 offset:34976
    v_mfma_f32_16x16x32_bf16 v[128:131], v[92:95], v[28:31], v[128:131]
    v_mfma_f32_16x16x32_bf16 v[164:167], v[92:95], v[32:35], v[164:167]
    ds_read_b64_tr_b16 v[58:59], v15 offset:39584
    ds_read_b64_tr_b16 v[60:61], v15 offset:35008
    ds_read_b64_tr_b16 v[62:63], v15 offset:39616
    v_mfma_f32_16x16x32_bf16 v[132:135], v[96:99], v[28:31], v[132:135]
    v_mfma_f32_16x16x32_bf16 v[168:171], v[96:99], v[32:35], v[168:171]
    ds_read_b64_tr_b16 v[64:65], v15 offset:35040
    ds_read_b64_tr_b16 v[66:67], v15 offset:39648
    ds_read_b64_tr_b16 v[68:69], v15 offset:35072
    v_mfma_f32_16x16x32_bf16 v[136:139], v[100:103], v[28:31], v[136:139]
    v_mfma_f32_16x16x32_bf16 v[172:175], v[100:103], v[32:35], v[172:175]
    ds_read_b64_tr_b16 v[70:71], v15 offset:39680
    v_mfma_f32_16x16x32_bf16 v[140:143], v[104:107], v[28:31], v[140:143]
    v_mfma_f32_16x16x32_bf16 v[176:179], v[104:107], v[32:35], v[176:179]
    s_waitcnt lgkmcnt(15)
    v_mfma_f32_16x16x32_bf16 v[108:111], v[36:39], v[20:23], v[108:111]
    v_mfma_f32_16x16x32_bf16 v[144:147], v[36:39], v[24:27], v[144:147]
    ds_read_b64 v[28:29], v13 offset:34816
    ds_read_b64 v[30:31], v14 offset:34816
    ds_read_b64 v[32:33], v13 offset:36864
    s_waitcnt lgkmcnt(15)
    v_mfma_f32_16x16x32_bf16 v[112:115], v[40:43], v[20:23], v[112:115]
    v_mfma_f32_16x16x32_bf16 v[148:151], v[40:43], v[24:27], v[148:151]
    ds_read_b64 v[34:35], v14 offset:36864
    ds_read_b64_tr_b16 v[72:73], v15 offset:44032
    ds_read_b64_tr_b16 v[74:75], v15 offset:48640
    v_mfma_f32_16x16x32_bf16 v[116:119], v[44:47], v[20:23], v[116:119]
    v_mfma_f32_16x16x32_bf16 v[152:155], v[44:47], v[24:27], v[152:155]
    ds_read_b64_tr_b16 v[76:77], v15 offset:44064
    ds_read_b64_tr_b16 v[78:79], v15 offset:48672
    ds_read_b64_tr_b16 v[80:81], v15 offset:44096
    s_waitcnt lgkmcnt(15)
    v_mfma_f32_16x16x32_bf16 v[120:123], v[48:51], v[20:23], v[120:123]
    v_mfma_f32_16x16x32_bf16 v[156:159], v[48:51], v[24:27], v[156:159]
    ds_read_b64_tr_b16 v[82:83], v15 offset:48704
    ds_read_b64_tr_b16 v[84:85], v15 offset:44128
    ds_read_b64_tr_b16 v[86:87], v15 offset:48736
    v_mfma_f32_16x16x32_bf16 v[124:127], v[52:55], v[20:23], v[124:127]
    v_mfma_f32_16x16x32_bf16 v[160:163], v[52:55], v[24:27], v[160:163]
    ds_read_b64_tr_b16 v[88:89], v15 offset:44160
    ds_read_b64_tr_b16 v[90:91], v15 offset:48768
    ds_read_b64_tr_b16 v[92:93], v15 offset:44192
    v_mfma_f32_16x16x32_bf16 v[128:131], v[56:59], v[20:23], v[128:131]
    v_mfma_f32_16x16x32_bf16 v[164:167], v[56:59], v[24:27], v[164:167]
    ds_read_b64_tr_b16 v[94:95], v15 offset:48800
    ds_read_b64_tr_b16 v[96:97], v15 offset:44224
    ds_read_b64_tr_b16 v[98:99], v15 offset:48832
    s_waitcnt lgkmcnt(15)
    v_mfma_f32_16x16x32_bf16 v[132:135], v[60:63], v[20:23], v[132:135]
    v_mfma_f32_16x16x32_bf16 v[168:171], v[60:63], v[24:27], v[168:171]
    ds_read_b64_tr_b16 v[100:101], v15 offset:44256
    ds_read_b64_tr_b16 v[102:103], v15 offset:48864
    ds_read_b64_tr_b16 v[104:105], v15 offset:44288
    v_mfma_f32_16x16x32_bf16 v[136:139], v[64:67], v[20:23], v[136:139]
    v_mfma_f32_16x16x32_bf16 v[172:175], v[64:67], v[24:27], v[172:175]
    ds_read_b64_tr_b16 v[106:107], v15 offset:48896
    v_mfma_f32_16x16x32_bf16 v[140:143], v[68:71], v[20:23], v[140:143]
    v_mfma_f32_16x16x32_bf16 v[176:179], v[68:71], v[24:27], v[176:179]
    s_waitcnt lgkmcnt(0)
    s_waitcnt vmcnt(0)
    s_barrier
    s_add_u32 s4, s4, 128
    s_addc_u32 s5, s5, 0
    s_add_u32 s6, s6, s18
    s_addc_u32 s7, s7, 0
    s_lshl_b32 s9, s8, 12
    s_add_u32 m0, s9, 34816
    s_nop 0
    global_load_lds_dwordx4 v2, s[4:5]
    s_lshl_b32 s9, s8, 12
    s_add_u32 m0, s9, 35840
    s_nop 0
    global_load_lds_dwordx4 v3, s[4:5]
    s_lshl_b32 s9, s8, 12
    s_add_u32 m0, s9, 36864
    s_nop 0
    global_load_lds_dwordx4 v4, s[4:5]
    s_lshl_b32 s9, s8, 12
    s_add_u32 m0, s9, 37888
    s_nop 0
    global_load_lds_dwordx4 v5, s[4:5]
    s_mul_i32 s9, s8, 4608
    s_add_u32 m0, s9, 51200
    s_nop 0
    global_load_lds_dwordx4 v6, s[6:7]
    s_mul_i32 s9, s8, 4608
    s_add_u32 m0, s9, 52224
    s_nop 0
    global_load_lds_dwordx4 v7, s[6:7]
    s_mul_i32 s9, s8, 4608
    s_add_u32 m0, s9, 53248
    s_nop 0
    global_load_lds_dwordx4 v8, s[6:7]
    s_mul_i32 s9, s8, 4608
    s_add_u32 m0, s9, 54272
    s_nop 0
    global_load_lds_dwordx4 v9, s[6:7]
    s_mul_i32 s9, s8, 4608
    s_add_u32 m0, s9, 55296
    s_mov_b32 exec_hi, 0
    global_load_lds_dwordx4 v10, s[6:7]
    s_mov_b64 exec, -1
    v_mfma_f32_16x16x32_bf16 v[108:111], v[72:75], v[28:31], v[108:111]
    v_mfma_f32_16x16x32_bf16 v[144:147], v[72:75], v[32:35], v[144:147]
    ds_read_b64 v[20:21], v11 offset:0
    ds_read_b64 v[22:23], v12 offset:0
    ds_read_b64 v[24:25], v11 offset:2048
    v_mfma_f32_16x16x32_bf16 v[112:115], v[76:79], v[28:31], v[112:115]
    v_mfma_f32_16x16x32_bf16 v[148:151], v[76:79], v[32:35], v[148:151]
    ds_read_b64 v[26:27], v12 offset:2048
    ds_read_b64_tr_b16 v[36:37], v15 offset:0
    ds_read_b64_tr_b16 v[38:39], v15 offset:4608
    v_mfma_f32_16x16x32_bf16 v[116:119], v[80:83], v[28:31], v[116:119]
    v_mfma_f32_16x16x32_bf16 v[152:155], v[80:83], v[32:35], v[152:155]
    ds_read_b64_tr_b16 v[40:41], v15 offset:32
    ds_read_b64_tr_b16 v[42:43], v15 offset:4640
    ds_read_b64_tr_b16 v[44:45], v15 offset:64
    v_mfma_f32_16x16x32_bf16 v[120:123], v[84:87], v[28:31], v[120:123]
    v_mfma_f32_16x16x32_bf16 v[156:159], v[84:87], v[32:35], v[156:159]
    ds_read_b64_tr_b16 v[46:47], v15 offset:4672
    ds_read_b64_tr_b16 v[48:49], v15 offset:96
    ds_read_b64_tr_b16 v[50:51], v15 offset:4704
    v_mfma_f32_16x16x32_bf16 v[124:127], v[88:91], v[28:31], v[124:127]
    v_mfma_f32_16x16x32_bf16 v[160:163], v[88:91], v[32:35], v[160:163]
    ds_read_b64_tr_b16 v[52:53], v15 offset:128
    ds_read_b64_tr_b16 v[54:55], v15 offset:4736
    ds_read_b64_tr_b16 v[56:57], v15 offset:160
    v_mfma_f32_16x16x32_bf16 v[128:131], v[92:95], v[28:31], v[128:131]
    v_mfma_f32_16x16x32_bf16 v[164:167], v[92:95], v[32:35], v[164:167]
    ds_read_b64_tr_b16 v[58:59], v15 offset:4768
    ds_read_b64_tr_b16 v[60:61], v15 offset:192
    ds_read_b64_tr_b16 v[62:63], v15 offset:4800
    v_mfma_f32_16x16x32_bf16 v[132:135], v[96:99], v[28:31], v[132:135]
    v_mfma_f32_16x16x32_bf16 v[168:171], v[96:99], v[32:35], v[168:171]
    ds_read_b64_tr_b16 v[64:65], v15 offset:224
    ds_read_b64_tr_b16 v[66:67], v15 offset:4832
    ds_read_b64_tr_b16 v[68:69], v15 offset:256
    v_mfma_f32_16x16x32_bf16 v[136:139], v[100:103], v[28:31], v[136:139]
    v_mfma_f32_16x16x32_bf16 v[172:175], v[100:103], v[32:35], v[172:175]
    ds_read_b64_tr_b16 v[70:71], v15 offset:4864
    v_mfma_f32_16x16x32_bf16 v[140:143], v[104:107], v[28:31], v[140:143]
    v_mfma_f32_16x16x32_bf16 v[176:179], v[104:107], v[32:35], v[176:179]
    s_waitcnt lgkmcnt(15)
    v_mfma_f32_16x16x32_bf16 v[108:111], v[36:39], v[20:23], v[108:111]
    v_mfma_f32_16x16x32_bf16 v[144:147], v[36:39], v[24:27], v[144:147]
    ds_read_b64 v[28:29], v13 offset:0
    ds_read_b64 v[30:31], v14 offset:0
    ds_read_b64 v[32:33], v13 offset:2048
    s_waitcnt lgkmcnt(15)
    v_mfma_f32_16x16x32_bf16 v[112:115], v[40:43], v[20:23], v[112:115]
    v_mfma_f32_16x16x32_bf16 v[148:151], v[40:43], v[24:27], v[148:151]
    ds_read_b64 v[34:35], v14 offset:2048
    ds_read_b64_tr_b16 v[72:73], v15 offset:9216
    ds_read_b64_tr_b16 v[74:75], v15 offset:13824
    v_mfma_f32_16x16x32_bf16 v[116:119], v[44:47], v[20:23], v[116:119]
    v_mfma_f32_16x16x32_bf16 v[152:155], v[44:47], v[24:27], v[152:155]
    ds_read_b64_tr_b16 v[76:77], v15 offset:9248
    ds_read_b64_tr_b16 v[78:79], v15 offset:13856
    ds_read_b64_tr_b16 v[80:81], v15 offset:9280
    s_waitcnt lgkmcnt(15)
    v_mfma_f32_16x16x32_bf16 v[120:123], v[48:51], v[20:23], v[120:123]
    v_mfma_f32_16x16x32_bf16 v[156:159], v[48:51], v[24:27], v[156:159]
    ds_read_b64_tr_b16 v[82:83], v15 offset:13888
    ds_read_b64_tr_b16 v[84:85], v15 offset:9312
    ds_read_b64_tr_b16 v[86:87], v15 offset:13920
    v_mfma_f32_16x16x32_bf16 v[124:127], v[52:55], v[20:23], v[124:127]
    v_mfma_f32_16x16x32_bf16 v[160:163], v[52:55], v[24:27], v[160:163]
    ds_read_b64_tr_b16 v[88:89], v15 offset:9344
    ds_read_b64_tr_b16 v[90:91], v15 offset:13952
    ds_read_b64_tr_b16 v[92:93], v15 offset:9376
    v_mfma_f32_16x16x32_bf16 v[128:131], v[56:59], v[20:23], v[128:131]
    v_mfma_f32_16x16x32_bf16 v[164:167], v[56:59], v[24:27], v[164:167]
    ds_read_b64_tr_b16 v[94:95], v15 offset:13984
    ds_read_b64_tr_b16 v[96:97], v15 offset:9408
    ds_read_b64_tr_b16 v[98:99], v15 offset:14016
    s_waitcnt lgkmcnt(15)
    v_mfma_f32_16x16x32_bf16 v[132:135], v[60:63], v[20:23], v[132:135]
    v_mfma_f32_16x16x32_bf16 v[168:171], v[60:63], v[24:27], v[168:171]
    ds_read_b64_tr_b16 v[100:101], v15 offset:9440
    ds_read_b64_tr_b16 v[102:103], v15 offset:14048
    ds_read_b64_tr_b16 v[104:105], v15 offset:9472
    v_mfma_f32_16x16x32_bf16 v[136:139], v[64:67], v[20:23], v[136:139]
    v_mfma_f32_16x16x32_bf16 v[172:175], v[64:67], v[24:27], v[172:175]
    ds_read_b64_tr_b16 v[106:107], v15 offset:14080
    v_mfma_f32_16x16x32_bf16 v[140:143], v[68:71], v[20:23], v[140:143]
    v_mfma_f32_16x16x32_bf16 v[176:179], v[68:71], v[24:27], v[176:179]
    s_waitcnt lgkmcnt(0)
    s_waitcnt vmcnt(0)
    s_barrier
    s_add_u32 s4, s4, 128
    s_addc_u32 s5, s5, 0
    s_add_u32 s6, s6, s18
    s_addc_u32 s7, s7, 0
    s_lshl_b32 s9, s8, 12
    s_add_u32 m0, s9, 0
    s_nop 0
    global_load_lds_dwordx4 v2, s[4:5]
    s_lshl_b32 s9, s8, 12
    s_add_u32 m0, s9, 1024
    s_nop 0
    global_load_lds_dwordx4 v3, s[4:5]
    s_lshl_b32 s9, s8, 12
    s_add_u32 m0, s9, 2048
    s_nop 0
    global_load_lds_dwordx4 v4, s[4:5]
    s_lshl_b32 s9, s8, 12
    s_add_u32 m0, s9, 3072
    s_nop 0
    global_load_lds_dwordx4 v5, s[4:5]
    s_mul_i32 s9, s8, 4608
    s_add_u32 m0, s9, 16384
    s_nop 0
    global_load_lds_dwordx4 v6, s[6:7]
    s_mul_i32 s9, s8, 4608
    s_add_u32 m0, s9, 17408
    s_nop 0
    global_load_lds_dwordx4 v7, s[6:7]
    s_mul_i32 s9, s8, 4608
    s_add_u32 m0, s9, 18432
    s_nop 0
    global_load_lds_dwordx4 v8, s[6:7]
    s_mul_i32 s9, s8, 4608
    s_add_u32 m0, s9, 19456
    s_nop 0
    global_load_lds_dwordx4 v9, s[6:7]
    s_mul_i32 s9, s8, 4608
    s_add_u32 m0, s9, 20480
    s_mov_b32 exec_hi, 0
    global_load_lds_dwordx4 v10, s[6:7]
    s_mov_b64 exec, -1
    v_mfma_f32_16x16x32_bf16 v[108:111], v[72:75], v[28:31], v[108:111]
    v_mfma_f32_16x16x32_bf16 v[144:147], v[72:75], v[32:35], v[144:147]
    ds_read_b64 v[20:21], v11 offset:34816
    ds_read_b64 v[22:23], v12 offset:34816
    ds_read_b64 v[24:25], v11 offset:36864
    v_mfma_f32_16x16x32_bf16 v[112:115], v[76:79], v[28:31], v[112:115]
    v_mfma_f32_16x16x32_bf16 v[148:151], v[76:79], v[32:35], v[148:151]
    ds_read_b64 v[26:27], v12 offset:36864
    ds_read_b64_tr_b16 v[36:37], v15 offset:34816
    ds_read_b64_tr_b16 v[38:39], v15 offset:39424
    v_mfma_f32_16x16x32_bf16 v[116:119], v[80:83], v[28:31], v[116:119]
    v_mfma_f32_16x16x32_bf16 v[152:155], v[80:83], v[32:35], v[152:155]
    ds_read_b64_tr_b16 v[40:41], v15 offset:34848
    ds_read_b64_tr_b16 v[42:43], v15 offset:39456
    ds_read_b64_tr_b16 v[44:45], v15 offset:34880
    v_mfma_f32_16x16x32_bf16 v[120:123], v[84:87], v[28:31], v[120:123]
    v_mfma_f32_16x16x32_bf16 v[156:159], v[84:87], v[32:35], v[156:159]
    ds_read_b64_tr_b16 v[46:47], v15 offset:39488
    ds_read_b64_tr_b16 v[48:49], v15 offset:34912
    ds_read_b64_tr_b16 v[50:51], v15 offset:39520
    v_mfma_f32_16x16x32_bf16 v[124:127], v[88:91], v[28:31], v[124:127]
    v_mfma_f32_16x16x32_bf16 v[160:163], v[88:91], v[32:35], v[160:163]
    ds_read_b64_tr_b16 v[52:53], v15 offset:34944
    ds_read_b64_tr_b16 v[54:55], v15 offset:39552
    ds_read_b64_tr_b16 v[56:57], v15 offset:34976
    v_mfma_f32_16x16x32_bf16 v[128:131], v[92:95], v[28:31], v[128:131]
    v_mfma_f32_16x16x32_bf16 v[164:167], v[92:95], v[32:35], v[164:167]
    ds_read_b64_tr_b16 v[58:59], v15 offset:39584
    ds_read_b64_tr_b16 v[60:61], v15 offset:35008
    ds_read_b64_tr_b16 v[62:63], v15 offset:39616
    v_mfma_f32_16x16x32_bf16 v[132:135], v[96:99], v[28:31], v[132:135]
    v_mfma_f32_16x16x32_bf16 v[168:171], v[96:99], v[32:35], v[168:171]
    ds_read_b64_tr_b16 v[64:65], v15 offset:35040
    ds_read_b64_tr_b16 v[66:67], v15 offset:39648
    ds_read_b64_tr_b16 v[68:69], v15 offset:35072
    v_mfma_f32_16x16x32_bf16 v[136:139], v[100:103], v[28:31], v[136:139]
    v_mfma_f32_16x16x32_bf16 v[172:175], v[100:103], v[32:35], v[172:175]
    ds_read_b64_tr_b16 v[70:71], v15 offset:39680
    v_mfma_f32_16x16x32_bf16 v[140:143], v[104:107], v[28:31], v[140:143]
    v_mfma_f32_16x16x32_bf16 v[176:179], v[104:107], v[32:35], v[176:179]
    s_waitcnt lgkmcnt(15)
    v_mfma_f32_16x16x32_bf16 v[108:111], v[36:39], v[20:23], v[108:111]
    v_mfma_f32_16x16x32_bf16 v[144:147], v[36:39], v[24:27], v[144:147]
    ds_read_b64 v[28:29], v13 offset:34816
    ds_read_b64 v[30:31], v14 offset:34816
    ds_read_b64 v[32:33], v13 offset:36864
    s_waitcnt lgkmcnt(15)
    v_mfma_f32_16x16x32_bf16 v[112:115], v[40:43], v[20:23], v[112:115]
    v_mfma_f32_16x16x32_bf16 v[148:151], v[40:43], v[24:27], v[148:151]
    ds_read_b64 v[34:35], v14 offset:36864
    ds_read_b64_tr_b16 v[72:73], v15 offset:44032
    ds_read_b64_tr_b16 v[74:75], v15 offset:48640
    v_mfma_f32_16x16x32_bf16 v[116:119], v[44:47], v[20:23], v[116:119]
    v_mfma_f32_16x16x32_bf16 v[152:155], v[44:47], v[24:27], v[152:155]
    ds_read_b64_tr_b16 v[76:77], v15 offset:44064
    ds_read_b64_tr_b16 v[78:79], v15 offset:48672
    ds_read_b64_tr_b16 v[80:81], v15 offset:44096
    s_waitcnt lgkmcnt(15)
    v_mfma_f32_16x16x32_bf16 v[120:123], v[48:51], v[20:23], v[120:123]
    v_mfma_f32_16x16x32_bf16 v[156:159], v[48:51], v[24:27], v[156:159]
    ds_read_b64_tr_b16 v[82:83], v15 offset:48704
    ds_read_b64_tr_b16 v[84:85], v15 offset:44128
    ds_read_b64_tr_b16 v[86:87], v15 offset:48736
    v_mfma_f32_16x16x32_bf16 v[124:127], v[52:55], v[20:23], v[124:127]
    v_mfma_f32_16x16x32_bf16 v[160:163], v[52:55], v[24:27], v[160:163]
    ds_read_b64_tr_b16 v[88:89], v15 offset:44160
    ds_read_b64_tr_b16 v[90:91], v15 offset:48768
    ds_read_b64_tr_b16 v[92:93], v15 offset:44192
    v_mfma_f32_16x16x32_bf16 v[128:131], v[56:59], v[20:23], v[128:131]
    v_mfma_f32_16x16x32_bf16 v[164:167], v[56:59], v[24:27], v[164:167]
    ds_read_b64_tr_b16 v[94:95], v15 offset:48800
    ds_read_b64_tr_b16 v[96:97], v15 offset:44224
    ds_read_b64_tr_b16 v[98:99], v15 offset:48832
    s_waitcnt lgkmcnt(15)
    v_mfma_f32_16x16x32_bf16 v[132:135], v[60:63], v[20:23], v[132:135]
    v_mfma_f32_16x16x32_bf16 v[168:171], v[60:63], v[24:27], v[168:171]
    ds_read_b64_tr_b16 v[100:101], v15 offset:44256
    ds_read_b64_tr_b16 v[102:103], v15 offset:48864
    ds_read_b64_tr_b16 v[104:105], v15 offset:44288
    v_mfma_f32_16x16x32_bf16 v[136:139], v[64:67], v[20:23], v[136:139]
    v_mfma_f32_16x16x32_bf16 v[172:175], v[64:67], v[24:27], v[172:175]
    ds_read_b64_tr_b16 v[106:107], v15 offset:48896
    v_mfma_f32_16x16x32_bf16 v[140:143], v[68:71], v[20:23], v[140:143]
    v_mfma_f32_16x16x32_bf16 v[176:179], v[68:71], v[24:27], v[176:179]
    s_waitcnt lgkmcnt(0)
    s_waitcnt vmcnt(0)
    s_barrier
    s_add_u32 s4, s4, 128
    s_addc_u32 s5, s5, 0
    s_add_u32 s6, s6, s18
    s_addc_u32 s7, s7, 0
    s_lshl_b32 s9, s8, 12
    s_add_u32 m0, s9, 34816
    s_nop 0
    global_load_lds_dwordx4 v2, s[4:5]
    s_lshl_b32 s9, s8, 12
    s_add_u32 m0, s9, 35840
    s_nop 0
    global_load_lds_dwordx4 v3, s[4:5]
    s_lshl_b32 s9, s8, 12
    s_add_u32 m0, s9, 36864
    s_nop 0
    global_load_lds_dwordx4 v4, s[4:5]
    s_lshl_b32 s9, s8, 12
    s_add_u32 m0, s9, 37888
    s_nop 0
    global_load_lds_dwordx4 v5, s[4:5]
    s_mul_i32 s9, s8, 4608
    s_add_u32 m0, s9, 51200
    s_nop 0
    global_load_lds_dwordx4 v6, s[6:7]
    s_mul_i32 s9, s8, 4608
    s_add_u32 m0, s9, 52224
    s_nop 0
    global_load_lds_dwordx4 v7, s[6:7]
    s_mul_i32 s9, s8, 4608
    s_add_u32 m0, s9, 53248
    s_nop 0
    global_load_lds_dwordx4 v8, s[6:7]
    s_mul_i32 s9, s8, 4608
    s_add_u32 m0, s9, 54272
    s_nop 0
    global_load_lds_dwordx4 v9, s[6:7]
    s_mul_i32 s9, s8, 4608
    s_add_u32 m0, s9, 55296
    s_mov_b32 exec_hi, 0
    global_load_lds_dwordx4 v10, s[6:7]
    s_mov_b64 exec, -1
    v_mfma_f32_16x16x32_bf16 v[108:111], v[72:75], v[28:31], v[108:111]
    v_mfma_f32_16x16x32_bf16 v[144:147], v[72:75], v[32:35], v[144:147]
    ds_read_b64 v[20:21], v11 offset:0
    ds_read_b64 v[22:23], v12 offset:0
    ds_read_b64 v[24:25], v11 offset:2048
    v_mfma_f32_16x16x32_bf16 v[112:115], v[76:79], v[28:31], v[112:115]
    v_mfma_f32_16x16x32_bf16 v[148:151], v[76:79], v[32:35], v[148:151]
    ds_read_b64 v[26:27], v12 offset:2048
    ds_read_b64_tr_b16 v[36:37], v15 offset:0
    ds_read_b64_tr_b16 v[38:39], v15 offset:4608
    v_mfma_f32_16x16x32_bf16 v[116:119], v[80:83], v[28:31], v[116:119]
    v_mfma_f32_16x16x32_bf16 v[152:155], v[80:83], v[32:35], v[152:155]
    ds_read_b64_tr_b16 v[40:41], v15 offset:32
    ds_read_b64_tr_b16 v[42:43], v15 offset:4640
    ds_read_b64_tr_b16 v[44:45], v15 offset:64
    v_mfma_f32_16x16x32_bf16 v[120:123], v[84:87], v[28:31], v[120:123]
    v_mfma_f32_16x16x32_bf16 v[156:159], v[84:87], v[32:35], v[156:159]
    ds_read_b64_tr_b16 v[46:47], v15 offset:4672
    ds_read_b64_tr_b16 v[48:49], v15 offset:96
    ds_read_b64_tr_b16 v[50:51], v15 offset:4704
    v_mfma_f32_16x16x32_bf16 v[124:127], v[88:91], v[28:31], v[124:127]
    v_mfma_f32_16x16x32_bf16 v[160:163], v[88:91], v[32:35], v[160:163]
    ds_read_b64_tr_b16 v[52:53], v15 offset:128
    ds_read_b64_tr_b16 v[54:55], v15 offset:4736
    ds_read_b64_tr_b16 v[56:57], v15 offset:160
    v_mfma_f32_16x16x32_bf16 v[128:131], v[92:95], v[28:31], v[128:131]
    v_mfma_f32_16x16x32_bf16 v[164:167], v[92:95], v[32:35], v[164:167]
    ds_read_b64_tr_b16 v[58:59], v15 offset:4768
    ds_read_b64_tr_b16 v[60:61], v15 offset:192
    ds_read_b64_tr_b16 v[62:63], v15 offset:4800
    v_mfma_f32_16x16x32_bf16 v[132:135], v[96:99], v[28:31], v[132:135]
    v_mfma_f32_16x16x32_bf16 v[168:171], v[96:99], v[32:35], v[168:171]
    ds_read_b64_tr_b16 v[64:65], v15 offset:224
    ds_read_b64_tr_b16 v[66:67], v15 offset:4832
    ds_read_b64_tr_b16 v[68:69], v15 offset:256
    v_mfma_f32_16x16x32_bf16 v[136:139], v[100:103], v[28:31], v[136:139]
    v_mfma_f32_16x16x32_bf16 v[172:175], v[100:103], v[32:35], v[172:175]
    ds_read_b64_tr_b16 v[70:71], v15 offset:4864
    v_mfma_f32_16x16x32_bf16 v[140:143], v[104:107], v[28:31], v[140:143]
    v_mfma_f32_16x16x32_bf16 v[176:179], v[104:107], v[32:35], v[176:179]
    s_waitcnt lgkmcnt(15)
    v_mfma_f32_16x16x32_bf16 v[108:111], v[36:39], v[20:23], v[108:111]
    v_mfma_f32_16x16x32_bf16 v[144:147], v[36:39], v[24:27], v[144:147]
    ds_read_b64 v[28:29], v13 offset:0
    ds_read_b64 v[30:31], v14 offset:0
    ds_read_b64 v[32:33], v13 offset:2048
    s_waitcnt lgkmcnt(15)
    v_mfma_f32_16x16x32_bf16 v[112:115], v[40:43], v[20:23], v[112:115]
    v_mfma_f32_16x16x32_bf16 v[148:151], v[40:43], v[24:27], v[148:151]
    ds_read_b64 v[34:35], v14 offset:2048
    ds_read_b64_tr_b16 v[72:73], v15 offset:9216
    ds_read_b64_tr_b16 v[74:75], v15 offset:13824
    v_mfma_f32_16x16x32_bf16 v[116:119], v[44:47], v[20:23], v[116:119]
    v_mfma_f32_16x16x32_bf16 v[152:155], v[44:47], v[24:27], v[152:155]
    ds_read_b64_tr_b16 v[76:77], v15 offset:9248
    ds_read_b64_tr_b16 v[78:79], v15 offset:13856
    ds_read_b64_tr_b16 v[80:81], v15 offset:9280
    s_waitcnt lgkmcnt(15)
    v_mfma_f32_16x16x32_bf16 v[120:123], v[48:51], v[20:23], v[120:123]
    v_mfma_f32_16x16x32_bf16 v[156:159], v[48:51], v[24:27], v[156:159]
    ds_read_b64_tr_b16 v[82:83], v15 offset:13888
    ds_read_b64_tr_b16 v[84:85], v15 offset:9312
    ds_read_b64_tr_b16 v[86:87], v15 offset:13920
    v_mfma_f32_16x16x32_bf16 v[124:127], v[52:55], v[20:23], v[124:127]
    v_mfma_f32_16x16x32_bf16 v[160:163], v[52:55], v[24:27], v[160:163]
    ds_read_b64_tr_b16 v[88:89], v15 offset:9344
    ds_read_b64_tr_b16 v[90:91], v15 offset:13952
    ds_read_b64_tr_b16 v[92:93], v15 offset:9376
    v_mfma_f32_16x16x32_bf16 v[128:131], v[56:59], v[20:23], v[128:131]
    v_mfma_f32_16x16x32_bf16 v[164:167], v[56:59], v[24:27], v[164:167]
    ds_read_b64_tr_b16 v[94:95], v15 offset:13984
    ds_read_b64_tr_b16 v[96:97], v15 offset:9408
    ds_read_b64_tr_b16 v[98:99], v15 offset:14016
    s_waitcnt lgkmcnt(15)
    v_mfma_f32_16x16x32_bf16 v[132:135], v[60:63], v[20:23], v[132:135]
    v_mfma_f32_16x16x32_bf16 v[168:171], v[60:63], v[24:27], v[168:171]
    ds_read_b64_tr_b16 v[100:101], v15 offset:9440
    ds_read_b64_tr_b16 v[102:103], v15 offset:14048
    ds_read_b64_tr_b16 v[104:105], v15 offset:9472
    v_mfma_f32_16x16x32_bf16 v[136:139], v[64:67], v[20:23], v[136:139]
    v_mfma_f32_16x16x32_bf16 v[172:175], v[64:67], v[24:27], v[172:175]
    ds_read_b64_tr_b16 v[106:107], v15 offset:14080
    v_mfma_f32_16x16x32_bf16 v[140:143], v[68:71], v[20:23], v[140:143]
    v_mfma_f32_16x16x32_bf16 v[176:179], v[68:71], v[24:27], v[176:179]
    s_waitcnt lgkmcnt(0)
    s_waitcnt vmcnt(0)
    s_barrier
    s_add_u32 s4, s4, 128
    s_addc_u32 s5, s5, 0
    s_add_u32 s6, s6, s18
    s_addc_u32 s7, s7, 0
    s_lshl_b32 s9, s8, 12
    s_add_u32 m0, s9, 0
    s_nop 0
    global_load_lds_dwordx4 v2, s[4:5]
    s_lshl_b32 s9, s8, 12
    s_add_u32 m0, s9, 1024
    s_nop 0
    global_load_lds_dwordx4 v3, s[4:5]
    s_lshl_b32 s9, s8, 12
    s_add_u32 m0, s9, 2048
    s_nop 0
    global_load_lds_dwordx4 v4, s[4:5]
    s_lshl_b32 s9, s8, 12
    s_add_u32 m0, s9, 3072
    s_nop 0
    global_load_lds_dwordx4 v5, s[4:5]
    s_mul_i32 s9, s8, 4608
    s_add_u32 m0, s9, 16384
    s_nop 0
    global_load_lds_dwordx4 v6, s[6:7]
    s_mul_i32 s9, s8, 4608
    s_add_u32 m0, s9, 17408
    s_nop 0
    global_load_lds_dwordx4 v7, s[6:7]
    s_mul_i32 s9, s8, 4608
    s_add_u32 m0, s9, 18432
    s_nop 0
    global_load_lds_dwordx4 v8, s[6:7]
    s_mul_i32 s9, s8, 4608
    s_add_u32 m0, s9, 19456
    s_nop 0
    global_load_lds_dwordx4 v9, s[6:7]
    s_mul_i32 s9, s8, 4608
    s_add_u32 m0, s9, 20480
    s_mov_b32 exec_hi, 0
    global_load_lds_dwordx4 v10, s[6:7]
    s_mov_b64 exec, -1
    v_mfma_f32_16x16x32_bf16 v[108:111], v[72:75], v[28:31], v[108:111]
    v_mfma_f32_16x16x32_bf16 v[144:147], v[72:75], v[32:35], v[144:147]
    ds_read_b64 v[20:21], v11 offset:34816
    ds_read_b64 v[22:23], v12 offset:34816
    ds_read_b64 v[24:25], v11 offset:36864
    v_mfma_f32_16x16x32_bf16 v[112:115], v[76:79], v[28:31], v[112:115]
    v_mfma_f32_16x16x32_bf16 v[148:151], v[76:79], v[32:35], v[148:151]
    ds_read_b64 v[26:27], v12 offset:36864
    ds_read_b64_tr_b16 v[36:37], v15 offset:34816
    ds_read_b64_tr_b16 v[38:39], v15 offset:39424
    v_mfma_f32_16x16x32_bf16 v[116:119], v[80:83], v[28:31], v[116:119]
    v_mfma_f32_16x16x32_bf16 v[152:155], v[80:83], v[32:35], v[152:155]
    ds_read_b64_tr_b16 v[40:41], v15 offset:34848
    ds_read_b64_tr_b16 v[42:43], v15 offset:39456
    ds_read_b64_tr_b16 v[44:45], v15 offset:34880
    v_mfma_f32_16x16x32_bf16 v[120:123], v[84:87], v[28:31], v[120:123]
    v_mfma_f32_16x16x32_bf16 v[156:159], v[84:87], v[32:35], v[156:159]
    ds_read_b64_tr_b16 v[46:47], v15 offset:39488
    ds_read_b64_tr_b16 v[48:49], v15 offset:34912
    ds_read_b64_tr_b16 v[50:51], v15 offset:39520
    v_mfma_f32_16x16x32_bf16 v[124:127], v[88:91], v[28:31], v[124:127]
    v_mfma_f32_16x16x32_bf16 v[160:163], v[88:91], v[32:35], v[160:163]
    ds_read_b64_tr_b16 v[52:53], v15 offset:34944
    ds_read_b64_tr_b16 v[54:55], v15 offset:39552
    ds_read_b64_tr_b16 v[56:57], v15 offset:34976
    v_mfma_f32_16x16x32_bf16 v[128:131], v[92:95], v[28:31], v[128:131]
    v_mfma_f32_16x16x32_bf16 v[164:167], v[92:95], v[32:35], v[164:167]
    ds_read_b64_tr_b16 v[58:59], v15 offset:39584
    ds_read_b64_tr_b16 v[60:61], v15 offset:35008
    ds_read_b64_tr_b16 v[62:63], v15 offset:39616
    v_mfma_f32_16x16x32_bf16 v[132:135], v[96:99], v[28:31], v[132:135]
    v_mfma_f32_16x16x32_bf16 v[168:171], v[96:99], v[32:35], v[168:171]
    ds_read_b64_tr_b16 v[64:65], v15 offset:35040
    ds_read_b64_tr_b16 v[66:67], v15 offset:39648
    ds_read_b64_tr_b16 v[68:69], v15 offset:35072
    v_mfma_f32_16x16x32_bf16 v[136:139], v[100:103], v[28:31], v[136:139]
    v_mfma_f32_16x16x32_bf16 v[172:175], v[100:103], v[32:35], v[172:175]
    ds_read_b64_tr_b16 v[70:71], v15 offset:39680
    v_mfma_f32_16x16x32_bf16 v[140:143], v[104:107], v[28:31], v[140:143]
    v_mfma_f32_16x16x32_bf16 v[176:179], v[104:107], v[32:35], v[176:179]
    s_waitcnt lgkmcnt(15)
    v_mfma_f32_16x16x32_bf16 v[108:111], v[36:39], v[20:23], v[108:111]
    v_mfma_f32_16x16x32_bf16 v[144:147], v[36:39], v[24:27], v[144:147]
    ds_read_b64 v[28:29], v13 offset:34816
    ds_read_b64 v[30:31], v14 offset:34816
    ds_read_b64 v[32:33], v13 offset:36864
    s_waitcnt lgkmcnt(15)
    v_mfma_f32_16x16x32_bf16 v[112:115], v[40:43], v[20:23], v[112:115]
    v_mfma_f32_16x16x32_bf16 v[148:151], v[40:43], v[24:27], v[148:151]
    ds_read_b64 v[34:35], v14 offset:36864
    ds_read_b64_tr_b16 v[72:73], v15 offset:44032
    ds_read_b64_tr_b16 v[74:75], v15 offset:48640
    v_mfma_f32_16x16x32_bf16 v[116:119], v[44:47], v[20:23], v[116:119]
    v_mfma_f32_16x16x32_bf16 v[152:155], v[44:47], v[24:27], v[152:155]
    ds_read_b64_tr_b16 v[76:77], v15 offset:44064
    ds_read_b64_tr_b16 v[78:79], v15 offset:48672
    ds_read_b64_tr_b16 v[80:81], v15 offset:44096
    s_waitcnt lgkmcnt(15)
    v_mfma_f32_16x16x32_bf16 v[120:123], v[48:51], v[20:23], v[120:123]
    v_mfma_f32_16x16x32_bf16 v[156:159], v[48:51], v[24:27], v[156:159]
    ds_read_b64_tr_b16 v[82:83], v15 offset:48704
    ds_read_b64_tr_b16 v[84:85], v15 offset:44128
    ds_read_b64_tr_b16 v[86:87], v15 offset:48736
    v_mfma_f32_16x16x32_bf16 v[124:127], v[52:55], v[20:23], v[124:127]
    v_mfma_f32_16x16x32_bf16 v[160:163], v[52:55], v[24:27], v[160:163]
    ds_read_b64_tr_b16 v[88:89], v15 offset:44160
    ds_read_b64_tr_b16 v[90:91], v15 offset:48768
    ds_read_b64_tr_b16 v[92:93], v15 offset:44192
    v_mfma_f32_16x16x32_bf16 v[128:131], v[56:59], v[20:23], v[128:131]
    v_mfma_f32_16x16x32_bf16 v[164:167], v[56:59], v[24:27], v[164:167]
    ds_read_b64_tr_b16 v[94:95], v15 offset:48800
    ds_read_b64_tr_b16 v[96:97], v15 offset:44224
    ds_read_b64_tr_b16 v[98:99], v15 offset:48832
    s_waitcnt lgkmcnt(15)
    v_mfma_f32_16x16x32_bf16 v[132:135], v[60:63], v[20:23], v[132:135]
    v_mfma_f32_16x16x32_bf16 v[168:171], v[60:63], v[24:27], v[168:171]
    ds_read_b64_tr_b16 v[100:101], v15 offset:44256
    ds_read_b64_tr_b16 v[102:103], v15 offset:48864
    ds_read_b64_tr_b16 v[104:105], v15 offset:44288
    v_mfma_f32_16x16x32_bf16 v[136:139], v[64:67], v[20:23], v[136:139]
    v_mfma_f32_16x16x32_bf16 v[172:175], v[64:67], v[24:27], v[172:175]
    ds_read_b64_tr_b16 v[106:107], v15 offset:48896
    v_mfma_f32_16x16x32_bf16 v[140:143], v[68:71], v[20:23], v[140:143]
    v_mfma_f32_16x16x32_bf16 v[176:179], v[68:71], v[24:27], v[176:179]
    s_waitcnt lgkmcnt(0)
    s_waitcnt vmcnt(0)
    s_barrier
    s_add_u32 s4, s4, 128
    s_addc_u32 s5, s5, 0
    s_add_u32 s6, s6, s18
    s_addc_u32 s7, s7, 0
    s_lshl_b32 s9, s8, 12
    s_add_u32 m0, s9, 34816
    s_nop 0
    global_load_lds_dwordx4 v2, s[4:5]
    s_lshl_b32 s9, s8, 12
    s_add_u32 m0, s9, 35840
    s_nop 0
    global_load_lds_dwordx4 v3, s[4:5]
    s_lshl_b32 s9, s8, 12
    s_add_u32 m0, s9, 36864
    s_nop 0
    global_load_lds_dwordx4 v4, s[4:5]
    s_lshl_b32 s9, s8, 12
    s_add_u32 m0, s9, 37888
    s_nop 0
    global_load_lds_dwordx4 v5, s[4:5]
    s_mul_i32 s9, s8, 4608
    s_add_u32 m0, s9, 51200
    s_nop 0
    global_load_lds_dwordx4 v6, s[6:7]
    s_mul_i32 s9, s8, 4608
    s_add_u32 m0, s9, 52224
    s_nop 0
    global_load_lds_dwordx4 v7, s[6:7]
    s_mul_i32 s9, s8, 4608
    s_add_u32 m0, s9, 53248
    s_nop 0
    global_load_lds_dwordx4 v8, s[6:7]
    s_mul_i32 s9, s8, 4608
    s_add_u32 m0, s9, 54272
    s_nop 0
    global_load_lds_dwordx4 v9, s[6:7]
    s_mul_i32 s9, s8, 4608
    s_add_u32 m0, s9, 55296
    s_mov_b32 exec_hi, 0
    global_load_lds_dwordx4 v10, s[6:7]
    s_mov_b64 exec, -1
    v_mfma_f32_16x16x32_bf16 v[108:111], v[72:75], v[28:31], v[108:111]
    v_mfma_f32_16x16x32_bf16 v[144:147], v[72:75], v[32:35], v[144:147]
    ds_read_b64 v[20:21], v11 offset:0
    ds_read_b64 v[22:23], v12 offset:0
    ds_read_b64 v[24:25], v11 offset:2048
    v_mfma_f32_16x16x32_bf16 v[112:115], v[76:79], v[28:31], v[112:115]
    v_mfma_f32_16x16x32_bf16 v[148:151], v[76:79], v[32:35], v[148:151]
    ds_read_b64 v[26:27], v12 offset:2048
    ds_read_b64_tr_b16 v[36:37], v15 offset:0
    ds_read_b64_tr_b16 v[38:39], v15 offset:4608
    v_mfma_f32_16x16x32_bf16 v[116:119], v[80:83], v[28:31], v[116:119]
    v_mfma_f32_16x16x32_bf16 v[152:155], v[80:83], v[32:35], v[152:155]
    ds_read_b64_tr_b16 v[40:41], v15 offset:32
    ds_read_b64_tr_b16 v[42:43], v15 offset:4640
    ds_read_b64_tr_b16 v[44:45], v15 offset:64
    v_mfma_f32_16x16x32_bf16 v[120:123], v[84:87], v[28:31], v[120:123]
    v_mfma_f32_16x16x32_bf16 v[156:159], v[84:87], v[32:35], v[156:159]
    ds_read_b64_tr_b16 v[46:47], v15 offset:4672
    ds_read_b64_tr_b16 v[48:49], v15 offset:96
    ds_read_b64_tr_b16 v[50:51], v15 offset:4704
    v_mfma_f32_16x16x32_bf16 v[124:127], v[88:91], v[28:31], v[124:127]
    v_mfma_f32_16x16x32_bf16 v[160:163], v[88:91], v[32:35], v[160:163]
    ds_read_b64_tr_b16 v[52:53], v15 offset:128
    ds_read_b64_tr_b16 v[54:55], v15 offset:4736
    ds_read_b64_tr_b16 v[56:57], v15 offset:160
    v_mfma_f32_16x16x32_bf16 v[128:131], v[92:95], v[28:31], v[128:131]
    v_mfma_f32_16x16x32_bf16 v[164:167], v[92:95], v[32:35], v[164:167]
    ds_read_b64_tr_b16 v[58:59], v15 offset:4768
    ds_read_b64_tr_b16 v[60:61], v15 offset:192
    ds_read_b64_tr_b16 v[62:63], v15 offset:4800
    v_mfma_f32_16x16x32_bf16 v[132:135], v[96:99], v[28:31], v[132:135]
    v_mfma_f32_16x16x32_bf16 v[168:171], v[96:99], v[32:35], v[168:171]
    ds_read_b64_tr_b16 v[64:65], v15 offset:224
    ds_read_b64_tr_b16 v[66:67], v15 offset:4832
    ds_read_b64_tr_b16 v[68:69], v15 offset:256
    v_mfma_f32_16x16x32_bf16 v[136:139], v[100:103], v[28:31], v[136:139]
    v_mfma_f32_16x16x32_bf16 v[172:175], v[100:103], v[32:35], v[172:175]
    ds_read_b64_tr_b16 v[70:71], v15 offset:4864
    v_mfma_f32_16x16x32_bf16 v[140:143], v[104:107], v[28:31], v[140:143]
    v_mfma_f32_16x16x32_bf16 v[176:179], v[104:107], v[32:35], v[176:179]
    s_waitcnt lgkmcnt(15)
    v_mfma_f32_16x16x32_bf16 v[108:111], v[36:39], v[20:23], v[108:111]
    v_mfma_f32_16x16x32_bf16 v[144:147], v[36:39], v[24:27], v[144:147]
    ds_read_b64 v[28:29], v13 offset:0
    ds_read_b64 v[30:31], v14 offset:0
    ds_read_b64 v[32:33], v13 offset:2048
    s_waitcnt lgkmcnt(15)
    v_mfma_f32_16x16x32_bf16 v[112:115], v[40:43], v[20:23], v[112:115]
    v_mfma_f32_16x16x32_bf16 v[148:151], v[40:43], v[24:27], v[148:151]
    ds_read_b64 v[34:35], v14 offset:2048
    ds_read_b64_tr_b16 v[72:73], v15 offset:9216
    ds_read_b64_tr_b16 v[74:75], v15 offset:13824
    v_mfma_f32_16x16x32_bf16 v[116:119], v[44:47], v[20:23], v[116:119]
    v_mfma_f32_16x16x32_bf16 v[152:155], v[44:47], v[24:27], v[152:155]
    ds_read_b64_tr_b16 v[76:77], v15 offset:9248
    ds_read_b64_tr_b16 v[78:79], v15 offset:13856
    ds_read_b64_tr_b16 v[80:81], v15 offset:9280
    s_waitcnt lgkmcnt(15)
    v_mfma_f32_16x16x32_bf16 v[120:123], v[48:51], v[20:23], v[120:123]
    v_mfma_f32_16x16x32_bf16 v[156:159], v[48:51], v[24:27], v[156:159]
    ds_read_b64_tr_b16 v[82:83], v15 offset:13888
    ds_read_b64_tr_b16 v[84:85], v15 offset:9312
    ds_read_b64_tr_b16 v[86:87], v15 offset:13920
    v_mfma_f32_16x16x32_bf16 v[124:127], v[52:55], v[20:23], v[124:127]
    v_mfma_f32_16x16x32_bf16 v[160:163], v[52:55], v[24:27], v[160:163]
    ds_read_b64_tr_b16 v[88:89], v15 offset:9344
    ds_read_b64_tr_b16 v[90:91], v15 offset:13952
    ds_read_b64_tr_b16 v[92:93], v15 offset:9376
    v_mfma_f32_16x16x32_bf16 v[128:131], v[56:59], v[20:23], v[128:131]
    v_mfma_f32_16x16x32_bf16 v[164:167], v[56:59], v[24:27], v[164:167]
    ds_read_b64_tr_b16 v[94:95], v15 offset:13984
    ds_read_b64_tr_b16 v[96:97], v15 offset:9408
    ds_read_b64_tr_b16 v[98:99], v15 offset:14016
    s_waitcnt lgkmcnt(15)
    v_mfma_f32_16x16x32_bf16 v[132:135], v[60:63], v[20:23], v[132:135]
    v_mfma_f32_16x16x32_bf16 v[168:171], v[60:63], v[24:27], v[168:171]
    ds_read_b64_tr_b16 v[100:101], v15 offset:9440
    ds_read_b64_tr_b16 v[102:103], v15 offset:14048
    ds_read_b64_tr_b16 v[104:105], v15 offset:9472
    v_mfma_f32_16x16x32_bf16 v[136:139], v[64:67], v[20:23], v[136:139]
    v_mfma_f32_16x16x32_bf16 v[172:175], v[64:67], v[24:27], v[172:175]
    ds_read_b64_tr_b16 v[106:107], v15 offset:14080
    v_mfma_f32_16x16x32_bf16 v[140:143], v[68:71], v[20:23], v[140:143]
    v_mfma_f32_16x16x32_bf16 v[176:179], v[68:71], v[24:27], v[176:179]
    s_waitcnt lgkmcnt(0)
    s_waitcnt vmcnt(0)
    s_barrier
    s_add_u32 s4, s4, 128
    s_addc_u32 s5, s5, 0
    s_add_u32 s6, s6, s18
    s_addc_u32 s7, s7, 0
    s_lshl_b32 s9, s8, 12
    s_add_u32 m0, s9, 0
    s_nop 0
    global_load_lds_dwordx4 v2, s[4:5]
    s_lshl_b32 s9, s8, 12
    s_add_u32 m0, s9, 1024
    s_nop 0
    global_load_lds_dwordx4 v3, s[4:5]
    s_lshl_b32 s9, s8, 12
    s_add_u32 m0, s9, 2048
    s_nop 0
    global_load_lds_dwordx4 v4, s[4:5]
    s_lshl_b32 s9, s8, 12
    s_add_u32 m0, s9, 3072
    s_nop 0
    global_load_lds_dwordx4 v5, s[4:5]
    s_mul_i32 s9, s8, 4608
    s_add_u32 m0, s9, 16384
    s_nop 0
    global_load_lds_dwordx4 v6, s[6:7]
    s_mul_i32 s9, s8, 4608
    s_add_u32 m0, s9, 17408
    s_nop 0
    global_load_lds_dwordx4 v7, s[6:7]
    s_mul_i32 s9, s8, 4608
    s_add_u32 m0, s9, 18432
    s_nop 0
    global_load_lds_dwordx4 v8, s[6:7]
    s_mul_i32 s9, s8, 4608
    s_add_u32 m0, s9, 19456
    s_nop 0
    global_load_lds_dwordx4 v9, s[6:7]
    s_mul_i32 s9, s8, 4608
    s_add_u32 m0, s9, 20480
    s_mov_b32 exec_hi, 0
    global_load_lds_dwordx4 v10, s[6:7]
    s_mov_b64 exec, -1
    v_mfma_f32_16x16x32_bf16 v[108:111], v[72:75], v[28:31], v[108:111]
    v_mfma_f32_16x16x32_bf16 v[144:147], v[72:75], v[32:35], v[144:147]
    ds_read_b64 v[20:21], v11 offset:34816
    ds_read_b64 v[22:23], v12 offset:34816
    ds_read_b64 v[24:25], v11 offset:36864
    v_mfma_f32_16x16x32_bf16 v[112:115], v[76:79], v[28:31], v[112:115]
    v_mfma_f32_16x16x32_bf16 v[148:151], v[76:79], v[32:35], v[148:151]
    ds_read_b64 v[26:27], v12 offset:36864
    ds_read_b64_tr_b16 v[36:37], v15 offset:34816
    ds_read_b64_tr_b16 v[38:39], v15 offset:39424
    v_mfma_f32_16x16x32_bf16 v[116:119], v[80:83], v[28:31], v[116:119]
    v_mfma_f32_16x16x32_bf16 v[152:155], v[80:83], v[32:35], v[152:155]
    ds_read_b64_tr_b16 v[40:41], v15 offset:34848
    ds_read_b64_tr_b16 v[42:43], v15 offset:39456
    ds_read_b64_tr_b16 v[44:45], v15 offset:34880
    v_mfma_f32_16x16x32_bf16 v[120:123], v[84:87], v[28:31], v[120:123]
    v_mfma_f32_16x16x32_bf16 v[156:159], v[84:87], v[32:35], v[156:159]
    ds_read_b64_tr_b16 v[46:47], v15 offset:39488
    ds_read_b64_tr_b16 v[48:49], v15 offset:34912
    ds_read_b64_tr_b16 v[50:51], v15 offset:39520
    v_mfma_f32_16x16x32_bf16 v[124:127], v[88:91], v[28:31], v[124:127]
    v_mfma_f32_16x16x32_bf16 v[160:163], v[88:91], v[32:35], v[160:163]
    ds_read_b64_tr_b16 v[52:53], v15 offset:34944
    ds_read_b64_tr_b16 v[54:55], v15 offset:39552
    ds_read_b64_tr_b16 v[56:57], v15 offset:34976
    v_mfma_f32_16x16x32_bf16 v[128:131], v[92:95], v[28:31], v[128:131]
    v_mfma_f32_16x16x32_bf16 v[164:167], v[92:95], v[32:35], v[164:167]
    ds_read_b64_tr_b16 v[58:59], v15 offset:39584
    ds_read_b64_tr_b16 v[60:61], v15 offset:35008
    ds_read_b64_tr_b16 v[62:63], v15 offset:39616
    v_mfma_f32_16x16x32_bf16 v[132:135], v[96:99], v[28:31], v[132:135]
    v_mfma_f32_16x16x32_bf16 v[168:171], v[96:99], v[32:35], v[168:171]
    ds_read_b64_tr_b16 v[64:65], v15 offset:35040
    ds_read_b64_tr_b16 v[66:67], v15 offset:39648
    ds_read_b64_tr_b16 v[68:69], v15 offset:35072
    v_mfma_f32_16x16x32_bf16 v[136:139], v[100:103], v[28:31], v[136:139]
    v_mfma_f32_16x16x32_bf16 v[172:175], v[100:103], v[32:35], v[172:175]
    ds_read_b64_tr_b16 v[70:71], v15 offset:39680
    v_mfma_f32_16x16x32_bf16 v[140:143], v[104:107], v[28:31], v[140:143]
    v_mfma_f32_16x16x32_bf16 v[176:179], v[104:107], v[32:35], v[176:179]
    s_waitcnt lgkmcnt(15)
    v_mfma_f32_16x16x32_bf16 v[108:111], v[36:39], v[20:23], v[108:111]
    v_mfma_f32_16x16x32_bf16 v[144:147], v[36:39], v[24:27], v[144:147]
    ds_read_b64 v[28:29], v13 offset:34816
    ds_read_b64 v[30:31], v14 offset:34816
    ds_read_b64 v[32:33], v13 offset:36864
    s_waitcnt lgkmcnt(15)
    v_mfma_f32_16x16x32_bf16 v[112:115], v[40:43], v[20:23], v[112:115]
    v_mfma_f32_16x16x32_bf16 v[148:151], v[40:43], v[24:27], v[148:151]
    ds_read_b64 v[34:35], v14 offset:36864
    ds_read_b64_tr_b16 v[72:73], v15 offset:44032
    ds_read_b64_tr_b16 v[74:75], v15 offset:48640
    v_mfma_f32_16x16x32_bf16 v[116:119], v[44:47], v[20:23], v[116:119]
    v_mfma_f32_16x16x32_bf16 v[152:155], v[44:47], v[24:27], v[152:155]
    ds_read_b64_tr_b16 v[76:77], v15 offset:44064
    ds_read_b64_tr_b16 v[78:79], v15 offset:48672
    ds_read_b64_tr_b16 v[80:81], v15 offset:44096
    s_waitcnt lgkmcnt(15)
    v_mfma_f32_16x16x32_bf16 v[120:123], v[48:51], v[20:23], v[120:123]
    v_mfma_f32_16x16x32_bf16 v[156:159], v[48:51], v[24:27], v[156:159]
    ds_read_b64_tr_b16 v[82:83], v15 offset:48704
    ds_read_b64_tr_b16 v[84:85], v15 offset:44128
    ds_read_b64_tr_b16 v[86:87], v15 offset:48736
    v_mfma_f32_16x16x32_bf16 v[124:127], v[52:55], v[20:23], v[124:127]
    v_mfma_f32_16x16x32_bf16 v[160:163], v[52:55], v[24:27], v[160:163]
    ds_read_b64_tr_b16 v[88:89], v15 offset:44160
    ds_read_b64_tr_b16 v[90:91], v15 offset:48768
    ds_read_b64_tr_b16 v[92:93], v15 offset:44192
    v_mfma_f32_16x16x32_bf16 v[128:131], v[56:59], v[20:23], v[128:131]
    v_mfma_f32_16x16x32_bf16 v[164:167], v[56:59], v[24:27], v[164:167]
    ds_read_b64_tr_b16 v[94:95], v15 offset:48800
    ds_read_b64_tr_b16 v[96:97], v15 offset:44224
    ds_read_b64_tr_b16 v[98:99], v15 offset:48832
    s_waitcnt lgkmcnt(15)
    v_mfma_f32_16x16x32_bf16 v[132:135], v[60:63], v[20:23], v[132:135]
    v_mfma_f32_16x16x32_bf16 v[168:171], v[60:63], v[24:27], v[168:171]
    ds_read_b64_tr_b16 v[100:101], v15 offset:44256
    ds_read_b64_tr_b16 v[102:103], v15 offset:48864
    ds_read_b64_tr_b16 v[104:105], v15 offset:44288
    v_mfma_f32_16x16x32_bf16 v[136:139], v[64:67], v[20:23], v[136:139]
    v_mfma_f32_16x16x32_bf16 v[172:175], v[64:67], v[24:27], v[172:175]
    ds_read_b64_tr_b16 v[106:107], v15 offset:48896
    v_mfma_f32_16x16x32_bf16 v[140:143], v[68:71], v[20:23], v[140:143]
    v_mfma_f32_16x16x32_bf16 v[176:179], v[68:71], v[24:27], v[176:179]
    s_waitcnt lgkmcnt(0)
    s_waitcnt vmcnt(0)
    s_barrier
    v_mfma_f32_16x16x32_bf16 v[108:111], v[72:75], v[28:31], v[108:111]
    v_mfma_f32_16x16x32_bf16 v[144:147], v[72:75], v[32:35], v[144:147]
    ds_read_b64 v[20:21], v11 offset:0
    ds_read_b64 v[22:23], v12 offset:0
    ds_read_b64 v[24:25], v11 offset:2048
    v_mfma_f32_16x16x32_bf16 v[112:115], v[76:79], v[28:31], v[112:115]
    v_mfma_f32_16x16x32_bf16 v[148:151], v[76:79], v[32:35], v[148:151]
    ds_read_b64 v[26:27], v12 offset:2048
    ds_read_b64_tr_b16 v[36:37], v15 offset:0
    ds_read_b64_tr_b16 v[38:39], v15 offset:4608
    v_mfma_f32_16x16x32_bf16 v[116:119], v[80:83], v[28:31], v[116:119]
    v_mfma_f32_16x16x32_bf16 v[152:155], v[80:83], v[32:35], v[152:155]
    ds_read_b64_tr_b16 v[40:41], v15 offset:32
    ds_read_b64_tr_b16 v[42:43], v15 offset:4640
    ds_read_b64_tr_b16 v[44:45], v15 offset:64
    v_mfma_f32_16x16x32_bf16 v[120:123], v[84:87], v[28:31], v[120:123]
    v_mfma_f32_16x16x32_bf16 v[156:159], v[84:87], v[32:35], v[156:159]
    ds_read_b64_tr_b16 v[46:47], v15 offset:4672
    ds_read_b64_tr_b16 v[48:49], v15 offset:96
    ds_read_b64_tr_b16 v[50:51], v15 offset:4704
    v_mfma_f32_16x16x32_bf16 v[124:127], v[88:91], v[28:31], v[124:127]
    v_mfma_f32_16x16x32_bf16 v[160:163], v[88:91], v[32:35], v[160:163]
    ds_read_b64_tr_b16 v[52:53], v15 offset:128
    ds_read_b64_tr_b16 v[54:55], v15 offset:4736
    ds_read_b64_tr_b16 v[56:57], v15 offset:160
    v_mfma_f32_16x16x32_bf16 v[128:131], v[92:95], v[28:31], v[128:131]
    v_mfma_f32_16x16x32_bf16 v[164:167], v[92:95], v[32:35], v[164:167]
    ds_read_b64_tr_b16 v[58:59], v15 offset:4768
    ds_read_b64_tr_b16 v[60:61], v15 offset:192
    ds_read_b64_tr_b16 v[62:63], v15 offset:4800
    v_mfma_f32_16x16x32_bf16 v[132:135], v[96:99], v[28:31], v[132:135]
    v_mfma_f32_16x16x32_bf16 v[168:171], v[96:99], v[32:35], v[168:171]
    ds_read_b64_tr_b16 v[64:65], v15 offset:224
    ds_read_b64_tr_b16 v[66:67], v15 offset:4832
    ds_read_b64_tr_b16 v[68:69], v15 offset:256
    v_mfma_f32_16x16x32_bf16 v[136:139], v[100:103], v[28:31], v[136:139]
    v_mfma_f32_16x16x32_bf16 v[172:175], v[100:103], v[32:35], v[172:175]
    ds_read_b64_tr_b16 v[70:71], v15 offset:4864
    v_mfma_f32_16x16x32_bf16 v[140:143], v[104:107], v[28:31], v[140:143]
    v_mfma_f32_16x16x32_bf16 v[176:179], v[104:107], v[32:35], v[176:179]
    s_waitcnt lgkmcnt(15)
    v_mfma_f32_16x16x32_bf16 v[108:111], v[36:39], v[20:23], v[108:111]
    v_mfma_f32_16x16x32_bf16 v[144:147], v[36:39], v[24:27], v[144:147]
    ds_read_b64 v[28:29], v13 offset:0
    ds_read_b64 v[30:31], v14 offset:0
    ds_read_b64 v[32:33], v13 offset:2048
    s_waitcnt lgkmcnt(15)
    v_mfma_f32_16x16x32_bf16 v[112:115], v[40:43], v[20:23], v[112:115]
    v_mfma_f32_16x16x32_bf16 v[148:151], v[40:43], v[24:27], v[148:151]
    ds_read_b64 v[34:35], v14 offset:2048
    ds_read_b64_tr_b16 v[72:73], v15 offset:9216
    ds_read_b64_tr_b16 v[74:75], v15 offset:13824
    v_mfma_f32_16x16x32_bf16 v[116:119], v[44:47], v[20:23], v[116:119]
    v_mfma_f32_16x16x32_bf16 v[152:155], v[44:47], v[24:27], v[152:155]
    ds_read_b64_tr_b16 v[76:77], v15 offset:9248
    ds_read_b64_tr_b16 v[78:79], v15 offset:13856
    ds_read_b64_tr_b16 v[80:81], v15 offset:9280
    s_waitcnt lgkmcnt(15)
    v_mfma_f32_16x16x32_bf16 v[120:123], v[48:51], v[20:23], v[120:123]
    v_mfma_f32_16x16x32_bf16 v[156:159], v[48:51], v[24:27], v[156:159]
    ds_read_b64_tr_b16 v[82:83], v15 offset:13888
    ds_read_b64_tr_b16 v[84:85], v15 offset:9312
    ds_read_b64_tr_b16 v[86:87], v15 offset:13920
    v_mfma_f32_16x16x32_bf16 v[124:127], v[52:55], v[20:23], v[124:127]
    v_mfma_f32_16x16x32_bf16 v[160:163], v[52:55], v[24:27], v[160:163]
    ds_read_b64_tr_b16 v[88:89], v15 offset:9344
    ds_read_b64_tr_b16 v[90:91], v15 offset:13952
    ds_read_b64_tr_b16 v[92:93], v15 offset:9376
    v_mfma_f32_16x16x32_bf16 v[128:131], v[56:59], v[20:23], v[128:131]
    v_mfma_f32_16x16x32_bf16 v[164:167], v[56:59], v[24:27], v[164:167]
    ds_read_b64_tr_b16 v[94:95], v15 offset:13984
    ds_read_b64_tr_b16 v[96:97], v15 offset:9408
    ds_read_b64_tr_b16 v[98:99], v15 offset:14016
    s_waitcnt lgkmcnt(15)
    v_mfma_f32_16x16x32_bf16 v[132:135], v[60:63], v[20:23], v[132:135]
    v_mfma_f32_16x16x32_bf16 v[168:171], v[60:63], v[24:27], v[168:171]
    ds_read_b64_tr_b16 v[100:101], v15 offset:9440
    ds_read_b64_tr_b16 v[102:103], v15 offset:14048
    ds_read_b64_tr_b16 v[104:105], v15 offset:9472
    v_mfma_f32_16x16x32_bf16 v[136:139], v[64:67], v[20:23], v[136:139]
    v_mfma_f32_16x16x32_bf16 v[172:175], v[64:67], v[24:27], v[172:175]
    ds_read_b64_tr_b16 v[106:107], v15 offset:14080
    v_mfma_f32_16x16x32_bf16 v[140:143], v[68:71], v[20:23], v[140:143]
    v_mfma_f32_16x16x32_bf16 v[176:179], v[68:71], v[24:27], v[176:179]
    s_waitcnt lgkmcnt(15)
    v_mfma_f32_16x16x32_bf16 v[108:111], v[72:75], v[28:31], v[108:111]
    v_mfma_f32_16x16x32_bf16 v[144:147], v[72:75], v[32:35], v[144:147]
    s_waitcnt lgkmcnt(14)
    v_mfma_f32_16x16x32_bf16 v[112:115], v[76:79], v[28:31], v[112:115]
    v_mfma_f32_16x16x32_bf16 v[148:151], v[76:79], v[32:35], v[148:151]
    s_waitcnt lgkmcnt(12)
    v_mfma_f32_16x16x32_bf16 v[116:119], v[80:83], v[28:31], v[116:119]
    v_mfma_f32_16x16x32_bf16 v[152:155], v[80:83], v[32:35], v[152:155]
    s_waitcnt lgkmcnt(10)
    v_mfma_f32_16x16x32_bf16 v[120:123], v[84:87], v[28:31], v[120:123]
    v_mfma_f32_16x16x32_bf16 v[156:159], v[84:87], v[32:35], v[156:159]
    s_waitcnt lgkmcnt(8)
    v_mfma_f32_16x16x32_bf16 v[124:127], v[88:91], v[28:31], v[124:127]
    v_mfma_f32_16x16x32_bf16 v[160:163], v[88:91], v[32:35], v[160:163]
    s_waitcnt lgkmcnt(6)
    v_mfma_f32_16x16x32_bf16 v[128:131], v[92:95], v[28:31], v[128:131]
    v_mfma_f32_16x16x32_bf16 v[164:167], v[92:95], v[32:35], v[164:167]
    s_waitcnt lgkmcnt(4)
    v_mfma_f32_16x16x32_bf16 v[132:135], v[96:99], v[28:31], v[132:135]
    v_mfma_f32_16x16x32_bf16 v[168:171], v[96:99], v[32:35], v[168:171]
    s_waitcnt lgkmcnt(2)
    v_mfma_f32_16x16x32_bf16 v[136:139], v[100:103], v[28:31], v[136:139]
    v_mfma_f32_16x16x32_bf16 v[172:175], v[100:103], v[32:35], v[172:175]
    s_waitcnt lgkmcnt(0)
    v_mfma_f32_16x16x32_bf16 v[140:143], v[104:107], v[28:31], v[140:143]
    v_mfma_f32_16x16x32_bf16 v[176:179], v[104:107], v[32:35], v[176:179]
    s_nop 15
    v_lshrrev_b32 v18, 4, v1
    v_and_b32 v19, 15, v1
    s_lshl_b32 s9, s8, 5
    s_add_u32 s9, s9, s15
    v_add_u32 v19, s9, v19
    s_mov_b32 s14, 9216
    v_mul_lo_u32 v19, v19, s14
    v_mul_u32_u24 v18, 8, v18
    v_add_u32 v19, v19, v18
    v_add_u32 v16, s12, v19
    v_add_u32 v17, 147456, v16
    v_max_f32 v108, 0, v108
    v_max_f32 v109, 0, v109
    v_max_f32 v110, 0, v110
    v_max_f32 v111, 0, v111
    v_cvt_pk_bf16_f32 v180, v108, v109
    v_cvt_pk_bf16_f32 v181, v110, v111
    global_store_dwordx2 v16, v[180:181], s[24:25] offset:0
    s_nop 1
    v_max_f32 v112, 0, v112
    v_max_f32 v113, 0, v113
    v_max_f32 v114, 0, v114
    v_max_f32 v115, 0, v115
    v_cvt_pk_bf16_f32 v180, v112, v113
    v_cvt_pk_bf16_f32 v181, v114, v115
    global_store_dwordx2 v16, v[180:181], s[24:25] offset:32
    s_nop 1
    v_max_f32 v116, 0, v116
    v_max_f32 v117, 0, v117
    v_max_f32 v118, 0, v118
    v_max_f32 v119, 0, v119
    v_cvt_pk_bf16_f32 v180, v116, v117
    v_cvt_pk_bf16_f32 v181, v118, v119
    global_store_dwordx2 v16, v[180:181], s[24:25] offset:64
    s_nop 1
    v_max_f32 v120, 0, v120
    v_max_f32 v121, 0, v121
    v_max_f32 v122, 0, v122
    v_max_f32 v123, 0, v123
    v_cvt_pk_bf16_f32 v180, v120, v121
    v_cvt_pk_bf16_f32 v181, v122, v123
    global_store_dwordx2 v16, v[180:181], s[24:25] offset:96
    s_nop 1
    v_max_f32 v124, 0, v124
    v_max_f32 v125, 0, v125
    v_max_f32 v126, 0, v126
    v_max_f32 v127, 0, v127
    v_cvt_pk_bf16_f32 v180, v124, v125
    v_cvt_pk_bf16_f32 v181, v126, v127
    global_store_dwordx2 v16, v[180:181], s[24:25] offset:128
    s_nop 1
    v_max_f32 v128, 0, v128
    v_max_f32 v129, 0, v129
    v_max_f32 v130, 0, v130
    v_max_f32 v131, 0, v131
    v_cvt_pk_bf16_f32 v180, v128, v129
    v_cvt_pk_bf16_f32 v181, v130, v131
    global_store_dwordx2 v16, v[180:181], s[24:25] offset:160
    s_nop 1
    v_max_f32 v132, 0, v132
    v_max_f32 v133, 0, v133
    v_max_f32 v134, 0, v134
    v_max_f32 v135, 0, v135
    v_cvt_pk_bf16_f32 v180, v132, v133
    v_cvt_pk_bf16_f32 v181, v134, v135
    global_store_dwordx2 v16, v[180:181], s[24:25] offset:192
    s_nop 1
    v_max_f32 v136, 0, v136
    v_max_f32 v137, 0, v137
    v_max_f32 v138, 0, v138
    v_max_f32 v139, 0, v139
    v_cvt_pk_bf16_f32 v180, v136, v137
    v_cvt_pk_bf16_f32 v181, v138, v139
    global_store_dwordx2 v16, v[180:181], s[24:25] offset:224
    s_nop 1
    v_max_f32 v140, 0, v140
    v_max_f32 v141, 0, v141
    v_max_f32 v142, 0, v142
    v_max_f32 v143, 0, v143
    v_cvt_pk_bf16_f32 v180, v140, v141
    v_cvt_pk_bf16_f32 v181, v142, v143
    global_store_dwordx2 v16, v[180:181], s[24:25] offset:256
    s_nop 1
    v_max_f32 v144, 0, v144
    v_max_f32 v145, 0, v145
    v_max_f32 v146, 0, v146
    v_max_f32 v147, 0, v147
    v_cvt_pk_bf16_f32 v180, v144, v145
    v_cvt_pk_bf16_f32 v181, v146, v147
    global_store_dwordx2 v17, v[180:181], s[24:25] offset:0
    s_nop 1
    v_max_f32 v148, 0, v148
    v_max_f32 v149, 0, v149
    v_max_f32 v150, 0, v150
    v_max_f32 v151, 0, v151
    v_cvt_pk_bf16_f32 v180, v148, v149
    v_cvt_pk_bf16_f32 v181, v150, v151
    global_store_dwordx2 v17, v[180:181], s[24:25] offset:32
    s_nop 1
    v_max_f32 v152, 0, v152
    v_max_f32 v153, 0, v153
    v_max_f32 v154, 0, v154
    v_max_f32 v155, 0, v155
    v_cvt_pk_bf16_f32 v180, v152, v153
    v_cvt_pk_bf16_f32 v181, v154, v155
    global_store_dwordx2 v17, v[180:181], s[24:25] offset:64
    s_nop 1
    v_max_f32 v156, 0, v156
    v_max_f32 v157, 0, v157
    v_max_f32 v158, 0, v158
    v_max_f32 v159, 0, v159
    v_cvt_pk_bf16_f32 v180, v156, v157
    v_cvt_pk_bf16_f32 v181, v158, v159
    global_store_dwordx2 v17, v[180:181], s[24:25] offset:96
    s_nop 1
    v_max_f32 v160, 0, v160
    v_max_f32 v161, 0, v161
    v_max_f32 v162, 0, v162
    v_max_f32 v163, 0, v163
    v_cvt_pk_bf16_f32 v180, v160, v161
    v_cvt_pk_bf16_f32 v181, v162, v163
    global_store_dwordx2 v17, v[180:181], s[24:25] offset:128
    s_nop 1
    v_max_f32 v164, 0, v164
    v_max_f32 v165, 0, v165
    v_max_f32 v166, 0, v166
    v_max_f32 v167, 0, v167
    v_cvt_pk_bf16_f32 v180, v164, v165
    v_cvt_pk_bf16_f32 v181, v166, v167
    global_store_dwordx2 v17, v[180:181], s[24:25] offset:160
    s_nop 1
    v_max_f32 v168, 0, v168
    v_max_f32 v169, 0, v169
    v_max_f32 v170, 0, v170
    v_max_f32 v171, 0, v171
    v_cvt_pk_bf16_f32 v180, v168, v169
    v_cvt_pk_bf16_f32 v181, v170, v171
    global_store_dwordx2 v17, v[180:181], s[24:25] offset:192
    s_nop 1
    v_max_f32 v172, 0, v172
    v_max_f32 v173, 0, v173
    v_max_f32 v174, 0, v174
    v_max_f32 v175, 0, v175
    v_cvt_pk_bf16_f32 v180, v172, v173
    v_cvt_pk_bf16_f32 v181, v174, v175
    global_store_dwordx2 v17, v[180:181], s[24:25] offset:224
    s_nop 1
    v_max_f32 v176, 0, v176
    v_max_f32 v177, 0, v177
    v_max_f32 v178, 0, v178
    v_max_f32 v179, 0, v179
    v_cvt_pk_bf16_f32 v180, v176, v177
    v_cvt_pk_bf16_f32 v181, v178, v179
    global_store_dwordx2 v17, v[180:181], s[24:25] offset:256
    s_nop 1
K1_END:
    s_endpgm
.globl k15_kernel
.p2align 8
.type k15_kernel,@function
k15_kernel:
    s_cmp_ge_u32 s2, 352
    s_cbranch_scc1 K15_END
    s_load_dwordx2 s[4:5], s[0:1], 0
    s_load_dwordx2 s[6:7], s[0:1], 16
    s_load_dwordx2 s[10:11], s[0:1], 48
    s_load_dwordx2 s[24:25], s[0:1], 72
    v_lshrrev_b32 v1, 6, v0
    s_nop 0
    v_readfirstlane_b32 s8, v1
    v_and_b32 v1, 63, v0
    s_waitcnt lgkmcnt(0)
    s_add_u32 s26, s24, 23592960
    s_addc_u32 s27, s25, 0
    s_cmp_ge_u32 s2, 96
    s_cbranch_scc1 K15_J2
    s_mul_i32 s36, s2, 43691
    s_lshr_b32 s36, s36, 17
    s_mul_i32 s37, s36, 3
    s_sub_u32 s37, s2, s37
    s_lshl_b32 s37, s37, 8
    v_add_u32 v9, 0, v0
    v_cmp_gt_u32 vcc, 342, v9
    s_and_saveexec_b64 s[30:31], vcc
    s_mul_i32 s9, s36, 1368
    v_lshlrev_b32 v2, 2, v9
    v_add_u32 v2, s9, v2
    v_mov_b32 v3, 0
    global_load_dword v10, v2, s[26:27]
    v_add_u32 v2, 43776, v2
    global_load_dword v11, v2, s[26:27]
    v_add_u32 v2, 43776, v2
    global_load_dword v12, v2, s[26:27]
    v_add_u32 v2, 43776, v2
    global_load_dword v13, v2, s[26:27]
    v_add_u32 v2, 43776, v2
    global_load_dword v14, v2, s[26:27]
    v_add_u32 v2, 43776, v2
    global_load_dword v15, v2, s[26:27]
    v_add_u32 v2, 43776, v2
    global_load_dword v16, v2, s[26:27]
    v_add_u32 v2, 43776, v2
    global_load_dword v17, v2, s[26:27]
    v_add_u32 v2, 43776, v2
    global_load_dword v18, v2, s[26:27]
    v_add_u32 v2, 43776, v2
    global_load_dword v19, v2, s[26:27]
    v_add_u32 v2, 43776, v2
    global_load_dword v20, v2, s[26:27]
    v_add_u32 v2, 43776, v2
    global_load_dword v21, v2, s[26:27]
    v_add_u32 v2, 43776, v2
    global_load_dword v22, v2, s[26:27]
    v_add_u32 v2, 43776, v2
    global_load_dword v23, v2, s[26:27]
    v_add_u32 v2, 43776, v2
    global_load_dword v24, v2, s[26:27]
    v_add_u32 v2, 43776, v2
    global_load_dword v25, v2, s[26:27]
    v_add_u32 v2, 43776, v2
    s_waitcnt vmcnt(0)
    v_add_f32 v3, v3, v10
    v_add_f32 v3, v3, v11
    v_add_f32 v3, v3, v12
    v_add_f32 v3, v3, v13
    v_add_f32 v3, v3, v14
    v_add_f32 v3, v3, v15
    v_add_f32 v3, v3, v16
    v_add_f32 v3, v3, v17
    v_add_f32 v3, v3, v18
    v_add_f32 v3, v3, v19
    v_add_f32 v3, v3, v20
    v_add_f32 v3, v3, v21
    v_add_f32 v3, v3, v22
    v_add_f32 v3, v3, v23
    v_add_f32 v3, v3, v24
    v_add_f32 v3, v3, v25
    v_cvt_pk_bf16_f32 v4, v3, v3
    v_lshlrev_b32 v3, 16, v4
    v_lshlrev_b32 v2, 2, v9
    ds_write_b32 v2, v3
    s_mov_b64 exec, s[30:31]
    v_add_u32 v9, 256, v0
    v_cmp_gt_u32 vcc, 342, v9
    s_and_saveexec_b64 s[30:31], vcc
    s_mul_i32 s9, s36, 1368
    v_lshlrev_b32 v2, 2, v9
    v_add_u32 v2, s9, v2
    v_mov_b32 v3, 0
    global_load_dword v10, v2, s[26:27]
    v_add_u32 v2, 43776, v2
    global_load_dword v11, v2, s[26:27]
    v_add_u32 v2, 43776, v2
    global_load_dword v12, v2, s[26:27]
    v_add_u32 v2, 43776, v2
    global_load_dword v13, v2, s[26:27]
    v_add_u32 v2, 43776, v2
    global_load_dword v14, v2, s[26:27]
    v_add_u32 v2, 43776, v2
    global_load_dword v15, v2, s[26:27]
    v_add_u32 v2, 43776, v2
    global_load_dword v16, v2, s[26:27]
    v_add_u32 v2, 43776, v2
    global_load_dword v17, v2, s[26:27]
    v_add_u32 v2, 43776, v2
    global_load_dword v18, v2, s[26:27]
    v_add_u32 v2, 43776, v2
    global_load_dword v19, v2, s[26:27]
    v_add_u32 v2, 43776, v2
    global_load_dword v20, v2, s[26:27]
    v_add_u32 v2, 43776, v2
    global_load_dword v21, v2, s[26:27]
    v_add_u32 v2, 43776, v2
    global_load_dword v22, v2, s[26:27]
    v_add_u32 v2, 43776, v2
    global_load_dword v23, v2, s[26:27]
    v_add_u32 v2, 43776, v2
    global_load_dword v24, v2, s[26:27]
    v_add_u32 v2, 43776, v2
    global_load_dword v25, v2, s[26:27]
    v_add_u32 v2, 43776, v2
    s_waitcnt vmcnt(0)
    v_add_f32 v3, v3, v10
    v_add_f32 v3, v3, v11
    v_add_f32 v3, v3, v12
    v_add_f32 v3, v3, v13
    v_add_f32 v3, v3, v14
    v_add_f32 v3, v3, v15
    v_add_f32 v3, v3, v16
    v_add_f32 v3, v3, v17
    v_add_f32 v3, v3, v18
    v_add_f32 v3, v3, v19
    v_add_f32 v3, v3, v20
    v_add_f32 v3, v3, v21
    v_add_f32 v3, v3, v22
    v_add_f32 v3, v3, v23
    v_add_f32 v3, v3, v24
    v_add_f32 v3, v3, v25
    v_cvt_pk_bf16_f32 v4, v3, v3
    v_lshlrev_b32 v3, 16, v4
    v_lshlrev_b32 v2, 2, v9
    ds_write_b32 v2, v3
    s_mov_b64 exec, s[30:31]
    s_waitcnt lgkmcnt(0)
    s_barrier
    v_add_u32 v2, s37, v0
    v_cmp_gt_u32 vcc, 576, v2
    s_and_saveexec_b64 s[30:31], vcc
    s_cbranch_execz J1S_77
    s_mul_i32 s9, s36, 20736
    v_lshlrev_b32 v3, 1, v2
    v_add_u32 v3, s9, v3
    v_mov_b32 v7, v3
    global_load_ushort v10, v7, s[6:7]
    v_add_u32 v7, 1152, v7
    global_load_ushort v11, v7, s[6:7]
    v_add_u32 v7, 1152, v7
    global_load_ushort v12, v7, s[6:7]
    v_add_u32 v7, 1152, v7
    global_load_ushort v13, v7, s[6:7]
    v_add_u32 v7, 1152, v7
    global_load_ushort v14, v7, s[6:7]
    v_add_u32 v7, 1152, v7
    global_load_ushort v15, v7, s[6:7]
    v_add_u32 v7, 1152, v7
    global_load_ushort v16, v7, s[6:7]
    v_add_u32 v7, 1152, v7
    global_load_ushort v17, v7, s[6:7]
    v_add_u32 v7, 1152, v7
    global_load_ushort v18, v7, s[6:7]
    v_add_u32 v7, 1152, v7
    global_load_ushort v19, v7, s[6:7]
    v_add_u32 v7, 1152, v7
    global_load_ushort v20, v7, s[6:7]
    v_add_u32 v7, 1152, v7
    global_load_ushort v21, v7, s[6:7]
    v_add_u32 v7, 1152, v7
    global_load_ushort v22, v7, s[6:7]
    v_add_u32 v7, 1152, v7
    global_load_ushort v23, v7, s[6:7]
    v_add_u32 v7, 1152, v7
    global_load_ushort v24, v7, s[6:7]
    v_add_u32 v7, 1152, v7
    global_load_ushort v25, v7, s[6:7]
    v_add_u32 v7, 1152, v7
    global_load_ushort v26, v7, s[6:7]
    v_add_u32 v7, 1152, v7
    global_load_ushort v27, v7, s[6:7]
    v_add_u32 v7, 1152, v7
    s_waitcnt vmcnt(0)
    v_lshlrev_b32 v10, 16, v10
    v_lshlrev_b32 v11, 16, v11
    v_lshlrev_b32 v12, 16, v12
    v_lshlrev_b32 v13, 16, v13
    v_lshlrev_b32 v14, 16, v14
    v_lshlrev_b32 v15, 16, v15
    v_lshlrev_b32 v16, 16, v16
    v_lshlrev_b32 v17, 16, v17
    v_lshlrev_b32 v18, 16, v18
    v_lshlrev_b32 v19, 16, v19
    v_lshlrev_b32 v20, 16, v20
    v_lshlrev_b32 v21, 16, v21
    v_lshlrev_b32 v22, 16, v22
    v_lshlrev_b32 v23, 16, v23
    v_lshlrev_b32 v24, 16, v24
    v_lshlrev_b32 v25, 16, v25
    v_lshlrev_b32 v26, 16, v26
    v_lshlrev_b32 v27, 16, v27
    v_mov_b32 v4, 0
    ds_read_b64 v[32:33], v4 offset:0
    ds_read_b64 v[34:35], v4 offset:8
    ds_read_b64 v[36:37], v4 offset:16
    ds_read_b64 v[38:39], v4 offset:24
    ds_read_b64 v[40:41], v4 offset:32
    ds_read_b64 v[42:43], v4 offset:40
    ds_read_b64 v[44:45], v4 offset:48
    ds_read_b64 v[46:47], v4 offset:56
    ds_read_b64 v[48:49], v4 offset:64
    s_waitcnt lgkmcnt(0)
    v_mul_f32 v5, v32, v10
    v_fmac_f32 v5, v33, v11
    v_fmac_f32 v5, v34, v12
    v_fmac_f32 v5, v35, v13
    v_fmac_f32 v5, v36, v14
    v_fmac_f32 v5, v37, v15
    v_fmac_f32 v5, v38, v16
    v_fmac_f32 v5, v39, v17
    v_fmac_f32 v5, v40, v18
    v_fmac_f32 v5, v41, v19
    v_fmac_f32 v5, v42, v20
    v_fmac_f32 v5, v43, v21
    v_fmac_f32 v5, v44, v22
    v_fmac_f32 v5, v45, v23
    v_fmac_f32 v5, v46, v24
    v_fmac_f32 v5, v47, v25
    v_fmac_f32 v5, v48, v26
    v_fmac_f32 v5, v49, v27
    v_cvt_pk_bf16_f32 v5, v5, v5
    v_add_u32 v6, 24293376, v3
    global_store_short v6, v5, s[24:25]
    ds_read_b64 v[32:33], v4 offset:72
    ds_read_b64 v[34:35], v4 offset:80
    ds_read_b64 v[36:37], v4 offset:88
    ds_read_b64 v[38:39], v4 offset:96
    ds_read_b64 v[40:41], v4 offset:104
    ds_read_b64 v[42:43], v4 offset:112
    ds_read_b64 v[44:45], v4 offset:120
    ds_read_b64 v[46:47], v4 offset:128
    ds_read_b64 v[48:49], v4 offset:136
    s_waitcnt lgkmcnt(0)
    v_mul_f32 v5, v32, v10
    v_fmac_f32 v5, v33, v11
    v_fmac_f32 v5, v34, v12
    v_fmac_f32 v5, v35, v13
    v_fmac_f32 v5, v36, v14
    v_fmac_f32 v5, v37, v15
    v_fmac_f32 v5, v38, v16
    v_fmac_f32 v5, v39, v17
    v_fmac_f32 v5, v40, v18
    v_fmac_f32 v5, v41, v19
    v_fmac_f32 v5, v42, v20
    v_fmac_f32 v5, v43, v21
    v_fmac_f32 v5, v44, v22
    v_fmac_f32 v5, v45, v23
    v_fmac_f32 v5, v46, v24
    v_fmac_f32 v5, v47, v25
    v_fmac_f32 v5, v48, v26
    v_fmac_f32 v5, v49, v27
    v_cvt_pk_bf16_f32 v5, v5, v5
    v_add_u32 v6, 24294528, v3
    global_store_short v6, v5, s[24:25]
    ds_read_b64 v[32:33], v4 offset:144
    ds_read_b64 v[34:35], v4 offset:152
    ds_read_b64 v[36:37], v4 offset:160
    ds_read_b64 v[38:39], v4 offset:168
    ds_read_b64 v[40:41], v4 offset:176
    ds_read_b64 v[42:43], v4 offset:184
    ds_read_b64 v[44:45], v4 offset:192
    ds_read_b64 v[46:47], v4 offset:200
    ds_read_b64 v[48:49], v4 offset:208
    s_waitcnt lgkmcnt(0)
    v_mul_f32 v5, v32, v10
    v_fmac_f32 v5, v33, v11
    v_fmac_f32 v5, v34, v12
    v_fmac_f32 v5, v35, v13
    v_fmac_f32 v5, v36, v14
    v_fmac_f32 v5, v37, v15
    v_fmac_f32 v5, v38, v16
    v_fmac_f32 v5, v39, v17
    v_fmac_f32 v5, v40, v18
    v_fmac_f32 v5, v41, v19
    v_fmac_f32 v5, v42, v20
    v_fmac_f32 v5, v43, v21
    v_fmac_f32 v5, v44, v22
    v_fmac_f32 v5, v45, v23
    v_fmac_f32 v5, v46, v24
    v_fmac_f32 v5, v47, v25
    v_fmac_f32 v5, v48, v26
    v_fmac_f32 v5, v49, v27
    v_cvt_pk_bf16_f32 v5, v5, v5
    v_add_u32 v6, 24295680, v3
    global_store_short v6, v5, s[24:25]
    ds_read_b64 v[32:33], v4 offset:216
    ds_read_b64 v[34:35], v4 offset:224
    ds_read_b64 v[36:37], v4 offset:232
    ds_read_b64 v[38:39], v4 offset:240
    ds_read_b64 v[40:41], v4 offset:248
    ds_read_b64 v[42:43], v4 offset:256
    ds_read_b64 v[44:45], v4 offset:264
    ds_read_b64 v[46:47], v4 offset:272
    ds_read_b64 v[48:49], v4 offset:280
    s_waitcnt lgkmcnt(0)
    v_mul_f32 v5, v32, v10
    v_fmac_f32 v5, v33, v11
    v_fmac_f32 v5, v34, v12
    v_fmac_f32 v5, v35, v13
    v_fmac_f32 v5, v36, v14
    v_fmac_f32 v5, v37, v15
    v_fmac_f32 v5, v38, v16
    v_fmac_f32 v5, v39, v17
    v_fmac_f32 v5, v40, v18
    v_fmac_f32 v5, v41, v19
    v_fmac_f32 v5, v42, v20
    v_fmac_f32 v5, v43, v21
    v_fmac_f32 v5, v44, v22
    v_fmac_f32 v5, v45, v23
    v_fmac_f32 v5, v46, v24
    v_fmac_f32 v5, v47, v25
    v_fmac_f32 v5, v48, v26
    v_fmac_f32 v5, v49, v27
    v_cvt_pk_bf16_f32 v5, v5, v5
    v_add_u32 v6, 24296832, v3
    global_store_short v6, v5, s[24:25]
    ds_read_b64 v[32:33], v4 offset:288
    ds_read_b64 v[34:35], v4 offset:296
    ds_read_b64 v[36:37], v4 offset:304
    ds_read_b64 v[38:39], v4 offset:312
    ds_read_b64 v[40:41], v4 offset:320
    ds_read_b64 v[42:43], v4 offset:328
    ds_read_b64 v[44:45], v4 offset:336
    ds_read_b64 v[46:47], v4 offset:344
    ds_read_b64 v[48:49], v4 offset:352
    s_waitcnt lgkmcnt(0)
    v_mul_f32 v5, v32, v10
    v_fmac_f32 v5, v33, v11
    v_fmac_f32 v5, v34, v12
    v_fmac_f32 v5, v35, v13
    v_fmac_f32 v5, v36, v14
    v_fmac_f32 v5, v37, v15
    v_fmac_f32 v5, v38, v16
    v_fmac_f32 v5, v39, v17
    v_fmac_f32 v5, v40, v18
    v_fmac_f32 v5, v41, v19
    v_fmac_f32 v5, v42, v20
    v_fmac_f32 v5, v43, v21
    v_fmac_f32 v5, v44, v22
    v_fmac_f32 v5, v45, v23
    v_fmac_f32 v5, v46, v24
    v_fmac_f32 v5, v47, v25
    v_fmac_f32 v5, v48, v26
    v_fmac_f32 v5, v49, v27
    v_cvt_pk_bf16_f32 v5, v5, v5
    v_add_u32 v6, 24297984, v3
    global_store_short v6, v5, s[24:25]
    ds_read_b64 v[32:33], v4 offset:360
    ds_read_b64 v[34:35], v4 offset:368
    ds_read_b64 v[36:37], v4 offset:376
    ds_read_b64 v[38:39], v4 offset:384
    ds_read_b64 v[40:41], v4 offset:392
    ds_read_b64 v[42:43], v4 offset:400
    ds_read_b64 v[44:45], v4 offset:408
    ds_read_b64 v[46:47], v4 offset:416
    ds_read_b64 v[48:49], v4 offset:424
    s_waitcnt lgkmcnt(0)
    v_mul_f32 v5, v32, v10
    v_fmac_f32 v5, v33, v11
    v_fmac_f32 v5, v34, v12
    v_fmac_f32 v5, v35, v13
    v_fmac_f32 v5, v36, v14
    v_fmac_f32 v5, v37, v15
    v_fmac_f32 v5, v38, v16
    v_fmac_f32 v5, v39, v17
    v_fmac_f32 v5, v40, v18
    v_fmac_f32 v5, v41, v19
    v_fmac_f32 v5, v42, v20
    v_fmac_f32 v5, v43, v21
    v_fmac_f32 v5, v44, v22
    v_fmac_f32 v5, v45, v23
    v_fmac_f32 v5, v46, v24
    v_fmac_f32 v5, v47, v25
    v_fmac_f32 v5, v48, v26
    v_fmac_f32 v5, v49, v27
    v_cvt_pk_bf16_f32 v5, v5, v5
    v_add_u32 v6, 24299136, v3
    global_store_short v6, v5, s[24:25]
    ds_read_b64 v[32:33], v4 offset:432
    ds_read_b64 v[34:35], v4 offset:440
    ds_read_b64 v[36:37], v4 offset:448
    ds_read_b64 v[38:39], v4 offset:456
    ds_read_b64 v[40:41], v4 offset:464
    ds_read_b64 v[42:43], v4 offset:472
    ds_read_b64 v[44:45], v4 offset:480
    ds_read_b64 v[46:47], v4 offset:488
    ds_read_b64 v[48:49], v4 offset:496
    s_waitcnt lgkmcnt(0)
    v_mul_f32 v5, v32, v10
    v_fmac_f32 v5, v33, v11
    v_fmac_f32 v5, v34, v12
    v_fmac_f32 v5, v35, v13
    v_fmac_f32 v5, v36, v14
    v_fmac_f32 v5, v37, v15
    v_fmac_f32 v5, v38, v16
    v_fmac_f32 v5, v39, v17
    v_fmac_f32 v5, v40, v18
    v_fmac_f32 v5, v41, v19
    v_fmac_f32 v5, v42, v20
    v_fmac_f32 v5, v43, v21
    v_fmac_f32 v5, v44, v22
    v_fmac_f32 v5, v45, v23
    v_fmac_f32 v5, v46, v24
    v_fmac_f32 v5, v47, v25
    v_fmac_f32 v5, v48, v26
    v_fmac_f32 v5, v49, v27
    v_cvt_pk_bf16_f32 v5, v5, v5
    v_add_u32 v6, 24300288, v3
    global_store_short v6, v5, s[24:25]
    ds_read_b64 v[32:33], v4 offset:504
    ds_read_b64 v[34:35], v4 offset:512
    ds_read_b64 v[36:37], v4 offset:520
    ds_read_b64 v[38:39], v4 offset:528
    ds_read_b64 v[40:41], v4 offset:536
    ds_read_b64 v[42:43], v4 offset:544
    ds_read_b64 v[44:45], v4 offset:552
    ds_read_b64 v[46:47], v4 offset:560
    ds_read_b64 v[48:49], v4 offset:568
    s_waitcnt lgkmcnt(0)
    v_mul_f32 v5, v32, v10
    v_fmac_f32 v5, v33, v11
    v_fmac_f32 v5, v34, v12
    v_fmac_f32 v5, v35, v13
    v_fmac_f32 v5, v36, v14
    v_fmac_f32 v5, v37, v15
    v_fmac_f32 v5, v38, v16
    v_fmac_f32 v5, v39, v17
    v_fmac_f32 v5, v40, v18
    v_fmac_f32 v5, v41, v19
    v_fmac_f32 v5, v42, v20
    v_fmac_f32 v5, v43, v21
    v_fmac_f32 v5, v44, v22
    v_fmac_f32 v5, v45, v23
    v_fmac_f32 v5, v46, v24
    v_fmac_f32 v5, v47, v25
    v_fmac_f32 v5, v48, v26
    v_fmac_f32 v5, v49, v27
    v_cvt_pk_bf16_f32 v5, v5, v5
    v_add_u32 v6, 24301440, v3
    global_store_short v6, v5, s[24:25]
    ds_read_b64 v[32:33], v4 offset:576
    ds_read_b64 v[34:35], v4 offset:584
    ds_read_b64 v[36:37], v4 offset:592
    ds_read_b64 v[38:39], v4 offset:600
    ds_read_b64 v[40:41], v4 offset:608
    ds_read_b64 v[42:43], v4 offset:616
    ds_read_b64 v[44:45], v4 offset:624
    ds_read_b64 v[46:47], v4 offset:632
    ds_read_b64 v[48:49], v4 offset:640
    s_waitcnt lgkmcnt(0)
    v_mul_f32 v5, v32, v10
    v_fmac_f32 v5, v33, v11
    v_fmac_f32 v5, v34, v12
    v_fmac_f32 v5, v35, v13
    v_fmac_f32 v5, v36, v14
    v_fmac_f32 v5, v37, v15
    v_fmac_f32 v5, v38, v16
    v_fmac_f32 v5, v39, v17
    v_fmac_f32 v5, v40, v18
    v_fmac_f32 v5, v41, v19
    v_fmac_f32 v5, v42, v20
    v_fmac_f32 v5, v43, v21
    v_fmac_f32 v5, v44, v22
    v_fmac_f32 v5, v45, v23
    v_fmac_f32 v5, v46, v24
    v_fmac_f32 v5, v47, v25
    v_fmac_f32 v5, v48, v26
    v_fmac_f32 v5, v49, v27
    v_cvt_pk_bf16_f32 v5, v5, v5
    v_add_u32 v6, 24302592, v3
    global_store_short v6, v5, s[24:25]
    ds_read_b64 v[32:33], v4 offset:648
    ds_read_b64 v[34:35], v4 offset:656
    ds_read_b64 v[36:37], v4 offset:664
    ds_read_b64 v[38:39], v4 offset:672
    ds_read_b64 v[40:41], v4 offset:680
    ds_read_b64 v[42:43], v4 offset:688
    ds_read_b64 v[44:45], v4 offset:696
    ds_read_b64 v[46:47], v4 offset:704
    ds_read_b64 v[48:49], v4 offset:712
    s_waitcnt lgkmcnt(0)
    v_mul_f32 v5, v32, v10
    v_fmac_f32 v5, v33, v11
    v_fmac_f32 v5, v34, v12
    v_fmac_f32 v5, v35, v13
    v_fmac_f32 v5, v36, v14
    v_fmac_f32 v5, v37, v15
    v_fmac_f32 v5, v38, v16
    v_fmac_f32 v5, v39, v17
    v_fmac_f32 v5, v40, v18
    v_fmac_f32 v5, v41, v19
    v_fmac_f32 v5, v42, v20
    v_fmac_f32 v5, v43, v21
    v_fmac_f32 v5, v44, v22
    v_fmac_f32 v5, v45, v23
    v_fmac_f32 v5, v46, v24
    v_fmac_f32 v5, v47, v25
    v_fmac_f32 v5, v48, v26
    v_fmac_f32 v5, v49, v27
    v_cvt_pk_bf16_f32 v5, v5, v5
    v_add_u32 v6, 24303744, v3
    global_store_short v6, v5, s[24:25]
    ds_read_b64 v[32:33], v4 offset:720
    ds_read_b64 v[34:35], v4 offset:728
    ds_read_b64 v[36:37], v4 offset:736
    ds_read_b64 v[38:39], v4 offset:744
    ds_read_b64 v[40:41], v4 offset:752
    ds_read_b64 v[42:43], v4 offset:760
    ds_read_b64 v[44:45], v4 offset:768
    ds_read_b64 v[46:47], v4 offset:776
    ds_read_b64 v[48:49], v4 offset:784
    s_waitcnt lgkmcnt(0)
    v_mul_f32 v5, v32, v10
    v_fmac_f32 v5, v33, v11
    v_fmac_f32 v5, v34, v12
    v_fmac_f32 v5, v35, v13
    v_fmac_f32 v5, v36, v14
    v_fmac_f32 v5, v37, v15
    v_fmac_f32 v5, v38, v16
    v_fmac_f32 v5, v39, v17
    v_fmac_f32 v5, v40, v18
    v_fmac_f32 v5, v41, v19
    v_fmac_f32 v5, v42, v20
    v_fmac_f32 v5, v43, v21
    v_fmac_f32 v5, v44, v22
    v_fmac_f32 v5, v45, v23
    v_fmac_f32 v5, v46, v24
    v_fmac_f32 v5, v47, v25
    v_fmac_f32 v5, v48, v26
    v_fmac_f32 v5, v49, v27
    v_cvt_pk_bf16_f32 v5, v5, v5
    v_add_u32 v6, 24304896, v3
    global_store_short v6, v5, s[24:25]
    ds_read_b64 v[32:33], v4 offset:792
    ds_read_b64 v[34:35], v4 offset:800
    ds_read_b64 v[36:37], v4 offset:808
    ds_read_b64 v[38:39], v4 offset:816
    ds_read_b64 v[40:41], v4 offset:824
    ds_read_b64 v[42:43], v4 offset:832
    ds_read_b64 v[44:45], v4 offset:840
    ds_read_b64 v[46:47], v4 offset:848
    ds_read_b64 v[48:49], v4 offset:856
    s_waitcnt lgkmcnt(0)
    v_mul_f32 v5, v32, v10
    v_fmac_f32 v5, v33, v11
    v_fmac_f32 v5, v34, v12
    v_fmac_f32 v5, v35, v13
    v_fmac_f32 v5, v36, v14
    v_fmac_f32 v5, v37, v15
    v_fmac_f32 v5, v38, v16
    v_fmac_f32 v5, v39, v17
    v_fmac_f32 v5, v40, v18
    v_fmac_f32 v5, v41, v19
    v_fmac_f32 v5, v42, v20
    v_fmac_f32 v5, v43, v21
    v_fmac_f32 v5, v44, v22
    v_fmac_f32 v5, v45, v23
    v_fmac_f32 v5, v46, v24
    v_fmac_f32 v5, v47, v25
    v_fmac_f32 v5, v48, v26
    v_fmac_f32 v5, v49, v27
    v_cvt_pk_bf16_f32 v5, v5, v5
    v_add_u32 v6, 24306048, v3
    global_store_short v6, v5, s[24:25]
    ds_read_b64 v[32:33], v4 offset:864
    ds_read_b64 v[34:35], v4 offset:872
    ds_read_b64 v[36:37], v4 offset:880
    ds_read_b64 v[38:39], v4 offset:888
    ds_read_b64 v[40:41], v4 offset:896
    ds_read_b64 v[42:43], v4 offset:904
    ds_read_b64 v[44:45], v4 offset:912
    ds_read_b64 v[46:47], v4 offset:920
    ds_read_b64 v[48:49], v4 offset:928
    s_waitcnt lgkmcnt(0)
    v_mul_f32 v5, v32, v10
    v_fmac_f32 v5, v33, v11
    v_fmac_f32 v5, v34, v12
    v_fmac_f32 v5, v35, v13
    v_fmac_f32 v5, v36, v14
    v_fmac_f32 v5, v37, v15
    v_fmac_f32 v5, v38, v16
    v_fmac_f32 v5, v39, v17
    v_fmac_f32 v5, v40, v18
    v_fmac_f32 v5, v41, v19
    v_fmac_f32 v5, v42, v20
    v_fmac_f32 v5, v43, v21
    v_fmac_f32 v5, v44, v22
    v_fmac_f32 v5, v45, v23
    v_fmac_f32 v5, v46, v24
    v_fmac_f32 v5, v47, v25
    v_fmac_f32 v5, v48, v26
    v_fmac_f32 v5, v49, v27
    v_cvt_pk_bf16_f32 v5, v5, v5
    v_add_u32 v6, 24307200, v3
    global_store_short v6, v5, s[24:25]
    ds_read_b64 v[32:33], v4 offset:936
    ds_read_b64 v[34:35], v4 offset:944
    ds_read_b64 v[36:37], v4 offset:952
    ds_read_b64 v[38:39], v4 offset:960
    ds_read_b64 v[40:41], v4 offset:968
    ds_read_b64 v[42:43], v4 offset:976
    ds_read_b64 v[44:45], v4 offset:984
    ds_read_b64 v[46:47], v4 offset:992
    ds_read_b64 v[48:49], v4 offset:1000
    s_waitcnt lgkmcnt(0)
    v_mul_f32 v5, v32, v10
    v_fmac_f32 v5, v33, v11
    v_fmac_f32 v5, v34, v12
    v_fmac_f32 v5, v35, v13
    v_fmac_f32 v5, v36, v14
    v_fmac_f32 v5, v37, v15
    v_fmac_f32 v5, v38, v16
    v_fmac_f32 v5, v39, v17
    v_fmac_f32 v5, v40, v18
    v_fmac_f32 v5, v41, v19
    v_fmac_f32 v5, v42, v20
    v_fmac_f32 v5, v43, v21
    v_fmac_f32 v5, v44, v22
    v_fmac_f32 v5, v45, v23
    v_fmac_f32 v5, v46, v24
    v_fmac_f32 v5, v47, v25
    v_fmac_f32 v5, v48, v26
    v_fmac_f32 v5, v49, v27
    v_cvt_pk_bf16_f32 v5, v5, v5
    v_add_u32 v6, 24308352, v3
    global_store_short v6, v5, s[24:25]
    ds_read_b64 v[32:33], v4 offset:1008
    ds_read_b64 v[34:35], v4 offset:1016
    ds_read_b64 v[36:37], v4 offset:1024
    ds_read_b64 v[38:39], v4 offset:1032
    ds_read_b64 v[40:41], v4 offset:1040
    ds_read_b64 v[42:43], v4 offset:1048
    ds_read_b64 v[44:45], v4 offset:1056
    ds_read_b64 v[46:47], v4 offset:1064
    ds_read_b64 v[48:49], v4 offset:1072
    s_waitcnt lgkmcnt(0)
    v_mul_f32 v5, v32, v10
    v_fmac_f32 v5, v33, v11
    v_fmac_f32 v5, v34, v12
    v_fmac_f32 v5, v35, v13
    v_fmac_f32 v5, v36, v14
    v_fmac_f32 v5, v37, v15
    v_fmac_f32 v5, v38, v16
    v_fmac_f32 v5, v39, v17
    v_fmac_f32 v5, v40, v18
    v_fmac_f32 v5, v41, v19
    v_fmac_f32 v5, v42, v20
    v_fmac_f32 v5, v43, v21
    v_fmac_f32 v5, v44, v22
    v_fmac_f32 v5, v45, v23
    v_fmac_f32 v5, v46, v24
    v_fmac_f32 v5, v47, v25
    v_fmac_f32 v5, v48, v26
    v_fmac_f32 v5, v49, v27
    v_cvt_pk_bf16_f32 v5, v5, v5
    v_add_u32 v6, 24309504, v3
    global_store_short v6, v5, s[24:25]
    ds_read_b64 v[32:33], v4 offset:1080
    ds_read_b64 v[34:35], v4 offset:1088
    ds_read_b64 v[36:37], v4 offset:1096
    ds_read_b64 v[38:39], v4 offset:1104
    ds_read_b64 v[40:41], v4 offset:1112
    ds_read_b64 v[42:43], v4 offset:1120
    ds_read_b64 v[44:45], v4 offset:1128
    ds_read_b64 v[46:47], v4 offset:1136
    ds_read_b64 v[48:49], v4 offset:1144
    s_waitcnt lgkmcnt(0)
    v_mul_f32 v5, v32, v10
    v_fmac_f32 v5, v33, v11
    v_fmac_f32 v5, v34, v12
    v_fmac_f32 v5, v35, v13
    v_fmac_f32 v5, v36, v14
    v_fmac_f32 v5, v37, v15
    v_fmac_f32 v5, v38, v16
    v_fmac_f32 v5, v39, v17
    v_fmac_f32 v5, v40, v18
    v_fmac_f32 v5, v41, v19
    v_fmac_f32 v5, v42, v20
    v_fmac_f32 v5, v43, v21
    v_fmac_f32 v5, v44, v22
    v_fmac_f32 v5, v45, v23
    v_fmac_f32 v5, v46, v24
    v_fmac_f32 v5, v47, v25
    v_fmac_f32 v5, v48, v26
    v_fmac_f32 v5, v49, v27
    v_cvt_pk_bf16_f32 v5, v5, v5
    v_add_u32 v6, 24310656, v3
    global_store_short v6, v5, s[24:25]
    ds_read_b64 v[32:33], v4 offset:1152
    ds_read_b64 v[34:35], v4 offset:1160
    ds_read_b64 v[36:37], v4 offset:1168
    ds_read_b64 v[38:39], v4 offset:1176
    ds_read_b64 v[40:41], v4 offset:1184
    ds_read_b64 v[42:43], v4 offset:1192
    ds_read_b64 v[44:45], v4 offset:1200
    ds_read_b64 v[46:47], v4 offset:1208
    ds_read_b64 v[48:49], v4 offset:1216
    s_waitcnt lgkmcnt(0)
    v_mul_f32 v5, v32, v10
    v_fmac_f32 v5, v33, v11
    v_fmac_f32 v5, v34, v12
    v_fmac_f32 v5, v35, v13
    v_fmac_f32 v5, v36, v14
    v_fmac_f32 v5, v37, v15
    v_fmac_f32 v5, v38, v16
    v_fmac_f32 v5, v39, v17
    v_fmac_f32 v5, v40, v18
    v_fmac_f32 v5, v41, v19
    v_fmac_f32 v5, v42, v20
    v_fmac_f32 v5, v43, v21
    v_fmac_f32 v5, v44, v22
    v_fmac_f32 v5, v45, v23
    v_fmac_f32 v5, v46, v24
    v_fmac_f32 v5, v47, v25
    v_fmac_f32 v5, v48, v26
    v_fmac_f32 v5, v49, v27
    v_cvt_pk_bf16_f32 v5, v5, v5
    v_add_u32 v6, 24311808, v3
    global_store_short v6, v5, s[24:25]
    ds_read_b64 v[32:33], v4 offset:1224
    ds_read_b64 v[34:35], v4 offset:1232
    ds_read_b64 v[36:37], v4 offset:1240
    ds_read_b64 v[38:39], v4 offset:1248
    ds_read_b64 v[40:41], v4 offset:1256
    ds_read_b64 v[42:43], v4 offset:1264
    ds_read_b64 v[44:45], v4 offset:1272
    ds_read_b64 v[46:47], v4 offset:1280
    ds_read_b64 v[48:49], v4 offset:1288
    s_waitcnt lgkmcnt(0)
    v_mul_f32 v5, v32, v10
    v_fmac_f32 v5, v33, v11
    v_fmac_f32 v5, v34, v12
    v_fmac_f32 v5, v35, v13
    v_fmac_f32 v5, v36, v14
    v_fmac_f32 v5, v37, v15
    v_fmac_f32 v5, v38, v16
    v_fmac_f32 v5, v39, v17
    v_fmac_f32 v5, v40, v18
    v_fmac_f32 v5, v41, v19
    v_fmac_f32 v5, v42, v20
    v_fmac_f32 v5, v43, v21
    v_fmac_f32 v5, v44, v22
    v_fmac_f32 v5, v45, v23
    v_fmac_f32 v5, v46, v24
    v_fmac_f32 v5, v47, v25
    v_fmac_f32 v5, v48, v26
    v_fmac_f32 v5, v49, v27
    v_cvt_pk_bf16_f32 v5, v5, v5
    v_add_u32 v6, 24312960, v3
    global_store_short v6, v5, s[24:25]
J1S_77:
    s_mov_b64 exec, s[30:31]
    s_branch K15_END
K15_J2:
    v_add_u32 v2, 0, v0
    v_cmp_gt_u32 vcc, 576, v2
    s_and_saveexec_b64 s[30:31], vcc
    s_cbranch_execz J2S_78
    v_mul_u32_u24 v3, 3641, v2
    v_lshrrev_b32 v3, 16, v3
    v_mul_u32_u24 v4, 18, v3
    v_sub_u32 v4, v2, v4
    v_mul_u32_u24 v3, 342, v3
    v_add_u32 v3, v3, v4
    v_add_u32 v3, 324, v3
    v_lshlrev_b32 v3, 2, v3
    global_load_dword v10, v3, s[26:27]
    v_add_u32 v3, 43776, v3
    global_load_dword v11, v3, s[26:27]
    v_add_u32 v3, 43776, v3
    global_load_dword v12, v3, s[26:27]
    v_add_u32 v3, 43776, v3
    global_load_dword v13, v3, s[26:27]
    v_add_u32 v3, 43776, v3
    global_load_dword v14, v3, s[26:27]
    v_add_u32 v3, 43776, v3
    global_load_dword v15, v3, s[26:27]
    v_add_u32 v3, 43776, v3
    global_load_dword v16, v3, s[26:27]
    v_add_u32 v3, 43776, v3
    global_load_dword v17, v3, s[26:27]
    v_add_u32 v3, 43776, v3
    global_load_dword v18, v3, s[26:27]
    v_add_u32 v3, 43776, v3
    global_load_dword v19, v3, s[26:27]
    v_add_u32 v3, 43776, v3
    global_load_dword v20, v3, s[26:27]
    v_add_u32 v3, 43776, v3
    global_load_dword v21, v3, s[26:27]
    v_add_u32 v3, 43776, v3
    global_load_dword v22, v3, s[26:27]
    v_add_u32 v3, 43776, v3
    global_load_dword v23, v3, s[26:27]
    v_add_u32 v3, 43776, v3
    global_load_dword v24, v3, s[26:27]
    v_add_u32 v3, 43776, v3
    global_load_dword v25, v3, s[26:27]
    v_add_u32 v3, 43776, v3
    s_waitcnt vmcnt(0)
    v_mov_b32 v4, 0
    v_add_f32 v4, v4, v10
    v_add_f32 v4, v4, v11
    v_add_f32 v4, v4, v12
    v_add_f32 v4, v4, v13
    v_add_f32 v4, v4, v14
    v_add_f32 v4, v4, v15
    v_add_f32 v4, v4, v16
    v_add_f32 v4, v4, v17
    v_add_f32 v4, v4, v18
    v_add_f32 v4, v4, v19
    v_add_f32 v4, v4, v20
    v_add_f32 v4, v4, v21
    v_add_f32 v4, v4, v22
    v_add_f32 v4, v4, v23
    v_add_f32 v4, v4, v24
    v_add_f32 v4, v4, v25
    v_cvt_pk_bf16_f32 v5, v4, v4
    v_lshlrev_b32 v4, 16, v5
    v_lshlrev_b32 v3, 2, v2
    ds_write_b32 v3, v4
J2S_78:
    s_mov_b64 exec, s[30:31]
    v_add_u32 v2, 256, v0
    v_cmp_gt_u32 vcc, 576, v2
    s_and_saveexec_b64 s[30:31], vcc
    s_cbranch_execz J2S_79
    v_mul_u32_u24 v3, 3641, v2
    v_lshrrev_b32 v3, 16, v3
    v_mul_u32_u24 v4, 18, v3
    v_sub_u32 v4, v2, v4
    v_mul_u32_u24 v3, 342, v3
    v_add_u32 v3, v3, v4
    v_add_u32 v3, 324, v3
    v_lshlrev_b32 v3, 2, v3
    global_load_dword v10, v3, s[26:27]
    v_add_u32 v3, 43776, v3
    global_load_dword v11, v3, s[26:27]
    v_add_u32 v3, 43776, v3
    global_load_dword v12, v3, s[26:27]
    v_add_u32 v3, 43776, v3
    global_load_dword v13, v3, s[26:27]
    v_add_u32 v3, 43776, v3
    global_load_dword v14, v3, s[26:27]
    v_add_u32 v3, 43776, v3
    global_load_dword v15, v3, s[26:27]
    v_add_u32 v3, 43776, v3
    global_load_dword v16, v3, s[26:27]
    v_add_u32 v3, 43776, v3
    global_load_dword v17, v3, s[26:27]
    v_add_u32 v3, 43776, v3
    global_load_dword v18, v3, s[26:27]
    v_add_u32 v3, 43776, v3
    global_load_dword v19, v3, s[26:27]
    v_add_u32 v3, 43776, v3
    global_load_dword v20, v3, s[26:27]
    v_add_u32 v3, 43776, v3
    global_load_dword v21, v3, s[26:27]
    v_add_u32 v3, 43776, v3
    global_load_dword v22, v3, s[26:27]
    v_add_u32 v3, 43776, v3
    global_load_dword v23, v3, s[26:27]
    v_add_u32 v3, 43776, v3
    global_load_dword v24, v3, s[26:27]
    v_add_u32 v3, 43776, v3
    global_load_dword v25, v3, s[26:27]
    v_add_u32 v3, 43776, v3
    s_waitcnt vmcnt(0)
    v_mov_b32 v4, 0
    v_add_f32 v4, v4, v10
    v_add_f32 v4, v4, v11
    v_add_f32 v4, v4, v12
    v_add_f32 v4, v4, v13
    v_add_f32 v4, v4, v14
    v_add_f32 v4, v4, v15
    v_add_f32 v4, v4, v16
    v_add_f32 v4, v4, v17
    v_add_f32 v4, v4, v18
    v_add_f32 v4, v4, v19
    v_add_f32 v4, v4, v20
    v_add_f32 v4, v4, v21
    v_add_f32 v4, v4, v22
    v_add_f32 v4, v4, v23
    v_add_f32 v4, v4, v24
    v_add_f32 v4, v4, v25
    v_cvt_pk_bf16_f32 v5, v4, v4
    v_lshlrev_b32 v4, 16, v5
    v_lshlrev_b32 v3, 2, v2
    ds_write_b32 v3, v4
J2S_79:
    s_mov_b64 exec, s[30:31]
    v_add_u32 v2, 512, v0
    v_cmp_gt_u32 vcc, 576, v2
    s_and_saveexec_b64 s[30:31], vcc
    s_cbranch_execz J2S_80
    v_mul_u32_u24 v3, 3641, v2
    v_lshrrev_b32 v3, 16, v3
    v_mul_u32_u24 v4, 18, v3
    v_sub_u32 v4, v2, v4
    v_mul_u32_u24 v3, 342, v3
    v_add_u32 v3, v3, v4
    v_add_u32 v3, 324, v3
    v_lshlrev_b32 v3, 2, v3
    global_load_dword v10, v3, s[26:27]
    v_add_u32 v3, 43776, v3
    global_load_dword v11, v3, s[26:27]
    v_add_u32 v3, 43776, v3
    global_load_dword v12, v3, s[26:27]
    v_add_u32 v3, 43776, v3
    global_load_dword v13, v3, s[26:27]
    v_add_u32 v3, 43776, v3
    global_load_dword v14, v3, s[26:27]
    v_add_u32 v3, 43776, v3
    global_load_dword v15, v3, s[26:27]
    v_add_u32 v3, 43776, v3
    global_load_dword v16, v3, s[26:27]
    v_add_u32 v3, 43776, v3
    global_load_dword v17, v3, s[26:27]
    v_add_u32 v3, 43776, v3
    global_load_dword v18, v3, s[26:27]
    v_add_u32 v3, 43776, v3
    global_load_dword v19, v3, s[26:27]
    v_add_u32 v3, 43776, v3
    global_load_dword v20, v3, s[26:27]
    v_add_u32 v3, 43776, v3
    global_load_dword v21, v3, s[26:27]
    v_add_u32 v3, 43776, v3
    global_load_dword v22, v3, s[26:27]
    v_add_u32 v3, 43776, v3
    global_load_dword v23, v3, s[26:27]
    v_add_u32 v3, 43776, v3
    global_load_dword v24, v3, s[26:27]
    v_add_u32 v3, 43776, v3
    global_load_dword v25, v3, s[26:27]
    v_add_u32 v3, 43776, v3
    s_waitcnt vmcnt(0)
    v_mov_b32 v4, 0
    v_add_f32 v4, v4, v10
    v_add_f32 v4, v4, v11
    v_add_f32 v4, v4, v12
    v_add_f32 v4, v4, v13
    v_add_f32 v4, v4, v14
    v_add_f32 v4, v4, v15
    v_add_f32 v4, v4, v16
    v_add_f32 v4, v4, v17
    v_add_f32 v4, v4, v18
    v_add_f32 v4, v4, v19
    v_add_f32 v4, v4, v20
    v_add_f32 v4, v4, v21
    v_add_f32 v4, v4, v22
    v_add_f32 v4, v4, v23
    v_add_f32 v4, v4, v24
    v_add_f32 v4, v4, v25
    v_cvt_pk_bf16_f32 v5, v4, v4
    v_lshlrev_b32 v4, 16, v5
    v_lshlrev_b32 v3, 2, v2
    ds_write_b32 v3, v4
J2S_80:
    s_mov_b64 exec, s[30:31]
    s_waitcnt lgkmcnt(0)
    s_barrier
    v_mul_u32_u24 v2, 36, v1
    ds_read_b32 v40, v2 offset:0
    ds_read_b32 v41, v2 offset:4
    ds_read_b32 v42, v2 offset:8
    ds_read_b32 v43, v2 offset:12
    ds_read_b32 v44, v2 offset:16
    ds_read_b32 v45, v2 offset:20
    ds_read_b32 v46, v2 offset:24
    ds_read_b32 v47, v2 offset:28
    ds_read_b32 v48, v2 offset:32
    v_mul_u32_u24 v3, 18, v1
    global_load_ushort v50, v3, s[10:11] offset:0
    global_load_ushort v51, v3, s[10:11] offset:2
    global_load_ushort v52, v3, s[10:11] offset:4
    global_load_ushort v53, v3, s[10:11] offset:6
    global_load_ushort v54, v3, s[10:11] offset:8
    global_load_ushort v55, v3, s[10:11] offset:10
    global_load_ushort v56, v3, s[10:11] offset:12
    global_load_ushort v57, v3, s[10:11] offset:14
    global_load_ushort v58, v3, s[10:11] offset:16
    s_waitcnt vmcnt(0) lgkmcnt(0)
    v_lshlrev_b32 v50, 16, v50
    v_lshlrev_b32 v51, 16, v51
    v_lshlrev_b32 v52, 16, v52
    v_lshlrev_b32 v53, 16, v53
    v_lshlrev_b32 v54, 16, v54
    v_lshlrev_b32 v55, 16, v55
    v_lshlrev_b32 v56, 16, v56
    v_lshlrev_b32 v57, 16, v57
    v_lshlrev_b32 v58, 16, v58
    s_sub_u32 s9, s2, 96
    s_lshl_b32 s9, s9, 3
    s_lshl_b32 s12, s8, 1
    s_add_u32 s9, s9, s12
    s_mul_i32 s12, s9, 1152
    v_add_u32 v3, s12, v3
    s_add_u32 s14, s24, 18874368
    s_addc_u32 s15, s25, 0
    s_add_u32 s16, s24, 21233664
    s_addc_u32 s17, s25, 0
    global_load_ushort v60, v3, s[4:5] offset:0
    global_load_ushort v70, v3, s[14:15] offset:0
    global_load_ushort v61, v3, s[4:5] offset:2
    global_load_ushort v71, v3, s[14:15] offset:2
    global_load_ushort v62, v3, s[4:5] offset:4
    global_load_ushort v72, v3, s[14:15] offset:4
    global_load_ushort v63, v3, s[4:5] offset:6
    global_load_ushort v73, v3, s[14:15] offset:6
    global_load_ushort v64, v3, s[4:5] offset:8
    global_load_ushort v74, v3, s[14:15] offset:8
    global_load_ushort v65, v3, s[4:5] offset:10
    global_load_ushort v75, v3, s[14:15] offset:10
    global_load_ushort v66, v3, s[4:5] offset:12
    global_load_ushort v76, v3, s[14:15] offset:12
    global_load_ushort v67, v3, s[4:5] offset:14
    global_load_ushort v77, v3, s[14:15] offset:14
    global_load_ushort v68, v3, s[4:5] offset:16
    global_load_ushort v78, v3, s[14:15] offset:16
    s_waitcnt vmcnt(0)
    v_mov_b32 v4, 0
    v_mov_b32 v5, 0
    v_lshlrev_b32 v60, 16, v60
    v_lshlrev_b32 v70, 16, v70
    v_fmac_f32 v4, v60, v50
    v_fmac_f32 v5, v70, v40
    v_lshlrev_b32 v61, 16, v61
    v_lshlrev_b32 v71, 16, v71
    v_fmac_f32 v4, v61, v51
    v_fmac_f32 v5, v71, v41
    v_lshlrev_b32 v62, 16, v62
    v_lshlrev_b32 v72, 16, v72
    v_fmac_f32 v4, v62, v52
    v_fmac_f32 v5, v72, v42
    v_lshlrev_b32 v63, 16, v63
    v_lshlrev_b32 v73, 16, v73
    v_fmac_f32 v4, v63, v53
    v_fmac_f32 v5, v73, v43
    v_lshlrev_b32 v64, 16, v64
    v_lshlrev_b32 v74, 16, v74
    v_fmac_f32 v4, v64, v54
    v_fmac_f32 v5, v74, v44
    v_lshlrev_b32 v65, 16, v65
    v_lshlrev_b32 v75, 16, v75
    v_fmac_f32 v4, v65, v55
    v_fmac_f32 v5, v75, v45
    v_lshlrev_b32 v66, 16, v66
    v_lshlrev_b32 v76, 16, v76
    v_fmac_f32 v4, v66, v56
    v_fmac_f32 v5, v76, v46
    v_lshlrev_b32 v67, 16, v67
    v_lshlrev_b32 v77, 16, v77
    v_fmac_f32 v4, v67, v57
    v_fmac_f32 v5, v77, v47
    v_lshlrev_b32 v68, 16, v68
    v_lshlrev_b32 v78, 16, v78
    v_fmac_f32 v4, v68, v58
    v_fmac_f32 v5, v78, v48
    ds_swizzle_b32 v6, v5 offset:0x041F
    s_waitcnt lgkmcnt(0)
    v_add_f32 v5, v5, v6
    v_cvt_pk_bf16_f32 v6, v5, v5
    v_lshlrev_b32 v5, 16, v6
    v_add_f32 v5, 0x358637bd, v5
    v_cvt_pk_bf16_f32 v6, v5, v5
    v_lshlrev_b32 v5, 16, v6
    ds_swizzle_b32 v6, v4 offset:0x41F
    s_waitcnt lgkmcnt(0)
    v_add_f32 v4, v4, v6
    ds_swizzle_b32 v6, v4 offset:0x81F
    s_waitcnt lgkmcnt(0)
    v_add_f32 v4, v4, v6
    ds_swizzle_b32 v6, v4 offset:0x101F
    s_waitcnt lgkmcnt(0)
    v_add_f32 v4, v4, v6
    ds_swizzle_b32 v6, v4 offset:0x201F
    s_waitcnt lgkmcnt(0)
    v_add_f32 v4, v4, v6
    ds_swizzle_b32 v6, v4 offset:0x401F
    s_waitcnt lgkmcnt(0)
    v_add_f32 v4, v4, v6
    s_nop 0
    v_readlane_b32 s20, v4, 0
    v_readlane_b32 s21, v4, 32
    s_nop 1
    v_mov_b32 v4, s20
    v_add_f32 v4, s21, v4
    v_cvt_pk_bf16_f32 v6, v4, v4
    v_lshlrev_b32 v4, 16, v6
    v_mul_f32 v6, 0xbfb8aa3b, v4
    v_exp_f32 v6, v6
    s_nop 0
    v_add_f32 v6, 1.0, v6
    v_rcp_f32 v6, v6
    s_nop 0
    v_cvt_pk_bf16_f32 v7, v6, v6
    v_lshlrev_b32 v6, 16, v7
    v_rcp_f32 v7, v5
    s_nop 0
    v_mul_f32 v7, v7, v6
    v_mul_f32 v8, v70, v7
    v_cvt_pk_bf16_f32 v8, v8, v8
    global_store_short v3, v8, s[16:17] offset:0
    v_mul_f32 v8, v71, v7
    v_cvt_pk_bf16_f32 v8, v8, v8
    global_store_short v3, v8, s[16:17] offset:2
    v_mul_f32 v8, v72, v7
    v_cvt_pk_bf16_f32 v8, v8, v8
    global_store_short v3, v8, s[16:17] offset:4
    v_mul_f32 v8, v73, v7
    v_cvt_pk_bf16_f32 v8, v8, v8
    global_store_short v3, v8, s[16:17] offset:6
    v_mul_f32 v8, v74, v7
    v_cvt_pk_bf16_f32 v8, v8, v8
    global_store_short v3, v8, s[16:17] offset:8
    v_mul_f32 v8, v75, v7
    v_cvt_pk_bf16_f32 v8, v8, v8
    global_store_short v3, v8, s[16:17] offset:10
    v_mul_f32 v8, v76, v7
    v_cvt_pk_bf16_f32 v8, v8, v8
    global_store_short v3, v8, s[16:17] offset:12
    v_mul_f32 v8, v77, v7
    v_cvt_pk_bf16_f32 v8, v8, v8
    global_store_short v3, v8, s[16:17] offset:14
    v_mul_f32 v8, v78, v7
    v_cvt_pk_bf16_f32 v8, v8, v8
    global_store_short v3, v8, s[16:17] offset:16
    s_add_u32 s12, s9, 0
    s_lshl_b32 s12, s12, 2
    s_add_u32 s12, s12, 24956928
    v_mov_b32 v8, s12
    s_mov_b64 s[30:31], exec
    s_mov_b64 exec, 1
    global_store_dword v8, v6, s[24:25]
    s_mov_b64 exec, s[30:31]
    v_add_u32 v3, 1152, v3
    global_load_ushort v60, v3, s[4:5] offset:0
    global_load_ushort v70, v3, s[14:15] offset:0
    global_load_ushort v61, v3, s[4:5] offset:2
    global_load_ushort v71, v3, s[14:15] offset:2
    global_load_ushort v62, v3, s[4:5] offset:4
    global_load_ushort v72, v3, s[14:15] offset:4
    global_load_ushort v63, v3, s[4:5] offset:6
    global_load_ushort v73, v3, s[14:15] offset:6
    global_load_ushort v64, v3, s[4:5] offset:8
    global_load_ushort v74, v3, s[14:15] offset:8
    global_load_ushort v65, v3, s[4:5] offset:10
    global_load_ushort v75, v3, s[14:15] offset:10
    global_load_ushort v66, v3, s[4:5] offset:12
    global_load_ushort v76, v3, s[14:15] offset:12
    global_load_ushort v67, v3, s[4:5] offset:14
    global_load_ushort v77, v3, s[14:15] offset:14
    global_load_ushort v68, v3, s[4:5] offset:16
    global_load_ushort v78, v3, s[14:15] offset:16
    s_waitcnt vmcnt(0)
    v_mov_b32 v4, 0
    v_mov_b32 v5, 0
    v_lshlrev_b32 v60, 16, v60
    v_lshlrev_b32 v70, 16, v70
    v_fmac_f32 v4, v60, v50
    v_fmac_f32 v5, v70, v40
    v_lshlrev_b32 v61, 16, v61
    v_lshlrev_b32 v71, 16, v71
    v_fmac_f32 v4, v61, v51
    v_fmac_f32 v5, v71, v41
    v_lshlrev_b32 v62, 16, v62
    v_lshlrev_b32 v72, 16, v72
    v_fmac_f32 v4, v62, v52
    v_fmac_f32 v5, v72, v42
    v_lshlrev_b32 v63, 16, v63
    v_lshlrev_b32 v73, 16, v73
    v_fmac_f32 v4, v63, v53
    v_fmac_f32 v5, v73, v43
    v_lshlrev_b32 v64, 16, v64
    v_lshlrev_b32 v74, 16, v74
    v_fmac_f32 v4, v64, v54
    v_fmac_f32 v5, v74, v44
    v_lshlrev_b32 v65, 16, v65
    v_lshlrev_b32 v75, 16, v75
    v_fmac_f32 v4, v65, v55
    v_fmac_f32 v5, v75, v45
    v_lshlrev_b32 v66, 16, v66
    v_lshlrev_b32 v76, 16, v76
    v_fmac_f32 v4, v66, v56
    v_fmac_f32 v5, v76, v46
    v_lshlrev_b32 v67, 16, v67
    v_lshlrev_b32 v77, 16, v77
    v_fmac_f32 v4, v67, v57
    v_fmac_f32 v5, v77, v47
    v_lshlrev_b32 v68, 16, v68
    v_lshlrev_b32 v78, 16, v78
    v_fmac_f32 v4, v68, v58
    v_fmac_f32 v5, v78, v48
    ds_swizzle_b32 v6, v5 offset:0x041F
    s_waitcnt lgkmcnt(0)
    v_add_f32 v5, v5, v6
    v_cvt_pk_bf16_f32 v6, v5, v5
    v_lshlrev_b32 v5, 16, v6
    v_add_f32 v5, 0x358637bd, v5
    v_cvt_pk_bf16_f32 v6, v5, v5
    v_lshlrev_b32 v5, 16, v6
    ds_swizzle_b32 v6, v4 offset:0x41F
    s_waitcnt lgkmcnt(0)
    v_add_f32 v4, v4, v6
    ds_swizzle_b32 v6, v4 offset:0x81F
    s_waitcnt lgkmcnt(0)
    v_add_f32 v4, v4, v6
    ds_swizzle_b32 v6, v4 offset:0x101F
    s_waitcnt lgkmcnt(0)
    v_add_f32 v4, v4, v6
    ds_swizzle_b32 v6, v4 offset:0x201F
    s_waitcnt lgkmcnt(0)
    v_add_f32 v4, v4, v6
    ds_swizzle_b32 v6, v4 offset:0x401F
    s_waitcnt lgkmcnt(0)
    v_add_f32 v4, v4, v6
    s_nop 0
    v_readlane_b32 s20, v4, 0
    v_readlane_b32 s21, v4, 32
    s_nop 1
    v_mov_b32 v4, s20
    v_add_f32 v4, s21, v4
    v_cvt_pk_bf16_f32 v6, v4, v4
    v_lshlrev_b32 v4, 16, v6
    v_mul_f32 v6, 0xbfb8aa3b, v4
    v_exp_f32 v6, v6
    s_nop 0
    v_add_f32 v6, 1.0, v6
    v_rcp_f32 v6, v6
    s_nop 0
    v_cvt_pk_bf16_f32 v7, v6, v6
    v_lshlrev_b32 v6, 16, v7
    v_rcp_f32 v7, v5
    s_nop 0
    v_mul_f32 v7, v7, v6
    v_mul_f32 v8, v70, v7
    v_cvt_pk_bf16_f32 v8, v8, v8
    global_store_short v3, v8, s[16:17] offset:0
    v_mul_f32 v8, v71, v7
    v_cvt_pk_bf16_f32 v8, v8, v8
    global_store_short v3, v8, s[16:17] offset:2
    v_mul_f32 v8, v72, v7
    v_cvt_pk_bf16_f32 v8, v8, v8
    global_store_short v3, v8, s[16:17] offset:4
    v_mul_f32 v8, v73, v7
    v_cvt_pk_bf16_f32 v8, v8, v8
    global_store_short v3, v8, s[16:17] offset:6
    v_mul_f32 v8, v74, v7
    v_cvt_pk_bf16_f32 v8, v8, v8
    global_store_short v3, v8, s[16:17] offset:8
    v_mul_f32 v8, v75, v7
    v_cvt_pk_bf16_f32 v8, v8, v8
    global_store_short v3, v8, s[16:17] offset:10
    v_mul_f32 v8, v76, v7
    v_cvt_pk_bf16_f32 v8, v8, v8
    global_store_short v3, v8, s[16:17] offset:12
    v_mul_f32 v8, v77, v7
    v_cvt_pk_bf16_f32 v8, v8, v8
    global_store_short v3, v8, s[16:17] offset:14
    v_mul_f32 v8, v78, v7
    v_cvt_pk_bf16_f32 v8, v8, v8
    global_store_short v3, v8, s[16:17] offset:16
    s_add_u32 s12, s9, 1
    s_lshl_b32 s12, s12, 2
    s_add_u32 s12, s12, 24956928
    v_mov_b32 v8, s12
    s_mov_b64 s[30:31], exec
    s_mov_b64 exec, 1
    global_store_dword v8, v6, s[24:25]
    s_mov_b64 exec, s[30:31]
    v_add_u32 v3, 1152, v3
K15_END:
    s_endpgm
.globl k2_kernel
.p2align 8
.type k2_kernel,@function
k2_kernel:
    s_cmp_ge_u32 s2, 256
    s_cbranch_scc1 K2_END
    s_load_dwordx2 s[22:23], s[0:1], 40
    s_load_dwordx2 s[24:25], s[0:1], 72
    v_lshrrev_b32 v1, 6, v0
    s_nop 0
    v_readfirstlane_b32 s8, v1
    s_nop 1
    v_and_b32 v1, 63, v0
    v_lshrrev_b32 v16, 4, v1
    v_and_b32 v17, 15, v1
    v_lshrrev_b32 v18, 1, v17
    v_and_b32 v18, 7, v18
    v_lshrrev_b32 v19, 1, v16
    v_xor_b32 v18, v18, v19
    v_lshlrev_b32 v18, 4, v18
    v_and_b32 v19, 1, v16
    v_lshlrev_b32 v19, 3, v19
    v_add_u32 v18, v18, v19
    s_lshl_b32 s9, s8, 5
    v_add_u32 v19, s9, v17
    v_lshlrev_b32 v19, 7, v19
    v_add_u32 v18, v18, v19
    v_xor_b32 v11, 0, v18
    v_xor_b32 v12, 32, v18
    v_xor_b32 v13, 64, v18
    v_xor_b32 v14, 96, v18
    v_lshlrev_b32 v18, 2, v16
    v_lshrrev_b32 v19, 2, v17
    v_add_u32 v18, v18, v19
    v_mul_u32_u24 v18, 288, v18
    v_and_b32 v19, 3, v17
    v_lshlrev_b32 v19, 3, v19
    v_add_u32 v18, v18, v19
    v_add_u32 v15, 16384, v18
    v_add_u32 v200, 69632, v11
    v_add_u32 v201, 69632, v12
    v_add_u32 v202, 69632, v13
    v_add_u32 v203, 69632, v14
    v_add_u32 v204, 69632, v15
    v_mov_b32 v108, 0
    v_mov_b32 v109, 0
    v_mov_b32 v110, 0
    v_mov_b32 v111, 0
    v_mov_b32 v112, 0
    v_mov_b32 v113, 0
    v_mov_b32 v114, 0
    v_mov_b32 v115, 0
    v_mov_b32 v116, 0
    v_mov_b32 v117, 0
    v_mov_b32 v118, 0
    v_mov_b32 v119, 0
    v_mov_b32 v120, 0
    v_mov_b32 v121, 0
    v_mov_b32 v122, 0
    v_mov_b32 v123, 0
    v_mov_b32 v124, 0
    v_mov_b32 v125, 0
    v_mov_b32 v126, 0
    v_mov_b32 v127, 0
    v_mov_b32 v128, 0
    v_mov_b32 v129, 0
    v_mov_b32 v130, 0
    v_mov_b32 v131, 0
    v_mov_b32 v132, 0
    v_mov_b32 v133, 0
    v_mov_b32 v134, 0
    v_mov_b32 v135, 0
    v_mov_b32 v136, 0
    v_mov_b32 v137, 0
    v_mov_b32 v138, 0
    v_mov_b32 v139, 0
    v_mov_b32 v140, 0
    v_mov_b32 v141, 0
    v_mov_b32 v142, 0
    v_mov_b32 v143, 0
    v_mov_b32 v144, 0
    v_mov_b32 v145, 0
    v_mov_b32 v146, 0
    v_mov_b32 v147, 0
    v_mov_b32 v148, 0
    v_mov_b32 v149, 0
    v_mov_b32 v150, 0
    v_mov_b32 v151, 0
    v_mov_b32 v152, 0
    v_mov_b32 v153, 0
    v_mov_b32 v154, 0
    v_mov_b32 v155, 0
    v_mov_b32 v156, 0
    v_mov_b32 v157, 0
    v_mov_b32 v158, 0
    v_mov_b32 v159, 0
    v_mov_b32 v160, 0
    v_mov_b32 v161, 0
    v_mov_b32 v162, 0
    v_mov_b32 v163, 0
    v_mov_b32 v164, 0
    v_mov_b32 v165, 0
    v_mov_b32 v166, 0
    v_mov_b32 v167, 0
    v_mov_b32 v168, 0
    v_mov_b32 v169, 0
    v_mov_b32 v170, 0
    v_mov_b32 v171, 0
    v_mov_b32 v172, 0
    v_mov_b32 v173, 0
    v_mov_b32 v174, 0
    v_mov_b32 v175, 0
    v_mov_b32 v176, 0
    v_mov_b32 v177, 0
    v_mov_b32 v178, 0
    v_mov_b32 v179, 0
    s_waitcnt lgkmcnt(0)
    s_mov_b32 s34, s24
    s_mov_b32 s35, s25
    s_lshr_b32 s20, s2, 4
    s_and_b32 s20, s20, 3
    s_lshr_b32 s12, s2, 6
    s_mul_i32 s12, s12, 288
    s_and_b32 s15, s2, 7
    s_lshl_b32 s15, s15, 1
    s_lshr_b32 s9, s2, 3
    s_and_b32 s9, s9, 1
    s_add_u32 s15, s15, s9
    s_lshl_b32 s15, s15, 7
    s_mul_i32 s21, s20, 20
    s_cmp_gt_u32 s20, 0
    s_cselect_b32 s9, 1, 0
    s_add_u32 s21, s21, s9
    s_lshl_b32 s9, s21, 7
    s_add_u32 s4, s24, s9
    s_addc_u32 s5, s25, 0
    s_mul_i32 s9, s21, 73728
    s_add_u32 s6, s22, s9
    s_addc_u32 s7, s23, 0
    s_mov_b32 s17, 1152
    s_mov_b32 s18, 73728
    s_mov_b32 s19, 9216
    s_lshl_b32 s9, s8, 8
    s_add_u32 s9, s9, 0
    v_add_u32 v16, s9, v1
    v_lshrrev_b32 v17, 3, v16
    v_and_b32 v18, 7, v16
    v_lshrrev_b32 v19, 1, v17
    v_and_b32 v19, 7, v19
    v_xor_b32 v18, v18, v19
    v_lshlrev_b32 v18, 4, v18
    v_add_u32 v17, s15, v17
    v_mul_lo_u32 v17, v17, s19
    v_add_u32 v2, v17, v18
    s_lshl_b32 s9, s8, 8
    s_add_u32 s9, s9, 64
    v_add_u32 v16, s9, v1
    v_lshrrev_b32 v17, 3, v16
    v_and_b32 v18, 7, v16
    v_lshrrev_b32 v19, 1, v17
    v_and_b32 v19, 7, v19
    v_xor_b32 v18, v18, v19
    v_lshlrev_b32 v18, 4, v18
    v_add_u32 v17, s15, v17
    v_mul_lo_u32 v17, v17, s19
    v_add_u32 v3, v17, v18
    s_lshl_b32 s9, s8, 8
    s_add_u32 s9, s9, 128
    v_add_u32 v16, s9, v1
    v_lshrrev_b32 v17, 3, v16
    v_and_b32 v18, 7, v16
    v_lshrrev_b32 v19, 1, v17
    v_and_b32 v19, 7, v19
    v_xor_b32 v18, v18, v19
    v_lshlrev_b32 v18, 4, v18
    v_add_u32 v17, s15, v17
    v_mul_lo_u32 v17, v17, s19
    v_add_u32 v4, v17, v18
    s_lshl_b32 s9, s8, 8
    s_add_u32 s9, s9, 192
    v_add_u32 v16, s9, v1
    v_lshrrev_b32 v17, 3, v16
    v_and_b32 v18, 7, v16
    v_lshrrev_b32 v19, 1, v17
    v_and_b32 v19, 7, v19
    v_xor_b32 v18, v18, v19
    v_lshlrev_b32 v18, 4, v18
    v_add_u32 v17, s15, v17
    v_mul_lo_u32 v17, v17, s19
    v_add_u32 v5, v17, v18
    s_mul_i32 s9, s8, 288
    s_add_u32 s9, s9, 0
    v_add_u32 v16, s9, v1
    v_mul_u32_u24 v17, 3641, v16
    v_lshrrev_b32 v17, 16, v17
    v_mul_u32_u24 v18, 18, v17
    v_sub_u32 v18, v16, v18
    v_mul_lo_u32 v17, v17, s17
    v_lshlrev_b32 v18, 4, v18
    v_add_u32 v17, v17, v18
    v_add_u32 v6, s12, v17
    s_mul_i32 s9, s8, 288
    s_add_u32 s9, s9, 64
    v_add_u32 v16, s9, v1
    v_mul_u32_u24 v17, 3641, v16
    v_lshrrev_b32 v17, 16, v17
    v_mul_u32_u24 v18, 18, v17
    v_sub_u32 v18, v16, v18
    v_mul_lo_u32 v17, v17, s17
    v_lshlrev_b32 v18, 4, v18
    v_add_u32 v17, v17, v18
    v_add_u32 v7, s12, v17
    s_mul_i32 s9, s8, 288
    s_add_u32 s9, s9, 128
    v_add_u32 v16, s9, v1
    v_mul_u32_u24 v17, 3641, v16
    v_lshrrev_b32 v17, 16, v17
    v_mul_u32_u24 v18, 18, v17
    v_sub_u32 v18, v16, v18
    v_mul_lo_u32 v17, v17, s17
    v_lshlrev_b32 v18, 4, v18
    v_add_u32 v17, v17, v18
    v_add_u32 v8, s12, v17
    s_mul_i32 s9, s8, 288
    s_add_u32 s9, s9, 192
    v_add_u32 v16, s9, v1
    v_mul_u32_u24 v17, 3641, v16
    v_lshrrev_b32 v17, 16, v17
    v_mul_u32_u24 v18, 18, v17
    v_sub_u32 v18, v16, v18
    v_mul_lo_u32 v17, v17, s17
    v_lshlrev_b32 v18, 4, v18
    v_add_u32 v17, v17, v18
    v_add_u32 v9, s12, v17
    s_mul_i32 s9, s8, 288
    s_add_u32 s9, s9, 256
    v_add_u32 v16, s9, v1
    v_mul_u32_u24 v17, 3641, v16
    v_lshrrev_b32 v17, 16, v17
    v_mul_u32_u24 v18, 18, v17
    v_sub_u32 v18, v16, v18
    v_mul_lo_u32 v17, v17, s17
    v_lshlrev_b32 v18, 4, v18
    v_add_u32 v17, v17, v18
    v_add_u32 v10, s12, v17
    s_cmp_eq_u32 s20, 0
    s_cbranch_scc1 K2_S0
    s_cmp_eq_u32 s20, 3
    s_cbranch_scc1 K2_S3
    s_lshl_b32 s9, s8, 12
    s_add_u32 m0, s9, 0
    s_nop 0
    global_load_lds_dwordx4 v2, s[4:5]
    s_lshl_b32 s9, s8, 12
    s_add_u32 m0, s9, 1024
    s_nop 0
    global_load_lds_dwordx4 v3, s[4:5]
    s_lshl_b32 s9, s8, 12
    s_add_u32 m0, s9, 2048
    s_nop 0
    global_load_lds_dwordx4 v4, s[4:5]
    s_lshl_b32 s9, s8, 12
    s_add_u32 m0, s9, 3072
    s_nop 0
    global_load_lds_dwordx4 v5, s[4:5]
    s_mul_i32 s9, s8, 4608
    s_add_u32 m0, s9, 16384
    s_nop 0
    global_load_lds_dwordx4 v6, s[6:7]
    s_mul_i32 s9, s8, 4608
    s_add_u32 m0, s9, 17408
    s_nop 0
    global_load_lds_dwordx4 v7, s[6:7]
    s_mul_i32 s9, s8, 4608
    s_add_u32 m0, s9, 18432
    s_nop 0
    global_load_lds_dwordx4 v8, s[6:7]
    s_mul_i32 s9, s8, 4608
    s_add_u32 m0, s9, 19456
    s_nop 0
    global_load_lds_dwordx4 v9, s[6:7]
    s_mul_i32 s9, s8, 4608
    s_add_u32 m0, s9, 20480
    s_mov_b32 exec_hi, 0
    global_load_lds_dwordx4 v10, s[6:7]
    s_mov_b64 exec, -1
    s_add_u32 s4, s4, 128
    s_addc_u32 s5, s5, 0
    s_add_u32 s6, s6, s18
    s_addc_u32 s7, s7, 0
    s_lshl_b32 s9, s8, 12
    s_add_u32 m0, s9, 34816
    s_nop 0
    global_load_lds_dwordx4 v2, s[4:5]
    s_lshl_b32 s9, s8, 12
    s_add_u32 m0, s9, 35840
    s_nop 0
    global_load_lds_dwordx4 v3, s[4:5]
    s_lshl_b32 s9, s8, 12
    s_add_u32 m0, s9, 36864
    s_nop 0
    global_load_lds_dwordx4 v4, s[4:5]
    s_lshl_b32 s9, s8, 12
    s_add_u32 m0, s9, 37888
    s_nop 0
    global_load_lds_dwordx4 v5, s[4:5]
    s_mul_i32 s9, s8, 4608
    s_add_u32 m0, s9, 51200
    s_nop 0
    global_load_lds_dwordx4 v6, s[6:7]
    s_mul_i32 s9, s8, 4608
    s_add_u32 m0, s9, 52224
    s_nop 0
    global_load_lds_dwordx4 v7, s[6:7]
    s_mul_i32 s9, s8, 4608
    s_add_u32 m0, s9, 53248
    s_nop 0
    global_load_lds_dwordx4 v8, s[6:7]
    s_mul_i32 s9, s8, 4608
    s_add_u32 m0, s9, 54272
    s_nop 0
    global_load_lds_dwordx4 v9, s[6:7]
    s_mul_i32 s9, s8, 4608
    s_add_u32 m0, s9, 55296
    s_mov_b32 exec_hi, 0
    global_load_lds_dwordx4 v10, s[6:7]
    s_mov_b64 exec, -1
    s_add_u32 s4, s4, 128
    s_addc_u32 s5, s5, 0
    s_add_u32 s6, s6, s18
    s_addc_u32 s7, s7, 0
    s_lshl_b32 s9, s8, 12
    s_add_u32 m0, s9, 69632
    s_nop 0
    global_load_lds_dwordx4 v2, s[4:5]
    s_lshl_b32 s9, s8, 12
    s_add_u32 m0, s9, 70656
    s_nop 0
    global_load_lds_dwordx4 v3, s[4:5]
    s_lshl_b32 s9, s8, 12
    s_add_u32 m0, s9, 71680
    s_nop 0
    global_load_lds_dwordx4 v4, s[4:5]
    s_lshl_b32 s9, s8, 12
    s_add_u32 m0, s9, 72704
    s_nop 0
    global_load_lds_dwordx4 v5, s[4:5]
    s_mul_i32 s9, s8, 4608
    s_add_u32 m0, s9, 86016
    s_nop 0
    global_load_lds_dwordx4 v6, s[6:7]
    s_mul_i32 s9, s8, 4608
    s_add_u32 m0, s9, 87040
    s_nop 0
    global_load_lds_dwordx4 v7, s[6:7]
    s_mul_i32 s9, s8, 4608
    s_add_u32 m0, s9, 88064
    s_nop 0
    global_load_lds_dwordx4 v8, s[6:7]
    s_mul_i32 s9, s8, 4608
    s_add_u32 m0, s9, 89088
    s_nop 0
    global_load_lds_dwordx4 v9, s[6:7]
    s_mul_i32 s9, s8, 4608
    s_add_u32 m0, s9, 90112
    s_mov_b32 exec_hi, 0
    global_load_lds_dwordx4 v10, s[6:7]
    s_mov_b64 exec, -1
    s_add_u32 s4, s4, 128
    s_addc_u32 s5, s5, 0
    s_add_u32 s6, s6, s18
    s_addc_u32 s7, s7, 0
    s_lshl_b32 s9, s8, 12
    s_add_u32 m0, s9, 104448
    s_nop 0
    global_load_lds_dwordx4 v2, s[4:5]
    s_lshl_b32 s9, s8, 12
    s_add_u32 m0, s9, 105472
    s_nop 0
    global_load_lds_dwordx4 v3, s[4:5]
    s_lshl_b32 s9, s8, 12
    s_add_u32 m0, s9, 106496
    s_nop 0
    global_load_lds_dwordx4 v4, s[4:5]
    s_lshl_b32 s9, s8, 12
    s_add_u32 m0, s9, 107520
    s_nop 0
    global_load_lds_dwordx4 v5, s[4:5]
    s_mul_i32 s9, s8, 4608
    s_add_u32 m0, s9, 120832
    s_nop 0
    global_load_lds_dwordx4 v6, s[6:7]
    s_mul_i32 s9, s8, 4608
    s_add_u32 m0, s9, 121856
    s_nop 0
    global_load_lds_dwordx4 v7, s[6:7]
    s_mul_i32 s9, s8, 4608
    s_add_u32 m0, s9, 122880
    s_nop 0
    global_load_lds_dwordx4 v8, s[6:7]
    s_mul_i32 s9, s8, 4608
    s_add_u32 m0, s9, 123904
    s_nop 0
    global_load_lds_dwordx4 v9, s[6:7]
    s_mul_i32 s9, s8, 4608
    s_add_u32 m0, s9, 124928
    s_mov_b32 exec_hi, 0
    global_load_lds_dwordx4 v10, s[6:7]
    s_mov_b64 exec, -1
    s_waitcnt vmcnt(27)
    s_barrier
    ds_read_b64 v[20:21], v11 offset:0
    ds_read_b64 v[22:23], v12 offset:0
    ds_read_b64 v[24:25], v11 offset:2048
    ds_read_b64 v[26:27], v12 offset:2048
    ds_read_b64_tr_b16 v[36:37], v15 offset:0
    ds_read_b64_tr_b16 v[38:39], v15 offset:4608
    ds_read_b64_tr_b16 v[40:41], v15 offset:32
    ds_read_b64_tr_b16 v[42:43], v15 offset:4640
    ds_read_b64_tr_b16 v[44:45], v15 offset:64
    ds_read_b64_tr_b16 v[46:47], v15 offset:4672
    ds_read_b64_tr_b16 v[48:49], v15 offset:96
    ds_read_b64_tr_b16 v[50:51], v15 offset:4704
    ds_read_b64_tr_b16 v[52:53], v15 offset:128
    ds_read_b64_tr_b16 v[54:55], v15 offset:4736
    ds_read_b64_tr_b16 v[56:57], v15 offset:160
    ds_read_b64_tr_b16 v[58:59], v15 offset:4768
    ds_read_b64_tr_b16 v[60:61], v15 offset:192
    ds_read_b64_tr_b16 v[62:63], v15 offset:4800
    ds_read_b64_tr_b16 v[64:65], v15 offset:224
    ds_read_b64_tr_b16 v[66:67], v15 offset:4832
    ds_read_b64_tr_b16 v[68:69], v15 offset:256
    ds_read_b64_tr_b16 v[70:71], v15 offset:4864
    s_waitcnt lgkmcnt(15)
    v_mfma_f32_16x16x32_bf16 v[108:111], v[36:39], v[20:23], v[108:111]
    v_mfma_f32_16x16x32_bf16 v[144:147], v[36:39], v[24:27], v[144:147]
    ds_read_b64 v[28:29], v13 offset:0
    ds_read_b64 v[30:31], v14 offset:0
    ds_read_b64 v[32:33], v13 offset:2048
    s_waitcnt lgkmcnt(15)
    v_mfma_f32_16x16x32_bf16 v[112:115], v[40:43], v[20:23], v[112:115]
    v_mfma_f32_16x16x32_bf16 v[148:151], v[40:43], v[24:27], v[148:151]
    ds_read_b64 v[34:35], v14 offset:2048
    ds_read_b64_tr_b16 v[72:73], v15 offset:9216
    ds_read_b64_tr_b16 v[74:75], v15 offset:13824
    v_mfma_f32_16x16x32_bf16 v[116:119], v[44:47], v[20:23], v[116:119]
    v_mfma_f32_16x16x32_bf16 v[152:155], v[44:47], v[24:27], v[152:155]
    ds_read_b64_tr_b16 v[76:77], v15 offset:9248
    ds_read_b64_tr_b16 v[78:79], v15 offset:13856
    ds_read_b64_tr_b16 v[80:81], v15 offset:9280
    s_waitcnt lgkmcnt(15)
    v_mfma_f32_16x16x32_bf16 v[120:123], v[48:51], v[20:23], v[120:123]
    v_mfma_f32_16x16x32_bf16 v[156:159], v[48:51], v[24:27], v[156:159]
    ds_read_b64_tr_b16 v[82:83], v15 offset:13888
    ds_read_b64_tr_b16 v[84:85], v15 offset:9312
    ds_read_b64_tr_b16 v[86:87], v15 offset:13920
    v_mfma_f32_16x16x32_bf16 v[124:127], v[52:55], v[20:23], v[124:127]
    v_mfma_f32_16x16x32_bf16 v[160:163], v[52:55], v[24:27], v[160:163]
    ds_read_b64_tr_b16 v[88:89], v15 offset:9344
    ds_read_b64_tr_b16 v[90:91], v15 offset:13952
    ds_read_b64_tr_b16 v[92:93], v15 offset:9376
    v_mfma_f32_16x16x32_bf16 v[128:131], v[56:59], v[20:23], v[128:131]
    v_mfma_f32_16x16x32_bf16 v[164:167], v[56:59], v[24:27], v[164:167]
    ds_read_b64_tr_b16 v[94:95], v15 offset:13984
    ds_read_b64_tr_b16 v[96:97], v15 offset:9408
    ds_read_b64_tr_b16 v[98:99], v15 offset:14016
    s_waitcnt lgkmcnt(15)
    v_mfma_f32_16x16x32_bf16 v[132:135], v[60:63], v[20:23], v[132:135]
    v_mfma_f32_16x16x32_bf16 v[168:171], v[60:63], v[24:27], v[168:171]
    ds_read_b64_tr_b16 v[100:101], v15 offset:9440
    ds_read_b64_tr_b16 v[102:103], v15 offset:14048
    ds_read_b64_tr_b16 v[104:105], v15 offset:9472
    v_mfma_f32_16x16x32_bf16 v[136:139], v[64:67], v[20:23], v[136:139]
    v_mfma_f32_16x16x32_bf16 v[172:175], v[64:67], v[24:27], v[172:175]
    ds_read_b64_tr_b16 v[106:107], v15 offset:14080
    v_mfma_f32_16x16x32_bf16 v[140:143], v[68:71], v[20:23], v[140:143]
    v_mfma_f32_16x16x32_bf16 v[176:179], v[68:71], v[24:27], v[176:179]
    s_waitcnt lgkmcnt(0)
    s_waitcnt vmcnt(18)
    s_barrier
    s_add_u32 s4, s4, 128
    s_addc_u32 s5, s5, 0
    s_add_u32 s6, s6, s18
    s_addc_u32 s7, s7, 0
    s_lshl_b32 s9, s8, 12
    s_add_u32 m0, s9, 0
    s_nop 0
    global_load_lds_dwordx4 v2, s[4:5]
    s_lshl_b32 s9, s8, 12
    s_add_u32 m0, s9, 1024
    s_nop 0
    global_load_lds_dwordx4 v3, s[4:5]
    s_lshl_b32 s9, s8, 12
    s_add_u32 m0, s9, 2048
    s_nop 0
    global_load_lds_dwordx4 v4, s[4:5]
    s_lshl_b32 s9, s8, 12
    s_add_u32 m0, s9, 3072
    s_nop 0
    global_load_lds_dwordx4 v5, s[4:5]
    s_mul_i32 s9, s8, 4608
    s_add_u32 m0, s9, 16384
    s_nop 0
    global_load_lds_dwordx4 v6, s[6:7]
    s_mul_i32 s9, s8, 4608
    s_add_u32 m0, s9, 17408
    s_nop 0
    global_load_lds_dwordx4 v7, s[6:7]
    s_mul_i32 s9, s8, 4608
    s_add_u32 m0, s9, 18432
    s_nop 0
    global_load_lds_dwordx4 v8, s[6:7]
    s_mul_i32 s9, s8, 4608
    s_add_u32 m0, s9, 19456
    s_nop 0
    global_load_lds_dwordx4 v9, s[6:7]
    s_mul_i32 s9, s8, 4608
    s_add_u32 m0, s9, 20480
    s_mov_b32 exec_hi, 0
    global_load_lds_dwordx4 v10, s[6:7]
    s_mov_b64 exec, -1
    v_mfma_f32_16x16x32_bf16 v[108:111], v[72:75], v[28:31], v[108:111]
    v_mfma_f32_16x16x32_bf16 v[144:147], v[72:75], v[32:35], v[144:147]
    ds_read_b64 v[20:21], v11 offset:34816
    ds_read_b64 v[22:23], v12 offset:34816
    ds_read_b64 v[24:25], v11 offset:36864
    v_mfma_f32_16x16x32_bf16 v[112:115], v[76:79], v[28:31], v[112:115]
    v_mfma_f32_16x16x32_bf16 v[148:151], v[76:79], v[32:35], v[148:151]
    ds_read_b64 v[26:27], v12 offset:36864
    ds_read_b64_tr_b16 v[36:37], v15 offset:34816
    ds_read_b64_tr_b16 v[38:39], v15 offset:39424
    v_mfma_f32_16x16x32_bf16 v[116:119], v[80:83], v[28:31], v[116:119]
    v_mfma_f32_16x16x32_bf16 v[152:155], v[80:83], v[32:35], v[152:155]
    ds_read_b64_tr_b16 v[40:41], v15 offset:34848
    ds_read_b64_tr_b16 v[42:43], v15 offset:39456
    ds_read_b64_tr_b16 v[44:45], v15 offset:34880
    v_mfma_f32_16x16x32_bf16 v[120:123], v[84:87], v[28:31], v[120:123]
    v_mfma_f32_16x16x32_bf16 v[156:159], v[84:87], v[32:35], v[156:159]
    ds_read_b64_tr_b16 v[46:47], v15 offset:39488
    ds_read_b64_tr_b16 v[48:49], v15 offset:34912
    ds_read_b64_tr_b16 v[50:51], v15 offset:39520
    v_mfma_f32_16x16x32_bf16 v[124:127], v[88:91], v[28:31], v[124:127]
    v_mfma_f32_16x16x32_bf16 v[160:163], v[88:91], v[32:35], v[160:163]
    ds_read_b64_tr_b16 v[52:53], v15 offset:34944
    ds_read_b64_tr_b16 v[54:55], v15 offset:39552
    ds_read_b64_tr_b16 v[56:57], v15 offset:34976
    v_mfma_f32_16x16x32_bf16 v[128:131], v[92:95], v[28:31], v[128:131]
    v_mfma_f32_16x16x32_bf16 v[164:167], v[92:95], v[32:35], v[164:167]
    ds_read_b64_tr_b16 v[58:59], v15 offset:39584
    ds_read_b64_tr_b16 v[60:61], v15 offset:35008
    ds_read_b64_tr_b16 v[62:63], v15 offset:39616
    v_mfma_f32_16x16x32_bf16 v[132:135], v[96:99], v[28:31], v[132:135]
    v_mfma_f32_16x16x32_bf16 v[168:171], v[96:99], v[32:35], v[168:171]
    ds_read_b64_tr_b16 v[64:65], v15 offset:35040
    ds_read_b64_tr_b16 v[66:67], v15 offset:39648
    ds_read_b64_tr_b16 v[68:69], v15 offset:35072
    v_mfma_f32_16x16x32_bf16 v[136:139], v[100:103], v[28:31], v[136:139]
    v_mfma_f32_16x16x32_bf16 v[172:175], v[100:103], v[32:35], v[172:175]
    ds_read_b64_tr_b16 v[70:71], v15 offset:39680
    v_mfma_f32_16x16x32_bf16 v[140:143], v[104:107], v[28:31], v[140:143]
    v_mfma_f32_16x16x32_bf16 v[176:179], v[104:107], v[32:35], v[176:179]
    s_waitcnt lgkmcnt(15)
    v_mfma_f32_16x16x32_bf16 v[108:111], v[36:39], v[20:23], v[108:111]
    v_mfma_f32_16x16x32_bf16 v[144:147], v[36:39], v[24:27], v[144:147]
    ds_read_b64 v[28:29], v13 offset:34816
    ds_read_b64 v[30:31], v14 offset:34816
    ds_read_b64 v[32:33], v13 offset:36864
    s_waitcnt lgkmcnt(15)
    v_mfma_f32_16x16x32_bf16 v[112:115], v[40:43], v[20:23], v[112:115]
    v_mfma_f32_16x16x32_bf16 v[148:151], v[40:43], v[24:27], v[148:151]
    ds_read_b64 v[34:35], v14 offset:36864
    ds_read_b64_tr_b16 v[72:73], v15 offset:44032
    ds_read_b64_tr_b16 v[74:75], v15 offset:48640
    v_mfma_f32_16x16x32_bf16 v[116:119], v[44:47], v[20:23], v[116:119]
    v_mfma_f32_16x16x32_bf16 v[152:155], v[44:47], v[24:27], v[152:155]
    ds_read_b64_tr_b16 v[76:77], v15 offset:44064
    ds_read_b64_tr_b16 v[78:79], v15 offset:48672
    ds_read_b64_tr_b16 v[80:81], v15 offset:44096
    s_waitcnt lgkmcnt(15)
    v_mfma_f32_16x16x32_bf16 v[120:123], v[48:51], v[20:23], v[120:123]
    v_mfma_f32_16x16x32_bf16 v[156:159], v[48:51], v[24:27], v[156:159]
    ds_read_b64_tr_b16 v[82:83], v15 offset:48704
    ds_read_b64_tr_b16 v[84:85], v15 offset:44128
    ds_read_b64_tr_b16 v[86:87], v15 offset:48736
    v_mfma_f32_16x16x32_bf16 v[124:127], v[52:55], v[20:23], v[124:127]
    v_mfma_f32_16x16x32_bf16 v[160:163], v[52:55], v[24:27], v[160:163]
    ds_read_b64_tr_b16 v[88:89], v15 offset:44160
    ds_read_b64_tr_b16 v[90:91], v15 offset:48768
    ds_read_b64_tr_b16 v[92:93], v15 offset:44192
    v_mfma_f32_16x16x32_bf16 v[128:131], v[56:59], v[20:23], v[128:131]
    v_mfma_f32_16x16x32_bf16 v[164:167], v[56:59], v[24:27], v[164:167]
    ds_read_b64_tr_b16 v[94:95], v15 offset:48800
    ds_read_b64_tr_b16 v[96:97], v15 offset:44224
    ds_read_b64_tr_b16 v[98:99], v15 offset:48832
    s_waitcnt lgkmcnt(15)
    v_mfma_f32_16x16x32_bf16 v[132:135], v[60:63], v[20:23], v[132:135]
    v_mfma_f32_16x16x32_bf16 v[168:171], v[60:63], v[24:27], v[168:171]
    ds_read_b64_tr_b16 v[100:101], v15 offset:44256
    ds_read_b64_tr_b16 v[102:103], v15 offset:48864
    ds_read_b64_tr_b16 v[104:105], v15 offset:44288
    v_mfma_f32_16x16x32_bf16 v[136:139], v[64:67], v[20:23], v[136:139]
    v_mfma_f32_16x16x32_bf16 v[172:175], v[64:67], v[24:27], v[172:175]
    ds_read_b64_tr_b16 v[106:107], v15 offset:48896
    v_mfma_f32_16x16x32_bf16 v[140:143], v[68:71], v[20:23], v[140:143]
    v_mfma_f32_16x16x32_bf16 v[176:179], v[68:71], v[24:27], v[176:179]
    s_waitcnt lgkmcnt(0)
    s_waitcnt vmcnt(18)
    s_barrier
    s_add_u32 s4, s4, 128
    s_addc_u32 s5, s5, 0
    s_add_u32 s6, s6, s18
    s_addc_u32 s7, s7, 0
    s_lshl_b32 s9, s8, 12
    s_add_u32 m0, s9, 34816
    s_nop 0
    global_load_lds_dwordx4 v2, s[4:5]
    s_lshl_b32 s9, s8, 12
    s_add_u32 m0, s9, 35840
    s_nop 0
    global_load_lds_dwordx4 v3, s[4:5]
    s_lshl_b32 s9, s8, 12
    s_add_u32 m0, s9, 36864
    s_nop 0
    global_load_lds_dwordx4 v4, s[4:5]
    s_lshl_b32 s9, s8, 12
    s_add_u32 m0, s9, 37888
    s_nop 0
    global_load_lds_dwordx4 v5, s[4:5]
    s_mul_i32 s9, s8, 4608
    s_add_u32 m0, s9, 51200
    s_nop 0
    global_load_lds_dwordx4 v6, s[6:7]
    s_mul_i32 s9, s8, 4608
    s_add_u32 m0, s9, 52224
    s_nop 0
    global_load_lds_dwordx4 v7, s[6:7]
    s_mul_i32 s9, s8, 4608
    s_add_u32 m0, s9, 53248
    s_nop 0
    global_load_lds_dwordx4 v8, s[6:7]
    s_mul_i32 s9, s8, 4608
    s_add_u32 m0, s9, 54272
    s_nop 0
    global_load_lds_dwordx4 v9, s[6:7]
    s_mul_i32 s9, s8, 4608
    s_add_u32 m0, s9, 55296
    s_mov_b32 exec_hi, 0
    global_load_lds_dwordx4 v10, s[6:7]
    s_mov_b64 exec, -1
    v_mfma_f32_16x16x32_bf16 v[108:111], v[72:75], v[28:31], v[108:111]
    v_mfma_f32_16x16x32_bf16 v[144:147], v[72:75], v[32:35], v[144:147]
    ds_read_b64 v[20:21], v200 offset:0
    ds_read_b64 v[22:23], v201 offset:0
    ds_read_b64 v[24:25], v200 offset:2048
    v_mfma_f32_16x16x32_bf16 v[112:115], v[76:79], v[28:31], v[112:115]
    v_mfma_f32_16x16x32_bf16 v[148:151], v[76:79], v[32:35], v[148:151]
    ds_read_b64 v[26:27], v201 offset:2048
    ds_read_b64_tr_b16 v[36:37], v204 offset:0
    ds_read_b64_tr_b16 v[38:39], v204 offset:4608
    v_mfma_f32_16x16x32_bf16 v[116:119], v[80:83], v[28:31], v[116:119]
    v_mfma_f32_16x16x32_bf16 v[152:155], v[80:83], v[32:35], v[152:155]
    ds_read_b64_tr_b16 v[40:41], v204 offset:32
    ds_read_b64_tr_b16 v[42:43], v204 offset:4640
    ds_read_b64_tr_b16 v[44:45], v204 offset:64
    v_mfma_f32_16x16x32_bf16 v[120:123], v[84:87], v[28:31], v[120:123]
    v_mfma_f32_16x16x32_bf16 v[156:159], v[84:87], v[32:35], v[156:159]
    ds_read_b64_tr_b16 v[46:47], v204 offset:4672
    ds_read_b64_tr_b16 v[48:49], v204 offset:96
    ds_read_b64_tr_b16 v[50:51], v204 offset:4704
    v_mfma_f32_16x16x32_bf16 v[124:127], v[88:91], v[28:31], v[124:127]
    v_mfma_f32_16x16x32_bf16 v[160:163], v[88:91], v[32:35], v[160:163]
    ds_read_b64_tr_b16 v[52:53], v204 offset:128
    ds_read_b64_tr_b16 v[54:55], v204 offset:4736
    ds_read_b64_tr_b16 v[56:57], v204 offset:160
    v_mfma_f32_16x16x32_bf16 v[128:131], v[92:95], v[28:31], v[128:131]
    v_mfma_f32_16x16x32_bf16 v[164:167], v[92:95], v[32:35], v[164:167]
    ds_read_b64_tr_b16 v[58:59], v204 offset:4768
    ds_read_b64_tr_b16 v[60:61], v204 offset:192
    ds_read_b64_tr_b16 v[62:63], v204 offset:4800
    v_mfma_f32_16x16x32_bf16 v[132:135], v[96:99], v[28:31], v[132:135]
    v_mfma_f32_16x16x32_bf16 v[168:171], v[96:99], v[32:35], v[168:171]
    ds_read_b64_tr_b16 v[64:65], v204 offset:224
    ds_read_b64_tr_b16 v[66:67], v204 offset:4832
    ds_read_b64_tr_b16 v[68:69], v204 offset:256
    v_mfma_f32_16x16x32_bf16 v[136:139], v[100:103], v[28:31], v[136:139]
    v_mfma_f32_16x16x32_bf16 v[172:175], v[100:103], v[32:35], v[172:175]
    ds_read_b64_tr_b16 v[70:71], v204 offset:4864
    v_mfma_f32_16x16x32_bf16 v[140:143], v[104:107], v[28:31], v[140:143]
    v_mfma_f32_16x16x32_bf16 v[176:179], v[104:107], v[32:35], v[176:179]
    s_waitcnt lgkmcnt(15)
    v_mfma_f32_16x16x32_bf16 v[108:111], v[36:39], v[20:23], v[108:111]
    v_mfma_f32_16x16x32_bf16 v[144:147], v[36:39], v[24:27], v[144:147]
    ds_read_b64 v[28:29], v202 offset:0
    ds_read_b64 v[30:31], v203 offset:0
    ds_read_b64 v[32:33], v202 offset:2048
    s_waitcnt lgkmcnt(15)
    v_mfma_f32_16x16x32_bf16 v[112:115], v[40:43], v[20:23], v[112:115]
    v_mfma_f32_16x16x32_bf16 v[148:151], v[40:43], v[24:27], v[148:151]
    ds_read_b64 v[34:35], v203 offset:2048
    ds_read_b64_tr_b16 v[72:73], v204 offset:9216
    ds_read_b64_tr_b16 v[74:75], v204 offset:13824
    v_mfma_f32_16x16x32_bf16 v[116:119], v[44:47], v[20:23], v[116:119]
    v_mfma_f32_16x16x32_bf16 v[152:155], v[44:47], v[24:27], v[152:155]
    ds_read_b64_tr_b16 v[76:77], v204 offset:9248
    ds_read_b64_tr_b16 v[78:79], v204 offset:13856
    ds_read_b64_tr_b16 v[80:81], v204 offset:9280
    s_waitcnt lgkmcnt(15)
    v_mfma_f32_16x16x32_bf16 v[120:123], v[48:51], v[20:23], v[120:123]
    v_mfma_f32_16x16x32_bf16 v[156:159], v[48:51], v[24:27], v[156:159]
    ds_read_b64_tr_b16 v[82:83], v204 offset:13888
    ds_read_b64_tr_b16 v[84:85], v204 offset:9312
    ds_read_b64_tr_b16 v[86:87], v204 offset:13920
    v_mfma_f32_16x16x32_bf16 v[124:127], v[52:55], v[20:23], v[124:127]
    v_mfma_f32_16x16x32_bf16 v[160:163], v[52:55], v[24:27], v[160:163]
    ds_read_b64_tr_b16 v[88:89], v204 offset:9344
    ds_read_b64_tr_b16 v[90:91], v204 offset:13952
    ds_read_b64_tr_b16 v[92:93], v204 offset:9376
    v_mfma_f32_16x16x32_bf16 v[128:131], v[56:59], v[20:23], v[128:131]
    v_mfma_f32_16x16x32_bf16 v[164:167], v[56:59], v[24:27], v[164:167]
    ds_read_b64_tr_b16 v[94:95], v204 offset:13984
    ds_read_b64_tr_b16 v[96:97], v204 offset:9408
    ds_read_b64_tr_b16 v[98:99], v204 offset:14016
    s_waitcnt lgkmcnt(15)
    v_mfma_f32_16x16x32_bf16 v[132:135], v[60:63], v[20:23], v[132:135]
    v_mfma_f32_16x16x32_bf16 v[168:171], v[60:63], v[24:27], v[168:171]
    ds_read_b64_tr_b16 v[100:101], v204 offset:9440
    ds_read_b64_tr_b16 v[102:103], v204 offset:14048
    ds_read_b64_tr_b16 v[104:105], v204 offset:9472
    v_mfma_f32_16x16x32_bf16 v[136:139], v[64:67], v[20:23], v[136:139]
    v_mfma_f32_16x16x32_bf16 v[172:175], v[64:67], v[24:27], v[172:175]
    ds_read_b64_tr_b16 v[106:107], v204 offset:14080
    v_mfma_f32_16x16x32_bf16 v[140:143], v[68:71], v[20:23], v[140:143]
    v_mfma_f32_16x16x32_bf16 v[176:179], v[68:71], v[24:27], v[176:179]
    s_waitcnt lgkmcnt(0)
    s_waitcnt vmcnt(18)
    s_barrier
    s_add_u32 s4, s4, 128
    s_addc_u32 s5, s5, 0
    s_add_u32 s6, s6, s18
    s_addc_u32 s7, s7, 0
    s_lshl_b32 s9, s8, 12
    s_add_u32 m0, s9, 69632
    s_nop 0
    global_load_lds_dwordx4 v2, s[4:5]
    s_lshl_b32 s9, s8, 12
    s_add_u32 m0, s9, 70656
    s_nop 0
    global_load_lds_dwordx4 v3, s[4:5]
    s_lshl_b32 s9, s8, 12
    s_add_u32 m0, s9, 71680
    s_nop 0
    global_load_lds_dwordx4 v4, s[4:5]
    s_lshl_b32 s9, s8, 12
    s_add_u32 m0, s9, 72704
    s_nop 0
    global_load_lds_dwordx4 v5, s[4:5]
    s_mul_i32 s9, s8, 4608
    s_add_u32 m0, s9, 86016
    s_nop 0
    global_load_lds_dwordx4 v6, s[6:7]
    s_mul_i32 s9, s8, 4608
    s_add_u32 m0, s9, 87040
    s_nop 0
    global_load_lds_dwordx4 v7, s[6:7]
    s_mul_i32 s9, s8, 4608
    s_add_u32 m0, s9, 88064
    s_nop 0
    global_load_lds_dwordx4 v8, s[6:7]
    s_mul_i32 s9, s8, 4608
    s_add_u32 m0, s9, 89088
    s_nop 0
    global_load_lds_dwordx4 v9, s[6:7]
    s_mul_i32 s9, s8, 4608
    s_add_u32 m0, s9, 90112
    s_mov_b32 exec_hi, 0
    global_load_lds_dwordx4 v10, s[6:7]
    s_mov_b64 exec, -1
    v_mfma_f32_16x16x32_bf16 v[108:111], v[72:75], v[28:31], v[108:111]
    v_mfma_f32_16x16x32_bf16 v[144:147], v[72:75], v[32:35], v[144:147]
    ds_read_b64 v[20:21], v200 offset:34816
    ds_read_b64 v[22:23], v201 offset:34816
    ds_read_b64 v[24:25], v200 offset:36864
    v_mfma_f32_16x16x32_bf16 v[112:115], v[76:79], v[28:31], v[112:115]
    v_mfma_f32_16x16x32_bf16 v[148:151], v[76:79], v[32:35], v[148:151]
    ds_read_b64 v[26:27], v201 offset:36864
    ds_read_b64_tr_b16 v[36:37], v204 offset:34816
    ds_read_b64_tr_b16 v[38:39], v204 offset:39424
    v_mfma_f32_16x16x32_bf16 v[116:119], v[80:83], v[28:31], v[116:119]
    v_mfma_f32_16x16x32_bf16 v[152:155], v[80:83], v[32:35], v[152:155]
    ds_read_b64_tr_b16 v[40:41], v204 offset:34848
    ds_read_b64_tr_b16 v[42:43], v204 offset:39456
    ds_read_b64_tr_b16 v[44:45], v204 offset:34880
    v_mfma_f32_16x16x32_bf16 v[120:123], v[84:87], v[28:31], v[120:123]
    v_mfma_f32_16x16x32_bf16 v[156:159], v[84:87], v[32:35], v[156:159]
    ds_read_b64_tr_b16 v[46:47], v204 offset:39488
    ds_read_b64_tr_b16 v[48:49], v204 offset:34912
    ds_read_b64_tr_b16 v[50:51], v204 offset:39520
    v_mfma_f32_16x16x32_bf16 v[124:127], v[88:91], v[28:31], v[124:127]
    v_mfma_f32_16x16x32_bf16 v[160:163], v[88:91], v[32:35], v[160:163]
    ds_read_b64_tr_b16 v[52:53], v204 offset:34944
    ds_read_b64_tr_b16 v[54:55], v204 offset:39552
    ds_read_b64_tr_b16 v[56:57], v204 offset:34976
    v_mfma_f32_16x16x32_bf16 v[128:131], v[92:95], v[28:31], v[128:131]
    v_mfma_f32_16x16x32_bf16 v[164:167], v[92:95], v[32:35], v[164:167]
    ds_read_b64_tr_b16 v[58:59], v204 offset:39584
    ds_read_b64_tr_b16 v[60:61], v204 offset:35008
    ds_read_b64_tr_b16 v[62:63], v204 offset:39616
    v_mfma_f32_16x16x32_bf16 v[132:135], v[96:99], v[28:31], v[132:135]
    v_mfma_f32_16x16x32_bf16 v[168:171], v[96:99], v[32:35], v[168:171]
    ds_read_b64_tr_b16 v[64:65], v204 offset:35040
    ds_read_b64_tr_b16 v[66:67], v204 offset:39648
    ds_read_b64_tr_b16 v[68:69], v204 offset:35072
    v_mfma_f32_16x16x32_bf16 v[136:139], v[100:103], v[28:31], v[136:139]
    v_mfma_f32_16x16x32_bf16 v[172:175], v[100:103], v[32:35], v[172:175]
    ds_read_b64_tr_b16 v[70:71], v204 offset:39680
    v_mfma_f32_16x16x32_bf16 v[140:143], v[104:107], v[28:31], v[140:143]
    v_mfma_f32_16x16x32_bf16 v[176:179], v[104:107], v[32:35], v[176:179]
    s_waitcnt lgkmcnt(15)
    v_mfma_f32_16x16x32_bf16 v[108:111], v[36:39], v[20:23], v[108:111]
    v_mfma_f32_16x16x32_bf16 v[144:147], v[36:39], v[24:27], v[144:147]
    ds_read_b64 v[28:29], v202 offset:34816
    ds_read_b64 v[30:31], v203 offset:34816
    ds_read_b64 v[32:33], v202 offset:36864
    s_waitcnt lgkmcnt(15)
    v_mfma_f32_16x16x32_bf16 v[112:115], v[40:43], v[20:23], v[112:115]
    v_mfma_f32_16x16x32_bf16 v[148:151], v[40:43], v[24:27], v[148:151]
    ds_read_b64 v[34:35], v203 offset:36864
    ds_read_b64_tr_b16 v[72:73], v204 offset:44032
    ds_read_b64_tr_b16 v[74:75], v204 offset:48640
    v_mfma_f32_16x16x32_bf16 v[116:119], v[44:47], v[20:23], v[116:119]
    v_mfma_f32_16x16x32_bf16 v[152:155], v[44:47], v[24:27], v[152:155]
    ds_read_b64_tr_b16 v[76:77], v204 offset:44064
    ds_read_b64_tr_b16 v[78:79], v204 offset:48672
    ds_read_b64_tr_b16 v[80:81], v204 offset:44096
    s_waitcnt lgkmcnt(15)
    v_mfma_f32_16x16x32_bf16 v[120:123], v[48:51], v[20:23], v[120:123]
    v_mfma_f32_16x16x32_bf16 v[156:159], v[48:51], v[24:27], v[156:159]
    ds_read_b64_tr_b16 v[82:83], v204 offset:48704
    ds_read_b64_tr_b16 v[84:85], v204 offset:44128
    ds_read_b64_tr_b16 v[86:87], v204 offset:48736
    v_mfma_f32_16x16x32_bf16 v[124:127], v[52:55], v[20:23], v[124:127]
    v_mfma_f32_16x16x32_bf16 v[160:163], v[52:55], v[24:27], v[160:163]
    ds_read_b64_tr_b16 v[88:89], v204 offset:44160
    ds_read_b64_tr_b16 v[90:91], v204 offset:48768
    ds_read_b64_tr_b16 v[92:93], v204 offset:44192
    v_mfma_f32_16x16x32_bf16 v[128:131], v[56:59], v[20:23], v[128:131]
    v_mfma_f32_16x16x32_bf16 v[164:167], v[56:59], v[24:27], v[164:167]
    ds_read_b64_tr_b16 v[94:95], v204 offset:48800
    ds_read_b64_tr_b16 v[96:97], v204 offset:44224
    ds_read_b64_tr_b16 v[98:99], v204 offset:48832
    s_waitcnt lgkmcnt(15)
    v_mfma_f32_16x16x32_bf16 v[132:135], v[60:63], v[20:23], v[132:135]
    v_mfma_f32_16x16x32_bf16 v[168:171], v[60:63], v[24:27], v[168:171]
    ds_read_b64_tr_b16 v[100:101], v204 offset:44256
    ds_read_b64_tr_b16 v[102:103], v204 offset:48864
    ds_read_b64_tr_b16 v[104:105], v204 offset:44288
    v_mfma_f32_16x16x32_bf16 v[136:139], v[64:67], v[20:23], v[136:139]
    v_mfma_f32_16x16x32_bf16 v[172:175], v[64:67], v[24:27], v[172:175]
    ds_read_b64_tr_b16 v[106:107], v204 offset:48896
    v_mfma_f32_16x16x32_bf16 v[140:143], v[68:71], v[20:23], v[140:143]
    v_mfma_f32_16x16x32_bf16 v[176:179], v[68:71], v[24:27], v[176:179]
    s_waitcnt lgkmcnt(0)
    s_waitcnt vmcnt(18)
    s_barrier
    s_add_u32 s4, s4, 128
    s_addc_u32 s5, s5, 0
    s_add_u32 s6, s6, s18
    s_addc_u32 s7, s7, 0
    s_lshl_b32 s9, s8, 12
    s_add_u32 m0, s9, 104448
    s_nop 0
    global_load_lds_dwordx4 v2, s[4:5]
    s_lshl_b32 s9, s8, 12
    s_add_u32 m0, s9, 105472
    s_nop 0
    global_load_lds_dwordx4 v3, s[4:5]
    s_lshl_b32 s9, s8, 12
    s_add_u32 m0, s9, 106496
    s_nop 0
    global_load_lds_dwordx4 v4, s[4:5]
    s_lshl_b32 s9, s8, 12
    s_add_u32 m0, s9, 107520
    s_nop 0
    global_load_lds_dwordx4 v5, s[4:5]
    s_mul_i32 s9, s8, 4608
    s_add_u32 m0, s9, 120832
    s_nop 0
    global_load_lds_dwordx4 v6, s[6:7]
    s_mul_i32 s9, s8, 4608
    s_add_u32 m0, s9, 121856
    s_nop 0
    global_load_lds_dwordx4 v7, s[6:7]
    s_mul_i32 s9, s8, 4608
    s_add_u32 m0, s9, 122880
    s_nop 0
    global_load_lds_dwordx4 v8, s[6:7]
    s_mul_i32 s9, s8, 4608
    s_add_u32 m0, s9, 123904
    s_nop 0
    global_load_lds_dwordx4 v9, s[6:7]
    s_mul_i32 s9, s8, 4608
    s_add_u32 m0, s9, 124928
    s_mov_b32 exec_hi, 0
    global_load_lds_dwordx4 v10, s[6:7]
    s_mov_b64 exec, -1
    v_mfma_f32_16x16x32_bf16 v[108:111], v[72:75], v[28:31], v[108:111]
    v_mfma_f32_16x16x32_bf16 v[144:147], v[72:75], v[32:35], v[144:147]
    ds_read_b64 v[20:21], v11 offset:0
    ds_read_b64 v[22:23], v12 offset:0
    ds_read_b64 v[24:25], v11 offset:2048
    v_mfma_f32_16x16x32_bf16 v[112:115], v[76:79], v[28:31], v[112:115]
    v_mfma_f32_16x16x32_bf16 v[148:151], v[76:79], v[32:35], v[148:151]
    ds_read_b64 v[26:27], v12 offset:2048
    ds_read_b64_tr_b16 v[36:37], v15 offset:0
    ds_read_b64_tr_b16 v[38:39], v15 offset:4608
    v_mfma_f32_16x16x32_bf16 v[116:119], v[80:83], v[28:31], v[116:119]
    v_mfma_f32_16x16x32_bf16 v[152:155], v[80:83], v[32:35], v[152:155]
    ds_read_b64_tr_b16 v[40:41], v15 offset:32
    ds_read_b64_tr_b16 v[42:43], v15 offset:4640
    ds_read_b64_tr_b16 v[44:45], v15 offset:64
    v_mfma_f32_16x16x32_bf16 v[120:123], v[84:87], v[28:31], v[120:123]
    v_mfma_f32_16x16x32_bf16 v[156:159], v[84:87], v[32:35], v[156:159]
    ds_read_b64_tr_b16 v[46:47], v15 offset:4672
    ds_read_b64_tr_b16 v[48:49], v15 offset:96
    ds_read_b64_tr_b16 v[50:51], v15 offset:4704
    v_mfma_f32_16x16x32_bf16 v[124:127], v[88:91], v[28:31], v[124:127]
    v_mfma_f32_16x16x32_bf16 v[160:163], v[88:91], v[32:35], v[160:163]
    ds_read_b64_tr_b16 v[52:53], v15 offset:128
    ds_read_b64_tr_b16 v[54:55], v15 offset:4736
    ds_read_b64_tr_b16 v[56:57], v15 offset:160
    v_mfma_f32_16x16x32_bf16 v[128:131], v[92:95], v[28:31], v[128:131]
    v_mfma_f32_16x16x32_bf16 v[164:167], v[92:95], v[32:35], v[164:167]
    ds_read_b64_tr_b16 v[58:59], v15 offset:4768
    ds_read_b64_tr_b16 v[60:61], v15 offset:192
    ds_read_b64_tr_b16 v[62:63], v15 offset:4800
    v_mfma_f32_16x16x32_bf16 v[132:135], v[96:99], v[28:31], v[132:135]
    v_mfma_f32_16x16x32_bf16 v[168:171], v[96:99], v[32:35], v[168:171]
    ds_read_b64_tr_b16 v[64:65], v15 offset:224
    ds_read_b64_tr_b16 v[66:67], v15 offset:4832
    ds_read_b64_tr_b16 v[68:69], v15 offset:256
    v_mfma_f32_16x16x32_bf16 v[136:139], v[100:103], v[28:31], v[136:139]
    v_mfma_f32_16x16x32_bf16 v[172:175], v[100:103], v[32:35], v[172:175]
    ds_read_b64_tr_b16 v[70:71], v15 offset:4864
    v_mfma_f32_16x16x32_bf16 v[140:143], v[104:107], v[28:31], v[140:143]
    v_mfma_f32_16x16x32_bf16 v[176:179], v[104:107], v[32:35], v[176:179]
    s_waitcnt lgkmcnt(15)
    v_mfma_f32_16x16x32_bf16 v[108:111], v[36:39], v[20:23], v[108:111]
    v_mfma_f32_16x16x32_bf16 v[144:147], v[36:39], v[24:27], v[144:147]
    ds_read_b64 v[28:29], v13 offset:0
    ds_read_b64 v[30:31], v14 offset:0
    ds_read_b64 v[32:33], v13 offset:2048
    s_waitcnt lgkmcnt(15)
    v_mfma_f32_16x16x32_bf16 v[112:115], v[40:43], v[20:23], v[112:115]
    v_mfma_f32_16x16x32_bf16 v[148:151], v[40:43], v[24:27], v[148:151]
    ds_read_b64 v[34:35], v14 offset:2048
    ds_read_b64_tr_b16 v[72:73], v15 offset:9216
    ds_read_b64_tr_b16 v[74:75], v15 offset:13824
    v_mfma_f32_16x16x32_bf16 v[116:119], v[44:47], v[20:23], v[116:119]
    v_mfma_f32_16x16x32_bf16 v[152:155], v[44:47], v[24:27], v[152:155]
    ds_read_b64_tr_b16 v[76:77], v15 offset:9248
    ds_read_b64_tr_b16 v[78:79], v15 offset:13856
    ds_read_b64_tr_b16 v[80:81], v15 offset:9280
    s_waitcnt lgkmcnt(15)
    v_mfma_f32_16x16x32_bf16 v[120:123], v[48:51], v[20:23], v[120:123]
    v_mfma_f32_16x16x32_bf16 v[156:159], v[48:51], v[24:27], v[156:159]
    ds_read_b64_tr_b16 v[82:83], v15 offset:13888
    ds_read_b64_tr_b16 v[84:85], v15 offset:9312
    ds_read_b64_tr_b16 v[86:87], v15 offset:13920
    v_mfma_f32_16x16x32_bf16 v[124:127], v[52:55], v[20:23], v[124:127]
    v_mfma_f32_16x16x32_bf16 v[160:163], v[52:55], v[24:27], v[160:163]
    ds_read_b64_tr_b16 v[88:89], v15 offset:9344
    ds_read_b64_tr_b16 v[90:91], v15 offset:13952
    ds_read_b64_tr_b16 v[92:93], v15 offset:9376
    v_mfma_f32_16x16x32_bf16 v[128:131], v[56:59], v[20:23], v[128:131]
    v_mfma_f32_16x16x32_bf16 v[164:167], v[56:59], v[24:27], v[164:167]
    ds_read_b64_tr_b16 v[94:95], v15 offset:13984
    ds_read_b64_tr_b16 v[96:97], v15 offset:9408
    ds_read_b64_tr_b16 v[98:99], v15 offset:14016
    s_waitcnt lgkmcnt(15)
    v_mfma_f32_16x16x32_bf16 v[132:135], v[60:63], v[20:23], v[132:135]
    v_mfma_f32_16x16x32_bf16 v[168:171], v[60:63], v[24:27], v[168:171]
    ds_read_b64_tr_b16 v[100:101], v15 offset:9440
    ds_read_b64_tr_b16 v[102:103], v15 offset:14048
    ds_read_b64_tr_b16 v[104:105], v15 offset:9472
    v_mfma_f32_16x16x32_bf16 v[136:139], v[64:67], v[20:23], v[136:139]
    v_mfma_f32_16x16x32_bf16 v[172:175], v[64:67], v[24:27], v[172:175]
    ds_read_b64_tr_b16 v[106:107], v15 offset:14080
    v_mfma_f32_16x16x32_bf16 v[140:143], v[68:71], v[20:23], v[140:143]
    v_mfma_f32_16x16x32_bf16 v[176:179], v[68:71], v[24:27], v[176:179]
    s_waitcnt lgkmcnt(0)
    s_waitcnt vmcnt(18)
    s_barrier
    s_add_u32 s4, s4, 128
    s_addc_u32 s5, s5, 0
    s_add_u32 s6, s6, s18
    s_addc_u32 s7, s7, 0
    s_lshl_b32 s9, s8, 12
    s_add_u32 m0, s9, 0
    s_nop 0
    global_load_lds_dwordx4 v2, s[4:5]
    s_lshl_b32 s9, s8, 12
    s_add_u32 m0, s9, 1024
    s_nop 0
    global_load_lds_dwordx4 v3, s[4:5]
    s_lshl_b32 s9, s8, 12
    s_add_u32 m0, s9, 2048
    s_nop 0
    global_load_lds_dwordx4 v4, s[4:5]
    s_lshl_b32 s9, s8, 12
    s_add_u32 m0, s9, 3072
    s_nop 0
    global_load_lds_dwordx4 v5, s[4:5]
    s_mul_i32 s9, s8, 4608
    s_add_u32 m0, s9, 16384
    s_nop 0
    global_load_lds_dwordx4 v6, s[6:7]
    s_mul_i32 s9, s8, 4608
    s_add_u32 m0, s9, 17408
    s_nop 0
    global_load_lds_dwordx4 v7, s[6:7]
    s_mul_i32 s9, s8, 4608
    s_add_u32 m0, s9, 18432
    s_nop 0
    global_load_lds_dwordx4 v8, s[6:7]
    s_mul_i32 s9, s8, 4608
    s_add_u32 m0, s9, 19456
    s_nop 0
    global_load_lds_dwordx4 v9, s[6:7]
    s_mul_i32 s9, s8, 4608
    s_add_u32 m0, s9, 20480
    s_mov_b32 exec_hi, 0
    global_load_lds_dwordx4 v10, s[6:7]
    s_mov_b64 exec, -1
    v_mfma_f32_16x16x32_bf16 v[108:111], v[72:75], v[28:31], v[108:111]
    v_mfma_f32_16x16x32_bf16 v[144:147], v[72:75], v[32:35], v[144:147]
    ds_read_b64 v[20:21], v11 offset:34816
    ds_read_b64 v[22:23], v12 offset:34816
    ds_read_b64 v[24:25], v11 offset:36864
    v_mfma_f32_16x16x32_bf16 v[112:115], v[76:79], v[28:31], v[112:115]
    v_mfma_f32_16x16x32_bf16 v[148:151], v[76:79], v[32:35], v[148:151]
    ds_read_b64 v[26:27], v12 offset:36864
    ds_read_b64_tr_b16 v[36:37], v15 offset:34816
    ds_read_b64_tr_b16 v[38:39], v15 offset:39424
    v_mfma_f32_16x16x32_bf16 v[116:119], v[80:83], v[28:31], v[116:119]
    v_mfma_f32_16x16x32_bf16 v[152:155], v[80:83], v[32:35], v[152:155]
    ds_read_b64_tr_b16 v[40:41], v15 offset:34848
    ds_read_b64_tr_b16 v[42:43], v15 offset:39456
    ds_read_b64_tr_b16 v[44:45], v15 offset:34880
    v_mfma_f32_16x16x32_bf16 v[120:123], v[84:87], v[28:31], v[120:123]
    v_mfma_f32_16x16x32_bf16 v[156:159], v[84:87], v[32:35], v[156:159]
    ds_read_b64_tr_b16 v[46:47], v15 offset:39488
    ds_read_b64_tr_b16 v[48:49], v15 offset:34912
    ds_read_b64_tr_b16 v[50:51], v15 offset:39520
    v_mfma_f32_16x16x32_bf16 v[124:127], v[88:91], v[28:31], v[124:127]
    v_mfma_f32_16x16x32_bf16 v[160:163], v[88:91], v[32:35], v[160:163]
    ds_read_b64_tr_b16 v[52:53], v15 offset:34944
    ds_read_b64_tr_b16 v[54:55], v15 offset:39552
    ds_read_b64_tr_b16 v[56:57], v15 offset:34976
    v_mfma_f32_16x16x32_bf16 v[128:131], v[92:95], v[28:31], v[128:131]
    v_mfma_f32_16x16x32_bf16 v[164:167], v[92:95], v[32:35], v[164:167]
    ds_read_b64_tr_b16 v[58:59], v15 offset:39584
    ds_read_b64_tr_b16 v[60:61], v15 offset:35008
    ds_read_b64_tr_b16 v[62:63], v15 offset:39616
    v_mfma_f32_16x16x32_bf16 v[132:135], v[96:99], v[28:31], v[132:135]
    v_mfma_f32_16x16x32_bf16 v[168:171], v[96:99], v[32:35], v[168:171]
    ds_read_b64_tr_b16 v[64:65], v15 offset:35040
    ds_read_b64_tr_b16 v[66:67], v15 offset:39648
    ds_read_b64_tr_b16 v[68:69], v15 offset:35072
    v_mfma_f32_16x16x32_bf16 v[136:139], v[100:103], v[28:31], v[136:139]
    v_mfma_f32_16x16x32_bf16 v[172:175], v[100:103], v[32:35], v[172:175]
    ds_read_b64_tr_b16 v[70:71], v15 offset:39680
    v_mfma_f32_16x16x32_bf16 v[140:143], v[104:107], v[28:31], v[140:143]
    v_mfma_f32_16x16x32_bf16 v[176:179], v[104:107], v[32:35], v[176:179]
    s_waitcnt lgkmcnt(15)
    v_mfma_f32_16x16x32_bf16 v[108:111], v[36:39], v[20:23], v[108:111]
    v_mfma_f32_16x16x32_bf16 v[144:147], v[36:39], v[24:27], v[144:147]
    ds_read_b64 v[28:29], v13 offset:34816
    ds_read_b64 v[30:31], v14 offset:34816
    ds_read_b64 v[32:33], v13 offset:36864
    s_waitcnt lgkmcnt(15)
    v_mfma_f32_16x16x32_bf16 v[112:115], v[40:43], v[20:23], v[112:115]
    v_mfma_f32_16x16x32_bf16 v[148:151], v[40:43], v[24:27], v[148:151]
    ds_read_b64 v[34:35], v14 offset:36864
    ds_read_b64_tr_b16 v[72:73], v15 offset:44032
    ds_read_b64_tr_b16 v[74:75], v15 offset:48640
    v_mfma_f32_16x16x32_bf16 v[116:119], v[44:47], v[20:23], v[116:119]
    v_mfma_f32_16x16x32_bf16 v[152:155], v[44:47], v[24:27], v[152:155]
    ds_read_b64_tr_b16 v[76:77], v15 offset:44064
    ds_read_b64_tr_b16 v[78:79], v15 offset:48672
    ds_read_b64_tr_b16 v[80:81], v15 offset:44096
    s_waitcnt lgkmcnt(15)
    v_mfma_f32_16x16x32_bf16 v[120:123], v[48:51], v[20:23], v[120:123]
    v_mfma_f32_16x16x32_bf16 v[156:159], v[48:51], v[24:27], v[156:159]
    ds_read_b64_tr_b16 v[82:83], v15 offset:48704
    ds_read_b64_tr_b16 v[84:85], v15 offset:44128
    ds_read_b64_tr_b16 v[86:87], v15 offset:48736
    v_mfma_f32_16x16x32_bf16 v[124:127], v[52:55], v[20:23], v[124:127]
    v_mfma_f32_16x16x32_bf16 v[160:163], v[52:55], v[24:27], v[160:163]
    ds_read_b64_tr_b16 v[88:89], v15 offset:44160
    ds_read_b64_tr_b16 v[90:91], v15 offset:48768
    ds_read_b64_tr_b16 v[92:93], v15 offset:44192
    v_mfma_f32_16x16x32_bf16 v[128:131], v[56:59], v[20:23], v[128:131]
    v_mfma_f32_16x16x32_bf16 v[164:167], v[56:59], v[24:27], v[164:167]
    ds_read_b64_tr_b16 v[94:95], v15 offset:48800
    ds_read_b64_tr_b16 v[96:97], v15 offset:44224
    ds_read_b64_tr_b16 v[98:99], v15 offset:48832
    s_waitcnt lgkmcnt(15)
    v_mfma_f32_16x16x32_bf16 v[132:135], v[60:63], v[20:23], v[132:135]
    v_mfma_f32_16x16x32_bf16 v[168:171], v[60:63], v[24:27], v[168:171]
    ds_read_b64_tr_b16 v[100:101], v15 offset:44256
    ds_read_b64_tr_b16 v[102:103], v15 offset:48864
    ds_read_b64_tr_b16 v[104:105], v15 offset:44288
    v_mfma_f32_16x16x32_bf16 v[136:139], v[64:67], v[20:23], v[136:139]
    v_mfma_f32_16x16x32_bf16 v[172:175], v[64:67], v[24:27], v[172:175]
    ds_read_b64_tr_b16 v[106:107], v15 offset:48896
    v_mfma_f32_16x16x32_bf16 v[140:143], v[68:71], v[20:23], v[140:143]
    v_mfma_f32_16x16x32_bf16 v[176:179], v[68:71], v[24:27], v[176:179]
    s_waitcnt lgkmcnt(0)
    s_waitcnt vmcnt(18)
    s_barrier
    s_add_u32 s4, s4, 128
    s_addc_u32 s5, s5, 0
    s_add_u32 s6, s6, s18
    s_addc_u32 s7, s7, 0
    s_lshl_b32 s9, s8, 12
    s_add_u32 m0, s9, 34816
    s_nop 0
    global_load_lds_dwordx4 v2, s[4:5]
    s_lshl_b32 s9, s8, 12
    s_add_u32 m0, s9, 35840
    s_nop 0
    global_load_lds_dwordx4 v3, s[4:5]
    s_lshl_b32 s9, s8, 12
    s_add_u32 m0, s9, 36864
    s_nop 0
    global_load_lds_dwordx4 v4, s[4:5]
    s_lshl_b32 s9, s8, 12
    s_add_u32 m0, s9, 37888
    s_nop 0
    global_load_lds_dwordx4 v5, s[4:5]
    s_mul_i32 s9, s8, 4608
    s_add_u32 m0, s9, 51200
    s_nop 0
    global_load_lds_dwordx4 v6, s[6:7]
    s_mul_i32 s9, s8, 4608
    s_add_u32 m0, s9, 52224
    s_nop 0
    global_load_lds_dwordx4 v7, s[6:7]
    s_mul_i32 s9, s8, 4608
    s_add_u32 m0, s9, 53248
    s_nop 0
    global_load_lds_dwordx4 v8, s[6:7]
    s_mul_i32 s9, s8, 4608
    s_add_u32 m0, s9, 54272
    s_nop 0
    global_load_lds_dwordx4 v9, s[6:7]
    s_mul_i32 s9, s8, 4608
    s_add_u32 m0, s9, 55296
    s_mov_b32 exec_hi, 0
    global_load_lds_dwordx4 v10, s[6:7]
    s_mov_b64 exec, -1
    v_mfma_f32_16x16x32_bf16 v[108:111], v[72:75], v[28:31], v[108:111]
    v_mfma_f32_16x16x32_bf16 v[144:147], v[72:75], v[32:35], v[144:147]
    ds_read_b64 v[20:21], v200 offset:0
    ds_read_b64 v[22:23], v201 offset:0
    ds_read_b64 v[24:25], v200 offset:2048
    v_mfma_f32_16x16x32_bf16 v[112:115], v[76:79], v[28:31], v[112:115]
    v_mfma_f32_16x16x32_bf16 v[148:151], v[76:79], v[32:35], v[148:151]
    ds_read_b64 v[26:27], v201 offset:2048
    ds_read_b64_tr_b16 v[36:37], v204 offset:0
    ds_read_b64_tr_b16 v[38:39], v204 offset:4608
    v_mfma_f32_16x16x32_bf16 v[116:119], v[80:83], v[28:31], v[116:119]
    v_mfma_f32_16x16x32_bf16 v[152:155], v[80:83], v[32:35], v[152:155]
    ds_read_b64_tr_b16 v[40:41], v204 offset:32
    ds_read_b64_tr_b16 v[42:43], v204 offset:4640
    ds_read_b64_tr_b16 v[44:45], v204 offset:64
    v_mfma_f32_16x16x32_bf16 v[120:123], v[84:87], v[28:31], v[120:123]
    v_mfma_f32_16x16x32_bf16 v[156:159], v[84:87], v[32:35], v[156:159]
    ds_read_b64_tr_b16 v[46:47], v204 offset:4672
    ds_read_b64_tr_b16 v[48:49], v204 offset:96
    ds_read_b64_tr_b16 v[50:51], v204 offset:4704
    v_mfma_f32_16x16x32_bf16 v[124:127], v[88:91], v[28:31], v[124:127]
    v_mfma_f32_16x16x32_bf16 v[160:163], v[88:91], v[32:35], v[160:163]
    ds_read_b64_tr_b16 v[52:53], v204 offset:128
    ds_read_b64_tr_b16 v[54:55], v204 offset:4736
    ds_read_b64_tr_b16 v[56:57], v204 offset:160
    v_mfma_f32_16x16x32_bf16 v[128:131], v[92:95], v[28:31], v[128:131]
    v_mfma_f32_16x16x32_bf16 v[164:167], v[92:95], v[32:35], v[164:167]
    ds_read_b64_tr_b16 v[58:59], v204 offset:4768
    ds_read_b64_tr_b16 v[60:61], v204 offset:192
    ds_read_b64_tr_b16 v[62:63], v204 offset:4800
    v_mfma_f32_16x16x32_bf16 v[132:135], v[96:99], v[28:31], v[132:135]
    v_mfma_f32_16x16x32_bf16 v[168:171], v[96:99], v[32:35], v[168:171]
    ds_read_b64_tr_b16 v[64:65], v204 offset:224
    ds_read_b64_tr_b16 v[66:67], v204 offset:4832
    ds_read_b64_tr_b16 v[68:69], v204 offset:256
    v_mfma_f32_16x16x32_bf16 v[136:139], v[100:103], v[28:31], v[136:139]
    v_mfma_f32_16x16x32_bf16 v[172:175], v[100:103], v[32:35], v[172:175]
    ds_read_b64_tr_b16 v[70:71], v204 offset:4864
    v_mfma_f32_16x16x32_bf16 v[140:143], v[104:107], v[28:31], v[140:143]
    v_mfma_f32_16x16x32_bf16 v[176:179], v[104:107], v[32:35], v[176:179]
    s_waitcnt lgkmcnt(15)
    v_mfma_f32_16x16x32_bf16 v[108:111], v[36:39], v[20:23], v[108:111]
    v_mfma_f32_16x16x32_bf16 v[144:147], v[36:39], v[24:27], v[144:147]
    ds_read_b64 v[28:29], v202 offset:0
    ds_read_b64 v[30:31], v203 offset:0
    ds_read_b64 v[32:33], v202 offset:2048
    s_waitcnt lgkmcnt(15)
    v_mfma_f32_16x16x32_bf16 v[112:115], v[40:43], v[20:23], v[112:115]
    v_mfma_f32_16x16x32_bf16 v[148:151], v[40:43], v[24:27], v[148:151]
    ds_read_b64 v[34:35], v203 offset:2048
    ds_read_b64_tr_b16 v[72:73], v204 offset:9216
    ds_read_b64_tr_b16 v[74:75], v204 offset:13824
    v_mfma_f32_16x16x32_bf16 v[116:119], v[44:47], v[20:23], v[116:119]
    v_mfma_f32_16x16x32_bf16 v[152:155], v[44:47], v[24:27], v[152:155]
    ds_read_b64_tr_b16 v[76:77], v204 offset:9248
    ds_read_b64_tr_b16 v[78:79], v204 offset:13856
    ds_read_b64_tr_b16 v[80:81], v204 offset:9280
    s_waitcnt lgkmcnt(15)
    v_mfma_f32_16x16x32_bf16 v[120:123], v[48:51], v[20:23], v[120:123]
    v_mfma_f32_16x16x32_bf16 v[156:159], v[48:51], v[24:27], v[156:159]
    ds_read_b64_tr_b16 v[82:83], v204 offset:13888
    ds_read_b64_tr_b16 v[84:85], v204 offset:9312
    ds_read_b64_tr_b16 v[86:87], v204 offset:13920
    v_mfma_f32_16x16x32_bf16 v[124:127], v[52:55], v[20:23], v[124:127]
    v_mfma_f32_16x16x32_bf16 v[160:163], v[52:55], v[24:27], v[160:163]
    ds_read_b64_tr_b16 v[88:89], v204 offset:9344
    ds_read_b64_tr_b16 v[90:91], v204 offset:13952
    ds_read_b64_tr_b16 v[92:93], v204 offset:9376
    v_mfma_f32_16x16x32_bf16 v[128:131], v[56:59], v[20:23], v[128:131]
    v_mfma_f32_16x16x32_bf16 v[164:167], v[56:59], v[24:27], v[164:167]
    ds_read_b64_tr_b16 v[94:95], v204 offset:13984
    ds_read_b64_tr_b16 v[96:97], v204 offset:9408
    ds_read_b64_tr_b16 v[98:99], v204 offset:14016
    s_waitcnt lgkmcnt(15)
    v_mfma_f32_16x16x32_bf16 v[132:135], v[60:63], v[20:23], v[132:135]
    v_mfma_f32_16x16x32_bf16 v[168:171], v[60:63], v[24:27], v[168:171]
    ds_read_b64_tr_b16 v[100:101], v204 offset:9440
    ds_read_b64_tr_b16 v[102:103], v204 offset:14048
    ds_read_b64_tr_b16 v[104:105], v204 offset:9472
    v_mfma_f32_16x16x32_bf16 v[136:139], v[64:67], v[20:23], v[136:139]
    v_mfma_f32_16x16x32_bf16 v[172:175], v[64:67], v[24:27], v[172:175]
    ds_read_b64_tr_b16 v[106:107], v204 offset:14080
    v_mfma_f32_16x16x32_bf16 v[140:143], v[68:71], v[20:23], v[140:143]
    v_mfma_f32_16x16x32_bf16 v[176:179], v[68:71], v[24:27], v[176:179]
    s_waitcnt lgkmcnt(0)
    s_waitcnt vmcnt(18)
    s_barrier
    s_add_u32 s4, s4, 128
    s_addc_u32 s5, s5, 0
    s_add_u32 s6, s6, s18
    s_addc_u32 s7, s7, 0
    s_lshl_b32 s9, s8, 12
    s_add_u32 m0, s9, 69632
    s_nop 0
    global_load_lds_dwordx4 v2, s[4:5]
    s_lshl_b32 s9, s8, 12
    s_add_u32 m0, s9, 70656
    s_nop 0
    global_load_lds_dwordx4 v3, s[4:5]
    s_lshl_b32 s9, s8, 12
    s_add_u32 m0, s9, 71680
    s_nop 0
    global_load_lds_dwordx4 v4, s[4:5]
    s_lshl_b32 s9, s8, 12
    s_add_u32 m0, s9, 72704
    s_nop 0
    global_load_lds_dwordx4 v5, s[4:5]
    s_mul_i32 s9, s8, 4608
    s_add_u32 m0, s9, 86016
    s_nop 0
    global_load_lds_dwordx4 v6, s[6:7]
    s_mul_i32 s9, s8, 4608
    s_add_u32 m0, s9, 87040
    s_nop 0
    global_load_lds_dwordx4 v7, s[6:7]
    s_mul_i32 s9, s8, 4608
    s_add_u32 m0, s9, 88064
    s_nop 0
    global_load_lds_dwordx4 v8, s[6:7]
    s_mul_i32 s9, s8, 4608
    s_add_u32 m0, s9, 89088
    s_nop 0
    global_load_lds_dwordx4 v9, s[6:7]
    s_mul_i32 s9, s8, 4608
    s_add_u32 m0, s9, 90112
    s_mov_b32 exec_hi, 0
    global_load_lds_dwordx4 v10, s[6:7]
    s_mov_b64 exec, -1
    v_mfma_f32_16x16x32_bf16 v[108:111], v[72:75], v[28:31], v[108:111]
    v_mfma_f32_16x16x32_bf16 v[144:147], v[72:75], v[32:35], v[144:147]
    ds_read_b64 v[20:21], v200 offset:34816
    ds_read_b64 v[22:23], v201 offset:34816
    ds_read_b64 v[24:25], v200 offset:36864
    v_mfma_f32_16x16x32_bf16 v[112:115], v[76:79], v[28:31], v[112:115]
    v_mfma_f32_16x16x32_bf16 v[148:151], v[76:79], v[32:35], v[148:151]
    ds_read_b64 v[26:27], v201 offset:36864
    ds_read_b64_tr_b16 v[36:37], v204 offset:34816
    ds_read_b64_tr_b16 v[38:39], v204 offset:39424
    v_mfma_f32_16x16x32_bf16 v[116:119], v[80:83], v[28:31], v[116:119]
    v_mfma_f32_16x16x32_bf16 v[152:155], v[80:83], v[32:35], v[152:155]
    ds_read_b64_tr_b16 v[40:41], v204 offset:34848
    ds_read_b64_tr_b16 v[42:43], v204 offset:39456
    ds_read_b64_tr_b16 v[44:45], v204 offset:34880
    v_mfma_f32_16x16x32_bf16 v[120:123], v[84:87], v[28:31], v[120:123]
    v_mfma_f32_16x16x32_bf16 v[156:159], v[84:87], v[32:35], v[156:159]
    ds_read_b64_tr_b16 v[46:47], v204 offset:39488
    ds_read_b64_tr_b16 v[48:49], v204 offset:34912
    ds_read_b64_tr_b16 v[50:51], v204 offset:39520
    v_mfma_f32_16x16x32_bf16 v[124:127], v[88:91], v[28:31], v[124:127]
    v_mfma_f32_16x16x32_bf16 v[160:163], v[88:91], v[32:35], v[160:163]
    ds_read_b64_tr_b16 v[52:53], v204 offset:34944
    ds_read_b64_tr_b16 v[54:55], v204 offset:39552
    ds_read_b64_tr_b16 v[56:57], v204 offset:34976
    v_mfma_f32_16x16x32_bf16 v[128:131], v[92:95], v[28:31], v[128:131]
    v_mfma_f32_16x16x32_bf16 v[164:167], v[92:95], v[32:35], v[164:167]
    ds_read_b64_tr_b16 v[58:59], v204 offset:39584
    ds_read_b64_tr_b16 v[60:61], v204 offset:35008
    ds_read_b64_tr_b16 v[62:63], v204 offset:39616
    v_mfma_f32_16x16x32_bf16 v[132:135], v[96:99], v[28:31], v[132:135]
    v_mfma_f32_16x16x32_bf16 v[168:171], v[96:99], v[32:35], v[168:171]
    ds_read_b64_tr_b16 v[64:65], v204 offset:35040
    ds_read_b64_tr_b16 v[66:67], v204 offset:39648
    ds_read_b64_tr_b16 v[68:69], v204 offset:35072
    v_mfma_f32_16x16x32_bf16 v[136:139], v[100:103], v[28:31], v[136:139]
    v_mfma_f32_16x16x32_bf16 v[172:175], v[100:103], v[32:35], v[172:175]
    ds_read_b64_tr_b16 v[70:71], v204 offset:39680
    v_mfma_f32_16x16x32_bf16 v[140:143], v[104:107], v[28:31], v[140:143]
    v_mfma_f32_16x16x32_bf16 v[176:179], v[104:107], v[32:35], v[176:179]
    s_waitcnt lgkmcnt(15)
    v_mfma_f32_16x16x32_bf16 v[108:111], v[36:39], v[20:23], v[108:111]
    v_mfma_f32_16x16x32_bf16 v[144:147], v[36:39], v[24:27], v[144:147]
    ds_read_b64 v[28:29], v202 offset:34816
    ds_read_b64 v[30:31], v203 offset:34816
    ds_read_b64 v[32:33], v202 offset:36864
    s_waitcnt lgkmcnt(15)
    v_mfma_f32_16x16x32_bf16 v[112:115], v[40:43], v[20:23], v[112:115]
    v_mfma_f32_16x16x32_bf16 v[148:151], v[40:43], v[24:27], v[148:151]
    ds_read_b64 v[34:35], v203 offset:36864
    ds_read_b64_tr_b16 v[72:73], v204 offset:44032
    ds_read_b64_tr_b16 v[74:75], v204 offset:48640
    v_mfma_f32_16x16x32_bf16 v[116:119], v[44:47], v[20:23], v[116:119]
    v_mfma_f32_16x16x32_bf16 v[152:155], v[44:47], v[24:27], v[152:155]
    ds_read_b64_tr_b16 v[76:77], v204 offset:44064
    ds_read_b64_tr_b16 v[78:79], v204 offset:48672
    ds_read_b64_tr_b16 v[80:81], v204 offset:44096
    s_waitcnt lgkmcnt(15)
    v_mfma_f32_16x16x32_bf16 v[120:123], v[48:51], v[20:23], v[120:123]
    v_mfma_f32_16x16x32_bf16 v[156:159], v[48:51], v[24:27], v[156:159]
    ds_read_b64_tr_b16 v[82:83], v204 offset:48704
    ds_read_b64_tr_b16 v[84:85], v204 offset:44128
    ds_read_b64_tr_b16 v[86:87], v204 offset:48736
    v_mfma_f32_16x16x32_bf16 v[124:127], v[52:55], v[20:23], v[124:127]
    v_mfma_f32_16x16x32_bf16 v[160:163], v[52:55], v[24:27], v[160:163]
    ds_read_b64_tr_b16 v[88:89], v204 offset:44160
    ds_read_b64_tr_b16 v[90:91], v204 offset:48768
    ds_read_b64_tr_b16 v[92:93], v204 offset:44192
    v_mfma_f32_16x16x32_bf16 v[128:131], v[56:59], v[20:23], v[128:131]
    v_mfma_f32_16x16x32_bf16 v[164:167], v[56:59], v[24:27], v[164:167]
    ds_read_b64_tr_b16 v[94:95], v204 offset:48800
    ds_read_b64_tr_b16 v[96:97], v204 offset:44224
    ds_read_b64_tr_b16 v[98:99], v204 offset:48832
    s_waitcnt lgkmcnt(15)
    v_mfma_f32_16x16x32_bf16 v[132:135], v[60:63], v[20:23], v[132:135]
    v_mfma_f32_16x16x32_bf16 v[168:171], v[60:63], v[24:27], v[168:171]
    ds_read_b64_tr_b16 v[100:101], v204 offset:44256
    ds_read_b64_tr_b16 v[102:103], v204 offset:48864
    ds_read_b64_tr_b16 v[104:105], v204 offset:44288
    v_mfma_f32_16x16x32_bf16 v[136:139], v[64:67], v[20:23], v[136:139]
    v_mfma_f32_16x16x32_bf16 v[172:175], v[64:67], v[24:27], v[172:175]
    ds_read_b64_tr_b16 v[106:107], v204 offset:48896
    v_mfma_f32_16x16x32_bf16 v[140:143], v[68:71], v[20:23], v[140:143]
    v_mfma_f32_16x16x32_bf16 v[176:179], v[68:71], v[24:27], v[176:179]
    s_waitcnt lgkmcnt(0)
    s_waitcnt vmcnt(18)
    s_barrier
    s_add_u32 s4, s4, 128
    s_addc_u32 s5, s5, 0
    s_add_u32 s6, s6, s18
    s_addc_u32 s7, s7, 0
    s_lshl_b32 s9, s8, 12
    s_add_u32 m0, s9, 104448
    s_nop 0
    global_load_lds_dwordx4 v2, s[4:5]
    s_lshl_b32 s9, s8, 12
    s_add_u32 m0, s9, 105472
    s_nop 0
    global_load_lds_dwordx4 v3, s[4:5]
    s_lshl_b32 s9, s8, 12
    s_add_u32 m0, s9, 106496
    s_nop 0
    global_load_lds_dwordx4 v4, s[4:5]
    s_lshl_b32 s9, s8, 12
    s_add_u32 m0, s9, 107520
    s_nop 0
    global_load_lds_dwordx4 v5, s[4:5]
    s_mul_i32 s9, s8, 4608
    s_add_u32 m0, s9, 120832
    s_nop 0
    global_load_lds_dwordx4 v6, s[6:7]
    s_mul_i32 s9, s8, 4608
    s_add_u32 m0, s9, 121856
    s_nop 0
    global_load_lds_dwordx4 v7, s[6:7]
    s_mul_i32 s9, s8, 4608
    s_add_u32 m0, s9, 122880
    s_nop 0
    global_load_lds_dwordx4 v8, s[6:7]
    s_mul_i32 s9, s8, 4608
    s_add_u32 m0, s9, 123904
    s_nop 0
    global_load_lds_dwordx4 v9, s[6:7]
    s_mul_i32 s9, s8, 4608
    s_add_u32 m0, s9, 124928
    s_mov_b32 exec_hi, 0
    global_load_lds_dwordx4 v10, s[6:7]
    s_mov_b64 exec, -1
    v_mfma_f32_16x16x32_bf16 v[108:111], v[72:75], v[28:31], v[108:111]
    v_mfma_f32_16x16x32_bf16 v[144:147], v[72:75], v[32:35], v[144:147]
    ds_read_b64 v[20:21], v11 offset:0
    ds_read_b64 v[22:23], v12 offset:0
    ds_read_b64 v[24:25], v11 offset:2048
    v_mfma_f32_16x16x32_bf16 v[112:115], v[76:79], v[28:31], v[112:115]
    v_mfma_f32_16x16x32_bf16 v[148:151], v[76:79], v[32:35], v[148:151]
    ds_read_b64 v[26:27], v12 offset:2048
    ds_read_b64_tr_b16 v[36:37], v15 offset:0
    ds_read_b64_tr_b16 v[38:39], v15 offset:4608
    v_mfma_f32_16x16x32_bf16 v[116:119], v[80:83], v[28:31], v[116:119]
    v_mfma_f32_16x16x32_bf16 v[152:155], v[80:83], v[32:35], v[152:155]
    ds_read_b64_tr_b16 v[40:41], v15 offset:32
    ds_read_b64_tr_b16 v[42:43], v15 offset:4640
    ds_read_b64_tr_b16 v[44:45], v15 offset:64
    v_mfma_f32_16x16x32_bf16 v[120:123], v[84:87], v[28:31], v[120:123]
    v_mfma_f32_16x16x32_bf16 v[156:159], v[84:87], v[32:35], v[156:159]
    ds_read_b64_tr_b16 v[46:47], v15 offset:4672
    ds_read_b64_tr_b16 v[48:49], v15 offset:96
    ds_read_b64_tr_b16 v[50:51], v15 offset:4704
    v_mfma_f32_16x16x32_bf16 v[124:127], v[88:91], v[28:31], v[124:127]
    v_mfma_f32_16x16x32_bf16 v[160:163], v[88:91], v[32:35], v[160:163]
    ds_read_b64_tr_b16 v[52:53], v15 offset:128
    ds_read_b64_tr_b16 v[54:55], v15 offset:4736
    ds_read_b64_tr_b16 v[56:57], v15 offset:160
    v_mfma_f32_16x16x32_bf16 v[128:131], v[92:95], v[28:31], v[128:131]
    v_mfma_f32_16x16x32_bf16 v[164:167], v[92:95], v[32:35], v[164:167]
    ds_read_b64_tr_b16 v[58:59], v15 offset:4768
    ds_read_b64_tr_b16 v[60:61], v15 offset:192
    ds_read_b64_tr_b16 v[62:63], v15 offset:4800
    v_mfma_f32_16x16x32_bf16 v[132:135], v[96:99], v[28:31], v[132:135]
    v_mfma_f32_16x16x32_bf16 v[168:171], v[96:99], v[32:35], v[168:171]
    ds_read_b64_tr_b16 v[64:65], v15 offset:224
    ds_read_b64_tr_b16 v[66:67], v15 offset:4832
    ds_read_b64_tr_b16 v[68:69], v15 offset:256
    v_mfma_f32_16x16x32_bf16 v[136:139], v[100:103], v[28:31], v[136:139]
    v_mfma_f32_16x16x32_bf16 v[172:175], v[100:103], v[32:35], v[172:175]
    ds_read_b64_tr_b16 v[70:71], v15 offset:4864
    v_mfma_f32_16x16x32_bf16 v[140:143], v[104:107], v[28:31], v[140:143]
    v_mfma_f32_16x16x32_bf16 v[176:179], v[104:107], v[32:35], v[176:179]
    s_waitcnt lgkmcnt(15)
    v_mfma_f32_16x16x32_bf16 v[108:111], v[36:39], v[20:23], v[108:111]
    v_mfma_f32_16x16x32_bf16 v[144:147], v[36:39], v[24:27], v[144:147]
    ds_read_b64 v[28:29], v13 offset:0
    ds_read_b64 v[30:31], v14 offset:0
    ds_read_b64 v[32:33], v13 offset:2048
    s_waitcnt lgkmcnt(15)
    v_mfma_f32_16x16x32_bf16 v[112:115], v[40:43], v[20:23], v[112:115]
    v_mfma_f32_16x16x32_bf16 v[148:151], v[40:43], v[24:27], v[148:151]
    ds_read_b64 v[34:35], v14 offset:2048
    ds_read_b64_tr_b16 v[72:73], v15 offset:9216
    ds_read_b64_tr_b16 v[74:75], v15 offset:13824
    v_mfma_f32_16x16x32_bf16 v[116:119], v[44:47], v[20:23], v[116:119]
    v_mfma_f32_16x16x32_bf16 v[152:155], v[44:47], v[24:27], v[152:155]
    ds_read_b64_tr_b16 v[76:77], v15 offset:9248
    ds_read_b64_tr_b16 v[78:79], v15 offset:13856
    ds_read_b64_tr_b16 v[80:81], v15 offset:9280
    s_waitcnt lgkmcnt(15)
    v_mfma_f32_16x16x32_bf16 v[120:123], v[48:51], v[20:23], v[120:123]
    v_mfma_f32_16x16x32_bf16 v[156:159], v[48:51], v[24:27], v[156:159]
    ds_read_b64_tr_b16 v[82:83], v15 offset:13888
    ds_read_b64_tr_b16 v[84:85], v15 offset:9312
    ds_read_b64_tr_b16 v[86:87], v15 offset:13920
    v_mfma_f32_16x16x32_bf16 v[124:127], v[52:55], v[20:23], v[124:127]
    v_mfma_f32_16x16x32_bf16 v[160:163], v[52:55], v[24:27], v[160:163]
    ds_read_b64_tr_b16 v[88:89], v15 offset:9344
    ds_read_b64_tr_b16 v[90:91], v15 offset:13952
    ds_read_b64_tr_b16 v[92:93], v15 offset:9376
    v_mfma_f32_16x16x32_bf16 v[128:131], v[56:59], v[20:23], v[128:131]
    v_mfma_f32_16x16x32_bf16 v[164:167], v[56:59], v[24:27], v[164:167]
    ds_read_b64_tr_b16 v[94:95], v15 offset:13984
    ds_read_b64_tr_b16 v[96:97], v15 offset:9408
    ds_read_b64_tr_b16 v[98:99], v15 offset:14016
    s_waitcnt lgkmcnt(15)
    v_mfma_f32_16x16x32_bf16 v[132:135], v[60:63], v[20:23], v[132:135]
    v_mfma_f32_16x16x32_bf16 v[168:171], v[60:63], v[24:27], v[168:171]
    ds_read_b64_tr_b16 v[100:101], v15 offset:9440
    ds_read_b64_tr_b16 v[102:103], v15 offset:14048
    ds_read_b64_tr_b16 v[104:105], v15 offset:9472
    v_mfma_f32_16x16x32_bf16 v[136:139], v[64:67], v[20:23], v[136:139]
    v_mfma_f32_16x16x32_bf16 v[172:175], v[64:67], v[24:27], v[172:175]
    ds_read_b64_tr_b16 v[106:107], v15 offset:14080
    v_mfma_f32_16x16x32_bf16 v[140:143], v[68:71], v[20:23], v[140:143]
    v_mfma_f32_16x16x32_bf16 v[176:179], v[68:71], v[24:27], v[176:179]
    s_waitcnt lgkmcnt(0)
    s_waitcnt vmcnt(18)
    s_barrier
    s_add_u32 s4, s4, 128
    s_addc_u32 s5, s5, 0
    s_add_u32 s6, s6, s18
    s_addc_u32 s7, s7, 0
    s_lshl_b32 s9, s8, 12
    s_add_u32 m0, s9, 0
    s_nop 0
    global_load_lds_dwordx4 v2, s[4:5]
    s_lshl_b32 s9, s8, 12
    s_add_u32 m0, s9, 1024
    s_nop 0
    global_load_lds_dwordx4 v3, s[4:5]
    s_lshl_b32 s9, s8, 12
    s_add_u32 m0, s9, 2048
    s_nop 0
    global_load_lds_dwordx4 v4, s[4:5]
    s_lshl_b32 s9, s8, 12
    s_add_u32 m0, s9, 3072
    s_nop 0
    global_load_lds_dwordx4 v5, s[4:5]
    s_mul_i32 s9, s8, 4608
    s_add_u32 m0, s9, 16384
    s_nop 0
    global_load_lds_dwordx4 v6, s[6:7]
    s_mul_i32 s9, s8, 4608
    s_add_u32 m0, s9, 17408
    s_nop 0
    global_load_lds_dwordx4 v7, s[6:7]
    s_mul_i32 s9, s8, 4608
    s_add_u32 m0, s9, 18432
    s_nop 0
    global_load_lds_dwordx4 v8, s[6:7]
    s_mul_i32 s9, s8, 4608
    s_add_u32 m0, s9, 19456
    s_nop 0
    global_load_lds_dwordx4 v9, s[6:7]
    s_mul_i32 s9, s8, 4608
    s_add_u32 m0, s9, 20480
    s_mov_b32 exec_hi, 0
    global_load_lds_dwordx4 v10, s[6:7]
    s_mov_b64 exec, -1
    v_mfma_f32_16x16x32_bf16 v[108:111], v[72:75], v[28:31], v[108:111]
    v_mfma_f32_16x16x32_bf16 v[144:147], v[72:75], v[32:35], v[144:147]
    ds_read_b64 v[20:21], v11 offset:34816
    ds_read_b64 v[22:23], v12 offset:34816
    ds_read_b64 v[24:25], v11 offset:36864
    v_mfma_f32_16x16x32_bf16 v[112:115], v[76:79], v[28:31], v[112:115]
    v_mfma_f32_16x16x32_bf16 v[148:151], v[76:79], v[32:35], v[148:151]
    ds_read_b64 v[26:27], v12 offset:36864
    ds_read_b64_tr_b16 v[36:37], v15 offset:34816
    ds_read_b64_tr_b16 v[38:39], v15 offset:39424
    v_mfma_f32_16x16x32_bf16 v[116:119], v[80:83], v[28:31], v[116:119]
    v_mfma_f32_16x16x32_bf16 v[152:155], v[80:83], v[32:35], v[152:155]
    ds_read_b64_tr_b16 v[40:41], v15 offset:34848
    ds_read_b64_tr_b16 v[42:43], v15 offset:39456
    ds_read_b64_tr_b16 v[44:45], v15 offset:34880
    v_mfma_f32_16x16x32_bf16 v[120:123], v[84:87], v[28:31], v[120:123]
    v_mfma_f32_16x16x32_bf16 v[156:159], v[84:87], v[32:35], v[156:159]
    ds_read_b64_tr_b16 v[46:47], v15 offset:39488
    ds_read_b64_tr_b16 v[48:49], v15 offset:34912
    ds_read_b64_tr_b16 v[50:51], v15 offset:39520
    v_mfma_f32_16x16x32_bf16 v[124:127], v[88:91], v[28:31], v[124:127]
    v_mfma_f32_16x16x32_bf16 v[160:163], v[88:91], v[32:35], v[160:163]
    ds_read_b64_tr_b16 v[52:53], v15 offset:34944
    ds_read_b64_tr_b16 v[54:55], v15 offset:39552
    ds_read_b64_tr_b16 v[56:57], v15 offset:34976
    v_mfma_f32_16x16x32_bf16 v[128:131], v[92:95], v[28:31], v[128:131]
    v_mfma_f32_16x16x32_bf16 v[164:167], v[92:95], v[32:35], v[164:167]
    ds_read_b64_tr_b16 v[58:59], v15 offset:39584
    ds_read_b64_tr_b16 v[60:61], v15 offset:35008
    ds_read_b64_tr_b16 v[62:63], v15 offset:39616
    v_mfma_f32_16x16x32_bf16 v[132:135], v[96:99], v[28:31], v[132:135]
    v_mfma_f32_16x16x32_bf16 v[168:171], v[96:99], v[32:35], v[168:171]
    ds_read_b64_tr_b16 v[64:65], v15 offset:35040
    ds_read_b64_tr_b16 v[66:67], v15 offset:39648
    ds_read_b64_tr_b16 v[68:69], v15 offset:35072
    v_mfma_f32_16x16x32_bf16 v[136:139], v[100:103], v[28:31], v[136:139]
    v_mfma_f32_16x16x32_bf16 v[172:175], v[100:103], v[32:35], v[172:175]
    ds_read_b64_tr_b16 v[70:71], v15 offset:39680
    v_mfma_f32_16x16x32_bf16 v[140:143], v[104:107], v[28:31], v[140:143]
    v_mfma_f32_16x16x32_bf16 v[176:179], v[104:107], v[32:35], v[176:179]
    s_waitcnt lgkmcnt(15)
    v_mfma_f32_16x16x32_bf16 v[108:111], v[36:39], v[20:23], v[108:111]
    v_mfma_f32_16x16x32_bf16 v[144:147], v[36:39], v[24:27], v[144:147]
    ds_read_b64 v[28:29], v13 offset:34816
    ds_read_b64 v[30:31], v14 offset:34816
    ds_read_b64 v[32:33], v13 offset:36864
    s_waitcnt lgkmcnt(15)
    v_mfma_f32_16x16x32_bf16 v[112:115], v[40:43], v[20:23], v[112:115]
    v_mfma_f32_16x16x32_bf16 v[148:151], v[40:43], v[24:27], v[148:151]
    ds_read_b64 v[34:35], v14 offset:36864
    ds_read_b64_tr_b16 v[72:73], v15 offset:44032
    ds_read_b64_tr_b16 v[74:75], v15 offset:48640
    v_mfma_f32_16x16x32_bf16 v[116:119], v[44:47], v[20:23], v[116:119]
    v_mfma_f32_16x16x32_bf16 v[152:155], v[44:47], v[24:27], v[152:155]
    ds_read_b64_tr_b16 v[76:77], v15 offset:44064
    ds_read_b64_tr_b16 v[78:79], v15 offset:48672
    ds_read_b64_tr_b16 v[80:81], v15 offset:44096
    s_waitcnt lgkmcnt(15)
    v_mfma_f32_16x16x32_bf16 v[120:123], v[48:51], v[20:23], v[120:123]
    v_mfma_f32_16x16x32_bf16 v[156:159], v[48:51], v[24:27], v[156:159]
    ds_read_b64_tr_b16 v[82:83], v15 offset:48704
    ds_read_b64_tr_b16 v[84:85], v15 offset:44128
    ds_read_b64_tr_b16 v[86:87], v15 offset:48736
    v_mfma_f32_16x16x32_bf16 v[124:127], v[52:55], v[20:23], v[124:127]
    v_mfma_f32_16x16x32_bf16 v[160:163], v[52:55], v[24:27], v[160:163]
    ds_read_b64_tr_b16 v[88:89], v15 offset:44160
    ds_read_b64_tr_b16 v[90:91], v15 offset:48768
    ds_read_b64_tr_b16 v[92:93], v15 offset:44192
    v_mfma_f32_16x16x32_bf16 v[128:131], v[56:59], v[20:23], v[128:131]
    v_mfma_f32_16x16x32_bf16 v[164:167], v[56:59], v[24:27], v[164:167]
    ds_read_b64_tr_b16 v[94:95], v15 offset:48800
    ds_read_b64_tr_b16 v[96:97], v15 offset:44224
    ds_read_b64_tr_b16 v[98:99], v15 offset:48832
    s_waitcnt lgkmcnt(15)
    v_mfma_f32_16x16x32_bf16 v[132:135], v[60:63], v[20:23], v[132:135]
    v_mfma_f32_16x16x32_bf16 v[168:171], v[60:63], v[24:27], v[168:171]
    ds_read_b64_tr_b16 v[100:101], v15 offset:44256
    ds_read_b64_tr_b16 v[102:103], v15 offset:48864
    ds_read_b64_tr_b16 v[104:105], v15 offset:44288
    v_mfma_f32_16x16x32_bf16 v[136:139], v[64:67], v[20:23], v[136:139]
    v_mfma_f32_16x16x32_bf16 v[172:175], v[64:67], v[24:27], v[172:175]
    ds_read_b64_tr_b16 v[106:107], v15 offset:48896
    v_mfma_f32_16x16x32_bf16 v[140:143], v[68:71], v[20:23], v[140:143]
    v_mfma_f32_16x16x32_bf16 v[176:179], v[68:71], v[24:27], v[176:179]
    s_waitcnt lgkmcnt(0)
    s_waitcnt vmcnt(18)
    s_barrier
    s_add_u32 s4, s4, 128
    s_addc_u32 s5, s5, 0
    s_add_u32 s6, s6, s18
    s_addc_u32 s7, s7, 0
    s_lshl_b32 s9, s8, 12
    s_add_u32 m0, s9, 34816
    s_nop 0
    global_load_lds_dwordx4 v2, s[4:5]
    s_lshl_b32 s9, s8, 12
    s_add_u32 m0, s9, 35840
    s_nop 0
    global_load_lds_dwordx4 v3, s[4:5]
    s_lshl_b32 s9, s8, 12
    s_add_u32 m0, s9, 36864
    s_nop 0
    global_load_lds_dwordx4 v4, s[4:5]
    s_lshl_b32 s9, s8, 12
    s_add_u32 m0, s9, 37888
    s_nop 0
    global_load_lds_dwordx4 v5, s[4:5]
    s_mul_i32 s9, s8, 4608
    s_add_u32 m0, s9, 51200
    s_nop 0
    global_load_lds_dwordx4 v6, s[6:7]
    s_mul_i32 s9, s8, 4608
    s_add_u32 m0, s9, 52224
    s_nop 0
    global_load_lds_dwordx4 v7, s[6:7]
    s_mul_i32 s9, s8, 4608
    s_add_u32 m0, s9, 53248
    s_nop 0
    global_load_lds_dwordx4 v8, s[6:7]
    s_mul_i32 s9, s8, 4608
    s_add_u32 m0, s9, 54272
    s_nop 0
    global_load_lds_dwordx4 v9, s[6:7]
    s_mul_i32 s9, s8, 4608
    s_add_u32 m0, s9, 55296
    s_mov_b32 exec_hi, 0
    global_load_lds_dwordx4 v10, s[6:7]
    s_mov_b64 exec, -1
    v_mfma_f32_16x16x32_bf16 v[108:111], v[72:75], v[28:31], v[108:111]
    v_mfma_f32_16x16x32_bf16 v[144:147], v[72:75], v[32:35], v[144:147]
    ds_read_b64 v[20:21], v200 offset:0
    ds_read_b64 v[22:23], v201 offset:0
    ds_read_b64 v[24:25], v200 offset:2048
    v_mfma_f32_16x16x32_bf16 v[112:115], v[76:79], v[28:31], v[112:115]
    v_mfma_f32_16x16x32_bf16 v[148:151], v[76:79], v[32:35], v[148:151]
    ds_read_b64 v[26:27], v201 offset:2048
    ds_read_b64_tr_b16 v[36:37], v204 offset:0
    ds_read_b64_tr_b16 v[38:39], v204 offset:4608
    v_mfma_f32_16x16x32_bf16 v[116:119], v[80:83], v[28:31], v[116:119]
    v_mfma_f32_16x16x32_bf16 v[152:155], v[80:83], v[32:35], v[152:155]
    ds_read_b64_tr_b16 v[40:41], v204 offset:32
    ds_read_b64_tr_b16 v[42:43], v204 offset:4640
    ds_read_b64_tr_b16 v[44:45], v204 offset:64
    v_mfma_f32_16x16x32_bf16 v[120:123], v[84:87], v[28:31], v[120:123]
    v_mfma_f32_16x16x32_bf16 v[156:159], v[84:87], v[32:35], v[156:159]
    ds_read_b64_tr_b16 v[46:47], v204 offset:4672
    ds_read_b64_tr_b16 v[48:49], v204 offset:96
    ds_read_b64_tr_b16 v[50:51], v204 offset:4704
    v_mfma_f32_16x16x32_bf16 v[124:127], v[88:91], v[28:31], v[124:127]
    v_mfma_f32_16x16x32_bf16 v[160:163], v[88:91], v[32:35], v[160:163]
    ds_read_b64_tr_b16 v[52:53], v204 offset:128
    ds_read_b64_tr_b16 v[54:55], v204 offset:4736
    ds_read_b64_tr_b16 v[56:57], v204 offset:160
    v_mfma_f32_16x16x32_bf16 v[128:131], v[92:95], v[28:31], v[128:131]
    v_mfma_f32_16x16x32_bf16 v[164:167], v[92:95], v[32:35], v[164:167]
    ds_read_b64_tr_b16 v[58:59], v204 offset:4768
    ds_read_b64_tr_b16 v[60:61], v204 offset:192
    ds_read_b64_tr_b16 v[62:63], v204 offset:4800
    v_mfma_f32_16x16x32_bf16 v[132:135], v[96:99], v[28:31], v[132:135]
    v_mfma_f32_16x16x32_bf16 v[168:171], v[96:99], v[32:35], v[168:171]
    ds_read_b64_tr_b16 v[64:65], v204 offset:224
    ds_read_b64_tr_b16 v[66:67], v204 offset:4832
    ds_read_b64_tr_b16 v[68:69], v204 offset:256
    v_mfma_f32_16x16x32_bf16 v[136:139], v[100:103], v[28:31], v[136:139]
    v_mfma_f32_16x16x32_bf16 v[172:175], v[100:103], v[32:35], v[172:175]
    ds_read_b64_tr_b16 v[70:71], v204 offset:4864
    v_mfma_f32_16x16x32_bf16 v[140:143], v[104:107], v[28:31], v[140:143]
    v_mfma_f32_16x16x32_bf16 v[176:179], v[104:107], v[32:35], v[176:179]
    s_waitcnt lgkmcnt(15)
    v_mfma_f32_16x16x32_bf16 v[108:111], v[36:39], v[20:23], v[108:111]
    v_mfma_f32_16x16x32_bf16 v[144:147], v[36:39], v[24:27], v[144:147]
    ds_read_b64 v[28:29], v202 offset:0
    ds_read_b64 v[30:31], v203 offset:0
    ds_read_b64 v[32:33], v202 offset:2048
    s_waitcnt lgkmcnt(15)
    v_mfma_f32_16x16x32_bf16 v[112:115], v[40:43], v[20:23], v[112:115]
    v_mfma_f32_16x16x32_bf16 v[148:151], v[40:43], v[24:27], v[148:151]
    ds_read_b64 v[34:35], v203 offset:2048
    ds_read_b64_tr_b16 v[72:73], v204 offset:9216
    ds_read_b64_tr_b16 v[74:75], v204 offset:13824
    v_mfma_f32_16x16x32_bf16 v[116:119], v[44:47], v[20:23], v[116:119]
    v_mfma_f32_16x16x32_bf16 v[152:155], v[44:47], v[24:27], v[152:155]
    ds_read_b64_tr_b16 v[76:77], v204 offset:9248
    ds_read_b64_tr_b16 v[78:79], v204 offset:13856
    ds_read_b64_tr_b16 v[80:81], v204 offset:9280
    s_waitcnt lgkmcnt(15)
    v_mfma_f32_16x16x32_bf16 v[120:123], v[48:51], v[20:23], v[120:123]
    v_mfma_f32_16x16x32_bf16 v[156:159], v[48:51], v[24:27], v[156:159]
    ds_read_b64_tr_b16 v[82:83], v204 offset:13888
    ds_read_b64_tr_b16 v[84:85], v204 offset:9312
    ds_read_b64_tr_b16 v[86:87], v204 offset:13920
    v_mfma_f32_16x16x32_bf16 v[124:127], v[52:55], v[20:23], v[124:127]
    v_mfma_f32_16x16x32_bf16 v[160:163], v[52:55], v[24:27], v[160:163]
    ds_read_b64_tr_b16 v[88:89], v204 offset:9344
    ds_read_b64_tr_b16 v[90:91], v204 offset:13952
    ds_read_b64_tr_b16 v[92:93], v204 offset:9376
    v_mfma_f32_16x16x32_bf16 v[128:131], v[56:59], v[20:23], v[128:131]
    v_mfma_f32_16x16x32_bf16 v[164:167], v[56:59], v[24:27], v[164:167]
    ds_read_b64_tr_b16 v[94:95], v204 offset:13984
    ds_read_b64_tr_b16 v[96:97], v204 offset:9408
    ds_read_b64_tr_b16 v[98:99], v204 offset:14016
    s_waitcnt lgkmcnt(15)
    v_mfma_f32_16x16x32_bf16 v[132:135], v[60:63], v[20:23], v[132:135]
    v_mfma_f32_16x16x32_bf16 v[168:171], v[60:63], v[24:27], v[168:171]
    ds_read_b64_tr_b16 v[100:101], v204 offset:9440
    ds_read_b64_tr_b16 v[102:103], v204 offset:14048
    ds_read_b64_tr_b16 v[104:105], v204 offset:9472
    v_mfma_f32_16x16x32_bf16 v[136:139], v[64:67], v[20:23], v[136:139]
    v_mfma_f32_16x16x32_bf16 v[172:175], v[64:67], v[24:27], v[172:175]
    ds_read_b64_tr_b16 v[106:107], v204 offset:14080
    v_mfma_f32_16x16x32_bf16 v[140:143], v[68:71], v[20:23], v[140:143]
    v_mfma_f32_16x16x32_bf16 v[176:179], v[68:71], v[24:27], v[176:179]
    s_waitcnt lgkmcnt(0)
    s_waitcnt vmcnt(18)
    s_barrier
    s_add_u32 s4, s4, 128
    s_addc_u32 s5, s5, 0
    s_add_u32 s6, s6, s18
    s_addc_u32 s7, s7, 0
    s_lshl_b32 s9, s8, 12
    s_add_u32 m0, s9, 69632
    s_nop 0
    global_load_lds_dwordx4 v2, s[4:5]
    s_lshl_b32 s9, s8, 12
    s_add_u32 m0, s9, 70656
    s_nop 0
    global_load_lds_dwordx4 v3, s[4:5]
    s_lshl_b32 s9, s8, 12
    s_add_u32 m0, s9, 71680
    s_nop 0
    global_load_lds_dwordx4 v4, s[4:5]
    s_lshl_b32 s9, s8, 12
    s_add_u32 m0, s9, 72704
    s_nop 0
    global_load_lds_dwordx4 v5, s[4:5]
    s_mul_i32 s9, s8, 4608
    s_add_u32 m0, s9, 86016
    s_nop 0
    global_load_lds_dwordx4 v6, s[6:7]
    s_mul_i32 s9, s8, 4608
    s_add_u32 m0, s9, 87040
    s_nop 0
    global_load_lds_dwordx4 v7, s[6:7]
    s_mul_i32 s9, s8, 4608
    s_add_u32 m0, s9, 88064
    s_nop 0
    global_load_lds_dwordx4 v8, s[6:7]
    s_mul_i32 s9, s8, 4608
    s_add_u32 m0, s9, 89088
    s_nop 0
    global_load_lds_dwordx4 v9, s[6:7]
    s_mul_i32 s9, s8, 4608
    s_add_u32 m0, s9, 90112
    s_mov_b32 exec_hi, 0
    global_load_lds_dwordx4 v10, s[6:7]
    s_mov_b64 exec, -1
    v_mfma_f32_16x16x32_bf16 v[108:111], v[72:75], v[28:31], v[108:111]
    v_mfma_f32_16x16x32_bf16 v[144:147], v[72:75], v[32:35], v[144:147]
    ds_read_b64 v[20:21], v200 offset:34816
    ds_read_b64 v[22:23], v201 offset:34816
    ds_read_b64 v[24:25], v200 offset:36864
    v_mfma_f32_16x16x32_bf16 v[112:115], v[76:79], v[28:31], v[112:115]
    v_mfma_f32_16x16x32_bf16 v[148:151], v[76:79], v[32:35], v[148:151]
    ds_read_b64 v[26:27], v201 offset:36864
    ds_read_b64_tr_b16 v[36:37], v204 offset:34816
    ds_read_b64_tr_b16 v[38:39], v204 offset:39424
    v_mfma_f32_16x16x32_bf16 v[116:119], v[80:83], v[28:31], v[116:119]
    v_mfma_f32_16x16x32_bf16 v[152:155], v[80:83], v[32:35], v[152:155]
    ds_read_b64_tr_b16 v[40:41], v204 offset:34848
    ds_read_b64_tr_b16 v[42:43], v204 offset:39456
    ds_read_b64_tr_b16 v[44:45], v204 offset:34880
    v_mfma_f32_16x16x32_bf16 v[120:123], v[84:87], v[28:31], v[120:123]
    v_mfma_f32_16x16x32_bf16 v[156:159], v[84:87], v[32:35], v[156:159]
    ds_read_b64_tr_b16 v[46:47], v204 offset:39488
    ds_read_b64_tr_b16 v[48:49], v204 offset:34912
    ds_read_b64_tr_b16 v[50:51], v204 offset:39520
    v_mfma_f32_16x16x32_bf16 v[124:127], v[88:91], v[28:31], v[124:127]
    v_mfma_f32_16x16x32_bf16 v[160:163], v[88:91], v[32:35], v[160:163]
    ds_read_b64_tr_b16 v[52:53], v204 offset:34944
    ds_read_b64_tr_b16 v[54:55], v204 offset:39552
    ds_read_b64_tr_b16 v[56:57], v204 offset:34976
    v_mfma_f32_16x16x32_bf16 v[128:131], v[92:95], v[28:31], v[128:131]
    v_mfma_f32_16x16x32_bf16 v[164:167], v[92:95], v[32:35], v[164:167]
    ds_read_b64_tr_b16 v[58:59], v204 offset:39584
    ds_read_b64_tr_b16 v[60:61], v204 offset:35008
    ds_read_b64_tr_b16 v[62:63], v204 offset:39616
    v_mfma_f32_16x16x32_bf16 v[132:135], v[96:99], v[28:31], v[132:135]
    v_mfma_f32_16x16x32_bf16 v[168:171], v[96:99], v[32:35], v[168:171]
    ds_read_b64_tr_b16 v[64:65], v204 offset:35040
    ds_read_b64_tr_b16 v[66:67], v204 offset:39648
    ds_read_b64_tr_b16 v[68:69], v204 offset:35072
    v_mfma_f32_16x16x32_bf16 v[136:139], v[100:103], v[28:31], v[136:139]
    v_mfma_f32_16x16x32_bf16 v[172:175], v[100:103], v[32:35], v[172:175]
    ds_read_b64_tr_b16 v[70:71], v204 offset:39680
    v_mfma_f32_16x16x32_bf16 v[140:143], v[104:107], v[28:31], v[140:143]
    v_mfma_f32_16x16x32_bf16 v[176:179], v[104:107], v[32:35], v[176:179]
    s_waitcnt lgkmcnt(15)
    v_mfma_f32_16x16x32_bf16 v[108:111], v[36:39], v[20:23], v[108:111]
    v_mfma_f32_16x16x32_bf16 v[144:147], v[36:39], v[24:27], v[144:147]
    ds_read_b64 v[28:29], v202 offset:34816
    ds_read_b64 v[30:31], v203 offset:34816
    ds_read_b64 v[32:33], v202 offset:36864
    s_waitcnt lgkmcnt(15)
    v_mfma_f32_16x16x32_bf16 v[112:115], v[40:43], v[20:23], v[112:115]
    v_mfma_f32_16x16x32_bf16 v[148:151], v[40:43], v[24:27], v[148:151]
    ds_read_b64 v[34:35], v203 offset:36864
    ds_read_b64_tr_b16 v[72:73], v204 offset:44032
    ds_read_b64_tr_b16 v[74:75], v204 offset:48640
    v_mfma_f32_16x16x32_bf16 v[116:119], v[44:47], v[20:23], v[116:119]
    v_mfma_f32_16x16x32_bf16 v[152:155], v[44:47], v[24:27], v[152:155]
    ds_read_b64_tr_b16 v[76:77], v204 offset:44064
    ds_read_b64_tr_b16 v[78:79], v204 offset:48672
    ds_read_b64_tr_b16 v[80:81], v204 offset:44096
    s_waitcnt lgkmcnt(15)
    v_mfma_f32_16x16x32_bf16 v[120:123], v[48:51], v[20:23], v[120:123]
    v_mfma_f32_16x16x32_bf16 v[156:159], v[48:51], v[24:27], v[156:159]
    ds_read_b64_tr_b16 v[82:83], v204 offset:48704
    ds_read_b64_tr_b16 v[84:85], v204 offset:44128
    ds_read_b64_tr_b16 v[86:87], v204 offset:48736
    v_mfma_f32_16x16x32_bf16 v[124:127], v[52:55], v[20:23], v[124:127]
    v_mfma_f32_16x16x32_bf16 v[160:163], v[52:55], v[24:27], v[160:163]
    ds_read_b64_tr_b16 v[88:89], v204 offset:44160
    ds_read_b64_tr_b16 v[90:91], v204 offset:48768
    ds_read_b64_tr_b16 v[92:93], v204 offset:44192
    v_mfma_f32_16x16x32_bf16 v[128:131], v[56:59], v[20:23], v[128:131]
    v_mfma_f32_16x16x32_bf16 v[164:167], v[56:59], v[24:27], v[164:167]
    ds_read_b64_tr_b16 v[94:95], v204 offset:48800
    ds_read_b64_tr_b16 v[96:97], v204 offset:44224
    ds_read_b64_tr_b16 v[98:99], v204 offset:48832
    s_waitcnt lgkmcnt(15)
    v_mfma_f32_16x16x32_bf16 v[132:135], v[60:63], v[20:23], v[132:135]
    v_mfma_f32_16x16x32_bf16 v[168:171], v[60:63], v[24:27], v[168:171]
    ds_read_b64_tr_b16 v[100:101], v204 offset:44256
    ds_read_b64_tr_b16 v[102:103], v204 offset:48864
    ds_read_b64_tr_b16 v[104:105], v204 offset:44288
    v_mfma_f32_16x16x32_bf16 v[136:139], v[64:67], v[20:23], v[136:139]
    v_mfma_f32_16x16x32_bf16 v[172:175], v[64:67], v[24:27], v[172:175]
    ds_read_b64_tr_b16 v[106:107], v204 offset:48896
    v_mfma_f32_16x16x32_bf16 v[140:143], v[68:71], v[20:23], v[140:143]
    v_mfma_f32_16x16x32_bf16 v[176:179], v[68:71], v[24:27], v[176:179]
    s_waitcnt lgkmcnt(0)
    s_waitcnt vmcnt(18)
    s_barrier
    s_add_u32 s4, s4, 128
    s_addc_u32 s5, s5, 0
    s_add_u32 s6, s6, s18
    s_addc_u32 s7, s7, 0
    s_lshl_b32 s9, s8, 12
    s_add_u32 m0, s9, 104448
    s_nop 0
    global_load_lds_dwordx4 v2, s[4:5]
    s_lshl_b32 s9, s8, 12
    s_add_u32 m0, s9, 105472
    s_nop 0
    global_load_lds_dwordx4 v3, s[4:5]
    s_lshl_b32 s9, s8, 12
    s_add_u32 m0, s9, 106496
    s_nop 0
    global_load_lds_dwordx4 v4, s[4:5]
    s_lshl_b32 s9, s8, 12
    s_add_u32 m0, s9, 107520
    s_nop 0
    global_load_lds_dwordx4 v5, s[4:5]
    s_mul_i32 s9, s8, 4608
    s_add_u32 m0, s9, 120832
    s_nop 0
    global_load_lds_dwordx4 v6, s[6:7]
    s_mul_i32 s9, s8, 4608
    s_add_u32 m0, s9, 121856
    s_nop 0
    global_load_lds_dwordx4 v7, s[6:7]
    s_mul_i32 s9, s8, 4608
    s_add_u32 m0, s9, 122880
    s_nop 0
    global_load_lds_dwordx4 v8, s[6:7]
    s_mul_i32 s9, s8, 4608
    s_add_u32 m0, s9, 123904
    s_nop 0
    global_load_lds_dwordx4 v9, s[6:7]
    s_mul_i32 s9, s8, 4608
    s_add_u32 m0, s9, 124928
    s_mov_b32 exec_hi, 0
    global_load_lds_dwordx4 v10, s[6:7]
    s_mov_b64 exec, -1
    v_mfma_f32_16x16x32_bf16 v[108:111], v[72:75], v[28:31], v[108:111]
    v_mfma_f32_16x16x32_bf16 v[144:147], v[72:75], v[32:35], v[144:147]
    ds_read_b64 v[20:21], v11 offset:0
    ds_read_b64 v[22:23], v12 offset:0
    ds_read_b64 v[24:25], v11 offset:2048
    v_mfma_f32_16x16x32_bf16 v[112:115], v[76:79], v[28:31], v[112:115]
    v_mfma_f32_16x16x32_bf16 v[148:151], v[76:79], v[32:35], v[148:151]
    ds_read_b64 v[26:27], v12 offset:2048
    ds_read_b64_tr_b16 v[36:37], v15 offset:0
    ds_read_b64_tr_b16 v[38:39], v15 offset:4608
    v_mfma_f32_16x16x32_bf16 v[116:119], v[80:83], v[28:31], v[116:119]
    v_mfma_f32_16x16x32_bf16 v[152:155], v[80:83], v[32:35], v[152:155]
    ds_read_b64_tr_b16 v[40:41], v15 offset:32
    ds_read_b64_tr_b16 v[42:43], v15 offset:4640
    ds_read_b64_tr_b16 v[44:45], v15 offset:64
    v_mfma_f32_16x16x32_bf16 v[120:123], v[84:87], v[28:31], v[120:123]
    v_mfma_f32_16x16x32_bf16 v[156:159], v[84:87], v[32:35], v[156:159]
    ds_read_b64_tr_b16 v[46:47], v15 offset:4672
    ds_read_b64_tr_b16 v[48:49], v15 offset:96
    ds_read_b64_tr_b16 v[50:51], v15 offset:4704
    v_mfma_f32_16x16x32_bf16 v[124:127], v[88:91], v[28:31], v[124:127]
    v_mfma_f32_16x16x32_bf16 v[160:163], v[88:91], v[32:35], v[160:163]
    ds_read_b64_tr_b16 v[52:53], v15 offset:128
    ds_read_b64_tr_b16 v[54:55], v15 offset:4736
    ds_read_b64_tr_b16 v[56:57], v15 offset:160
    v_mfma_f32_16x16x32_bf16 v[128:131], v[92:95], v[28:31], v[128:131]
    v_mfma_f32_16x16x32_bf16 v[164:167], v[92:95], v[32:35], v[164:167]
    ds_read_b64_tr_b16 v[58:59], v15 offset:4768
    ds_read_b64_tr_b16 v[60:61], v15 offset:192
    ds_read_b64_tr_b16 v[62:63], v15 offset:4800
    v_mfma_f32_16x16x32_bf16 v[132:135], v[96:99], v[28:31], v[132:135]
    v_mfma_f32_16x16x32_bf16 v[168:171], v[96:99], v[32:35], v[168:171]
    ds_read_b64_tr_b16 v[64:65], v15 offset:224
    ds_read_b64_tr_b16 v[66:67], v15 offset:4832
    ds_read_b64_tr_b16 v[68:69], v15 offset:256
    v_mfma_f32_16x16x32_bf16 v[136:139], v[100:103], v[28:31], v[136:139]
    v_mfma_f32_16x16x32_bf16 v[172:175], v[100:103], v[32:35], v[172:175]
    ds_read_b64_tr_b16 v[70:71], v15 offset:4864
    v_mfma_f32_16x16x32_bf16 v[140:143], v[104:107], v[28:31], v[140:143]
    v_mfma_f32_16x16x32_bf16 v[176:179], v[104:107], v[32:35], v[176:179]
    s_waitcnt lgkmcnt(15)
    v_mfma_f32_16x16x32_bf16 v[108:111], v[36:39], v[20:23], v[108:111]
    v_mfma_f32_16x16x32_bf16 v[144:147], v[36:39], v[24:27], v[144:147]
    ds_read_b64 v[28:29], v13 offset:0
    ds_read_b64 v[30:31], v14 offset:0
    ds_read_b64 v[32:33], v13 offset:2048
    s_waitcnt lgkmcnt(15)
    v_mfma_f32_16x16x32_bf16 v[112:115], v[40:43], v[20:23], v[112:115]
    v_mfma_f32_16x16x32_bf16 v[148:151], v[40:43], v[24:27], v[148:151]
    ds_read_b64 v[34:35], v14 offset:2048
    ds_read_b64_tr_b16 v[72:73], v15 offset:9216
    ds_read_b64_tr_b16 v[74:75], v15 offset:13824
    v_mfma_f32_16x16x32_bf16 v[116:119], v[44:47], v[20:23], v[116:119]
    v_mfma_f32_16x16x32_bf16 v[152:155], v[44:47], v[24:27], v[152:155]
    ds_read_b64_tr_b16 v[76:77], v15 offset:9248
    ds_read_b64_tr_b16 v[78:79], v15 offset:13856
    ds_read_b64_tr_b16 v[80:81], v15 offset:9280
    s_waitcnt lgkmcnt(15)
    v_mfma_f32_16x16x32_bf16 v[120:123], v[48:51], v[20:23], v[120:123]
    v_mfma_f32_16x16x32_bf16 v[156:159], v[48:51], v[24:27], v[156:159]
    ds_read_b64_tr_b16 v[82:83], v15 offset:13888
    ds_read_b64_tr_b16 v[84:85], v15 offset:9312
    ds_read_b64_tr_b16 v[86:87], v15 offset:13920
    v_mfma_f32_16x16x32_bf16 v[124:127], v[52:55], v[20:23], v[124:127]
    v_mfma_f32_16x16x32_bf16 v[160:163], v[52:55], v[24:27], v[160:163]
    ds_read_b64_tr_b16 v[88:89], v15 offset:9344
    ds_read_b64_tr_b16 v[90:91], v15 offset:13952
    ds_read_b64_tr_b16 v[92:93], v15 offset:9376
    v_mfma_f32_16x16x32_bf16 v[128:131], v[56:59], v[20:23], v[128:131]
    v_mfma_f32_16x16x32_bf16 v[164:167], v[56:59], v[24:27], v[164:167]
    ds_read_b64_tr_b16 v[94:95], v15 offset:13984
    ds_read_b64_tr_b16 v[96:97], v15 offset:9408
    ds_read_b64_tr_b16 v[98:99], v15 offset:14016
    s_waitcnt lgkmcnt(15)
    v_mfma_f32_16x16x32_bf16 v[132:135], v[60:63], v[20:23], v[132:135]
    v_mfma_f32_16x16x32_bf16 v[168:171], v[60:63], v[24:27], v[168:171]
    ds_read_b64_tr_b16 v[100:101], v15 offset:9440
    ds_read_b64_tr_b16 v[102:103], v15 offset:14048
    ds_read_b64_tr_b16 v[104:105], v15 offset:9472
    v_mfma_f32_16x16x32_bf16 v[136:139], v[64:67], v[20:23], v[136:139]
    v_mfma_f32_16x16x32_bf16 v[172:175], v[64:67], v[24:27], v[172:175]
    ds_read_b64_tr_b16 v[106:107], v15 offset:14080
    v_mfma_f32_16x16x32_bf16 v[140:143], v[68:71], v[20:23], v[140:143]
    v_mfma_f32_16x16x32_bf16 v[176:179], v[68:71], v[24:27], v[176:179]
    s_waitcnt lgkmcnt(0)
    s_waitcnt vmcnt(18)
    s_barrier
    s_add_u32 s4, s4, 128
    s_addc_u32 s5, s5, 0
    s_add_u32 s6, s6, s18
    s_addc_u32 s7, s7, 0
    s_lshl_b32 s9, s8, 12
    s_add_u32 m0, s9, 0
    s_nop 0
    global_load_lds_dwordx4 v2, s[4:5]
    s_lshl_b32 s9, s8, 12
    s_add_u32 m0, s9, 1024
    s_nop 0
    global_load_lds_dwordx4 v3, s[4:5]
    s_lshl_b32 s9, s8, 12
    s_add_u32 m0, s9, 2048
    s_nop 0
    global_load_lds_dwordx4 v4, s[4:5]
    s_lshl_b32 s9, s8, 12
    s_add_u32 m0, s9, 3072
    s_nop 0
    global_load_lds_dwordx4 v5, s[4:5]
    s_mul_i32 s9, s8, 4608
    s_add_u32 m0, s9, 16384
    s_nop 0
    global_load_lds_dwordx4 v6, s[6:7]
    s_mul_i32 s9, s8, 4608
    s_add_u32 m0, s9, 17408
    s_nop 0
    global_load_lds_dwordx4 v7, s[6:7]
    s_mul_i32 s9, s8, 4608
    s_add_u32 m0, s9, 18432
    s_nop 0
    global_load_lds_dwordx4 v8, s[6:7]
    s_mul_i32 s9, s8, 4608
    s_add_u32 m0, s9, 19456
    s_nop 0
    global_load_lds_dwordx4 v9, s[6:7]
    s_mul_i32 s9, s8, 4608
    s_add_u32 m0, s9, 20480
    s_mov_b32 exec_hi, 0
    global_load_lds_dwordx4 v10, s[6:7]
    s_mov_b64 exec, -1
    v_mfma_f32_16x16x32_bf16 v[108:111], v[72:75], v[28:31], v[108:111]
    v_mfma_f32_16x16x32_bf16 v[144:147], v[72:75], v[32:35], v[144:147]
    ds_read_b64 v[20:21], v11 offset:34816
    ds_read_b64 v[22:23], v12 offset:34816
    ds_read_b64 v[24:25], v11 offset:36864
    v_mfma_f32_16x16x32_bf16 v[112:115], v[76:79], v[28:31], v[112:115]
    v_mfma_f32_16x16x32_bf16 v[148:151], v[76:79], v[32:35], v[148:151]
    ds_read_b64 v[26:27], v12 offset:36864
    ds_read_b64_tr_b16 v[36:37], v15 offset:34816
    ds_read_b64_tr_b16 v[38:39], v15 offset:39424
    v_mfma_f32_16x16x32_bf16 v[116:119], v[80:83], v[28:31], v[116:119]
    v_mfma_f32_16x16x32_bf16 v[152:155], v[80:83], v[32:35], v[152:155]
    ds_read_b64_tr_b16 v[40:41], v15 offset:34848
    ds_read_b64_tr_b16 v[42:43], v15 offset:39456
    ds_read_b64_tr_b16 v[44:45], v15 offset:34880
    v_mfma_f32_16x16x32_bf16 v[120:123], v[84:87], v[28:31], v[120:123]
    v_mfma_f32_16x16x32_bf16 v[156:159], v[84:87], v[32:35], v[156:159]
    ds_read_b64_tr_b16 v[46:47], v15 offset:39488
    ds_read_b64_tr_b16 v[48:49], v15 offset:34912
    ds_read_b64_tr_b16 v[50:51], v15 offset:39520
    v_mfma_f32_16x16x32_bf16 v[124:127], v[88:91], v[28:31], v[124:127]
    v_mfma_f32_16x16x32_bf16 v[160:163], v[88:91], v[32:35], v[160:163]
    ds_read_b64_tr_b16 v[52:53], v15 offset:34944
    ds_read_b64_tr_b16 v[54:55], v15 offset:39552
    ds_read_b64_tr_b16 v[56:57], v15 offset:34976
    v_mfma_f32_16x16x32_bf16 v[128:131], v[92:95], v[28:31], v[128:131]
    v_mfma_f32_16x16x32_bf16 v[164:167], v[92:95], v[32:35], v[164:167]
    ds_read_b64_tr_b16 v[58:59], v15 offset:39584
    ds_read_b64_tr_b16 v[60:61], v15 offset:35008
    ds_read_b64_tr_b16 v[62:63], v15 offset:39616
    v_mfma_f32_16x16x32_bf16 v[132:135], v[96:99], v[28:31], v[132:135]
    v_mfma_f32_16x16x32_bf16 v[168:171], v[96:99], v[32:35], v[168:171]
    ds_read_b64_tr_b16 v[64:65], v15 offset:35040
    ds_read_b64_tr_b16 v[66:67], v15 offset:39648
    ds_read_b64_tr_b16 v[68:69], v15 offset:35072
    v_mfma_f32_16x16x32_bf16 v[136:139], v[100:103], v[28:31], v[136:139]
    v_mfma_f32_16x16x32_bf16 v[172:175], v[100:103], v[32:35], v[172:175]
    ds_read_b64_tr_b16 v[70:71], v15 offset:39680
    v_mfma_f32_16x16x32_bf16 v[140:143], v[104:107], v[28:31], v[140:143]
    v_mfma_f32_16x16x32_bf16 v[176:179], v[104:107], v[32:35], v[176:179]
    s_waitcnt lgkmcnt(15)
    v_mfma_f32_16x16x32_bf16 v[108:111], v[36:39], v[20:23], v[108:111]
    v_mfma_f32_16x16x32_bf16 v[144:147], v[36:39], v[24:27], v[144:147]
    ds_read_b64 v[28:29], v13 offset:34816
    ds_read_b64 v[30:31], v14 offset:34816
    ds_read_b64 v[32:33], v13 offset:36864
    s_waitcnt lgkmcnt(15)
    v_mfma_f32_16x16x32_bf16 v[112:115], v[40:43], v[20:23], v[112:115]
    v_mfma_f32_16x16x32_bf16 v[148:151], v[40:43], v[24:27], v[148:151]
    ds_read_b64 v[34:35], v14 offset:36864
    ds_read_b64_tr_b16 v[72:73], v15 offset:44032
    ds_read_b64_tr_b16 v[74:75], v15 offset:48640
    v_mfma_f32_16x16x32_bf16 v[116:119], v[44:47], v[20:23], v[116:119]
    v_mfma_f32_16x16x32_bf16 v[152:155], v[44:47], v[24:27], v[152:155]
    ds_read_b64_tr_b16 v[76:77], v15 offset:44064
    ds_read_b64_tr_b16 v[78:79], v15 offset:48672
    ds_read_b64_tr_b16 v[80:81], v15 offset:44096
    s_waitcnt lgkmcnt(15)
    v_mfma_f32_16x16x32_bf16 v[120:123], v[48:51], v[20:23], v[120:123]
    v_mfma_f32_16x16x32_bf16 v[156:159], v[48:51], v[24:27], v[156:159]
    ds_read_b64_tr_b16 v[82:83], v15 offset:48704
    ds_read_b64_tr_b16 v[84:85], v15 offset:44128
    ds_read_b64_tr_b16 v[86:87], v15 offset:48736
    v_mfma_f32_16x16x32_bf16 v[124:127], v[52:55], v[20:23], v[124:127]
    v_mfma_f32_16x16x32_bf16 v[160:163], v[52:55], v[24:27], v[160:163]
    ds_read_b64_tr_b16 v[88:89], v15 offset:44160
    ds_read_b64_tr_b16 v[90:91], v15 offset:48768
    ds_read_b64_tr_b16 v[92:93], v15 offset:44192
    v_mfma_f32_16x16x32_bf16 v[128:131], v[56:59], v[20:23], v[128:131]
    v_mfma_f32_16x16x32_bf16 v[164:167], v[56:59], v[24:27], v[164:167]
    ds_read_b64_tr_b16 v[94:95], v15 offset:48800
    ds_read_b64_tr_b16 v[96:97], v15 offset:44224
    ds_read_b64_tr_b16 v[98:99], v15 offset:48832
    s_waitcnt lgkmcnt(15)
    v_mfma_f32_16x16x32_bf16 v[132:135], v[60:63], v[20:23], v[132:135]
    v_mfma_f32_16x16x32_bf16 v[168:171], v[60:63], v[24:27], v[168:171]
    ds_read_b64_tr_b16 v[100:101], v15 offset:44256
    ds_read_b64_tr_b16 v[102:103], v15 offset:48864
    ds_read_b64_tr_b16 v[104:105], v15 offset:44288
    v_mfma_f32_16x16x32_bf16 v[136:139], v[64:67], v[20:23], v[136:139]
    v_mfma_f32_16x16x32_bf16 v[172:175], v[64:67], v[24:27], v[172:175]
    ds_read_b64_tr_b16 v[106:107], v15 offset:48896
    v_mfma_f32_16x16x32_bf16 v[140:143], v[68:71], v[20:23], v[140:143]
    v_mfma_f32_16x16x32_bf16 v[176:179], v[68:71], v[24:27], v[176:179]
    s_waitcnt lgkmcnt(0)
    s_waitcnt vmcnt(18)
    s_barrier
    s_add_u32 s4, s4, 128
    s_addc_u32 s5, s5, 0
    s_add_u32 s6, s6, s18
    s_addc_u32 s7, s7, 0
    s_lshl_b32 s9, s8, 12
    s_add_u32 m0, s9, 34816
    s_nop 0
    global_load_lds_dwordx4 v2, s[4:5]
    s_lshl_b32 s9, s8, 12
    s_add_u32 m0, s9, 35840
    s_nop 0
    global_load_lds_dwordx4 v3, s[4:5]
    s_lshl_b32 s9, s8, 12
    s_add_u32 m0, s9, 36864
    s_nop 0
    global_load_lds_dwordx4 v4, s[4:5]
    s_lshl_b32 s9, s8, 12
    s_add_u32 m0, s9, 37888
    s_nop 0
    global_load_lds_dwordx4 v5, s[4:5]
    s_mul_i32 s9, s8, 4608
    s_add_u32 m0, s9, 51200
    s_nop 0
    global_load_lds_dwordx4 v6, s[6:7]
    s_mul_i32 s9, s8, 4608
    s_add_u32 m0, s9, 52224
    s_nop 0
    global_load_lds_dwordx4 v7, s[6:7]
    s_mul_i32 s9, s8, 4608
    s_add_u32 m0, s9, 53248
    s_nop 0
    global_load_lds_dwordx4 v8, s[6:7]
    s_mul_i32 s9, s8, 4608
    s_add_u32 m0, s9, 54272
    s_nop 0
    global_load_lds_dwordx4 v9, s[6:7]
    s_mul_i32 s9, s8, 4608
    s_add_u32 m0, s9, 55296
    s_mov_b32 exec_hi, 0
    global_load_lds_dwordx4 v10, s[6:7]
    s_mov_b64 exec, -1
    v_mfma_f32_16x16x32_bf16 v[108:111], v[72:75], v[28:31], v[108:111]
    v_mfma_f32_16x16x32_bf16 v[144:147], v[72:75], v[32:35], v[144:147]
    ds_read_b64 v[20:21], v200 offset:0
    ds_read_b64 v[22:23], v201 offset:0
    ds_read_b64 v[24:25], v200 offset:2048
    v_mfma_f32_16x16x32_bf16 v[112:115], v[76:79], v[28:31], v[112:115]
    v_mfma_f32_16x16x32_bf16 v[148:151], v[76:79], v[32:35], v[148:151]
    ds_read_b64 v[26:27], v201 offset:2048
    ds_read_b64_tr_b16 v[36:37], v204 offset:0
    ds_read_b64_tr_b16 v[38:39], v204 offset:4608
    v_mfma_f32_16x16x32_bf16 v[116:119], v[80:83], v[28:31], v[116:119]
    v_mfma_f32_16x16x32_bf16 v[152:155], v[80:83], v[32:35], v[152:155]
    ds_read_b64_tr_b16 v[40:41], v204 offset:32
    ds_read_b64_tr_b16 v[42:43], v204 offset:4640
    ds_read_b64_tr_b16 v[44:45], v204 offset:64
    v_mfma_f32_16x16x32_bf16 v[120:123], v[84:87], v[28:31], v[120:123]
    v_mfma_f32_16x16x32_bf16 v[156:159], v[84:87], v[32:35], v[156:159]
    ds_read_b64_tr_b16 v[46:47], v204 offset:4672
    ds_read_b64_tr_b16 v[48:49], v204 offset:96
    ds_read_b64_tr_b16 v[50:51], v204 offset:4704
    v_mfma_f32_16x16x32_bf16 v[124:127], v[88:91], v[28:31], v[124:127]
    v_mfma_f32_16x16x32_bf16 v[160:163], v[88:91], v[32:35], v[160:163]
    ds_read_b64_tr_b16 v[52:53], v204 offset:128
    ds_read_b64_tr_b16 v[54:55], v204 offset:4736
    ds_read_b64_tr_b16 v[56:57], v204 offset:160
    v_mfma_f32_16x16x32_bf16 v[128:131], v[92:95], v[28:31], v[128:131]
    v_mfma_f32_16x16x32_bf16 v[164:167], v[92:95], v[32:35], v[164:167]
    ds_read_b64_tr_b16 v[58:59], v204 offset:4768
    ds_read_b64_tr_b16 v[60:61], v204 offset:192
    ds_read_b64_tr_b16 v[62:63], v204 offset:4800
    v_mfma_f32_16x16x32_bf16 v[132:135], v[96:99], v[28:31], v[132:135]
    v_mfma_f32_16x16x32_bf16 v[168:171], v[96:99], v[32:35], v[168:171]
    ds_read_b64_tr_b16 v[64:65], v204 offset:224
    ds_read_b64_tr_b16 v[66:67], v204 offset:4832
    ds_read_b64_tr_b16 v[68:69], v204 offset:256
    v_mfma_f32_16x16x32_bf16 v[136:139], v[100:103], v[28:31], v[136:139]
    v_mfma_f32_16x16x32_bf16 v[172:175], v[100:103], v[32:35], v[172:175]
    ds_read_b64_tr_b16 v[70:71], v204 offset:4864
    v_mfma_f32_16x16x32_bf16 v[140:143], v[104:107], v[28:31], v[140:143]
    v_mfma_f32_16x16x32_bf16 v[176:179], v[104:107], v[32:35], v[176:179]
    s_waitcnt lgkmcnt(15)
    v_mfma_f32_16x16x32_bf16 v[108:111], v[36:39], v[20:23], v[108:111]
    v_mfma_f32_16x16x32_bf16 v[144:147], v[36:39], v[24:27], v[144:147]
    ds_read_b64 v[28:29], v202 offset:0
    ds_read_b64 v[30:31], v203 offset:0
    ds_read_b64 v[32:33], v202 offset:2048
    s_waitcnt lgkmcnt(15)
    v_mfma_f32_16x16x32_bf16 v[112:115], v[40:43], v[20:23], v[112:115]
    v_mfma_f32_16x16x32_bf16 v[148:151], v[40:43], v[24:27], v[148:151]
    ds_read_b64 v[34:35], v203 offset:2048
    ds_read_b64_tr_b16 v[72:73], v204 offset:9216
    ds_read_b64_tr_b16 v[74:75], v204 offset:13824
    v_mfma_f32_16x16x32_bf16 v[116:119], v[44:47], v[20:23], v[116:119]
    v_mfma_f32_16x16x32_bf16 v[152:155], v[44:47], v[24:27], v[152:155]
    ds_read_b64_tr_b16 v[76:77], v204 offset:9248
    ds_read_b64_tr_b16 v[78:79], v204 offset:13856
    ds_read_b64_tr_b16 v[80:81], v204 offset:9280
    s_waitcnt lgkmcnt(15)
    v_mfma_f32_16x16x32_bf16 v[120:123], v[48:51], v[20:23], v[120:123]
    v_mfma_f32_16x16x32_bf16 v[156:159], v[48:51], v[24:27], v[156:159]
    ds_read_b64_tr_b16 v[82:83], v204 offset:13888
    ds_read_b64_tr_b16 v[84:85], v204 offset:9312
    ds_read_b64_tr_b16 v[86:87], v204 offset:13920
    v_mfma_f32_16x16x32_bf16 v[124:127], v[52:55], v[20:23], v[124:127]
    v_mfma_f32_16x16x32_bf16 v[160:163], v[52:55], v[24:27], v[160:163]
    ds_read_b64_tr_b16 v[88:89], v204 offset:9344
    ds_read_b64_tr_b16 v[90:91], v204 offset:13952
    ds_read_b64_tr_b16 v[92:93], v204 offset:9376
    v_mfma_f32_16x16x32_bf16 v[128:131], v[56:59], v[20:23], v[128:131]
    v_mfma_f32_16x16x32_bf16 v[164:167], v[56:59], v[24:27], v[164:167]
    ds_read_b64_tr_b16 v[94:95], v204 offset:13984
    ds_read_b64_tr_b16 v[96:97], v204 offset:9408
    ds_read_b64_tr_b16 v[98:99], v204 offset:14016
    s_waitcnt lgkmcnt(15)
    v_mfma_f32_16x16x32_bf16 v[132:135], v[60:63], v[20:23], v[132:135]
    v_mfma_f32_16x16x32_bf16 v[168:171], v[60:63], v[24:27], v[168:171]
    ds_read_b64_tr_b16 v[100:101], v204 offset:9440
    ds_read_b64_tr_b16 v[102:103], v204 offset:14048
    ds_read_b64_tr_b16 v[104:105], v204 offset:9472
    v_mfma_f32_16x16x32_bf16 v[136:139], v[64:67], v[20:23], v[136:139]
    v_mfma_f32_16x16x32_bf16 v[172:175], v[64:67], v[24:27], v[172:175]
    ds_read_b64_tr_b16 v[106:107], v204 offset:14080
    v_mfma_f32_16x16x32_bf16 v[140:143], v[68:71], v[20:23], v[140:143]
    v_mfma_f32_16x16x32_bf16 v[176:179], v[68:71], v[24:27], v[176:179]
    s_waitcnt lgkmcnt(0)
    s_waitcnt vmcnt(18)
    s_barrier
    s_add_u32 s4, s4, 128
    s_addc_u32 s5, s5, 0
    s_add_u32 s6, s6, s18
    s_addc_u32 s7, s7, 0
    s_lshl_b32 s9, s8, 12
    s_add_u32 m0, s9, 69632
    s_nop 0
    global_load_lds_dwordx4 v2, s[4:5]
    s_lshl_b32 s9, s8, 12
    s_add_u32 m0, s9, 70656
    s_nop 0
    global_load_lds_dwordx4 v3, s[4:5]
    s_lshl_b32 s9, s8, 12
    s_add_u32 m0, s9, 71680
    s_nop 0
    global_load_lds_dwordx4 v4, s[4:5]
    s_lshl_b32 s9, s8, 12
    s_add_u32 m0, s9, 72704
    s_nop 0
    global_load_lds_dwordx4 v5, s[4:5]
    s_mul_i32 s9, s8, 4608
    s_add_u32 m0, s9, 86016
    s_nop 0
    global_load_lds_dwordx4 v6, s[6:7]
    s_mul_i32 s9, s8, 4608
    s_add_u32 m0, s9, 87040
    s_nop 0
    global_load_lds_dwordx4 v7, s[6:7]
    s_mul_i32 s9, s8, 4608
    s_add_u32 m0, s9, 88064
    s_nop 0
    global_load_lds_dwordx4 v8, s[6:7]
    s_mul_i32 s9, s8, 4608
    s_add_u32 m0, s9, 89088
    s_nop 0
    global_load_lds_dwordx4 v9, s[6:7]
    s_mul_i32 s9, s8, 4608
    s_add_u32 m0, s9, 90112
    s_mov_b32 exec_hi, 0
    global_load_lds_dwordx4 v10, s[6:7]
    s_mov_b64 exec, -1
    v_mfma_f32_16x16x32_bf16 v[108:111], v[72:75], v[28:31], v[108:111]
    v_mfma_f32_16x16x32_bf16 v[144:147], v[72:75], v[32:35], v[144:147]
    ds_read_b64 v[20:21], v200 offset:34816
    ds_read_b64 v[22:23], v201 offset:34816
    ds_read_b64 v[24:25], v200 offset:36864
    v_mfma_f32_16x16x32_bf16 v[112:115], v[76:79], v[28:31], v[112:115]
    v_mfma_f32_16x16x32_bf16 v[148:151], v[76:79], v[32:35], v[148:151]
    ds_read_b64 v[26:27], v201 offset:36864
    ds_read_b64_tr_b16 v[36:37], v204 offset:34816
    ds_read_b64_tr_b16 v[38:39], v204 offset:39424
    v_mfma_f32_16x16x32_bf16 v[116:119], v[80:83], v[28:31], v[116:119]
    v_mfma_f32_16x16x32_bf16 v[152:155], v[80:83], v[32:35], v[152:155]
    ds_read_b64_tr_b16 v[40:41], v204 offset:34848
    ds_read_b64_tr_b16 v[42:43], v204 offset:39456
    ds_read_b64_tr_b16 v[44:45], v204 offset:34880
    v_mfma_f32_16x16x32_bf16 v[120:123], v[84:87], v[28:31], v[120:123]
    v_mfma_f32_16x16x32_bf16 v[156:159], v[84:87], v[32:35], v[156:159]
    ds_read_b64_tr_b16 v[46:47], v204 offset:39488
    ds_read_b64_tr_b16 v[48:49], v204 offset:34912
    ds_read_b64_tr_b16 v[50:51], v204 offset:39520
    v_mfma_f32_16x16x32_bf16 v[124:127], v[88:91], v[28:31], v[124:127]
    v_mfma_f32_16x16x32_bf16 v[160:163], v[88:91], v[32:35], v[160:163]
    ds_read_b64_tr_b16 v[52:53], v204 offset:34944
    ds_read_b64_tr_b16 v[54:55], v204 offset:39552
    ds_read_b64_tr_b16 v[56:57], v204 offset:34976
    v_mfma_f32_16x16x32_bf16 v[128:131], v[92:95], v[28:31], v[128:131]
    v_mfma_f32_16x16x32_bf16 v[164:167], v[92:95], v[32:35], v[164:167]
    ds_read_b64_tr_b16 v[58:59], v204 offset:39584
    ds_read_b64_tr_b16 v[60:61], v204 offset:35008
    ds_read_b64_tr_b16 v[62:63], v204 offset:39616
    v_mfma_f32_16x16x32_bf16 v[132:135], v[96:99], v[28:31], v[132:135]
    v_mfma_f32_16x16x32_bf16 v[168:171], v[96:99], v[32:35], v[168:171]
    ds_read_b64_tr_b16 v[64:65], v204 offset:35040
    ds_read_b64_tr_b16 v[66:67], v204 offset:39648
    ds_read_b64_tr_b16 v[68:69], v204 offset:35072
    v_mfma_f32_16x16x32_bf16 v[136:139], v[100:103], v[28:31], v[136:139]
    v_mfma_f32_16x16x32_bf16 v[172:175], v[100:103], v[32:35], v[172:175]
    ds_read_b64_tr_b16 v[70:71], v204 offset:39680
    v_mfma_f32_16x16x32_bf16 v[140:143], v[104:107], v[28:31], v[140:143]
    v_mfma_f32_16x16x32_bf16 v[176:179], v[104:107], v[32:35], v[176:179]
    s_waitcnt lgkmcnt(15)
    v_mfma_f32_16x16x32_bf16 v[108:111], v[36:39], v[20:23], v[108:111]
    v_mfma_f32_16x16x32_bf16 v[144:147], v[36:39], v[24:27], v[144:147]
    ds_read_b64 v[28:29], v202 offset:34816
    ds_read_b64 v[30:31], v203 offset:34816
    ds_read_b64 v[32:33], v202 offset:36864
    s_waitcnt lgkmcnt(15)
    v_mfma_f32_16x16x32_bf16 v[112:115], v[40:43], v[20:23], v[112:115]
    v_mfma_f32_16x16x32_bf16 v[148:151], v[40:43], v[24:27], v[148:151]
    ds_read_b64 v[34:35], v203 offset:36864
    ds_read_b64_tr_b16 v[72:73], v204 offset:44032
    ds_read_b64_tr_b16 v[74:75], v204 offset:48640
    v_mfma_f32_16x16x32_bf16 v[116:119], v[44:47], v[20:23], v[116:119]
    v_mfma_f32_16x16x32_bf16 v[152:155], v[44:47], v[24:27], v[152:155]
    ds_read_b64_tr_b16 v[76:77], v204 offset:44064
    ds_read_b64_tr_b16 v[78:79], v204 offset:48672
    ds_read_b64_tr_b16 v[80:81], v204 offset:44096
    s_waitcnt lgkmcnt(15)
    v_mfma_f32_16x16x32_bf16 v[120:123], v[48:51], v[20:23], v[120:123]
    v_mfma_f32_16x16x32_bf16 v[156:159], v[48:51], v[24:27], v[156:159]
    ds_read_b64_tr_b16 v[82:83], v204 offset:48704
    ds_read_b64_tr_b16 v[84:85], v204 offset:44128
    ds_read_b64_tr_b16 v[86:87], v204 offset:48736
    v_mfma_f32_16x16x32_bf16 v[124:127], v[52:55], v[20:23], v[124:127]
    v_mfma_f32_16x16x32_bf16 v[160:163], v[52:55], v[24:27], v[160:163]
    ds_read_b64_tr_b16 v[88:89], v204 offset:44160
    ds_read_b64_tr_b16 v[90:91], v204 offset:48768
    ds_read_b64_tr_b16 v[92:93], v204 offset:44192
    v_mfma_f32_16x16x32_bf16 v[128:131], v[56:59], v[20:23], v[128:131]
    v_mfma_f32_16x16x32_bf16 v[164:167], v[56:59], v[24:27], v[164:167]
    ds_read_b64_tr_b16 v[94:95], v204 offset:48800
    ds_read_b64_tr_b16 v[96:97], v204 offset:44224
    ds_read_b64_tr_b16 v[98:99], v204 offset:48832
    s_waitcnt lgkmcnt(15)
    v_mfma_f32_16x16x32_bf16 v[132:135], v[60:63], v[20:23], v[132:135]
    v_mfma_f32_16x16x32_bf16 v[168:171], v[60:63], v[24:27], v[168:171]
    ds_read_b64_tr_b16 v[100:101], v204 offset:44256
    ds_read_b64_tr_b16 v[102:103], v204 offset:48864
    ds_read_b64_tr_b16 v[104:105], v204 offset:44288
    v_mfma_f32_16x16x32_bf16 v[136:139], v[64:67], v[20:23], v[136:139]
    v_mfma_f32_16x16x32_bf16 v[172:175], v[64:67], v[24:27], v[172:175]
    ds_read_b64_tr_b16 v[106:107], v204 offset:48896
    v_mfma_f32_16x16x32_bf16 v[140:143], v[68:71], v[20:23], v[140:143]
    v_mfma_f32_16x16x32_bf16 v[176:179], v[68:71], v[24:27], v[176:179]
    s_waitcnt lgkmcnt(0)
    s_waitcnt vmcnt(18)
    s_barrier
    s_add_u32 s4, s4, 128
    s_addc_u32 s5, s5, 0
    s_add_u32 s6, s6, s18
    s_addc_u32 s7, s7, 0
    s_lshl_b32 s9, s8, 12
    s_add_u32 m0, s9, 104448
    s_nop 0
    global_load_lds_dwordx4 v2, s[4:5]
    s_lshl_b32 s9, s8, 12
    s_add_u32 m0, s9, 105472
    s_nop 0
    global_load_lds_dwordx4 v3, s[4:5]
    s_lshl_b32 s9, s8, 12
    s_add_u32 m0, s9, 106496
    s_nop 0
    global_load_lds_dwordx4 v4, s[4:5]
    s_lshl_b32 s9, s8, 12
    s_add_u32 m0, s9, 107520
    s_nop 0
    global_load_lds_dwordx4 v5, s[4:5]
    s_mul_i32 s9, s8, 4608
    s_add_u32 m0, s9, 120832
    s_nop 0
    global_load_lds_dwordx4 v6, s[6:7]
    s_mul_i32 s9, s8, 4608
    s_add_u32 m0, s9, 121856
    s_nop 0
    global_load_lds_dwordx4 v7, s[6:7]
    s_mul_i32 s9, s8, 4608
    s_add_u32 m0, s9, 122880
    s_nop 0
    global_load_lds_dwordx4 v8, s[6:7]
    s_mul_i32 s9, s8, 4608
    s_add_u32 m0, s9, 123904
    s_nop 0
    global_load_lds_dwordx4 v9, s[6:7]
    s_mul_i32 s9, s8, 4608
    s_add_u32 m0, s9, 124928
    s_mov_b32 exec_hi, 0
    global_load_lds_dwordx4 v10, s[6:7]
    s_mov_b64 exec, -1
    v_mfma_f32_16x16x32_bf16 v[108:111], v[72:75], v[28:31], v[108:111]
    v_mfma_f32_16x16x32_bf16 v[144:147], v[72:75], v[32:35], v[144:147]
    ds_read_b64 v[20:21], v11 offset:0
    ds_read_b64 v[22:23], v12 offset:0
    ds_read_b64 v[24:25], v11 offset:2048
    v_mfma_f32_16x16x32_bf16 v[112:115], v[76:79], v[28:31], v[112:115]
    v_mfma_f32_16x16x32_bf16 v[148:151], v[76:79], v[32:35], v[148:151]
    ds_read_b64 v[26:27], v12 offset:2048
    ds_read_b64_tr_b16 v[36:37], v15 offset:0
    ds_read_b64_tr_b16 v[38:39], v15 offset:4608
    v_mfma_f32_16x16x32_bf16 v[116:119], v[80:83], v[28:31], v[116:119]
    v_mfma_f32_16x16x32_bf16 v[152:155], v[80:83], v[32:35], v[152:155]
    ds_read_b64_tr_b16 v[40:41], v15 offset:32
    ds_read_b64_tr_b16 v[42:43], v15 offset:4640
    ds_read_b64_tr_b16 v[44:45], v15 offset:64
    v_mfma_f32_16x16x32_bf16 v[120:123], v[84:87], v[28:31], v[120:123]
    v_mfma_f32_16x16x32_bf16 v[156:159], v[84:87], v[32:35], v[156:159]
    ds_read_b64_tr_b16 v[46:47], v15 offset:4672
    ds_read_b64_tr_b16 v[48:49], v15 offset:96
    ds_read_b64_tr_b16 v[50:51], v15 offset:4704
    v_mfma_f32_16x16x32_bf16 v[124:127], v[88:91], v[28:31], v[124:127]
    v_mfma_f32_16x16x32_bf16 v[160:163], v[88:91], v[32:35], v[160:163]
    ds_read_b64_tr_b16 v[52:53], v15 offset:128
    ds_read_b64_tr_b16 v[54:55], v15 offset:4736
    ds_read_b64_tr_b16 v[56:57], v15 offset:160
    v_mfma_f32_16x16x32_bf16 v[128:131], v[92:95], v[28:31], v[128:131]
    v_mfma_f32_16x16x32_bf16 v[164:167], v[92:95], v[32:35], v[164:167]
    ds_read_b64_tr_b16 v[58:59], v15 offset:4768
    ds_read_b64_tr_b16 v[60:61], v15 offset:192
    ds_read_b64_tr_b16 v[62:63], v15 offset:4800
    v_mfma_f32_16x16x32_bf16 v[132:135], v[96:99], v[28:31], v[132:135]
    v_mfma_f32_16x16x32_bf16 v[168:171], v[96:99], v[32:35], v[168:171]
    ds_read_b64_tr_b16 v[64:65], v15 offset:224
    ds_read_b64_tr_b16 v[66:67], v15 offset:4832
    ds_read_b64_tr_b16 v[68:69], v15 offset:256
    v_mfma_f32_16x16x32_bf16 v[136:139], v[100:103], v[28:31], v[136:139]
    v_mfma_f32_16x16x32_bf16 v[172:175], v[100:103], v[32:35], v[172:175]
    ds_read_b64_tr_b16 v[70:71], v15 offset:4864
    v_mfma_f32_16x16x32_bf16 v[140:143], v[104:107], v[28:31], v[140:143]
    v_mfma_f32_16x16x32_bf16 v[176:179], v[104:107], v[32:35], v[176:179]
    s_waitcnt lgkmcnt(15)
    v_mfma_f32_16x16x32_bf16 v[108:111], v[36:39], v[20:23], v[108:111]
    v_mfma_f32_16x16x32_bf16 v[144:147], v[36:39], v[24:27], v[144:147]
    ds_read_b64 v[28:29], v13 offset:0
    ds_read_b64 v[30:31], v14 offset:0
    ds_read_b64 v[32:33], v13 offset:2048
    s_waitcnt lgkmcnt(15)
    v_mfma_f32_16x16x32_bf16 v[112:115], v[40:43], v[20:23], v[112:115]
    v_mfma_f32_16x16x32_bf16 v[148:151], v[40:43], v[24:27], v[148:151]
    ds_read_b64 v[34:35], v14 offset:2048
    ds_read_b64_tr_b16 v[72:73], v15 offset:9216
    ds_read_b64_tr_b16 v[74:75], v15 offset:13824
    v_mfma_f32_16x16x32_bf16 v[116:119], v[44:47], v[20:23], v[116:119]
    v_mfma_f32_16x16x32_bf16 v[152:155], v[44:47], v[24:27], v[152:155]
    ds_read_b64_tr_b16 v[76:77], v15 offset:9248
    ds_read_b64_tr_b16 v[78:79], v15 offset:13856
    ds_read_b64_tr_b16 v[80:81], v15 offset:9280
    s_waitcnt lgkmcnt(15)
    v_mfma_f32_16x16x32_bf16 v[120:123], v[48:51], v[20:23], v[120:123]
    v_mfma_f32_16x16x32_bf16 v[156:159], v[48:51], v[24:27], v[156:159]
    ds_read_b64_tr_b16 v[82:83], v15 offset:13888
    ds_read_b64_tr_b16 v[84:85], v15 offset:9312
    ds_read_b64_tr_b16 v[86:87], v15 offset:13920
    v_mfma_f32_16x16x32_bf16 v[124:127], v[52:55], v[20:23], v[124:127]
    v_mfma_f32_16x16x32_bf16 v[160:163], v[52:55], v[24:27], v[160:163]
    ds_read_b64_tr_b16 v[88:89], v15 offset:9344
    ds_read_b64_tr_b16 v[90:91], v15 offset:13952
    ds_read_b64_tr_b16 v[92:93], v15 offset:9376
    v_mfma_f32_16x16x32_bf16 v[128:131], v[56:59], v[20:23], v[128:131]
    v_mfma_f32_16x16x32_bf16 v[164:167], v[56:59], v[24:27], v[164:167]
    ds_read_b64_tr_b16 v[94:95], v15 offset:13984
    ds_read_b64_tr_b16 v[96:97], v15 offset:9408
    ds_read_b64_tr_b16 v[98:99], v15 offset:14016
    s_waitcnt lgkmcnt(15)
    v_mfma_f32_16x16x32_bf16 v[132:135], v[60:63], v[20:23], v[132:135]
    v_mfma_f32_16x16x32_bf16 v[168:171], v[60:63], v[24:27], v[168:171]
    ds_read_b64_tr_b16 v[100:101], v15 offset:9440
    ds_read_b64_tr_b16 v[102:103], v15 offset:14048
    ds_read_b64_tr_b16 v[104:105], v15 offset:9472
    v_mfma_f32_16x16x32_bf16 v[136:139], v[64:67], v[20:23], v[136:139]
    v_mfma_f32_16x16x32_bf16 v[172:175], v[64:67], v[24:27], v[172:175]
    ds_read_b64_tr_b16 v[106:107], v15 offset:14080
    v_mfma_f32_16x16x32_bf16 v[140:143], v[68:71], v[20:23], v[140:143]
    v_mfma_f32_16x16x32_bf16 v[176:179], v[68:71], v[24:27], v[176:179]
    s_waitcnt lgkmcnt(0)
    s_waitcnt vmcnt(18)
    s_barrier
    v_mfma_f32_16x16x32_bf16 v[108:111], v[72:75], v[28:31], v[108:111]
    v_mfma_f32_16x16x32_bf16 v[144:147], v[72:75], v[32:35], v[144:147]
    ds_read_b64 v[20:21], v11 offset:34816
    ds_read_b64 v[22:23], v12 offset:34816
    ds_read_b64 v[24:25], v11 offset:36864
    v_mfma_f32_16x16x32_bf16 v[112:115], v[76:79], v[28:31], v[112:115]
    v_mfma_f32_16x16x32_bf16 v[148:151], v[76:79], v[32:35], v[148:151]
    ds_read_b64 v[26:27], v12 offset:36864
    ds_read_b64_tr_b16 v[36:37], v15 offset:34816
    ds_read_b64_tr_b16 v[38:39], v15 offset:39424
    v_mfma_f32_16x16x32_bf16 v[116:119], v[80:83], v[28:31], v[116:119]
    v_mfma_f32_16x16x32_bf16 v[152:155], v[80:83], v[32:35], v[152:155]
    ds_read_b64_tr_b16 v[40:41], v15 offset:34848
    ds_read_b64_tr_b16 v[42:43], v15 offset:39456
    ds_read_b64_tr_b16 v[44:45], v15 offset:34880
    v_mfma_f32_16x16x32_bf16 v[120:123], v[84:87], v[28:31], v[120:123]
    v_mfma_f32_16x16x32_bf16 v[156:159], v[84:87], v[32:35], v[156:159]
    ds_read_b64_tr_b16 v[46:47], v15 offset:39488
    ds_read_b64_tr_b16 v[48:49], v15 offset:34912
    ds_read_b64_tr_b16 v[50:51], v15 offset:39520
    v_mfma_f32_16x16x32_bf16 v[124:127], v[88:91], v[28:31], v[124:127]
    v_mfma_f32_16x16x32_bf16 v[160:163], v[88:91], v[32:35], v[160:163]
    ds_read_b64_tr_b16 v[52:53], v15 offset:34944
    ds_read_b64_tr_b16 v[54:55], v15 offset:39552
    ds_read_b64_tr_b16 v[56:57], v15 offset:34976
    v_mfma_f32_16x16x32_bf16 v[128:131], v[92:95], v[28:31], v[128:131]
    v_mfma_f32_16x16x32_bf16 v[164:167], v[92:95], v[32:35], v[164:167]
    ds_read_b64_tr_b16 v[58:59], v15 offset:39584
    ds_read_b64_tr_b16 v[60:61], v15 offset:35008
    ds_read_b64_tr_b16 v[62:63], v15 offset:39616
    v_mfma_f32_16x16x32_bf16 v[132:135], v[96:99], v[28:31], v[132:135]
    v_mfma_f32_16x16x32_bf16 v[168:171], v[96:99], v[32:35], v[168:171]
    ds_read_b64_tr_b16 v[64:65], v15 offset:35040
    ds_read_b64_tr_b16 v[66:67], v15 offset:39648
    ds_read_b64_tr_b16 v[68:69], v15 offset:35072
    v_mfma_f32_16x16x32_bf16 v[136:139], v[100:103], v[28:31], v[136:139]
    v_mfma_f32_16x16x32_bf16 v[172:175], v[100:103], v[32:35], v[172:175]
    ds_read_b64_tr_b16 v[70:71], v15 offset:39680
    v_mfma_f32_16x16x32_bf16 v[140:143], v[104:107], v[28:31], v[140:143]
    v_mfma_f32_16x16x32_bf16 v[176:179], v[104:107], v[32:35], v[176:179]
    s_waitcnt lgkmcnt(15)
    v_mfma_f32_16x16x32_bf16 v[108:111], v[36:39], v[20:23], v[108:111]
    v_mfma_f32_16x16x32_bf16 v[144:147], v[36:39], v[24:27], v[144:147]
    ds_read_b64 v[28:29], v13 offset:34816
    ds_read_b64 v[30:31], v14 offset:34816
    ds_read_b64 v[32:33], v13 offset:36864
    s_waitcnt lgkmcnt(15)
    v_mfma_f32_16x16x32_bf16 v[112:115], v[40:43], v[20:23], v[112:115]
    v_mfma_f32_16x16x32_bf16 v[148:151], v[40:43], v[24:27], v[148:151]
    ds_read_b64 v[34:35], v14 offset:36864
    ds_read_b64_tr_b16 v[72:73], v15 offset:44032
    ds_read_b64_tr_b16 v[74:75], v15 offset:48640
    v_mfma_f32_16x16x32_bf16 v[116:119], v[44:47], v[20:23], v[116:119]
    v_mfma_f32_16x16x32_bf16 v[152:155], v[44:47], v[24:27], v[152:155]
    ds_read_b64_tr_b16 v[76:77], v15 offset:44064
    ds_read_b64_tr_b16 v[78:79], v15 offset:48672
    ds_read_b64_tr_b16 v[80:81], v15 offset:44096
    s_waitcnt lgkmcnt(15)
    v_mfma_f32_16x16x32_bf16 v[120:123], v[48:51], v[20:23], v[120:123]
    v_mfma_f32_16x16x32_bf16 v[156:159], v[48:51], v[24:27], v[156:159]
    ds_read_b64_tr_b16 v[82:83], v15 offset:48704
    ds_read_b64_tr_b16 v[84:85], v15 offset:44128
    ds_read_b64_tr_b16 v[86:87], v15 offset:48736
    v_mfma_f32_16x16x32_bf16 v[124:127], v[52:55], v[20:23], v[124:127]
    v_mfma_f32_16x16x32_bf16 v[160:163], v[52:55], v[24:27], v[160:163]
    ds_read_b64_tr_b16 v[88:89], v15 offset:44160
    ds_read_b64_tr_b16 v[90:91], v15 offset:48768
    ds_read_b64_tr_b16 v[92:93], v15 offset:44192
    v_mfma_f32_16x16x32_bf16 v[128:131], v[56:59], v[20:23], v[128:131]
    v_mfma_f32_16x16x32_bf16 v[164:167], v[56:59], v[24:27], v[164:167]
    ds_read_b64_tr_b16 v[94:95], v15 offset:48800
    ds_read_b64_tr_b16 v[96:97], v15 offset:44224
    ds_read_b64_tr_b16 v[98:99], v15 offset:48832
    s_waitcnt lgkmcnt(15)
    v_mfma_f32_16x16x32_bf16 v[132:135], v[60:63], v[20:23], v[132:135]
    v_mfma_f32_16x16x32_bf16 v[168:171], v[60:63], v[24:27], v[168:171]
    ds_read_b64_tr_b16 v[100:101], v15 offset:44256
    ds_read_b64_tr_b16 v[102:103], v15 offset:48864
    ds_read_b64_tr_b16 v[104:105], v15 offset:44288
    v_mfma_f32_16x16x32_bf16 v[136:139], v[64:67], v[20:23], v[136:139]
    v_mfma_f32_16x16x32_bf16 v[172:175], v[64:67], v[24:27], v[172:175]
    ds_read_b64_tr_b16 v[106:107], v15 offset:48896
    v_mfma_f32_16x16x32_bf16 v[140:143], v[68:71], v[20:23], v[140:143]
    v_mfma_f32_16x16x32_bf16 v[176:179], v[68:71], v[24:27], v[176:179]
    s_waitcnt lgkmcnt(0)
    s_waitcnt vmcnt(9)
    s_barrier
    v_mfma_f32_16x16x32_bf16 v[108:111], v[72:75], v[28:31], v[108:111]
    v_mfma_f32_16x16x32_bf16 v[144:147], v[72:75], v[32:35], v[144:147]
    ds_read_b64 v[20:21], v200 offset:0
    ds_read_b64 v[22:23], v201 offset:0
    ds_read_b64 v[24:25], v200 offset:2048
    v_mfma_f32_16x16x32_bf16 v[112:115], v[76:79], v[28:31], v[112:115]
    v_mfma_f32_16x16x32_bf16 v[148:151], v[76:79], v[32:35], v[148:151]
    ds_read_b64 v[26:27], v201 offset:2048
    ds_read_b64_tr_b16 v[36:37], v204 offset:0
    ds_read_b64_tr_b16 v[38:39], v204 offset:4608
    v_mfma_f32_16x16x32_bf16 v[116:119], v[80:83], v[28:31], v[116:119]
    v_mfma_f32_16x16x32_bf16 v[152:155], v[80:83], v[32:35], v[152:155]
    ds_read_b64_tr_b16 v[40:41], v204 offset:32
    ds_read_b64_tr_b16 v[42:43], v204 offset:4640
    ds_read_b64_tr_b16 v[44:45], v204 offset:64
    v_mfma_f32_16x16x32_bf16 v[120:123], v[84:87], v[28:31], v[120:123]
    v_mfma_f32_16x16x32_bf16 v[156:159], v[84:87], v[32:35], v[156:159]
    ds_read_b64_tr_b16 v[46:47], v204 offset:4672
    ds_read_b64_tr_b16 v[48:49], v204 offset:96
    ds_read_b64_tr_b16 v[50:51], v204 offset:4704
    v_mfma_f32_16x16x32_bf16 v[124:127], v[88:91], v[28:31], v[124:127]
    v_mfma_f32_16x16x32_bf16 v[160:163], v[88:91], v[32:35], v[160:163]
    ds_read_b64_tr_b16 v[52:53], v204 offset:128
    ds_read_b64_tr_b16 v[54:55], v204 offset:4736
    ds_read_b64_tr_b16 v[56:57], v204 offset:160
    v_mfma_f32_16x16x32_bf16 v[128:131], v[92:95], v[28:31], v[128:131]
    v_mfma_f32_16x16x32_bf16 v[164:167], v[92:95], v[32:35], v[164:167]
    ds_read_b64_tr_b16 v[58:59], v204 offset:4768
    ds_read_b64_tr_b16 v[60:61], v204 offset:192
    ds_read_b64_tr_b16 v[62:63], v204 offset:4800
    v_mfma_f32_16x16x32_bf16 v[132:135], v[96:99], v[28:31], v[132:135]
    v_mfma_f32_16x16x32_bf16 v[168:171], v[96:99], v[32:35], v[168:171]
    ds_read_b64_tr_b16 v[64:65], v204 offset:224
    ds_read_b64_tr_b16 v[66:67], v204 offset:4832
    ds_read_b64_tr_b16 v[68:69], v204 offset:256
    v_mfma_f32_16x16x32_bf16 v[136:139], v[100:103], v[28:31], v[136:139]
    v_mfma_f32_16x16x32_bf16 v[172:175], v[100:103], v[32:35], v[172:175]
    ds_read_b64_tr_b16 v[70:71], v204 offset:4864
    v_mfma_f32_16x16x32_bf16 v[140:143], v[104:107], v[28:31], v[140:143]
    v_mfma_f32_16x16x32_bf16 v[176:179], v[104:107], v[32:35], v[176:179]
    s_waitcnt lgkmcnt(15)
    v_mfma_f32_16x16x32_bf16 v[108:111], v[36:39], v[20:23], v[108:111]
    v_mfma_f32_16x16x32_bf16 v[144:147], v[36:39], v[24:27], v[144:147]
    ds_read_b64 v[28:29], v202 offset:0
    ds_read_b64 v[30:31], v203 offset:0
    ds_read_b64 v[32:33], v202 offset:2048
    s_waitcnt lgkmcnt(15)
    v_mfma_f32_16x16x32_bf16 v[112:115], v[40:43], v[20:23], v[112:115]
    v_mfma_f32_16x16x32_bf16 v[148:151], v[40:43], v[24:27], v[148:151]
    ds_read_b64 v[34:35], v203 offset:2048
    ds_read_b64_tr_b16 v[72:73], v204 offset:9216
    ds_read_b64_tr_b16 v[74:75], v204 offset:13824
    v_mfma_f32_16x16x32_bf16 v[116:119], v[44:47], v[20:23], v[116:119]
    v_mfma_f32_16x16x32_bf16 v[152:155], v[44:47], v[24:27], v[152:155]
    ds_read_b64_tr_b16 v[76:77], v204 offset:9248
    ds_read_b64_tr_b16 v[78:79], v204 offset:13856
    ds_read_b64_tr_b16 v[80:81], v204 offset:9280
    s_waitcnt lgkmcnt(15)
    v_mfma_f32_16x16x32_bf16 v[120:123], v[48:51], v[20:23], v[120:123]
    v_mfma_f32_16x16x32_bf16 v[156:159], v[48:51], v[24:27], v[156:159]
    ds_read_b64_tr_b16 v[82:83], v204 offset:13888
    ds_read_b64_tr_b16 v[84:85], v204 offset:9312
    ds_read_b64_tr_b16 v[86:87], v204 offset:13920
    v_mfma_f32_16x16x32_bf16 v[124:127], v[52:55], v[20:23], v[124:127]
    v_mfma_f32_16x16x32_bf16 v[160:163], v[52:55], v[24:27], v[160:163]
    ds_read_b64_tr_b16 v[88:89], v204 offset:9344
    ds_read_b64_tr_b16 v[90:91], v204 offset:13952
    ds_read_b64_tr_b16 v[92:93], v204 offset:9376
    v_mfma_f32_16x16x32_bf16 v[128:131], v[56:59], v[20:23], v[128:131]
    v_mfma_f32_16x16x32_bf16 v[164:167], v[56:59], v[24:27], v[164:167]
    ds_read_b64_tr_b16 v[94:95], v204 offset:13984
    ds_read_b64_tr_b16 v[96:97], v204 offset:9408
    ds_read_b64_tr_b16 v[98:99], v204 offset:14016
    s_waitcnt lgkmcnt(15)
    v_mfma_f32_16x16x32_bf16 v[132:135], v[60:63], v[20:23], v[132:135]
    v_mfma_f32_16x16x32_bf16 v[168:171], v[60:63], v[24:27], v[168:171]
    ds_read_b64_tr_b16 v[100:101], v204 offset:9440
    ds_read_b64_tr_b16 v[102:103], v204 offset:14048
    ds_read_b64_tr_b16 v[104:105], v204 offset:9472
    v_mfma_f32_16x16x32_bf16 v[136:139], v[64:67], v[20:23], v[136:139]
    v_mfma_f32_16x16x32_bf16 v[172:175], v[64:67], v[24:27], v[172:175]
    ds_read_b64_tr_b16 v[106:107], v204 offset:14080
    v_mfma_f32_16x16x32_bf16 v[140:143], v[68:71], v[20:23], v[140:143]
    v_mfma_f32_16x16x32_bf16 v[176:179], v[68:71], v[24:27], v[176:179]
    s_waitcnt lgkmcnt(0)
    s_waitcnt vmcnt(0)
    s_barrier
    v_mfma_f32_16x16x32_bf16 v[108:111], v[72:75], v[28:31], v[108:111]
    v_mfma_f32_16x16x32_bf16 v[144:147], v[72:75], v[32:35], v[144:147]
    ds_read_b64 v[20:21], v200 offset:34816
    ds_read_b64 v[22:23], v201 offset:34816
    ds_read_b64 v[24:25], v200 offset:36864
    v_mfma_f32_16x16x32_bf16 v[112:115], v[76:79], v[28:31], v[112:115]
    v_mfma_f32_16x16x32_bf16 v[148:151], v[76:79], v[32:35], v[148:151]
    ds_read_b64 v[26:27], v201 offset:36864
    ds_read_b64_tr_b16 v[36:37], v204 offset:34816
    ds_read_b64_tr_b16 v[38:39], v204 offset:39424
    v_mfma_f32_16x16x32_bf16 v[116:119], v[80:83], v[28:31], v[116:119]
    v_mfma_f32_16x16x32_bf16 v[152:155], v[80:83], v[32:35], v[152:155]
    ds_read_b64_tr_b16 v[40:41], v204 offset:34848
    ds_read_b64_tr_b16 v[42:43], v204 offset:39456
    ds_read_b64_tr_b16 v[44:45], v204 offset:34880
    v_mfma_f32_16x16x32_bf16 v[120:123], v[84:87], v[28:31], v[120:123]
    v_mfma_f32_16x16x32_bf16 v[156:159], v[84:87], v[32:35], v[156:159]
    ds_read_b64_tr_b16 v[46:47], v204 offset:39488
    ds_read_b64_tr_b16 v[48:49], v204 offset:34912
    ds_read_b64_tr_b16 v[50:51], v204 offset:39520
    v_mfma_f32_16x16x32_bf16 v[124:127], v[88:91], v[28:31], v[124:127]
    v_mfma_f32_16x16x32_bf16 v[160:163], v[88:91], v[32:35], v[160:163]
    ds_read_b64_tr_b16 v[52:53], v204 offset:34944
    ds_read_b64_tr_b16 v[54:55], v204 offset:39552
    ds_read_b64_tr_b16 v[56:57], v204 offset:34976
    v_mfma_f32_16x16x32_bf16 v[128:131], v[92:95], v[28:31], v[128:131]
    v_mfma_f32_16x16x32_bf16 v[164:167], v[92:95], v[32:35], v[164:167]
    ds_read_b64_tr_b16 v[58:59], v204 offset:39584
    ds_read_b64_tr_b16 v[60:61], v204 offset:35008
    ds_read_b64_tr_b16 v[62:63], v204 offset:39616
    v_mfma_f32_16x16x32_bf16 v[132:135], v[96:99], v[28:31], v[132:135]
    v_mfma_f32_16x16x32_bf16 v[168:171], v[96:99], v[32:35], v[168:171]
    ds_read_b64_tr_b16 v[64:65], v204 offset:35040
    ds_read_b64_tr_b16 v[66:67], v204 offset:39648
    ds_read_b64_tr_b16 v[68:69], v204 offset:35072
    v_mfma_f32_16x16x32_bf16 v[136:139], v[100:103], v[28:31], v[136:139]
    v_mfma_f32_16x16x32_bf16 v[172:175], v[100:103], v[32:35], v[172:175]
    ds_read_b64_tr_b16 v[70:71], v204 offset:39680
    v_mfma_f32_16x16x32_bf16 v[140:143], v[104:107], v[28:31], v[140:143]
    v_mfma_f32_16x16x32_bf16 v[176:179], v[104:107], v[32:35], v[176:179]
    s_waitcnt lgkmcnt(15)
    v_mfma_f32_16x16x32_bf16 v[108:111], v[36:39], v[20:23], v[108:111]
    v_mfma_f32_16x16x32_bf16 v[144:147], v[36:39], v[24:27], v[144:147]
    ds_read_b64 v[28:29], v202 offset:34816
    ds_read_b64 v[30:31], v203 offset:34816
    ds_read_b64 v[32:33], v202 offset:36864
    s_waitcnt lgkmcnt(15)
    v_mfma_f32_16x16x32_bf16 v[112:115], v[40:43], v[20:23], v[112:115]
    v_mfma_f32_16x16x32_bf16 v[148:151], v[40:43], v[24:27], v[148:151]
    ds_read_b64 v[34:35], v203 offset:36864
    ds_read_b64_tr_b16 v[72:73], v204 offset:44032
    ds_read_b64_tr_b16 v[74:75], v204 offset:48640
    v_mfma_f32_16x16x32_bf16 v[116:119], v[44:47], v[20:23], v[116:119]
    v_mfma_f32_16x16x32_bf16 v[152:155], v[44:47], v[24:27], v[152:155]
    ds_read_b64_tr_b16 v[76:77], v204 offset:44064
    ds_read_b64_tr_b16 v[78:79], v204 offset:48672
    ds_read_b64_tr_b16 v[80:81], v204 offset:44096
    s_waitcnt lgkmcnt(15)
    v_mfma_f32_16x16x32_bf16 v[120:123], v[48:51], v[20:23], v[120:123]
    v_mfma_f32_16x16x32_bf16 v[156:159], v[48:51], v[24:27], v[156:159]
    ds_read_b64_tr_b16 v[82:83], v204 offset:48704
    ds_read_b64_tr_b16 v[84:85], v204 offset:44128
    ds_read_b64_tr_b16 v[86:87], v204 offset:48736
    v_mfma_f32_16x16x32_bf16 v[124:127], v[52:55], v[20:23], v[124:127]
    v_mfma_f32_16x16x32_bf16 v[160:163], v[52:55], v[24:27], v[160:163]
    ds_read_b64_tr_b16 v[88:89], v204 offset:44160
    ds_read_b64_tr_b16 v[90:91], v204 offset:48768
    ds_read_b64_tr_b16 v[92:93], v204 offset:44192
    v_mfma_f32_16x16x32_bf16 v[128:131], v[56:59], v[20:23], v[128:131]
    v_mfma_f32_16x16x32_bf16 v[164:167], v[56:59], v[24:27], v[164:167]
    ds_read_b64_tr_b16 v[94:95], v204 offset:48800
    ds_read_b64_tr_b16 v[96:97], v204 offset:44224
    ds_read_b64_tr_b16 v[98:99], v204 offset:48832
    s_waitcnt lgkmcnt(15)
    v_mfma_f32_16x16x32_bf16 v[132:135], v[60:63], v[20:23], v[132:135]
    v_mfma_f32_16x16x32_bf16 v[168:171], v[60:63], v[24:27], v[168:171]
    ds_read_b64_tr_b16 v[100:101], v204 offset:44256
    ds_read_b64_tr_b16 v[102:103], v204 offset:48864
    ds_read_b64_tr_b16 v[104:105], v204 offset:44288
    v_mfma_f32_16x16x32_bf16 v[136:139], v[64:67], v[20:23], v[136:139]
    v_mfma_f32_16x16x32_bf16 v[172:175], v[64:67], v[24:27], v[172:175]
    ds_read_b64_tr_b16 v[106:107], v204 offset:48896
    v_mfma_f32_16x16x32_bf16 v[140:143], v[68:71], v[20:23], v[140:143]
    v_mfma_f32_16x16x32_bf16 v[176:179], v[68:71], v[24:27], v[176:179]
    s_waitcnt lgkmcnt(15)
    v_mfma_f32_16x16x32_bf16 v[108:111], v[72:75], v[28:31], v[108:111]
    v_mfma_f32_16x16x32_bf16 v[144:147], v[72:75], v[32:35], v[144:147]
    s_waitcnt lgkmcnt(14)
    v_mfma_f32_16x16x32_bf16 v[112:115], v[76:79], v[28:31], v[112:115]
    v_mfma_f32_16x16x32_bf16 v[148:151], v[76:79], v[32:35], v[148:151]
    s_waitcnt lgkmcnt(12)
    v_mfma_f32_16x16x32_bf16 v[116:119], v[80:83], v[28:31], v[116:119]
    v_mfma_f32_16x16x32_bf16 v[152:155], v[80:83], v[32:35], v[152:155]
    s_waitcnt lgkmcnt(10)
    v_mfma_f32_16x16x32_bf16 v[120:123], v[84:87], v[28:31], v[120:123]
    v_mfma_f32_16x16x32_bf16 v[156:159], v[84:87], v[32:35], v[156:159]
    s_waitcnt lgkmcnt(8)
    v_mfma_f32_16x16x32_bf16 v[124:127], v[88:91], v[28:31], v[124:127]
    v_mfma_f32_16x16x32_bf16 v[160:163], v[88:91], v[32:35], v[160:163]
    s_waitcnt lgkmcnt(6)
    v_mfma_f32_16x16x32_bf16 v[128:131], v[92:95], v[28:31], v[128:131]
    v_mfma_f32_16x16x32_bf16 v[164:167], v[92:95], v[32:35], v[164:167]
    s_waitcnt lgkmcnt(4)
    v_mfma_f32_16x16x32_bf16 v[132:135], v[96:99], v[28:31], v[132:135]
    v_mfma_f32_16x16x32_bf16 v[168:171], v[96:99], v[32:35], v[168:171]
    s_waitcnt lgkmcnt(2)
    v_mfma_f32_16x16x32_bf16 v[136:139], v[100:103], v[28:31], v[136:139]
    v_mfma_f32_16x16x32_bf16 v[172:175], v[100:103], v[32:35], v[172:175]
    s_waitcnt lgkmcnt(0)
    v_mfma_f32_16x16x32_bf16 v[140:143], v[104:107], v[28:31], v[140:143]
    v_mfma_f32_16x16x32_bf16 v[176:179], v[104:107], v[32:35], v[176:179]
    s_branch K2_EPI
K2_S0:
    s_lshl_b32 s9, s8, 12
    s_add_u32 m0, s9, 0
    s_nop 0
    global_load_lds_dwordx4 v2, s[4:5]
    s_lshl_b32 s9, s8, 12
    s_add_u32 m0, s9, 1024
    s_nop 0
    global_load_lds_dwordx4 v3, s[4:5]
    s_lshl_b32 s9, s8, 12
    s_add_u32 m0, s9, 2048
    s_nop 0
    global_load_lds_dwordx4 v4, s[4:5]
    s_lshl_b32 s9, s8, 12
    s_add_u32 m0, s9, 3072
    s_nop 0
    global_load_lds_dwordx4 v5, s[4:5]
    s_mul_i32 s9, s8, 4608
    s_add_u32 m0, s9, 16384
    s_nop 0
    global_load_lds_dwordx4 v6, s[6:7]
    s_mul_i32 s9, s8, 4608
    s_add_u32 m0, s9, 17408
    s_nop 0
    global_load_lds_dwordx4 v7, s[6:7]
    s_mul_i32 s9, s8, 4608
    s_add_u32 m0, s9, 18432
    s_nop 0
    global_load_lds_dwordx4 v8, s[6:7]
    s_mul_i32 s9, s8, 4608
    s_add_u32 m0, s9, 19456
    s_nop 0
    global_load_lds_dwordx4 v9, s[6:7]
    s_mul_i32 s9, s8, 4608
    s_add_u32 m0, s9, 20480
    s_mov_b32 exec_hi, 0
    global_load_lds_dwordx4 v10, s[6:7]
    s_mov_b64 exec, -1
    s_add_u32 s4, s4, 128
    s_addc_u32 s5, s5, 0
    s_add_u32 s6, s6, s18
    s_addc_u32 s7, s7, 0
    s_lshl_b32 s9, s8, 12
    s_add_u32 m0, s9, 34816
    s_nop 0
    global_load_lds_dwordx4 v2, s[4:5]
    s_lshl_b32 s9, s8, 12
    s_add_u32 m0, s9, 35840
    s_nop 0
    global_load_lds_dwordx4 v3, s[4:5]
    s_lshl_b32 s9, s8, 12
    s_add_u32 m0, s9, 36864
    s_nop 0
    global_load_lds_dwordx4 v4, s[4:5]
    s_lshl_b32 s9, s8, 12
    s_add_u32 m0, s9, 37888
    s_nop 0
    global_load_lds_dwordx4 v5, s[4:5]
    s_mul_i32 s9, s8, 4608
    s_add_u32 m0, s9, 51200
    s_nop 0
    global_load_lds_dwordx4 v6, s[6:7]
    s_mul_i32 s9, s8, 4608
    s_add_u32 m0, s9, 52224
    s_nop 0
    global_load_lds_dwordx4 v7, s[6:7]
    s_mul_i32 s9, s8, 4608
    s_add_u32 m0, s9, 53248
    s_nop 0
    global_load_lds_dwordx4 v8, s[6:7]
    s_mul_i32 s9, s8, 4608
    s_add_u32 m0, s9, 54272
    s_nop 0
    global_load_lds_dwordx4 v9, s[6:7]
    s_mul_i32 s9, s8, 4608
    s_add_u32 m0, s9, 55296
    s_mov_b32 exec_hi, 0
    global_load_lds_dwordx4 v10, s[6:7]
    s_mov_b64 exec, -1
    s_add_u32 s4, s4, 128
    s_addc_u32 s5, s5, 0
    s_add_u32 s6, s6, s18
    s_addc_u32 s7, s7, 0
    s_lshl_b32 s9, s8, 12
    s_add_u32 m0, s9, 69632
    s_nop 0
    global_load_lds_dwordx4 v2, s[4:5]
    s_lshl_b32 s9, s8, 12
    s_add_u32 m0, s9, 70656
    s_nop 0
    global_load_lds_dwordx4 v3, s[4:5]
    s_lshl_b32 s9, s8, 12
    s_add_u32 m0, s9, 71680
    s_nop 0
    global_load_lds_dwordx4 v4, s[4:5]
    s_lshl_b32 s9, s8, 12
    s_add_u32 m0, s9, 72704
    s_nop 0
    global_load_lds_dwordx4 v5, s[4:5]
    s_mul_i32 s9, s8, 4608
    s_add_u32 m0, s9, 86016
    s_nop 0
    global_load_lds_dwordx4 v6, s[6:7]
    s_mul_i32 s9, s8, 4608
    s_add_u32 m0, s9, 87040
    s_nop 0
    global_load_lds_dwordx4 v7, s[6:7]
    s_mul_i32 s9, s8, 4608
    s_add_u32 m0, s9, 88064
    s_nop 0
    global_load_lds_dwordx4 v8, s[6:7]
    s_mul_i32 s9, s8, 4608
    s_add_u32 m0, s9, 89088
    s_nop 0
    global_load_lds_dwordx4 v9, s[6:7]
    s_mul_i32 s9, s8, 4608
    s_add_u32 m0, s9, 90112
    s_mov_b32 exec_hi, 0
    global_load_lds_dwordx4 v10, s[6:7]
    s_mov_b64 exec, -1
    s_add_u32 s4, s4, 128
    s_addc_u32 s5, s5, 0
    s_add_u32 s6, s6, s18
    s_addc_u32 s7, s7, 0
    s_lshl_b32 s9, s8, 12
    s_add_u32 m0, s9, 104448
    s_nop 0
    global_load_lds_dwordx4 v2, s[4:5]
    s_lshl_b32 s9, s8, 12
    s_add_u32 m0, s9, 105472
    s_nop 0
    global_load_lds_dwordx4 v3, s[4:5]
    s_lshl_b32 s9, s8, 12
    s_add_u32 m0, s9, 106496
    s_nop 0
    global_load_lds_dwordx4 v4, s[4:5]
    s_lshl_b32 s9, s8, 12
    s_add_u32 m0, s9, 107520
    s_nop 0
    global_load_lds_dwordx4 v5, s[4:5]
    s_mul_i32 s9, s8, 4608
    s_add_u32 m0, s9, 120832
    s_nop 0
    global_load_lds_dwordx4 v6, s[6:7]
    s_mul_i32 s9, s8, 4608
    s_add_u32 m0, s9, 121856
    s_nop 0
    global_load_lds_dwordx4 v7, s[6:7]
    s_mul_i32 s9, s8, 4608
    s_add_u32 m0, s9, 122880
    s_nop 0
    global_load_lds_dwordx4 v8, s[6:7]
    s_mul_i32 s9, s8, 4608
    s_add_u32 m0, s9, 123904
    s_nop 0
    global_load_lds_dwordx4 v9, s[6:7]
    s_mul_i32 s9, s8, 4608
    s_add_u32 m0, s9, 124928
    s_mov_b32 exec_hi, 0
    global_load_lds_dwordx4 v10, s[6:7]
    s_mov_b64 exec, -1
    s_waitcnt vmcnt(27)
    s_barrier
    ds_read_b64 v[20:21], v11 offset:0
    ds_read_b64 v[22:23], v12 offset:0
    ds_read_b64 v[24:25], v11 offset:2048
    ds_read_b64 v[26:27], v12 offset:2048
    ds_read_b64_tr_b16 v[36:37], v15 offset:0
    ds_read_b64_tr_b16 v[38:39], v15 offset:4608
    ds_read_b64_tr_b16 v[40:41], v15 offset:32
    ds_read_b64_tr_b16 v[42:43], v15 offset:4640
    ds_read_b64_tr_b16 v[44:45], v15 offset:64
    ds_read_b64_tr_b16 v[46:47], v15 offset:4672
    ds_read_b64_tr_b16 v[48:49], v15 offset:96
    ds_read_b64_tr_b16 v[50:51], v15 offset:4704
    ds_read_b64_tr_b16 v[52:53], v15 offset:128
    ds_read_b64_tr_b16 v[54:55], v15 offset:4736
    ds_read_b64_tr_b16 v[56:57], v15 offset:160
    ds_read_b64_tr_b16 v[58:59], v15 offset:4768
    ds_read_b64_tr_b16 v[60:61], v15 offset:192
    ds_read_b64_tr_b16 v[62:63], v15 offset:4800
    ds_read_b64_tr_b16 v[64:65], v15 offset:224
    ds_read_b64_tr_b16 v[66:67], v15 offset:4832
    ds_read_b64_tr_b16 v[68:69], v15 offset:256
    ds_read_b64_tr_b16 v[70:71], v15 offset:4864
    s_waitcnt lgkmcnt(15)
    v_mfma_f32_16x16x32_bf16 v[108:111], v[36:39], v[20:23], v[108:111]
    v_mfma_f32_16x16x32_bf16 v[144:147], v[36:39], v[24:27], v[144:147]
    ds_read_b64 v[28:29], v13 offset:0
    ds_read_b64 v[30:31], v14 offset:0
    ds_read_b64 v[32:33], v13 offset:2048
    s_waitcnt lgkmcnt(15)
    v_mfma_f32_16x16x32_bf16 v[112:115], v[40:43], v[20:23], v[112:115]
    v_mfma_f32_16x16x32_bf16 v[148:151], v[40:43], v[24:27], v[148:151]
    ds_read_b64 v[34:35], v14 offset:2048
    ds_read_b64_tr_b16 v[72:73], v15 offset:9216
    ds_read_b64_tr_b16 v[74:75], v15 offset:13824
    v_mfma_f32_16x16x32_bf16 v[116:119], v[44:47], v[20:23], v[116:119]
    v_mfma_f32_16x16x32_bf16 v[152:155], v[44:47], v[24:27], v[152:155]
    ds_read_b64_tr_b16 v[76:77], v15 offset:9248
    ds_read_b64_tr_b16 v[78:79], v15 offset:13856
    ds_read_b64_tr_b16 v[80:81], v15 offset:9280
    s_waitcnt lgkmcnt(15)
    v_mfma_f32_16x16x32_bf16 v[120:123], v[48:51], v[20:23], v[120:123]
    v_mfma_f32_16x16x32_bf16 v[156:159], v[48:51], v[24:27], v[156:159]
    ds_read_b64_tr_b16 v[82:83], v15 offset:13888
    ds_read_b64_tr_b16 v[84:85], v15 offset:9312
    ds_read_b64_tr_b16 v[86:87], v15 offset:13920
    v_mfma_f32_16x16x32_bf16 v[124:127], v[52:55], v[20:23], v[124:127]
    v_mfma_f32_16x16x32_bf16 v[160:163], v[52:55], v[24:27], v[160:163]
    ds_read_b64_tr_b16 v[88:89], v15 offset:9344
    ds_read_b64_tr_b16 v[90:91], v15 offset:13952
    ds_read_b64_tr_b16 v[92:93], v15 offset:9376
    v_mfma_f32_16x16x32_bf16 v[128:131], v[56:59], v[20:23], v[128:131]
    v_mfma_f32_16x16x32_bf16 v[164:167], v[56:59], v[24:27], v[164:167]
    ds_read_b64_tr_b16 v[94:95], v15 offset:13984
    ds_read_b64_tr_b16 v[96:97], v15 offset:9408
    ds_read_b64_tr_b16 v[98:99], v15 offset:14016
    s_waitcnt lgkmcnt(15)
    v_mfma_f32_16x16x32_bf16 v[132:135], v[60:63], v[20:23], v[132:135]
    v_mfma_f32_16x16x32_bf16 v[168:171], v[60:63], v[24:27], v[168:171]
    ds_read_b64_tr_b16 v[100:101], v15 offset:9440
    ds_read_b64_tr_b16 v[102:103], v15 offset:14048
    ds_read_b64_tr_b16 v[104:105], v15 offset:9472
    v_mfma_f32_16x16x32_bf16 v[136:139], v[64:67], v[20:23], v[136:139]
    v_mfma_f32_16x16x32_bf16 v[172:175], v[64:67], v[24:27], v[172:175]
    ds_read_b64_tr_b16 v[106:107], v15 offset:14080
    v_mfma_f32_16x16x32_bf16 v[140:143], v[68:71], v[20:23], v[140:143]
    v_mfma_f32_16x16x32_bf16 v[176:179], v[68:71], v[24:27], v[176:179]
    s_waitcnt lgkmcnt(0)
    s_waitcnt vmcnt(18)
    s_barrier
    s_add_u32 s4, s4, 128
    s_addc_u32 s5, s5, 0
    s_add_u32 s6, s6, s18
    s_addc_u32 s7, s7, 0
    s_lshl_b32 s9, s8, 12
    s_add_u32 m0, s9, 0
    s_nop 0
    global_load_lds_dwordx4 v2, s[4:5]
    s_lshl_b32 s9, s8, 12
    s_add_u32 m0, s9, 1024
    s_nop 0
    global_load_lds_dwordx4 v3, s[4:5]
    s_lshl_b32 s9, s8, 12
    s_add_u32 m0, s9, 2048
    s_nop 0
    global_load_lds_dwordx4 v4, s[4:5]
    s_lshl_b32 s9, s8, 12
    s_add_u32 m0, s9, 3072
    s_nop 0
    global_load_lds_dwordx4 v5, s[4:5]
    s_mul_i32 s9, s8, 4608
    s_add_u32 m0, s9, 16384
    s_nop 0
    global_load_lds_dwordx4 v6, s[6:7]
    s_mul_i32 s9, s8, 4608
    s_add_u32 m0, s9, 17408
    s_nop 0
    global_load_lds_dwordx4 v7, s[6:7]
    s_mul_i32 s9, s8, 4608
    s_add_u32 m0, s9, 18432
    s_nop 0
    global_load_lds_dwordx4 v8, s[6:7]
    s_mul_i32 s9, s8, 4608
    s_add_u32 m0, s9, 19456
    s_nop 0
    global_load_lds_dwordx4 v9, s[6:7]
    s_mul_i32 s9, s8, 4608
    s_add_u32 m0, s9, 20480
    s_mov_b32 exec_hi, 0
    global_load_lds_dwordx4 v10, s[6:7]
    s_mov_b64 exec, -1
    v_mfma_f32_16x16x32_bf16 v[108:111], v[72:75], v[28:31], v[108:111]
    v_mfma_f32_16x16x32_bf16 v[144:147], v[72:75], v[32:35], v[144:147]
    ds_read_b64 v[20:21], v11 offset:34816
    ds_read_b64 v[22:23], v12 offset:34816
    ds_read_b64 v[24:25], v11 offset:36864
    v_mfma_f32_16x16x32_bf16 v[112:115], v[76:79], v[28:31], v[112:115]
    v_mfma_f32_16x16x32_bf16 v[148:151], v[76:79], v[32:35], v[148:151]
    ds_read_b64 v[26:27], v12 offset:36864
    ds_read_b64_tr_b16 v[36:37], v15 offset:34816
    ds_read_b64_tr_b16 v[38:39], v15 offset:39424
    v_mfma_f32_16x16x32_bf16 v[116:119], v[80:83], v[28:31], v[116:119]
    v_mfma_f32_16x16x32_bf16 v[152:155], v[80:83], v[32:35], v[152:155]
    ds_read_b64_tr_b16 v[40:41], v15 offset:34848
    ds_read_b64_tr_b16 v[42:43], v15 offset:39456
    ds_read_b64_tr_b16 v[44:45], v15 offset:34880
    v_mfma_f32_16x16x32_bf16 v[120:123], v[84:87], v[28:31], v[120:123]
    v_mfma_f32_16x16x32_bf16 v[156:159], v[84:87], v[32:35], v[156:159]
    ds_read_b64_tr_b16 v[46:47], v15 offset:39488
    ds_read_b64_tr_b16 v[48:49], v15 offset:34912
    ds_read_b64_tr_b16 v[50:51], v15 offset:39520
    v_mfma_f32_16x16x32_bf16 v[124:127], v[88:91], v[28:31], v[124:127]
    v_mfma_f32_16x16x32_bf16 v[160:163], v[88:91], v[32:35], v[160:163]
    ds_read_b64_tr_b16 v[52:53], v15 offset:34944
    ds_read_b64_tr_b16 v[54:55], v15 offset:39552
    ds_read_b64_tr_b16 v[56:57], v15 offset:34976
    v_mfma_f32_16x16x32_bf16 v[128:131], v[92:95], v[28:31], v[128:131]
    v_mfma_f32_16x16x32_bf16 v[164:167], v[92:95], v[32:35], v[164:167]
    ds_read_b64_tr_b16 v[58:59], v15 offset:39584
    ds_read_b64_tr_b16 v[60:61], v15 offset:35008
    ds_read_b64_tr_b16 v[62:63], v15 offset:39616
    v_mfma_f32_16x16x32_bf16 v[132:135], v[96:99], v[28:31], v[132:135]
    v_mfma_f32_16x16x32_bf16 v[168:171], v[96:99], v[32:35], v[168:171]
    ds_read_b64_tr_b16 v[64:65], v15 offset:35040
    ds_read_b64_tr_b16 v[66:67], v15 offset:39648
    ds_read_b64_tr_b16 v[68:69], v15 offset:35072
    v_mfma_f32_16x16x32_bf16 v[136:139], v[100:103], v[28:31], v[136:139]
    v_mfma_f32_16x16x32_bf16 v[172:175], v[100:103], v[32:35], v[172:175]
    ds_read_b64_tr_b16 v[70:71], v15 offset:39680
    v_mfma_f32_16x16x32_bf16 v[140:143], v[104:107], v[28:31], v[140:143]
    v_mfma_f32_16x16x32_bf16 v[176:179], v[104:107], v[32:35], v[176:179]
    s_waitcnt lgkmcnt(15)
    v_mfma_f32_16x16x32_bf16 v[108:111], v[36:39], v[20:23], v[108:111]
    v_mfma_f32_16x16x32_bf16 v[144:147], v[36:39], v[24:27], v[144:147]
    ds_read_b64 v[28:29], v13 offset:34816
    ds_read_b64 v[30:31], v14 offset:34816
    ds_read_b64 v[32:33], v13 offset:36864
    s_waitcnt lgkmcnt(15)
    v_mfma_f32_16x16x32_bf16 v[112:115], v[40:43], v[20:23], v[112:115]
    v_mfma_f32_16x16x32_bf16 v[148:151], v[40:43], v[24:27], v[148:151]
    ds_read_b64 v[34:35], v14 offset:36864
    ds_read_b64_tr_b16 v[72:73], v15 offset:44032
    ds_read_b64_tr_b16 v[74:75], v15 offset:48640
    v_mfma_f32_16x16x32_bf16 v[116:119], v[44:47], v[20:23], v[116:119]
    v_mfma_f32_16x16x32_bf16 v[152:155], v[44:47], v[24:27], v[152:155]
    ds_read_b64_tr_b16 v[76:77], v15 offset:44064
    ds_read_b64_tr_b16 v[78:79], v15 offset:48672
    ds_read_b64_tr_b16 v[80:81], v15 offset:44096
    s_waitcnt lgkmcnt(15)
    v_mfma_f32_16x16x32_bf16 v[120:123], v[48:51], v[20:23], v[120:123]
    v_mfma_f32_16x16x32_bf16 v[156:159], v[48:51], v[24:27], v[156:159]
    ds_read_b64_tr_b16 v[82:83], v15 offset:48704
    ds_read_b64_tr_b16 v[84:85], v15 offset:44128
    ds_read_b64_tr_b16 v[86:87], v15 offset:48736
    v_mfma_f32_16x16x32_bf16 v[124:127], v[52:55], v[20:23], v[124:127]
    v_mfma_f32_16x16x32_bf16 v[160:163], v[52:55], v[24:27], v[160:163]
    ds_read_b64_tr_b16 v[88:89], v15 offset:44160
    ds_read_b64_tr_b16 v[90:91], v15 offset:48768
    ds_read_b64_tr_b16 v[92:93], v15 offset:44192
    v_mfma_f32_16x16x32_bf16 v[128:131], v[56:59], v[20:23], v[128:131]
    v_mfma_f32_16x16x32_bf16 v[164:167], v[56:59], v[24:27], v[164:167]
    ds_read_b64_tr_b16 v[94:95], v15 offset:48800
    ds_read_b64_tr_b16 v[96:97], v15 offset:44224
    ds_read_b64_tr_b16 v[98:99], v15 offset:48832
    s_waitcnt lgkmcnt(15)
    v_mfma_f32_16x16x32_bf16 v[132:135], v[60:63], v[20:23], v[132:135]
    v_mfma_f32_16x16x32_bf16 v[168:171], v[60:63], v[24:27], v[168:171]
    ds_read_b64_tr_b16 v[100:101], v15 offset:44256
    ds_read_b64_tr_b16 v[102:103], v15 offset:48864
    ds_read_b64_tr_b16 v[104:105], v15 offset:44288
    v_mfma_f32_16x16x32_bf16 v[136:139], v[64:67], v[20:23], v[136:139]
    v_mfma_f32_16x16x32_bf16 v[172:175], v[64:67], v[24:27], v[172:175]
    ds_read_b64_tr_b16 v[106:107], v15 offset:48896
    v_mfma_f32_16x16x32_bf16 v[140:143], v[68:71], v[20:23], v[140:143]
    v_mfma_f32_16x16x32_bf16 v[176:179], v[68:71], v[24:27], v[176:179]
    s_waitcnt lgkmcnt(0)
    s_waitcnt vmcnt(18)
    s_barrier
    s_add_u32 s4, s4, 128
    s_addc_u32 s5, s5, 0
    s_add_u32 s6, s6, s18
    s_addc_u32 s7, s7, 0
    s_lshl_b32 s9, s8, 12
    s_add_u32 m0, s9, 34816
    s_nop 0
    global_load_lds_dwordx4 v2, s[4:5]
    s_lshl_b32 s9, s8, 12
    s_add_u32 m0, s9, 35840
    s_nop 0
    global_load_lds_dwordx4 v3, s[4:5]
    s_lshl_b32 s9, s8, 12
    s_add_u32 m0, s9, 36864
    s_nop 0
    global_load_lds_dwordx4 v4, s[4:5]
    s_lshl_b32 s9, s8, 12
    s_add_u32 m0, s9, 37888
    s_nop 0
    global_load_lds_dwordx4 v5, s[4:5]
    s_mul_i32 s9, s8, 4608
    s_add_u32 m0, s9, 51200
    s_nop 0
    global_load_lds_dwordx4 v6, s[6:7]
    s_mul_i32 s9, s8, 4608
    s_add_u32 m0, s9, 52224
    s_nop 0
    global_load_lds_dwordx4 v7, s[6:7]
    s_mul_i32 s9, s8, 4608
    s_add_u32 m0, s9, 53248
    s_nop 0
    global_load_lds_dwordx4 v8, s[6:7]
    s_mul_i32 s9, s8, 4608
    s_add_u32 m0, s9, 54272
    s_nop 0
    global_load_lds_dwordx4 v9, s[6:7]
    s_mul_i32 s9, s8, 4608
    s_add_u32 m0, s9, 55296
    s_mov_b32 exec_hi, 0
    global_load_lds_dwordx4 v10, s[6:7]
    s_mov_b64 exec, -1
    v_mfma_f32_16x16x32_bf16 v[108:111], v[72:75], v[28:31], v[108:111]
    v_mfma_f32_16x16x32_bf16 v[144:147], v[72:75], v[32:35], v[144:147]
    ds_read_b64 v[20:21], v200 offset:0
    ds_read_b64 v[22:23], v201 offset:0
    ds_read_b64 v[24:25], v200 offset:2048
    v_mfma_f32_16x16x32_bf16 v[112:115], v[76:79], v[28:31], v[112:115]
    v_mfma_f32_16x16x32_bf16 v[148:151], v[76:79], v[32:35], v[148:151]
    ds_read_b64 v[26:27], v201 offset:2048
    ds_read_b64_tr_b16 v[36:37], v204 offset:0
    ds_read_b64_tr_b16 v[38:39], v204 offset:4608
    v_mfma_f32_16x16x32_bf16 v[116:119], v[80:83], v[28:31], v[116:119]
    v_mfma_f32_16x16x32_bf16 v[152:155], v[80:83], v[32:35], v[152:155]
    ds_read_b64_tr_b16 v[40:41], v204 offset:32
    ds_read_b64_tr_b16 v[42:43], v204 offset:4640
    ds_read_b64_tr_b16 v[44:45], v204 offset:64
    v_mfma_f32_16x16x32_bf16 v[120:123], v[84:87], v[28:31], v[120:123]
    v_mfma_f32_16x16x32_bf16 v[156:159], v[84:87], v[32:35], v[156:159]
    ds_read_b64_tr_b16 v[46:47], v204 offset:4672
    ds_read_b64_tr_b16 v[48:49], v204 offset:96
    ds_read_b64_tr_b16 v[50:51], v204 offset:4704
    v_mfma_f32_16x16x32_bf16 v[124:127], v[88:91], v[28:31], v[124:127]
    v_mfma_f32_16x16x32_bf16 v[160:163], v[88:91], v[32:35], v[160:163]
    ds_read_b64_tr_b16 v[52:53], v204 offset:128
    ds_read_b64_tr_b16 v[54:55], v204 offset:4736
    ds_read_b64_tr_b16 v[56:57], v204 offset:160
    v_mfma_f32_16x16x32_bf16 v[128:131], v[92:95], v[28:31], v[128:131]
    v_mfma_f32_16x16x32_bf16 v[164:167], v[92:95], v[32:35], v[164:167]
    ds_read_b64_tr_b16 v[58:59], v204 offset:4768
    ds_read_b64_tr_b16 v[60:61], v204 offset:192
    ds_read_b64_tr_b16 v[62:63], v204 offset:4800
    v_mfma_f32_16x16x32_bf16 v[132:135], v[96:99], v[28:31], v[132:135]
    v_mfma_f32_16x16x32_bf16 v[168:171], v[96:99], v[32:35], v[168:171]
    ds_read_b64_tr_b16 v[64:65], v204 offset:224
    ds_read_b64_tr_b16 v[66:67], v204 offset:4832
    ds_read_b64_tr_b16 v[68:69], v204 offset:256
    v_mfma_f32_16x16x32_bf16 v[136:139], v[100:103], v[28:31], v[136:139]
    v_mfma_f32_16x16x32_bf16 v[172:175], v[100:103], v[32:35], v[172:175]
    ds_read_b64_tr_b16 v[70:71], v204 offset:4864
    v_mfma_f32_16x16x32_bf16 v[140:143], v[104:107], v[28:31], v[140:143]
    v_mfma_f32_16x16x32_bf16 v[176:179], v[104:107], v[32:35], v[176:179]
    s_waitcnt lgkmcnt(15)
    v_mfma_f32_16x16x32_bf16 v[108:111], v[36:39], v[20:23], v[108:111]
    v_mfma_f32_16x16x32_bf16 v[144:147], v[36:39], v[24:27], v[144:147]
    ds_read_b64 v[28:29], v202 offset:0
    ds_read_b64 v[30:31], v203 offset:0
    ds_read_b64 v[32:33], v202 offset:2048
    s_waitcnt lgkmcnt(15)
    v_mfma_f32_16x16x32_bf16 v[112:115], v[40:43], v[20:23], v[112:115]
    v_mfma_f32_16x16x32_bf16 v[148:151], v[40:43], v[24:27], v[148:151]
    ds_read_b64 v[34:35], v203 offset:2048
    ds_read_b64_tr_b16 v[72:73], v204 offset:9216
    ds_read_b64_tr_b16 v[74:75], v204 offset:13824
    v_mfma_f32_16x16x32_bf16 v[116:119], v[44:47], v[20:23], v[116:119]
    v_mfma_f32_16x16x32_bf16 v[152:155], v[44:47], v[24:27], v[152:155]
    ds_read_b64_tr_b16 v[76:77], v204 offset:9248
    ds_read_b64_tr_b16 v[78:79], v204 offset:13856
    ds_read_b64_tr_b16 v[80:81], v204 offset:9280
    s_waitcnt lgkmcnt(15)
    v_mfma_f32_16x16x32_bf16 v[120:123], v[48:51], v[20:23], v[120:123]
    v_mfma_f32_16x16x32_bf16 v[156:159], v[48:51], v[24:27], v[156:159]
    ds_read_b64_tr_b16 v[82:83], v204 offset:13888
    ds_read_b64_tr_b16 v[84:85], v204 offset:9312
    ds_read_b64_tr_b16 v[86:87], v204 offset:13920
    v_mfma_f32_16x16x32_bf16 v[124:127], v[52:55], v[20:23], v[124:127]
    v_mfma_f32_16x16x32_bf16 v[160:163], v[52:55], v[24:27], v[160:163]
    ds_read_b64_tr_b16 v[88:89], v204 offset:9344
    ds_read_b64_tr_b16 v[90:91], v204 offset:13952
    ds_read_b64_tr_b16 v[92:93], v204 offset:9376
    v_mfma_f32_16x16x32_bf16 v[128:131], v[56:59], v[20:23], v[128:131]
    v_mfma_f32_16x16x32_bf16 v[164:167], v[56:59], v[24:27], v[164:167]
    ds_read_b64_tr_b16 v[94:95], v204 offset:13984
    ds_read_b64_tr_b16 v[96:97], v204 offset:9408
    ds_read_b64_tr_b16 v[98:99], v204 offset:14016
    s_waitcnt lgkmcnt(15)
    v_mfma_f32_16x16x32_bf16 v[132:135], v[60:63], v[20:23], v[132:135]
    v_mfma_f32_16x16x32_bf16 v[168:171], v[60:63], v[24:27], v[168:171]
    ds_read_b64_tr_b16 v[100:101], v204 offset:9440
    ds_read_b64_tr_b16 v[102:103], v204 offset:14048
    ds_read_b64_tr_b16 v[104:105], v204 offset:9472
    v_mfma_f32_16x16x32_bf16 v[136:139], v[64:67], v[20:23], v[136:139]
    v_mfma_f32_16x16x32_bf16 v[172:175], v[64:67], v[24:27], v[172:175]
    ds_read_b64_tr_b16 v[106:107], v204 offset:14080
    v_mfma_f32_16x16x32_bf16 v[140:143], v[68:71], v[20:23], v[140:143]
    v_mfma_f32_16x16x32_bf16 v[176:179], v[68:71], v[24:27], v[176:179]
    s_waitcnt lgkmcnt(0)
    s_waitcnt vmcnt(18)
    s_barrier
    s_add_u32 s4, s4, 128
    s_addc_u32 s5, s5, 0
    s_add_u32 s6, s6, s18
    s_addc_u32 s7, s7, 0
    s_lshl_b32 s9, s8, 12
    s_add_u32 m0, s9, 69632
    s_nop 0
    global_load_lds_dwordx4 v2, s[4:5]
    s_lshl_b32 s9, s8, 12
    s_add_u32 m0, s9, 70656
    s_nop 0
    global_load_lds_dwordx4 v3, s[4:5]
    s_lshl_b32 s9, s8, 12
    s_add_u32 m0, s9, 71680
    s_nop 0
    global_load_lds_dwordx4 v4, s[4:5]
    s_lshl_b32 s9, s8, 12
    s_add_u32 m0, s9, 72704
    s_nop 0
    global_load_lds_dwordx4 v5, s[4:5]
    s_mul_i32 s9, s8, 4608
    s_add_u32 m0, s9, 86016
    s_nop 0
    global_load_lds_dwordx4 v6, s[6:7]
    s_mul_i32 s9, s8, 4608
    s_add_u32 m0, s9, 87040
    s_nop 0
    global_load_lds_dwordx4 v7, s[6:7]
    s_mul_i32 s9, s8, 4608
    s_add_u32 m0, s9, 88064
    s_nop 0
    global_load_lds_dwordx4 v8, s[6:7]
    s_mul_i32 s9, s8, 4608
    s_add_u32 m0, s9, 89088
    s_nop 0
    global_load_lds_dwordx4 v9, s[6:7]
    s_mul_i32 s9, s8, 4608
    s_add_u32 m0, s9, 90112
    s_mov_b32 exec_hi, 0
    global_load_lds_dwordx4 v10, s[6:7]
    s_mov_b64 exec, -1
    v_mfma_f32_16x16x32_bf16 v[108:111], v[72:75], v[28:31], v[108:111]
    v_mfma_f32_16x16x32_bf16 v[144:147], v[72:75], v[32:35], v[144:147]
    ds_read_b64 v[20:21], v200 offset:34816
    ds_read_b64 v[22:23], v201 offset:34816
    ds_read_b64 v[24:25], v200 offset:36864
    v_mfma_f32_16x16x32_bf16 v[112:115], v[76:79], v[28:31], v[112:115]
    v_mfma_f32_16x16x32_bf16 v[148:151], v[76:79], v[32:35], v[148:151]
    ds_read_b64 v[26:27], v201 offset:36864
    ds_read_b64_tr_b16 v[36:37], v204 offset:34816
    ds_read_b64_tr_b16 v[38:39], v204 offset:39424
    v_mfma_f32_16x16x32_bf16 v[116:119], v[80:83], v[28:31], v[116:119]
    v_mfma_f32_16x16x32_bf16 v[152:155], v[80:83], v[32:35], v[152:155]
    ds_read_b64_tr_b16 v[40:41], v204 offset:34848
    ds_read_b64_tr_b16 v[42:43], v204 offset:39456
    ds_read_b64_tr_b16 v[44:45], v204 offset:34880
    v_mfma_f32_16x16x32_bf16 v[120:123], v[84:87], v[28:31], v[120:123]
    v_mfma_f32_16x16x32_bf16 v[156:159], v[84:87], v[32:35], v[156:159]
    ds_read_b64_tr_b16 v[46:47], v204 offset:39488
    ds_read_b64_tr_b16 v[48:49], v204 offset:34912
    ds_read_b64_tr_b16 v[50:51], v204 offset:39520
    v_mfma_f32_16x16x32_bf16 v[124:127], v[88:91], v[28:31], v[124:127]
    v_mfma_f32_16x16x32_bf16 v[160:163], v[88:91], v[32:35], v[160:163]
    ds_read_b64_tr_b16 v[52:53], v204 offset:34944
    ds_read_b64_tr_b16 v[54:55], v204 offset:39552
    ds_read_b64_tr_b16 v[56:57], v204 offset:34976
    v_mfma_f32_16x16x32_bf16 v[128:131], v[92:95], v[28:31], v[128:131]
    v_mfma_f32_16x16x32_bf16 v[164:167], v[92:95], v[32:35], v[164:167]
    ds_read_b64_tr_b16 v[58:59], v204 offset:39584
    ds_read_b64_tr_b16 v[60:61], v204 offset:35008
    ds_read_b64_tr_b16 v[62:63], v204 offset:39616
    v_mfma_f32_16x16x32_bf16 v[132:135], v[96:99], v[28:31], v[132:135]
    v_mfma_f32_16x16x32_bf16 v[168:171], v[96:99], v[32:35], v[168:171]
    ds_read_b64_tr_b16 v[64:65], v204 offset:35040
    ds_read_b64_tr_b16 v[66:67], v204 offset:39648
    ds_read_b64_tr_b16 v[68:69], v204 offset:35072
    v_mfma_f32_16x16x32_bf16 v[136:139], v[100:103], v[28:31], v[136:139]
    v_mfma_f32_16x16x32_bf16 v[172:175], v[100:103], v[32:35], v[172:175]
    ds_read_b64_tr_b16 v[70:71], v204 offset:39680
    v_mfma_f32_16x16x32_bf16 v[140:143], v[104:107], v[28:31], v[140:143]
    v_mfma_f32_16x16x32_bf16 v[176:179], v[104:107], v[32:35], v[176:179]
    s_waitcnt lgkmcnt(15)
    v_mfma_f32_16x16x32_bf16 v[108:111], v[36:39], v[20:23], v[108:111]
    v_mfma_f32_16x16x32_bf16 v[144:147], v[36:39], v[24:27], v[144:147]
    ds_read_b64 v[28:29], v202 offset:34816
    ds_read_b64 v[30:31], v203 offset:34816
    ds_read_b64 v[32:33], v202 offset:36864
    s_waitcnt lgkmcnt(15)
    v_mfma_f32_16x16x32_bf16 v[112:115], v[40:43], v[20:23], v[112:115]
    v_mfma_f32_16x16x32_bf16 v[148:151], v[40:43], v[24:27], v[148:151]
    ds_read_b64 v[34:35], v203 offset:36864
    ds_read_b64_tr_b16 v[72:73], v204 offset:44032
    ds_read_b64_tr_b16 v[74:75], v204 offset:48640
    v_mfma_f32_16x16x32_bf16 v[116:119], v[44:47], v[20:23], v[116:119]
    v_mfma_f32_16x16x32_bf16 v[152:155], v[44:47], v[24:27], v[152:155]
    ds_read_b64_tr_b16 v[76:77], v204 offset:44064
    ds_read_b64_tr_b16 v[78:79], v204 offset:48672
    ds_read_b64_tr_b16 v[80:81], v204 offset:44096
    s_waitcnt lgkmcnt(15)
    v_mfma_f32_16x16x32_bf16 v[120:123], v[48:51], v[20:23], v[120:123]
    v_mfma_f32_16x16x32_bf16 v[156:159], v[48:51], v[24:27], v[156:159]
    ds_read_b64_tr_b16 v[82:83], v204 offset:48704
    ds_read_b64_tr_b16 v[84:85], v204 offset:44128
    ds_read_b64_tr_b16 v[86:87], v204 offset:48736
    v_mfma_f32_16x16x32_bf16 v[124:127], v[52:55], v[20:23], v[124:127]
    v_mfma_f32_16x16x32_bf16 v[160:163], v[52:55], v[24:27], v[160:163]
    ds_read_b64_tr_b16 v[88:89], v204 offset:44160
    ds_read_b64_tr_b16 v[90:91], v204 offset:48768
    ds_read_b64_tr_b16 v[92:93], v204 offset:44192
    v_mfma_f32_16x16x32_bf16 v[128:131], v[56:59], v[20:23], v[128:131]
    v_mfma_f32_16x16x32_bf16 v[164:167], v[56:59], v[24:27], v[164:167]
    ds_read_b64_tr_b16 v[94:95], v204 offset:48800
    ds_read_b64_tr_b16 v[96:97], v204 offset:44224
    ds_read_b64_tr_b16 v[98:99], v204 offset:48832
    s_waitcnt lgkmcnt(15)
    v_mfma_f32_16x16x32_bf16 v[132:135], v[60:63], v[20:23], v[132:135]
    v_mfma_f32_16x16x32_bf16 v[168:171], v[60:63], v[24:27], v[168:171]
    ds_read_b64_tr_b16 v[100:101], v204 offset:44256
    ds_read_b64_tr_b16 v[102:103], v204 offset:48864
    ds_read_b64_tr_b16 v[104:105], v204 offset:44288
    v_mfma_f32_16x16x32_bf16 v[136:139], v[64:67], v[20:23], v[136:139]
    v_mfma_f32_16x16x32_bf16 v[172:175], v[64:67], v[24:27], v[172:175]
    ds_read_b64_tr_b16 v[106:107], v204 offset:48896
    v_mfma_f32_16x16x32_bf16 v[140:143], v[68:71], v[20:23], v[140:143]
    v_mfma_f32_16x16x32_bf16 v[176:179], v[68:71], v[24:27], v[176:179]
    s_waitcnt lgkmcnt(0)
    s_waitcnt vmcnt(18)
    s_barrier
    s_add_u32 s4, s4, 128
    s_addc_u32 s5, s5, 0
    s_add_u32 s6, s6, s18
    s_addc_u32 s7, s7, 0
    s_lshl_b32 s9, s8, 12
    s_add_u32 m0, s9, 104448
    s_nop 0
    global_load_lds_dwordx4 v2, s[4:5]
    s_lshl_b32 s9, s8, 12
    s_add_u32 m0, s9, 105472
    s_nop 0
    global_load_lds_dwordx4 v3, s[4:5]
    s_lshl_b32 s9, s8, 12
    s_add_u32 m0, s9, 106496
    s_nop 0
    global_load_lds_dwordx4 v4, s[4:5]
    s_lshl_b32 s9, s8, 12
    s_add_u32 m0, s9, 107520
    s_nop 0
    global_load_lds_dwordx4 v5, s[4:5]
    s_mul_i32 s9, s8, 4608
    s_add_u32 m0, s9, 120832
    s_nop 0
    global_load_lds_dwordx4 v6, s[6:7]
    s_mul_i32 s9, s8, 4608
    s_add_u32 m0, s9, 121856
    s_nop 0
    global_load_lds_dwordx4 v7, s[6:7]
    s_mul_i32 s9, s8, 4608
    s_add_u32 m0, s9, 122880
    s_nop 0
    global_load_lds_dwordx4 v8, s[6:7]
    s_mul_i32 s9, s8, 4608
    s_add_u32 m0, s9, 123904
    s_nop 0
    global_load_lds_dwordx4 v9, s[6:7]
    s_mul_i32 s9, s8, 4608
    s_add_u32 m0, s9, 124928
    s_mov_b32 exec_hi, 0
    global_load_lds_dwordx4 v10, s[6:7]
    s_mov_b64 exec, -1
    v_mfma_f32_16x16x32_bf16 v[108:111], v[72:75], v[28:31], v[108:111]
    v_mfma_f32_16x16x32_bf16 v[144:147], v[72:75], v[32:35], v[144:147]
    ds_read_b64 v[20:21], v11 offset:0
    ds_read_b64 v[22:23], v12 offset:0
    ds_read_b64 v[24:25], v11 offset:2048
    v_mfma_f32_16x16x32_bf16 v[112:115], v[76:79], v[28:31], v[112:115]
    v_mfma_f32_16x16x32_bf16 v[148:151], v[76:79], v[32:35], v[148:151]
    ds_read_b64 v[26:27], v12 offset:2048
    ds_read_b64_tr_b16 v[36:37], v15 offset:0
    ds_read_b64_tr_b16 v[38:39], v15 offset:4608
    v_mfma_f32_16x16x32_bf16 v[116:119], v[80:83], v[28:31], v[116:119]
    v_mfma_f32_16x16x32_bf16 v[152:155], v[80:83], v[32:35], v[152:155]
    ds_read_b64_tr_b16 v[40:41], v15 offset:32
    ds_read_b64_tr_b16 v[42:43], v15 offset:4640
    ds_read_b64_tr_b16 v[44:45], v15 offset:64
    v_mfma_f32_16x16x32_bf16 v[120:123], v[84:87], v[28:31], v[120:123]
    v_mfma_f32_16x16x32_bf16 v[156:159], v[84:87], v[32:35], v[156:159]
    ds_read_b64_tr_b16 v[46:47], v15 offset:4672
    ds_read_b64_tr_b16 v[48:49], v15 offset:96
    ds_read_b64_tr_b16 v[50:51], v15 offset:4704
    v_mfma_f32_16x16x32_bf16 v[124:127], v[88:91], v[28:31], v[124:127]
    v_mfma_f32_16x16x32_bf16 v[160:163], v[88:91], v[32:35], v[160:163]
    ds_read_b64_tr_b16 v[52:53], v15 offset:128
    ds_read_b64_tr_b16 v[54:55], v15 offset:4736
    ds_read_b64_tr_b16 v[56:57], v15 offset:160
    v_mfma_f32_16x16x32_bf16 v[128:131], v[92:95], v[28:31], v[128:131]
    v_mfma_f32_16x16x32_bf16 v[164:167], v[92:95], v[32:35], v[164:167]
    ds_read_b64_tr_b16 v[58:59], v15 offset:4768
    ds_read_b64_tr_b16 v[60:61], v15 offset:192
    ds_read_b64_tr_b16 v[62:63], v15 offset:4800
    v_mfma_f32_16x16x32_bf16 v[132:135], v[96:99], v[28:31], v[132:135]
    v_mfma_f32_16x16x32_bf16 v[168:171], v[96:99], v[32:35], v[168:171]
    ds_read_b64_tr_b16 v[64:65], v15 offset:224
    ds_read_b64_tr_b16 v[66:67], v15 offset:4832
    ds_read_b64_tr_b16 v[68:69], v15 offset:256
    v_mfma_f32_16x16x32_bf16 v[136:139], v[100:103], v[28:31], v[136:139]
    v_mfma_f32_16x16x32_bf16 v[172:175], v[100:103], v[32:35], v[172:175]
    ds_read_b64_tr_b16 v[70:71], v15 offset:4864
    v_mfma_f32_16x16x32_bf16 v[140:143], v[104:107], v[28:31], v[140:143]
    v_mfma_f32_16x16x32_bf16 v[176:179], v[104:107], v[32:35], v[176:179]
    s_waitcnt lgkmcnt(15)
    v_mfma_f32_16x16x32_bf16 v[108:111], v[36:39], v[20:23], v[108:111]
    v_mfma_f32_16x16x32_bf16 v[144:147], v[36:39], v[24:27], v[144:147]
    ds_read_b64 v[28:29], v13 offset:0
    ds_read_b64 v[30:31], v14 offset:0
    ds_read_b64 v[32:33], v13 offset:2048
    s_waitcnt lgkmcnt(15)
    v_mfma_f32_16x16x32_bf16 v[112:115], v[40:43], v[20:23], v[112:115]
    v_mfma_f32_16x16x32_bf16 v[148:151], v[40:43], v[24:27], v[148:151]
    ds_read_b64 v[34:35], v14 offset:2048
    ds_read_b64_tr_b16 v[72:73], v15 offset:9216
    ds_read_b64_tr_b16 v[74:75], v15 offset:13824
    v_mfma_f32_16x16x32_bf16 v[116:119], v[44:47], v[20:23], v[116:119]
    v_mfma_f32_16x16x32_bf16 v[152:155], v[44:47], v[24:27], v[152:155]
    ds_read_b64_tr_b16 v[76:77], v15 offset:9248
    ds_read_b64_tr_b16 v[78:79], v15 offset:13856
    ds_read_b64_tr_b16 v[80:81], v15 offset:9280
    s_waitcnt lgkmcnt(15)
    v_mfma_f32_16x16x32_bf16 v[120:123], v[48:51], v[20:23], v[120:123]
    v_mfma_f32_16x16x32_bf16 v[156:159], v[48:51], v[24:27], v[156:159]
    ds_read_b64_tr_b16 v[82:83], v15 offset:13888
    ds_read_b64_tr_b16 v[84:85], v15 offset:9312
    ds_read_b64_tr_b16 v[86:87], v15 offset:13920
    v_mfma_f32_16x16x32_bf16 v[124:127], v[52:55], v[20:23], v[124:127]
    v_mfma_f32_16x16x32_bf16 v[160:163], v[52:55], v[24:27], v[160:163]
    ds_read_b64_tr_b16 v[88:89], v15 offset:9344
    ds_read_b64_tr_b16 v[90:91], v15 offset:13952
    ds_read_b64_tr_b16 v[92:93], v15 offset:9376
    v_mfma_f32_16x16x32_bf16 v[128:131], v[56:59], v[20:23], v[128:131]
    v_mfma_f32_16x16x32_bf16 v[164:167], v[56:59], v[24:27], v[164:167]
    ds_read_b64_tr_b16 v[94:95], v15 offset:13984
    ds_read_b64_tr_b16 v[96:97], v15 offset:9408
    ds_read_b64_tr_b16 v[98:99], v15 offset:14016
    s_waitcnt lgkmcnt(15)
    v_mfma_f32_16x16x32_bf16 v[132:135], v[60:63], v[20:23], v[132:135]
    v_mfma_f32_16x16x32_bf16 v[168:171], v[60:63], v[24:27], v[168:171]
    ds_read_b64_tr_b16 v[100:101], v15 offset:9440
    ds_read_b64_tr_b16 v[102:103], v15 offset:14048
    ds_read_b64_tr_b16 v[104:105], v15 offset:9472
    v_mfma_f32_16x16x32_bf16 v[136:139], v[64:67], v[20:23], v[136:139]
    v_mfma_f32_16x16x32_bf16 v[172:175], v[64:67], v[24:27], v[172:175]
    ds_read_b64_tr_b16 v[106:107], v15 offset:14080
    v_mfma_f32_16x16x32_bf16 v[140:143], v[68:71], v[20:23], v[140:143]
    v_mfma_f32_16x16x32_bf16 v[176:179], v[68:71], v[24:27], v[176:179]
    s_waitcnt lgkmcnt(0)
    s_waitcnt vmcnt(18)
    s_barrier
    s_add_u32 s4, s4, 128
    s_addc_u32 s5, s5, 0
    s_add_u32 s6, s6, s18
    s_addc_u32 s7, s7, 0
    s_lshl_b32 s9, s8, 12
    s_add_u32 m0, s9, 0
    s_nop 0
    global_load_lds_dwordx4 v2, s[4:5]
    s_lshl_b32 s9, s8, 12
    s_add_u32 m0, s9, 1024
    s_nop 0
    global_load_lds_dwordx4 v3, s[4:5]
    s_lshl_b32 s9, s8, 12
    s_add_u32 m0, s9, 2048
    s_nop 0
    global_load_lds_dwordx4 v4, s[4:5]
    s_lshl_b32 s9, s8, 12
    s_add_u32 m0, s9, 3072
    s_nop 0
    global_load_lds_dwordx4 v5, s[4:5]
    s_mul_i32 s9, s8, 4608
    s_add_u32 m0, s9, 16384
    s_nop 0
    global_load_lds_dwordx4 v6, s[6:7]
    s_mul_i32 s9, s8, 4608
    s_add_u32 m0, s9, 17408
    s_nop 0
    global_load_lds_dwordx4 v7, s[6:7]
    s_mul_i32 s9, s8, 4608
    s_add_u32 m0, s9, 18432
    s_nop 0
    global_load_lds_dwordx4 v8, s[6:7]
    s_mul_i32 s9, s8, 4608
    s_add_u32 m0, s9, 19456
    s_nop 0
    global_load_lds_dwordx4 v9, s[6:7]
    s_mul_i32 s9, s8, 4608
    s_add_u32 m0, s9, 20480
    s_mov_b32 exec_hi, 0
    global_load_lds_dwordx4 v10, s[6:7]
    s_mov_b64 exec, -1
    v_mfma_f32_16x16x32_bf16 v[108:111], v[72:75], v[28:31], v[108:111]
    v_mfma_f32_16x16x32_bf16 v[144:147], v[72:75], v[32:35], v[144:147]
    ds_read_b64 v[20:21], v11 offset:34816
    ds_read_b64 v[22:23], v12 offset:34816
    ds_read_b64 v[24:25], v11 offset:36864
    v_mfma_f32_16x16x32_bf16 v[112:115], v[76:79], v[28:31], v[112:115]
    v_mfma_f32_16x16x32_bf16 v[148:151], v[76:79], v[32:35], v[148:151]
    ds_read_b64 v[26:27], v12 offset:36864
    ds_read_b64_tr_b16 v[36:37], v15 offset:34816
    ds_read_b64_tr_b16 v[38:39], v15 offset:39424
    v_mfma_f32_16x16x32_bf16 v[116:119], v[80:83], v[28:31], v[116:119]
    v_mfma_f32_16x16x32_bf16 v[152:155], v[80:83], v[32:35], v[152:155]
    ds_read_b64_tr_b16 v[40:41], v15 offset:34848
    ds_read_b64_tr_b16 v[42:43], v15 offset:39456
    ds_read_b64_tr_b16 v[44:45], v15 offset:34880
    v_mfma_f32_16x16x32_bf16 v[120:123], v[84:87], v[28:31], v[120:123]
    v_mfma_f32_16x16x32_bf16 v[156:159], v[84:87], v[32:35], v[156:159]
    ds_read_b64_tr_b16 v[46:47], v15 offset:39488
    ds_read_b64_tr_b16 v[48:49], v15 offset:34912
    ds_read_b64_tr_b16 v[50:51], v15 offset:39520
    v_mfma_f32_16x16x32_bf16 v[124:127], v[88:91], v[28:31], v[124:127]
    v_mfma_f32_16x16x32_bf16 v[160:163], v[88:91], v[32:35], v[160:163]
    ds_read_b64_tr_b16 v[52:53], v15 offset:34944
    ds_read_b64_tr_b16 v[54:55], v15 offset:39552
    ds_read_b64_tr_b16 v[56:57], v15 offset:34976
    v_mfma_f32_16x16x32_bf16 v[128:131], v[92:95], v[28:31], v[128:131]
    v_mfma_f32_16x16x32_bf16 v[164:167], v[92:95], v[32:35], v[164:167]
    ds_read_b64_tr_b16 v[58:59], v15 offset:39584
    ds_read_b64_tr_b16 v[60:61], v15 offset:35008
    ds_read_b64_tr_b16 v[62:63], v15 offset:39616
    v_mfma_f32_16x16x32_bf16 v[132:135], v[96:99], v[28:31], v[132:135]
    v_mfma_f32_16x16x32_bf16 v[168:171], v[96:99], v[32:35], v[168:171]
    ds_read_b64_tr_b16 v[64:65], v15 offset:35040
    ds_read_b64_tr_b16 v[66:67], v15 offset:39648
    ds_read_b64_tr_b16 v[68:69], v15 offset:35072
    v_mfma_f32_16x16x32_bf16 v[136:139], v[100:103], v[28:31], v[136:139]
    v_mfma_f32_16x16x32_bf16 v[172:175], v[100:103], v[32:35], v[172:175]
    ds_read_b64_tr_b16 v[70:71], v15 offset:39680
    v_mfma_f32_16x16x32_bf16 v[140:143], v[104:107], v[28:31], v[140:143]
    v_mfma_f32_16x16x32_bf16 v[176:179], v[104:107], v[32:35], v[176:179]
    s_waitcnt lgkmcnt(15)
    v_mfma_f32_16x16x32_bf16 v[108:111], v[36:39], v[20:23], v[108:111]
    v_mfma_f32_16x16x32_bf16 v[144:147], v[36:39], v[24:27], v[144:147]
    ds_read_b64 v[28:29], v13 offset:34816
    ds_read_b64 v[30:31], v14 offset:34816
    ds_read_b64 v[32:33], v13 offset:36864
    s_waitcnt lgkmcnt(15)
    v_mfma_f32_16x16x32_bf16 v[112:115], v[40:43], v[20:23], v[112:115]
    v_mfma_f32_16x16x32_bf16 v[148:151], v[40:43], v[24:27], v[148:151]
    ds_read_b64 v[34:35], v14 offset:36864
    ds_read_b64_tr_b16 v[72:73], v15 offset:44032
    ds_read_b64_tr_b16 v[74:75], v15 offset:48640
    v_mfma_f32_16x16x32_bf16 v[116:119], v[44:47], v[20:23], v[116:119]
    v_mfma_f32_16x16x32_bf16 v[152:155], v[44:47], v[24:27], v[152:155]
    ds_read_b64_tr_b16 v[76:77], v15 offset:44064
    ds_read_b64_tr_b16 v[78:79], v15 offset:48672
    ds_read_b64_tr_b16 v[80:81], v15 offset:44096
    s_waitcnt lgkmcnt(15)
    v_mfma_f32_16x16x32_bf16 v[120:123], v[48:51], v[20:23], v[120:123]
    v_mfma_f32_16x16x32_bf16 v[156:159], v[48:51], v[24:27], v[156:159]
    ds_read_b64_tr_b16 v[82:83], v15 offset:48704
    ds_read_b64_tr_b16 v[84:85], v15 offset:44128
    ds_read_b64_tr_b16 v[86:87], v15 offset:48736
    v_mfma_f32_16x16x32_bf16 v[124:127], v[52:55], v[20:23], v[124:127]
    v_mfma_f32_16x16x32_bf16 v[160:163], v[52:55], v[24:27], v[160:163]
    ds_read_b64_tr_b16 v[88:89], v15 offset:44160
    ds_read_b64_tr_b16 v[90:91], v15 offset:48768
    ds_read_b64_tr_b16 v[92:93], v15 offset:44192
    v_mfma_f32_16x16x32_bf16 v[128:131], v[56:59], v[20:23], v[128:131]
    v_mfma_f32_16x16x32_bf16 v[164:167], v[56:59], v[24:27], v[164:167]
    ds_read_b64_tr_b16 v[94:95], v15 offset:48800
    ds_read_b64_tr_b16 v[96:97], v15 offset:44224
    ds_read_b64_tr_b16 v[98:99], v15 offset:48832
    s_waitcnt lgkmcnt(15)
    v_mfma_f32_16x16x32_bf16 v[132:135], v[60:63], v[20:23], v[132:135]
    v_mfma_f32_16x16x32_bf16 v[168:171], v[60:63], v[24:27], v[168:171]
    ds_read_b64_tr_b16 v[100:101], v15 offset:44256
    ds_read_b64_tr_b16 v[102:103], v15 offset:48864
    ds_read_b64_tr_b16 v[104:105], v15 offset:44288
    v_mfma_f32_16x16x32_bf16 v[136:139], v[64:67], v[20:23], v[136:139]
    v_mfma_f32_16x16x32_bf16 v[172:175], v[64:67], v[24:27], v[172:175]
    ds_read_b64_tr_b16 v[106:107], v15 offset:48896
    v_mfma_f32_16x16x32_bf16 v[140:143], v[68:71], v[20:23], v[140:143]
    v_mfma_f32_16x16x32_bf16 v[176:179], v[68:71], v[24:27], v[176:179]
    s_waitcnt lgkmcnt(0)
    s_waitcnt vmcnt(18)
    s_barrier
    s_add_u32 s4, s4, 128
    s_addc_u32 s5, s5, 0
    s_add_u32 s6, s6, s18
    s_addc_u32 s7, s7, 0
    s_lshl_b32 s9, s8, 12
    s_add_u32 m0, s9, 34816
    s_nop 0
    global_load_lds_dwordx4 v2, s[4:5]
    s_lshl_b32 s9, s8, 12
    s_add_u32 m0, s9, 35840
    s_nop 0
    global_load_lds_dwordx4 v3, s[4:5]
    s_lshl_b32 s9, s8, 12
    s_add_u32 m0, s9, 36864
    s_nop 0
    global_load_lds_dwordx4 v4, s[4:5]
    s_lshl_b32 s9, s8, 12
    s_add_u32 m0, s9, 37888
    s_nop 0
    global_load_lds_dwordx4 v5, s[4:5]
    s_mul_i32 s9, s8, 4608
    s_add_u32 m0, s9, 51200
    s_nop 0
    global_load_lds_dwordx4 v6, s[6:7]
    s_mul_i32 s9, s8, 4608
    s_add_u32 m0, s9, 52224
    s_nop 0
    global_load_lds_dwordx4 v7, s[6:7]
    s_mul_i32 s9, s8, 4608
    s_add_u32 m0, s9, 53248
    s_nop 0
    global_load_lds_dwordx4 v8, s[6:7]
    s_mul_i32 s9, s8, 4608
    s_add_u32 m0, s9, 54272
    s_nop 0
    global_load_lds_dwordx4 v9, s[6:7]
    s_mul_i32 s9, s8, 4608
    s_add_u32 m0, s9, 55296
    s_mov_b32 exec_hi, 0
    global_load_lds_dwordx4 v10, s[6:7]
    s_mov_b64 exec, -1
    v_mfma_f32_16x16x32_bf16 v[108:111], v[72:75], v[28:31], v[108:111]
    v_mfma_f32_16x16x32_bf16 v[144:147], v[72:75], v[32:35], v[144:147]
    ds_read_b64 v[20:21], v200 offset:0
    ds_read_b64 v[22:23], v201 offset:0
    ds_read_b64 v[24:25], v200 offset:2048
    v_mfma_f32_16x16x32_bf16 v[112:115], v[76:79], v[28:31], v[112:115]
    v_mfma_f32_16x16x32_bf16 v[148:151], v[76:79], v[32:35], v[148:151]
    ds_read_b64 v[26:27], v201 offset:2048
    ds_read_b64_tr_b16 v[36:37], v204 offset:0
    ds_read_b64_tr_b16 v[38:39], v204 offset:4608
    v_mfma_f32_16x16x32_bf16 v[116:119], v[80:83], v[28:31], v[116:119]
    v_mfma_f32_16x16x32_bf16 v[152:155], v[80:83], v[32:35], v[152:155]
    ds_read_b64_tr_b16 v[40:41], v204 offset:32
    ds_read_b64_tr_b16 v[42:43], v204 offset:4640
    ds_read_b64_tr_b16 v[44:45], v204 offset:64
    v_mfma_f32_16x16x32_bf16 v[120:123], v[84:87], v[28:31], v[120:123]
    v_mfma_f32_16x16x32_bf16 v[156:159], v[84:87], v[32:35], v[156:159]
    ds_read_b64_tr_b16 v[46:47], v204 offset:4672
    ds_read_b64_tr_b16 v[48:49], v204 offset:96
    ds_read_b64_tr_b16 v[50:51], v204 offset:4704
    v_mfma_f32_16x16x32_bf16 v[124:127], v[88:91], v[28:31], v[124:127]
    v_mfma_f32_16x16x32_bf16 v[160:163], v[88:91], v[32:35], v[160:163]
    ds_read_b64_tr_b16 v[52:53], v204 offset:128
    ds_read_b64_tr_b16 v[54:55], v204 offset:4736
    ds_read_b64_tr_b16 v[56:57], v204 offset:160
    v_mfma_f32_16x16x32_bf16 v[128:131], v[92:95], v[28:31], v[128:131]
    v_mfma_f32_16x16x32_bf16 v[164:167], v[92:95], v[32:35], v[164:167]
    ds_read_b64_tr_b16 v[58:59], v204 offset:4768
    ds_read_b64_tr_b16 v[60:61], v204 offset:192
    ds_read_b64_tr_b16 v[62:63], v204 offset:4800
    v_mfma_f32_16x16x32_bf16 v[132:135], v[96:99], v[28:31], v[132:135]
    v_mfma_f32_16x16x32_bf16 v[168:171], v[96:99], v[32:35], v[168:171]
    ds_read_b64_tr_b16 v[64:65], v204 offset:224
    ds_read_b64_tr_b16 v[66:67], v204 offset:4832
    ds_read_b64_tr_b16 v[68:69], v204 offset:256
    v_mfma_f32_16x16x32_bf16 v[136:139], v[100:103], v[28:31], v[136:139]
    v_mfma_f32_16x16x32_bf16 v[172:175], v[100:103], v[32:35], v[172:175]
    ds_read_b64_tr_b16 v[70:71], v204 offset:4864
    v_mfma_f32_16x16x32_bf16 v[140:143], v[104:107], v[28:31], v[140:143]
    v_mfma_f32_16x16x32_bf16 v[176:179], v[104:107], v[32:35], v[176:179]
    s_waitcnt lgkmcnt(15)
    v_mfma_f32_16x16x32_bf16 v[108:111], v[36:39], v[20:23], v[108:111]
    v_mfma_f32_16x16x32_bf16 v[144:147], v[36:39], v[24:27], v[144:147]
    ds_read_b64 v[28:29], v202 offset:0
    ds_read_b64 v[30:31], v203 offset:0
    ds_read_b64 v[32:33], v202 offset:2048
    s_waitcnt lgkmcnt(15)
    v_mfma_f32_16x16x32_bf16 v[112:115], v[40:43], v[20:23], v[112:115]
    v_mfma_f32_16x16x32_bf16 v[148:151], v[40:43], v[24:27], v[148:151]
    ds_read_b64 v[34:35], v203 offset:2048
    ds_read_b64_tr_b16 v[72:73], v204 offset:9216
    ds_read_b64_tr_b16 v[74:75], v204 offset:13824
    v_mfma_f32_16x16x32_bf16 v[116:119], v[44:47], v[20:23], v[116:119]
    v_mfma_f32_16x16x32_bf16 v[152:155], v[44:47], v[24:27], v[152:155]
    ds_read_b64_tr_b16 v[76:77], v204 offset:9248
    ds_read_b64_tr_b16 v[78:79], v204 offset:13856
    ds_read_b64_tr_b16 v[80:81], v204 offset:9280
    s_waitcnt lgkmcnt(15)
    v_mfma_f32_16x16x32_bf16 v[120:123], v[48:51], v[20:23], v[120:123]
    v_mfma_f32_16x16x32_bf16 v[156:159], v[48:51], v[24:27], v[156:159]
    ds_read_b64_tr_b16 v[82:83], v204 offset:13888
    ds_read_b64_tr_b16 v[84:85], v204 offset:9312
    ds_read_b64_tr_b16 v[86:87], v204 offset:13920
    v_mfma_f32_16x16x32_bf16 v[124:127], v[52:55], v[20:23], v[124:127]
    v_mfma_f32_16x16x32_bf16 v[160:163], v[52:55], v[24:27], v[160:163]
    ds_read_b64_tr_b16 v[88:89], v204 offset:9344
    ds_read_b64_tr_b16 v[90:91], v204 offset:13952
    ds_read_b64_tr_b16 v[92:93], v204 offset:9376
    v_mfma_f32_16x16x32_bf16 v[128:131], v[56:59], v[20:23], v[128:131]
    v_mfma_f32_16x16x32_bf16 v[164:167], v[56:59], v[24:27], v[164:167]
    ds_read_b64_tr_b16 v[94:95], v204 offset:13984
    ds_read_b64_tr_b16 v[96:97], v204 offset:9408
    ds_read_b64_tr_b16 v[98:99], v204 offset:14016
    s_waitcnt lgkmcnt(15)
    v_mfma_f32_16x16x32_bf16 v[132:135], v[60:63], v[20:23], v[132:135]
    v_mfma_f32_16x16x32_bf16 v[168:171], v[60:63], v[24:27], v[168:171]
    ds_read_b64_tr_b16 v[100:101], v204 offset:9440
    ds_read_b64_tr_b16 v[102:103], v204 offset:14048
    ds_read_b64_tr_b16 v[104:105], v204 offset:9472
    v_mfma_f32_16x16x32_bf16 v[136:139], v[64:67], v[20:23], v[136:139]
    v_mfma_f32_16x16x32_bf16 v[172:175], v[64:67], v[24:27], v[172:175]
    ds_read_b64_tr_b16 v[106:107], v204 offset:14080
    v_mfma_f32_16x16x32_bf16 v[140:143], v[68:71], v[20:23], v[140:143]
    v_mfma_f32_16x16x32_bf16 v[176:179], v[68:71], v[24:27], v[176:179]
    s_waitcnt lgkmcnt(0)
    s_waitcnt vmcnt(18)
    s_barrier
    s_add_u32 s4, s4, 128
    s_addc_u32 s5, s5, 0
    s_add_u32 s6, s6, s18
    s_addc_u32 s7, s7, 0
    s_lshl_b32 s9, s8, 12
    s_add_u32 m0, s9, 69632
    s_nop 0
    global_load_lds_dwordx4 v2, s[4:5]
    s_lshl_b32 s9, s8, 12
    s_add_u32 m0, s9, 70656
    s_nop 0
    global_load_lds_dwordx4 v3, s[4:5]
    s_lshl_b32 s9, s8, 12
    s_add_u32 m0, s9, 71680
    s_nop 0
    global_load_lds_dwordx4 v4, s[4:5]
    s_lshl_b32 s9, s8, 12
    s_add_u32 m0, s9, 72704
    s_nop 0
    global_load_lds_dwordx4 v5, s[4:5]
    s_mul_i32 s9, s8, 4608
    s_add_u32 m0, s9, 86016
    s_nop 0
    global_load_lds_dwordx4 v6, s[6:7]
    s_mul_i32 s9, s8, 4608
    s_add_u32 m0, s9, 87040
    s_nop 0
    global_load_lds_dwordx4 v7, s[6:7]
    s_mul_i32 s9, s8, 4608
    s_add_u32 m0, s9, 88064
    s_nop 0
    global_load_lds_dwordx4 v8, s[6:7]
    s_mul_i32 s9, s8, 4608
    s_add_u32 m0, s9, 89088
    s_nop 0
    global_load_lds_dwordx4 v9, s[6:7]
    s_mul_i32 s9, s8, 4608
    s_add_u32 m0, s9, 90112
    s_mov_b32 exec_hi, 0
    global_load_lds_dwordx4 v10, s[6:7]
    s_mov_b64 exec, -1
    v_mfma_f32_16x16x32_bf16 v[108:111], v[72:75], v[28:31], v[108:111]
    v_mfma_f32_16x16x32_bf16 v[144:147], v[72:75], v[32:35], v[144:147]
    ds_read_b64 v[20:21], v200 offset:34816
    ds_read_b64 v[22:23], v201 offset:34816
    ds_read_b64 v[24:25], v200 offset:36864
    v_mfma_f32_16x16x32_bf16 v[112:115], v[76:79], v[28:31], v[112:115]
    v_mfma_f32_16x16x32_bf16 v[148:151], v[76:79], v[32:35], v[148:151]
    ds_read_b64 v[26:27], v201 offset:36864
    ds_read_b64_tr_b16 v[36:37], v204 offset:34816
    ds_read_b64_tr_b16 v[38:39], v204 offset:39424
    v_mfma_f32_16x16x32_bf16 v[116:119], v[80:83], v[28:31], v[116:119]
    v_mfma_f32_16x16x32_bf16 v[152:155], v[80:83], v[32:35], v[152:155]
    ds_read_b64_tr_b16 v[40:41], v204 offset:34848
    ds_read_b64_tr_b16 v[42:43], v204 offset:39456
    ds_read_b64_tr_b16 v[44:45], v204 offset:34880
    v_mfma_f32_16x16x32_bf16 v[120:123], v[84:87], v[28:31], v[120:123]
    v_mfma_f32_16x16x32_bf16 v[156:159], v[84:87], v[32:35], v[156:159]
    ds_read_b64_tr_b16 v[46:47], v204 offset:39488
    ds_read_b64_tr_b16 v[48:49], v204 offset:34912
    ds_read_b64_tr_b16 v[50:51], v204 offset:39520
    v_mfma_f32_16x16x32_bf16 v[124:127], v[88:91], v[28:31], v[124:127]
    v_mfma_f32_16x16x32_bf16 v[160:163], v[88:91], v[32:35], v[160:163]
    ds_read_b64_tr_b16 v[52:53], v204 offset:34944
    ds_read_b64_tr_b16 v[54:55], v204 offset:39552
    ds_read_b64_tr_b16 v[56:57], v204 offset:34976
    v_mfma_f32_16x16x32_bf16 v[128:131], v[92:95], v[28:31], v[128:131]
    v_mfma_f32_16x16x32_bf16 v[164:167], v[92:95], v[32:35], v[164:167]
    ds_read_b64_tr_b16 v[58:59], v204 offset:39584
    ds_read_b64_tr_b16 v[60:61], v204 offset:35008
    ds_read_b64_tr_b16 v[62:63], v204 offset:39616
    v_mfma_f32_16x16x32_bf16 v[132:135], v[96:99], v[28:31], v[132:135]
    v_mfma_f32_16x16x32_bf16 v[168:171], v[96:99], v[32:35], v[168:171]
    ds_read_b64_tr_b16 v[64:65], v204 offset:35040
    ds_read_b64_tr_b16 v[66:67], v204 offset:39648
    ds_read_b64_tr_b16 v[68:69], v204 offset:35072
    v_mfma_f32_16x16x32_bf16 v[136:139], v[100:103], v[28:31], v[136:139]
    v_mfma_f32_16x16x32_bf16 v[172:175], v[100:103], v[32:35], v[172:175]
    ds_read_b64_tr_b16 v[70:71], v204 offset:39680
    v_mfma_f32_16x16x32_bf16 v[140:143], v[104:107], v[28:31], v[140:143]
    v_mfma_f32_16x16x32_bf16 v[176:179], v[104:107], v[32:35], v[176:179]
    s_waitcnt lgkmcnt(15)
    v_mfma_f32_16x16x32_bf16 v[108:111], v[36:39], v[20:23], v[108:111]
    v_mfma_f32_16x16x32_bf16 v[144:147], v[36:39], v[24:27], v[144:147]
    ds_read_b64 v[28:29], v202 offset:34816
    ds_read_b64 v[30:31], v203 offset:34816
    ds_read_b64 v[32:33], v202 offset:36864
    s_waitcnt lgkmcnt(15)
    v_mfma_f32_16x16x32_bf16 v[112:115], v[40:43], v[20:23], v[112:115]
    v_mfma_f32_16x16x32_bf16 v[148:151], v[40:43], v[24:27], v[148:151]
    ds_read_b64 v[34:35], v203 offset:36864
    ds_read_b64_tr_b16 v[72:73], v204 offset:44032
    ds_read_b64_tr_b16 v[74:75], v204 offset:48640
    v_mfma_f32_16x16x32_bf16 v[116:119], v[44:47], v[20:23], v[116:119]
    v_mfma_f32_16x16x32_bf16 v[152:155], v[44:47], v[24:27], v[152:155]
    ds_read_b64_tr_b16 v[76:77], v204 offset:44064
    ds_read_b64_tr_b16 v[78:79], v204 offset:48672
    ds_read_b64_tr_b16 v[80:81], v204 offset:44096
    s_waitcnt lgkmcnt(15)
    v_mfma_f32_16x16x32_bf16 v[120:123], v[48:51], v[20:23], v[120:123]
    v_mfma_f32_16x16x32_bf16 v[156:159], v[48:51], v[24:27], v[156:159]
    ds_read_b64_tr_b16 v[82:83], v204 offset:48704
    ds_read_b64_tr_b16 v[84:85], v204 offset:44128
    ds_read_b64_tr_b16 v[86:87], v204 offset:48736
    v_mfma_f32_16x16x32_bf16 v[124:127], v[52:55], v[20:23], v[124:127]
    v_mfma_f32_16x16x32_bf16 v[160:163], v[52:55], v[24:27], v[160:163]
    ds_read_b64_tr_b16 v[88:89], v204 offset:44160
    ds_read_b64_tr_b16 v[90:91], v204 offset:48768
    ds_read_b64_tr_b16 v[92:93], v204 offset:44192
    v_mfma_f32_16x16x32_bf16 v[128:131], v[56:59], v[20:23], v[128:131]
    v_mfma_f32_16x16x32_bf16 v[164:167], v[56:59], v[24:27], v[164:167]
    ds_read_b64_tr_b16 v[94:95], v204 offset:48800
    ds_read_b64_tr_b16 v[96:97], v204 offset:44224
    ds_read_b64_tr_b16 v[98:99], v204 offset:48832
    s_waitcnt lgkmcnt(15)
    v_mfma_f32_16x16x32_bf16 v[132:135], v[60:63], v[20:23], v[132:135]
    v_mfma_f32_16x16x32_bf16 v[168:171], v[60:63], v[24:27], v[168:171]
    ds_read_b64_tr_b16 v[100:101], v204 offset:44256
    ds_read_b64_tr_b16 v[102:103], v204 offset:48864
    ds_read_b64_tr_b16 v[104:105], v204 offset:44288
    v_mfma_f32_16x16x32_bf16 v[136:139], v[64:67], v[20:23], v[136:139]
    v_mfma_f32_16x16x32_bf16 v[172:175], v[64:67], v[24:27], v[172:175]
    ds_read_b64_tr_b16 v[106:107], v204 offset:48896
    v_mfma_f32_16x16x32_bf16 v[140:143], v[68:71], v[20:23], v[140:143]
    v_mfma_f32_16x16x32_bf16 v[176:179], v[68:71], v[24:27], v[176:179]
    s_waitcnt lgkmcnt(0)
    s_waitcnt vmcnt(18)
    s_barrier
    s_add_u32 s4, s4, 128
    s_addc_u32 s5, s5, 0
    s_add_u32 s6, s6, s18
    s_addc_u32 s7, s7, 0
    s_lshl_b32 s9, s8, 12
    s_add_u32 m0, s9, 104448
    s_nop 0
    global_load_lds_dwordx4 v2, s[4:5]
    s_lshl_b32 s9, s8, 12
    s_add_u32 m0, s9, 105472
    s_nop 0
    global_load_lds_dwordx4 v3, s[4:5]
    s_lshl_b32 s9, s8, 12
    s_add_u32 m0, s9, 106496
    s_nop 0
    global_load_lds_dwordx4 v4, s[4:5]
    s_lshl_b32 s9, s8, 12
    s_add_u32 m0, s9, 107520
    s_nop 0
    global_load_lds_dwordx4 v5, s[4:5]
    s_mul_i32 s9, s8, 4608
    s_add_u32 m0, s9, 120832
    s_nop 0
    global_load_lds_dwordx4 v6, s[6:7]
    s_mul_i32 s9, s8, 4608
    s_add_u32 m0, s9, 121856
    s_nop 0
    global_load_lds_dwordx4 v7, s[6:7]
    s_mul_i32 s9, s8, 4608
    s_add_u32 m0, s9, 122880
    s_nop 0
    global_load_lds_dwordx4 v8, s[6:7]
    s_mul_i32 s9, s8, 4608
    s_add_u32 m0, s9, 123904
    s_nop 0
    global_load_lds_dwordx4 v9, s[6:7]
    s_mul_i32 s9, s8, 4608
    s_add_u32 m0, s9, 124928
    s_mov_b32 exec_hi, 0
    global_load_lds_dwordx4 v10, s[6:7]
    s_mov_b64 exec, -1
    v_mfma_f32_16x16x32_bf16 v[108:111], v[72:75], v[28:31], v[108:111]
    v_mfma_f32_16x16x32_bf16 v[144:147], v[72:75], v[32:35], v[144:147]
    ds_read_b64 v[20:21], v11 offset:0
    ds_read_b64 v[22:23], v12 offset:0
    ds_read_b64 v[24:25], v11 offset:2048
    v_mfma_f32_16x16x32_bf16 v[112:115], v[76:79], v[28:31], v[112:115]
    v_mfma_f32_16x16x32_bf16 v[148:151], v[76:79], v[32:35], v[148:151]
    ds_read_b64 v[26:27], v12 offset:2048
    ds_read_b64_tr_b16 v[36:37], v15 offset:0
    ds_read_b64_tr_b16 v[38:39], v15 offset:4608
    v_mfma_f32_16x16x32_bf16 v[116:119], v[80:83], v[28:31], v[116:119]
    v_mfma_f32_16x16x32_bf16 v[152:155], v[80:83], v[32:35], v[152:155]
    ds_read_b64_tr_b16 v[40:41], v15 offset:32
    ds_read_b64_tr_b16 v[42:43], v15 offset:4640
    ds_read_b64_tr_b16 v[44:45], v15 offset:64
    v_mfma_f32_16x16x32_bf16 v[120:123], v[84:87], v[28:31], v[120:123]
    v_mfma_f32_16x16x32_bf16 v[156:159], v[84:87], v[32:35], v[156:159]
    ds_read_b64_tr_b16 v[46:47], v15 offset:4672
    ds_read_b64_tr_b16 v[48:49], v15 offset:96
    ds_read_b64_tr_b16 v[50:51], v15 offset:4704
    v_mfma_f32_16x16x32_bf16 v[124:127], v[88:91], v[28:31], v[124:127]
    v_mfma_f32_16x16x32_bf16 v[160:163], v[88:91], v[32:35], v[160:163]
    ds_read_b64_tr_b16 v[52:53], v15 offset:128
    ds_read_b64_tr_b16 v[54:55], v15 offset:4736
    ds_read_b64_tr_b16 v[56:57], v15 offset:160
    v_mfma_f32_16x16x32_bf16 v[128:131], v[92:95], v[28:31], v[128:131]
    v_mfma_f32_16x16x32_bf16 v[164:167], v[92:95], v[32:35], v[164:167]
    ds_read_b64_tr_b16 v[58:59], v15 offset:4768
    ds_read_b64_tr_b16 v[60:61], v15 offset:192
    ds_read_b64_tr_b16 v[62:63], v15 offset:4800
    v_mfma_f32_16x16x32_bf16 v[132:135], v[96:99], v[28:31], v[132:135]
    v_mfma_f32_16x16x32_bf16 v[168:171], v[96:99], v[32:35], v[168:171]
    ds_read_b64_tr_b16 v[64:65], v15 offset:224
    ds_read_b64_tr_b16 v[66:67], v15 offset:4832
    ds_read_b64_tr_b16 v[68:69], v15 offset:256
    v_mfma_f32_16x16x32_bf16 v[136:139], v[100:103], v[28:31], v[136:139]
    v_mfma_f32_16x16x32_bf16 v[172:175], v[100:103], v[32:35], v[172:175]
    ds_read_b64_tr_b16 v[70:71], v15 offset:4864
    v_mfma_f32_16x16x32_bf16 v[140:143], v[104:107], v[28:31], v[140:143]
    v_mfma_f32_16x16x32_bf16 v[176:179], v[104:107], v[32:35], v[176:179]
    s_waitcnt lgkmcnt(15)
    v_mfma_f32_16x16x32_bf16 v[108:111], v[36:39], v[20:23], v[108:111]
    v_mfma_f32_16x16x32_bf16 v[144:147], v[36:39], v[24:27], v[144:147]
    ds_read_b64 v[28:29], v13 offset:0
    ds_read_b64 v[30:31], v14 offset:0
    ds_read_b64 v[32:33], v13 offset:2048
    s_waitcnt lgkmcnt(15)
    v_mfma_f32_16x16x32_bf16 v[112:115], v[40:43], v[20:23], v[112:115]
    v_mfma_f32_16x16x32_bf16 v[148:151], v[40:43], v[24:27], v[148:151]
    ds_read_b64 v[34:35], v14 offset:2048
    ds_read_b64_tr_b16 v[72:73], v15 offset:9216
    ds_read_b64_tr_b16 v[74:75], v15 offset:13824
    v_mfma_f32_16x16x32_bf16 v[116:119], v[44:47], v[20:23], v[116:119]
    v_mfma_f32_16x16x32_bf16 v[152:155], v[44:47], v[24:27], v[152:155]
    ds_read_b64_tr_b16 v[76:77], v15 offset:9248
    ds_read_b64_tr_b16 v[78:79], v15 offset:13856
    ds_read_b64_tr_b16 v[80:81], v15 offset:9280
    s_waitcnt lgkmcnt(15)
    v_mfma_f32_16x16x32_bf16 v[120:123], v[48:51], v[20:23], v[120:123]
    v_mfma_f32_16x16x32_bf16 v[156:159], v[48:51], v[24:27], v[156:159]
    ds_read_b64_tr_b16 v[82:83], v15 offset:13888
    ds_read_b64_tr_b16 v[84:85], v15 offset:9312
    ds_read_b64_tr_b16 v[86:87], v15 offset:13920
    v_mfma_f32_16x16x32_bf16 v[124:127], v[52:55], v[20:23], v[124:127]
    v_mfma_f32_16x16x32_bf16 v[160:163], v[52:55], v[24:27], v[160:163]
    ds_read_b64_tr_b16 v[88:89], v15 offset:9344
    ds_read_b64_tr_b16 v[90:91], v15 offset:13952
    ds_read_b64_tr_b16 v[92:93], v15 offset:9376
    v_mfma_f32_16x16x32_bf16 v[128:131], v[56:59], v[20:23], v[128:131]
    v_mfma_f32_16x16x32_bf16 v[164:167], v[56:59], v[24:27], v[164:167]
    ds_read_b64_tr_b16 v[94:95], v15 offset:13984
    ds_read_b64_tr_b16 v[96:97], v15 offset:9408
    ds_read_b64_tr_b16 v[98:99], v15 offset:14016
    s_waitcnt lgkmcnt(15)
    v_mfma_f32_16x16x32_bf16 v[132:135], v[60:63], v[20:23], v[132:135]
    v_mfma_f32_16x16x32_bf16 v[168:171], v[60:63], v[24:27], v[168:171]
    ds_read_b64_tr_b16 v[100:101], v15 offset:9440
    ds_read_b64_tr_b16 v[102:103], v15 offset:14048
    ds_read_b64_tr_b16 v[104:105], v15 offset:9472
    v_mfma_f32_16x16x32_bf16 v[136:139], v[64:67], v[20:23], v[136:139]
    v_mfma_f32_16x16x32_bf16 v[172:175], v[64:67], v[24:27], v[172:175]
    ds_read_b64_tr_b16 v[106:107], v15 offset:14080
    v_mfma_f32_16x16x32_bf16 v[140:143], v[68:71], v[20:23], v[140:143]
    v_mfma_f32_16x16x32_bf16 v[176:179], v[68:71], v[24:27], v[176:179]
    s_waitcnt lgkmcnt(0)
    s_waitcnt vmcnt(18)
    s_barrier
    s_add_u32 s4, s4, 128
    s_addc_u32 s5, s5, 0
    s_add_u32 s6, s6, s18
    s_addc_u32 s7, s7, 0
    s_lshl_b32 s9, s8, 12
    s_add_u32 m0, s9, 0
    s_nop 0
    global_load_lds_dwordx4 v2, s[4:5]
    s_lshl_b32 s9, s8, 12
    s_add_u32 m0, s9, 1024
    s_nop 0
    global_load_lds_dwordx4 v3, s[4:5]
    s_lshl_b32 s9, s8, 12
    s_add_u32 m0, s9, 2048
    s_nop 0
    global_load_lds_dwordx4 v4, s[4:5]
    s_lshl_b32 s9, s8, 12
    s_add_u32 m0, s9, 3072
    s_nop 0
    global_load_lds_dwordx4 v5, s[4:5]
    s_mul_i32 s9, s8, 4608
    s_add_u32 m0, s9, 16384
    s_nop 0
    global_load_lds_dwordx4 v6, s[6:7]
    s_mul_i32 s9, s8, 4608
    s_add_u32 m0, s9, 17408
    s_nop 0
    global_load_lds_dwordx4 v7, s[6:7]
    s_mul_i32 s9, s8, 4608
    s_add_u32 m0, s9, 18432
    s_nop 0
    global_load_lds_dwordx4 v8, s[6:7]
    s_mul_i32 s9, s8, 4608
    s_add_u32 m0, s9, 19456
    s_nop 0
    global_load_lds_dwordx4 v9, s[6:7]
    s_mul_i32 s9, s8, 4608
    s_add_u32 m0, s9, 20480
    s_mov_b32 exec_hi, 0
    global_load_lds_dwordx4 v10, s[6:7]
    s_mov_b64 exec, -1
    v_mfma_f32_16x16x32_bf16 v[108:111], v[72:75], v[28:31], v[108:111]
    v_mfma_f32_16x16x32_bf16 v[144:147], v[72:75], v[32:35], v[144:147]
    ds_read_b64 v[20:21], v11 offset:34816
    ds_read_b64 v[22:23], v12 offset:34816
    ds_read_b64 v[24:25], v11 offset:36864
    v_mfma_f32_16x16x32_bf16 v[112:115], v[76:79], v[28:31], v[112:115]
    v_mfma_f32_16x16x32_bf16 v[148:151], v[76:79], v[32:35], v[148:151]
    ds_read_b64 v[26:27], v12 offset:36864
    ds_read_b64_tr_b16 v[36:37], v15 offset:34816
    ds_read_b64_tr_b16 v[38:39], v15 offset:39424
    v_mfma_f32_16x16x32_bf16 v[116:119], v[80:83], v[28:31], v[116:119]
    v_mfma_f32_16x16x32_bf16 v[152:155], v[80:83], v[32:35], v[152:155]
    ds_read_b64_tr_b16 v[40:41], v15 offset:34848
    ds_read_b64_tr_b16 v[42:43], v15 offset:39456
    ds_read_b64_tr_b16 v[44:45], v15 offset:34880
    v_mfma_f32_16x16x32_bf16 v[120:123], v[84:87], v[28:31], v[120:123]
    v_mfma_f32_16x16x32_bf16 v[156:159], v[84:87], v[32:35], v[156:159]
    ds_read_b64_tr_b16 v[46:47], v15 offset:39488
    ds_read_b64_tr_b16 v[48:49], v15 offset:34912
    ds_read_b64_tr_b16 v[50:51], v15 offset:39520
    v_mfma_f32_16x16x32_bf16 v[124:127], v[88:91], v[28:31], v[124:127]
    v_mfma_f32_16x16x32_bf16 v[160:163], v[88:91], v[32:35], v[160:163]
    ds_read_b64_tr_b16 v[52:53], v15 offset:34944
    ds_read_b64_tr_b16 v[54:55], v15 offset:39552
    ds_read_b64_tr_b16 v[56:57], v15 offset:34976
    v_mfma_f32_16x16x32_bf16 v[128:131], v[92:95], v[28:31], v[128:131]
    v_mfma_f32_16x16x32_bf16 v[164:167], v[92:95], v[32:35], v[164:167]
    ds_read_b64_tr_b16 v[58:59], v15 offset:39584
    ds_read_b64_tr_b16 v[60:61], v15 offset:35008
    ds_read_b64_tr_b16 v[62:63], v15 offset:39616
    v_mfma_f32_16x16x32_bf16 v[132:135], v[96:99], v[28:31], v[132:135]
    v_mfma_f32_16x16x32_bf16 v[168:171], v[96:99], v[32:35], v[168:171]
    ds_read_b64_tr_b16 v[64:65], v15 offset:35040
    ds_read_b64_tr_b16 v[66:67], v15 offset:39648
    ds_read_b64_tr_b16 v[68:69], v15 offset:35072
    v_mfma_f32_16x16x32_bf16 v[136:139], v[100:103], v[28:31], v[136:139]
    v_mfma_f32_16x16x32_bf16 v[172:175], v[100:103], v[32:35], v[172:175]
    ds_read_b64_tr_b16 v[70:71], v15 offset:39680
    v_mfma_f32_16x16x32_bf16 v[140:143], v[104:107], v[28:31], v[140:143]
    v_mfma_f32_16x16x32_bf16 v[176:179], v[104:107], v[32:35], v[176:179]
    s_waitcnt lgkmcnt(15)
    v_mfma_f32_16x16x32_bf16 v[108:111], v[36:39], v[20:23], v[108:111]
    v_mfma_f32_16x16x32_bf16 v[144:147], v[36:39], v[24:27], v[144:147]
    ds_read_b64 v[28:29], v13 offset:34816
    ds_read_b64 v[30:31], v14 offset:34816
    ds_read_b64 v[32:33], v13 offset:36864
    s_waitcnt lgkmcnt(15)
    v_mfma_f32_16x16x32_bf16 v[112:115], v[40:43], v[20:23], v[112:115]
    v_mfma_f32_16x16x32_bf16 v[148:151], v[40:43], v[24:27], v[148:151]
    ds_read_b64 v[34:35], v14 offset:36864
    ds_read_b64_tr_b16 v[72:73], v15 offset:44032
    ds_read_b64_tr_b16 v[74:75], v15 offset:48640
    v_mfma_f32_16x16x32_bf16 v[116:119], v[44:47], v[20:23], v[116:119]
    v_mfma_f32_16x16x32_bf16 v[152:155], v[44:47], v[24:27], v[152:155]
    ds_read_b64_tr_b16 v[76:77], v15 offset:44064
    ds_read_b64_tr_b16 v[78:79], v15 offset:48672
    ds_read_b64_tr_b16 v[80:81], v15 offset:44096
    s_waitcnt lgkmcnt(15)
    v_mfma_f32_16x16x32_bf16 v[120:123], v[48:51], v[20:23], v[120:123]
    v_mfma_f32_16x16x32_bf16 v[156:159], v[48:51], v[24:27], v[156:159]
    ds_read_b64_tr_b16 v[82:83], v15 offset:48704
    ds_read_b64_tr_b16 v[84:85], v15 offset:44128
    ds_read_b64_tr_b16 v[86:87], v15 offset:48736
    v_mfma_f32_16x16x32_bf16 v[124:127], v[52:55], v[20:23], v[124:127]
    v_mfma_f32_16x16x32_bf16 v[160:163], v[52:55], v[24:27], v[160:163]
    ds_read_b64_tr_b16 v[88:89], v15 offset:44160
    ds_read_b64_tr_b16 v[90:91], v15 offset:48768
    ds_read_b64_tr_b16 v[92:93], v15 offset:44192
    v_mfma_f32_16x16x32_bf16 v[128:131], v[56:59], v[20:23], v[128:131]
    v_mfma_f32_16x16x32_bf16 v[164:167], v[56:59], v[24:27], v[164:167]
    ds_read_b64_tr_b16 v[94:95], v15 offset:48800
    ds_read_b64_tr_b16 v[96:97], v15 offset:44224
    ds_read_b64_tr_b16 v[98:99], v15 offset:48832
    s_waitcnt lgkmcnt(15)
    v_mfma_f32_16x16x32_bf16 v[132:135], v[60:63], v[20:23], v[132:135]
    v_mfma_f32_16x16x32_bf16 v[168:171], v[60:63], v[24:27], v[168:171]
    ds_read_b64_tr_b16 v[100:101], v15 offset:44256
    ds_read_b64_tr_b16 v[102:103], v15 offset:48864
    ds_read_b64_tr_b16 v[104:105], v15 offset:44288
    v_mfma_f32_16x16x32_bf16 v[136:139], v[64:67], v[20:23], v[136:139]
    v_mfma_f32_16x16x32_bf16 v[172:175], v[64:67], v[24:27], v[172:175]
    ds_read_b64_tr_b16 v[106:107], v15 offset:48896
    v_mfma_f32_16x16x32_bf16 v[140:143], v[68:71], v[20:23], v[140:143]
    v_mfma_f32_16x16x32_bf16 v[176:179], v[68:71], v[24:27], v[176:179]
    s_waitcnt lgkmcnt(0)
    s_waitcnt vmcnt(18)
    s_barrier
    s_add_u32 s4, s4, 128
    s_addc_u32 s5, s5, 0
    s_add_u32 s6, s6, s18
    s_addc_u32 s7, s7, 0
    s_lshl_b32 s9, s8, 12
    s_add_u32 m0, s9, 34816
    s_nop 0
    global_load_lds_dwordx4 v2, s[4:5]
    s_lshl_b32 s9, s8, 12
    s_add_u32 m0, s9, 35840
    s_nop 0
    global_load_lds_dwordx4 v3, s[4:5]
    s_lshl_b32 s9, s8, 12
    s_add_u32 m0, s9, 36864
    s_nop 0
    global_load_lds_dwordx4 v4, s[4:5]
    s_lshl_b32 s9, s8, 12
    s_add_u32 m0, s9, 37888
    s_nop 0
    global_load_lds_dwordx4 v5, s[4:5]
    s_mul_i32 s9, s8, 4608
    s_add_u32 m0, s9, 51200
    s_nop 0
    global_load_lds_dwordx4 v6, s[6:7]
    s_mul_i32 s9, s8, 4608
    s_add_u32 m0, s9, 52224
    s_nop 0
    global_load_lds_dwordx4 v7, s[6:7]
    s_mul_i32 s9, s8, 4608
    s_add_u32 m0, s9, 53248
    s_nop 0
    global_load_lds_dwordx4 v8, s[6:7]
    s_mul_i32 s9, s8, 4608
    s_add_u32 m0, s9, 54272
    s_nop 0
    global_load_lds_dwordx4 v9, s[6:7]
    s_mul_i32 s9, s8, 4608
    s_add_u32 m0, s9, 55296
    s_mov_b32 exec_hi, 0
    global_load_lds_dwordx4 v10, s[6:7]
    s_mov_b64 exec, -1
    v_mfma_f32_16x16x32_bf16 v[108:111], v[72:75], v[28:31], v[108:111]
    v_mfma_f32_16x16x32_bf16 v[144:147], v[72:75], v[32:35], v[144:147]
    ds_read_b64 v[20:21], v200 offset:0
    ds_read_b64 v[22:23], v201 offset:0
    ds_read_b64 v[24:25], v200 offset:2048
    v_mfma_f32_16x16x32_bf16 v[112:115], v[76:79], v[28:31], v[112:115]
    v_mfma_f32_16x16x32_bf16 v[148:151], v[76:79], v[32:35], v[148:151]
    ds_read_b64 v[26:27], v201 offset:2048
    ds_read_b64_tr_b16 v[36:37], v204 offset:0
    ds_read_b64_tr_b16 v[38:39], v204 offset:4608
    v_mfma_f32_16x16x32_bf16 v[116:119], v[80:83], v[28:31], v[116:119]
    v_mfma_f32_16x16x32_bf16 v[152:155], v[80:83], v[32:35], v[152:155]
    ds_read_b64_tr_b16 v[40:41], v204 offset:32
    ds_read_b64_tr_b16 v[42:43], v204 offset:4640
    ds_read_b64_tr_b16 v[44:45], v204 offset:64
    v_mfma_f32_16x16x32_bf16 v[120:123], v[84:87], v[28:31], v[120:123]
    v_mfma_f32_16x16x32_bf16 v[156:159], v[84:87], v[32:35], v[156:159]
    ds_read_b64_tr_b16 v[46:47], v204 offset:4672
    ds_read_b64_tr_b16 v[48:49], v204 offset:96
    ds_read_b64_tr_b16 v[50:51], v204 offset:4704
    v_mfma_f32_16x16x32_bf16 v[124:127], v[88:91], v[28:31], v[124:127]
    v_mfma_f32_16x16x32_bf16 v[160:163], v[88:91], v[32:35], v[160:163]
    ds_read_b64_tr_b16 v[52:53], v204 offset:128
    ds_read_b64_tr_b16 v[54:55], v204 offset:4736
    ds_read_b64_tr_b16 v[56:57], v204 offset:160
    v_mfma_f32_16x16x32_bf16 v[128:131], v[92:95], v[28:31], v[128:131]
    v_mfma_f32_16x16x32_bf16 v[164:167], v[92:95], v[32:35], v[164:167]
    ds_read_b64_tr_b16 v[58:59], v204 offset:4768
    ds_read_b64_tr_b16 v[60:61], v204 offset:192
    ds_read_b64_tr_b16 v[62:63], v204 offset:4800
    v_mfma_f32_16x16x32_bf16 v[132:135], v[96:99], v[28:31], v[132:135]
    v_mfma_f32_16x16x32_bf16 v[168:171], v[96:99], v[32:35], v[168:171]
    ds_read_b64_tr_b16 v[64:65], v204 offset:224
    ds_read_b64_tr_b16 v[66:67], v204 offset:4832
    ds_read_b64_tr_b16 v[68:69], v204 offset:256
    v_mfma_f32_16x16x32_bf16 v[136:139], v[100:103], v[28:31], v[136:139]
    v_mfma_f32_16x16x32_bf16 v[172:175], v[100:103], v[32:35], v[172:175]
    ds_read_b64_tr_b16 v[70:71], v204 offset:4864
    v_mfma_f32_16x16x32_bf16 v[140:143], v[104:107], v[28:31], v[140:143]
    v_mfma_f32_16x16x32_bf16 v[176:179], v[104:107], v[32:35], v[176:179]
    s_waitcnt lgkmcnt(15)
    v_mfma_f32_16x16x32_bf16 v[108:111], v[36:39], v[20:23], v[108:111]
    v_mfma_f32_16x16x32_bf16 v[144:147], v[36:39], v[24:27], v[144:147]
    ds_read_b64 v[28:29], v202 offset:0
    ds_read_b64 v[30:31], v203 offset:0
    ds_read_b64 v[32:33], v202 offset:2048
    s_waitcnt lgkmcnt(15)
    v_mfma_f32_16x16x32_bf16 v[112:115], v[40:43], v[20:23], v[112:115]
    v_mfma_f32_16x16x32_bf16 v[148:151], v[40:43], v[24:27], v[148:151]
    ds_read_b64 v[34:35], v203 offset:2048
    ds_read_b64_tr_b16 v[72:73], v204 offset:9216
    ds_read_b64_tr_b16 v[74:75], v204 offset:13824
    v_mfma_f32_16x16x32_bf16 v[116:119], v[44:47], v[20:23], v[116:119]
    v_mfma_f32_16x16x32_bf16 v[152:155], v[44:47], v[24:27], v[152:155]
    ds_read_b64_tr_b16 v[76:77], v204 offset:9248
    ds_read_b64_tr_b16 v[78:79], v204 offset:13856
    ds_read_b64_tr_b16 v[80:81], v204 offset:9280
    s_waitcnt lgkmcnt(15)
    v_mfma_f32_16x16x32_bf16 v[120:123], v[48:51], v[20:23], v[120:123]
    v_mfma_f32_16x16x32_bf16 v[156:159], v[48:51], v[24:27], v[156:159]
    ds_read_b64_tr_b16 v[82:83], v204 offset:13888
    ds_read_b64_tr_b16 v[84:85], v204 offset:9312
    ds_read_b64_tr_b16 v[86:87], v204 offset:13920
    v_mfma_f32_16x16x32_bf16 v[124:127], v[52:55], v[20:23], v[124:127]
    v_mfma_f32_16x16x32_bf16 v[160:163], v[52:55], v[24:27], v[160:163]
    ds_read_b64_tr_b16 v[88:89], v204 offset:9344
    ds_read_b64_tr_b16 v[90:91], v204 offset:13952
    ds_read_b64_tr_b16 v[92:93], v204 offset:9376
    v_mfma_f32_16x16x32_bf16 v[128:131], v[56:59], v[20:23], v[128:131]
    v_mfma_f32_16x16x32_bf16 v[164:167], v[56:59], v[24:27], v[164:167]
    ds_read_b64_tr_b16 v[94:95], v204 offset:13984
    ds_read_b64_tr_b16 v[96:97], v204 offset:9408
    ds_read_b64_tr_b16 v[98:99], v204 offset:14016
    s_waitcnt lgkmcnt(15)
    v_mfma_f32_16x16x32_bf16 v[132:135], v[60:63], v[20:23], v[132:135]
    v_mfma_f32_16x16x32_bf16 v[168:171], v[60:63], v[24:27], v[168:171]
    ds_read_b64_tr_b16 v[100:101], v204 offset:9440
    ds_read_b64_tr_b16 v[102:103], v204 offset:14048
    ds_read_b64_tr_b16 v[104:105], v204 offset:9472
    v_mfma_f32_16x16x32_bf16 v[136:139], v[64:67], v[20:23], v[136:139]
    v_mfma_f32_16x16x32_bf16 v[172:175], v[64:67], v[24:27], v[172:175]
    ds_read_b64_tr_b16 v[106:107], v204 offset:14080
    v_mfma_f32_16x16x32_bf16 v[140:143], v[68:71], v[20:23], v[140:143]
    v_mfma_f32_16x16x32_bf16 v[176:179], v[68:71], v[24:27], v[176:179]
    s_waitcnt lgkmcnt(0)
    s_waitcnt vmcnt(18)
    s_barrier
    s_add_u32 s4, s4, 128
    s_addc_u32 s5, s5, 0
    s_add_u32 s6, s6, s18
    s_addc_u32 s7, s7, 0
    s_lshl_b32 s9, s8, 12
    s_add_u32 m0, s9, 69632
    s_nop 0
    global_load_lds_dwordx4 v2, s[4:5]
    s_lshl_b32 s9, s8, 12
    s_add_u32 m0, s9, 70656
    s_nop 0
    global_load_lds_dwordx4 v3, s[4:5]
    s_lshl_b32 s9, s8, 12
    s_add_u32 m0, s9, 71680
    s_nop 0
    global_load_lds_dwordx4 v4, s[4:5]
    s_lshl_b32 s9, s8, 12
    s_add_u32 m0, s9, 72704
    s_nop 0
    global_load_lds_dwordx4 v5, s[4:5]
    s_mul_i32 s9, s8, 4608
    s_add_u32 m0, s9, 86016
    s_nop 0
    global_load_lds_dwordx4 v6, s[6:7]
    s_mul_i32 s9, s8, 4608
    s_add_u32 m0, s9, 87040
    s_nop 0
    global_load_lds_dwordx4 v7, s[6:7]
    s_mul_i32 s9, s8, 4608
    s_add_u32 m0, s9, 88064
    s_nop 0
    global_load_lds_dwordx4 v8, s[6:7]
    s_mul_i32 s9, s8, 4608
    s_add_u32 m0, s9, 89088
    s_nop 0
    global_load_lds_dwordx4 v9, s[6:7]
    s_mul_i32 s9, s8, 4608
    s_add_u32 m0, s9, 90112
    s_mov_b32 exec_hi, 0
    global_load_lds_dwordx4 v10, s[6:7]
    s_mov_b64 exec, -1
    v_mfma_f32_16x16x32_bf16 v[108:111], v[72:75], v[28:31], v[108:111]
    v_mfma_f32_16x16x32_bf16 v[144:147], v[72:75], v[32:35], v[144:147]
    ds_read_b64 v[20:21], v200 offset:34816
    ds_read_b64 v[22:23], v201 offset:34816
    ds_read_b64 v[24:25], v200 offset:36864
    v_mfma_f32_16x16x32_bf16 v[112:115], v[76:79], v[28:31], v[112:115]
    v_mfma_f32_16x16x32_bf16 v[148:151], v[76:79], v[32:35], v[148:151]
    ds_read_b64 v[26:27], v201 offset:36864
    ds_read_b64_tr_b16 v[36:37], v204 offset:34816
    ds_read_b64_tr_b16 v[38:39], v204 offset:39424
    v_mfma_f32_16x16x32_bf16 v[116:119], v[80:83], v[28:31], v[116:119]
    v_mfma_f32_16x16x32_bf16 v[152:155], v[80:83], v[32:35], v[152:155]
    ds_read_b64_tr_b16 v[40:41], v204 offset:34848
    ds_read_b64_tr_b16 v[42:43], v204 offset:39456
    ds_read_b64_tr_b16 v[44:45], v204 offset:34880
    v_mfma_f32_16x16x32_bf16 v[120:123], v[84:87], v[28:31], v[120:123]
    v_mfma_f32_16x16x32_bf16 v[156:159], v[84:87], v[32:35], v[156:159]
    ds_read_b64_tr_b16 v[46:47], v204 offset:39488
    ds_read_b64_tr_b16 v[48:49], v204 offset:34912
    ds_read_b64_tr_b16 v[50:51], v204 offset:39520
    v_mfma_f32_16x16x32_bf16 v[124:127], v[88:91], v[28:31], v[124:127]
    v_mfma_f32_16x16x32_bf16 v[160:163], v[88:91], v[32:35], v[160:163]
    ds_read_b64_tr_b16 v[52:53], v204 offset:34944
    ds_read_b64_tr_b16 v[54:55], v204 offset:39552
    ds_read_b64_tr_b16 v[56:57], v204 offset:34976
    v_mfma_f32_16x16x32_bf16 v[128:131], v[92:95], v[28:31], v[128:131]
    v_mfma_f32_16x16x32_bf16 v[164:167], v[92:95], v[32:35], v[164:167]
    ds_read_b64_tr_b16 v[58:59], v204 offset:39584
    ds_read_b64_tr_b16 v[60:61], v204 offset:35008
    ds_read_b64_tr_b16 v[62:63], v204 offset:39616
    v_mfma_f32_16x16x32_bf16 v[132:135], v[96:99], v[28:31], v[132:135]
    v_mfma_f32_16x16x32_bf16 v[168:171], v[96:99], v[32:35], v[168:171]
    ds_read_b64_tr_b16 v[64:65], v204 offset:35040
    ds_read_b64_tr_b16 v[66:67], v204 offset:39648
    ds_read_b64_tr_b16 v[68:69], v204 offset:35072
    v_mfma_f32_16x16x32_bf16 v[136:139], v[100:103], v[28:31], v[136:139]
    v_mfma_f32_16x16x32_bf16 v[172:175], v[100:103], v[32:35], v[172:175]
    ds_read_b64_tr_b16 v[70:71], v204 offset:39680
    v_mfma_f32_16x16x32_bf16 v[140:143], v[104:107], v[28:31], v[140:143]
    v_mfma_f32_16x16x32_bf16 v[176:179], v[104:107], v[32:35], v[176:179]
    s_waitcnt lgkmcnt(15)
    v_mfma_f32_16x16x32_bf16 v[108:111], v[36:39], v[20:23], v[108:111]
    v_mfma_f32_16x16x32_bf16 v[144:147], v[36:39], v[24:27], v[144:147]
    ds_read_b64 v[28:29], v202 offset:34816
    ds_read_b64 v[30:31], v203 offset:34816
    ds_read_b64 v[32:33], v202 offset:36864
    s_waitcnt lgkmcnt(15)
    v_mfma_f32_16x16x32_bf16 v[112:115], v[40:43], v[20:23], v[112:115]
    v_mfma_f32_16x16x32_bf16 v[148:151], v[40:43], v[24:27], v[148:151]
    ds_read_b64 v[34:35], v203 offset:36864
    ds_read_b64_tr_b16 v[72:73], v204 offset:44032
    ds_read_b64_tr_b16 v[74:75], v204 offset:48640
    v_mfma_f32_16x16x32_bf16 v[116:119], v[44:47], v[20:23], v[116:119]
    v_mfma_f32_16x16x32_bf16 v[152:155], v[44:47], v[24:27], v[152:155]
    ds_read_b64_tr_b16 v[76:77], v204 offset:44064
    ds_read_b64_tr_b16 v[78:79], v204 offset:48672
    ds_read_b64_tr_b16 v[80:81], v204 offset:44096
    s_waitcnt lgkmcnt(15)
    v_mfma_f32_16x16x32_bf16 v[120:123], v[48:51], v[20:23], v[120:123]
    v_mfma_f32_16x16x32_bf16 v[156:159], v[48:51], v[24:27], v[156:159]
    ds_read_b64_tr_b16 v[82:83], v204 offset:48704
    ds_read_b64_tr_b16 v[84:85], v204 offset:44128
    ds_read_b64_tr_b16 v[86:87], v204 offset:48736
    v_mfma_f32_16x16x32_bf16 v[124:127], v[52:55], v[20:23], v[124:127]
    v_mfma_f32_16x16x32_bf16 v[160:163], v[52:55], v[24:27], v[160:163]
    ds_read_b64_tr_b16 v[88:89], v204 offset:44160
    ds_read_b64_tr_b16 v[90:91], v204 offset:48768
    ds_read_b64_tr_b16 v[92:93], v204 offset:44192
    v_mfma_f32_16x16x32_bf16 v[128:131], v[56:59], v[20:23], v[128:131]
    v_mfma_f32_16x16x32_bf16 v[164:167], v[56:59], v[24:27], v[164:167]
    ds_read_b64_tr_b16 v[94:95], v204 offset:48800
    ds_read_b64_tr_b16 v[96:97], v204 offset:44224
    ds_read_b64_tr_b16 v[98:99], v204 offset:48832
    s_waitcnt lgkmcnt(15)
    v_mfma_f32_16x16x32_bf16 v[132:135], v[60:63], v[20:23], v[132:135]
    v_mfma_f32_16x16x32_bf16 v[168:171], v[60:63], v[24:27], v[168:171]
    ds_read_b64_tr_b16 v[100:101], v204 offset:44256
    ds_read_b64_tr_b16 v[102:103], v204 offset:48864
    ds_read_b64_tr_b16 v[104:105], v204 offset:44288
    v_mfma_f32_16x16x32_bf16 v[136:139], v[64:67], v[20:23], v[136:139]
    v_mfma_f32_16x16x32_bf16 v[172:175], v[64:67], v[24:27], v[172:175]
    ds_read_b64_tr_b16 v[106:107], v204 offset:48896
    v_mfma_f32_16x16x32_bf16 v[140:143], v[68:71], v[20:23], v[140:143]
    v_mfma_f32_16x16x32_bf16 v[176:179], v[68:71], v[24:27], v[176:179]
    s_waitcnt lgkmcnt(0)
    s_waitcnt vmcnt(18)
    s_barrier
    s_add_u32 s4, s4, 128
    s_addc_u32 s5, s5, 0
    s_add_u32 s6, s6, s18
    s_addc_u32 s7, s7, 0
    s_lshl_b32 s9, s8, 12
    s_add_u32 m0, s9, 104448
    s_nop 0
    global_load_lds_dwordx4 v2, s[4:5]
    s_lshl_b32 s9, s8, 12
    s_add_u32 m0, s9, 105472
    s_nop 0
    global_load_lds_dwordx4 v3, s[4:5]
    s_lshl_b32 s9, s8, 12
    s_add_u32 m0, s9, 106496
    s_nop 0
    global_load_lds_dwordx4 v4, s[4:5]
    s_lshl_b32 s9, s8, 12
    s_add_u32 m0, s9, 107520
    s_nop 0
    global_load_lds_dwordx4 v5, s[4:5]
    s_mul_i32 s9, s8, 4608
    s_add_u32 m0, s9, 120832
    s_nop 0
    global_load_lds_dwordx4 v6, s[6:7]
    s_mul_i32 s9, s8, 4608
    s_add_u32 m0, s9, 121856
    s_nop 0
    global_load_lds_dwordx4 v7, s[6:7]
    s_mul_i32 s9, s8, 4608
    s_add_u32 m0, s9, 122880
    s_nop 0
    global_load_lds_dwordx4 v8, s[6:7]
    s_mul_i32 s9, s8, 4608
    s_add_u32 m0, s9, 123904
    s_nop 0
    global_load_lds_dwordx4 v9, s[6:7]
    s_mul_i32 s9, s8, 4608
    s_add_u32 m0, s9, 124928
    s_mov_b32 exec_hi, 0
    global_load_lds_dwordx4 v10, s[6:7]
    s_mov_b64 exec, -1
    v_mfma_f32_16x16x32_bf16 v[108:111], v[72:75], v[28:31], v[108:111]
    v_mfma_f32_16x16x32_bf16 v[144:147], v[72:75], v[32:35], v[144:147]
    ds_read_b64 v[20:21], v11 offset:0
    ds_read_b64 v[22:23], v12 offset:0
    ds_read_b64 v[24:25], v11 offset:2048
    v_mfma_f32_16x16x32_bf16 v[112:115], v[76:79], v[28:31], v[112:115]
    v_mfma_f32_16x16x32_bf16 v[148:151], v[76:79], v[32:35], v[148:151]
    ds_read_b64 v[26:27], v12 offset:2048
    ds_read_b64_tr_b16 v[36:37], v15 offset:0
    ds_read_b64_tr_b16 v[38:39], v15 offset:4608
    v_mfma_f32_16x16x32_bf16 v[116:119], v[80:83], v[28:31], v[116:119]
    v_mfma_f32_16x16x32_bf16 v[152:155], v[80:83], v[32:35], v[152:155]
    ds_read_b64_tr_b16 v[40:41], v15 offset:32
    ds_read_b64_tr_b16 v[42:43], v15 offset:4640
    ds_read_b64_tr_b16 v[44:45], v15 offset:64
    v_mfma_f32_16x16x32_bf16 v[120:123], v[84:87], v[28:31], v[120:123]
    v_mfma_f32_16x16x32_bf16 v[156:159], v[84:87], v[32:35], v[156:159]
    ds_read_b64_tr_b16 v[46:47], v15 offset:4672
    ds_read_b64_tr_b16 v[48:49], v15 offset:96
    ds_read_b64_tr_b16 v[50:51], v15 offset:4704
    v_mfma_f32_16x16x32_bf16 v[124:127], v[88:91], v[28:31], v[124:127]
    v_mfma_f32_16x16x32_bf16 v[160:163], v[88:91], v[32:35], v[160:163]
    ds_read_b64_tr_b16 v[52:53], v15 offset:128
    ds_read_b64_tr_b16 v[54:55], v15 offset:4736
    ds_read_b64_tr_b16 v[56:57], v15 offset:160
    v_mfma_f32_16x16x32_bf16 v[128:131], v[92:95], v[28:31], v[128:131]
    v_mfma_f32_16x16x32_bf16 v[164:167], v[92:95], v[32:35], v[164:167]
    ds_read_b64_tr_b16 v[58:59], v15 offset:4768
    ds_read_b64_tr_b16 v[60:61], v15 offset:192
    ds_read_b64_tr_b16 v[62:63], v15 offset:4800
    v_mfma_f32_16x16x32_bf16 v[132:135], v[96:99], v[28:31], v[132:135]
    v_mfma_f32_16x16x32_bf16 v[168:171], v[96:99], v[32:35], v[168:171]
    ds_read_b64_tr_b16 v[64:65], v15 offset:224
    ds_read_b64_tr_b16 v[66:67], v15 offset:4832
    ds_read_b64_tr_b16 v[68:69], v15 offset:256
    v_mfma_f32_16x16x32_bf16 v[136:139], v[100:103], v[28:31], v[136:139]
    v_mfma_f32_16x16x32_bf16 v[172:175], v[100:103], v[32:35], v[172:175]
    ds_read_b64_tr_b16 v[70:71], v15 offset:4864
    v_mfma_f32_16x16x32_bf16 v[140:143], v[104:107], v[28:31], v[140:143]
    v_mfma_f32_16x16x32_bf16 v[176:179], v[104:107], v[32:35], v[176:179]
    s_waitcnt lgkmcnt(15)
    v_mfma_f32_16x16x32_bf16 v[108:111], v[36:39], v[20:23], v[108:111]
    v_mfma_f32_16x16x32_bf16 v[144:147], v[36:39], v[24:27], v[144:147]
    ds_read_b64 v[28:29], v13 offset:0
    ds_read_b64 v[30:31], v14 offset:0
    ds_read_b64 v[32:33], v13 offset:2048
    s_waitcnt lgkmcnt(15)
    v_mfma_f32_16x16x32_bf16 v[112:115], v[40:43], v[20:23], v[112:115]
    v_mfma_f32_16x16x32_bf16 v[148:151], v[40:43], v[24:27], v[148:151]
    ds_read_b64 v[34:35], v14 offset:2048
    ds_read_b64_tr_b16 v[72:73], v15 offset:9216
    ds_read_b64_tr_b16 v[74:75], v15 offset:13824
    v_mfma_f32_16x16x32_bf16 v[116:119], v[44:47], v[20:23], v[116:119]
    v_mfma_f32_16x16x32_bf16 v[152:155], v[44:47], v[24:27], v[152:155]
    ds_read_b64_tr_b16 v[76:77], v15 offset:9248
    ds_read_b64_tr_b16 v[78:79], v15 offset:13856
    ds_read_b64_tr_b16 v[80:81], v15 offset:9280
    s_waitcnt lgkmcnt(15)
    v_mfma_f32_16x16x32_bf16 v[120:123], v[48:51], v[20:23], v[120:123]
    v_mfma_f32_16x16x32_bf16 v[156:159], v[48:51], v[24:27], v[156:159]
    ds_read_b64_tr_b16 v[82:83], v15 offset:13888
    ds_read_b64_tr_b16 v[84:85], v15 offset:9312
    ds_read_b64_tr_b16 v[86:87], v15 offset:13920
    v_mfma_f32_16x16x32_bf16 v[124:127], v[52:55], v[20:23], v[124:127]
    v_mfma_f32_16x16x32_bf16 v[160:163], v[52:55], v[24:27], v[160:163]
    ds_read_b64_tr_b16 v[88:89], v15 offset:9344
    ds_read_b64_tr_b16 v[90:91], v15 offset:13952
    ds_read_b64_tr_b16 v[92:93], v15 offset:9376
    v_mfma_f32_16x16x32_bf16 v[128:131], v[56:59], v[20:23], v[128:131]
    v_mfma_f32_16x16x32_bf16 v[164:167], v[56:59], v[24:27], v[164:167]
    ds_read_b64_tr_b16 v[94:95], v15 offset:13984
    ds_read_b64_tr_b16 v[96:97], v15 offset:9408
    ds_read_b64_tr_b16 v[98:99], v15 offset:14016
    s_waitcnt lgkmcnt(15)
    v_mfma_f32_16x16x32_bf16 v[132:135], v[60:63], v[20:23], v[132:135]
    v_mfma_f32_16x16x32_bf16 v[168:171], v[60:63], v[24:27], v[168:171]
    ds_read_b64_tr_b16 v[100:101], v15 offset:9440
    ds_read_b64_tr_b16 v[102:103], v15 offset:14048
    ds_read_b64_tr_b16 v[104:105], v15 offset:9472
    v_mfma_f32_16x16x32_bf16 v[136:139], v[64:67], v[20:23], v[136:139]
    v_mfma_f32_16x16x32_bf16 v[172:175], v[64:67], v[24:27], v[172:175]
    ds_read_b64_tr_b16 v[106:107], v15 offset:14080
    v_mfma_f32_16x16x32_bf16 v[140:143], v[68:71], v[20:23], v[140:143]
    v_mfma_f32_16x16x32_bf16 v[176:179], v[68:71], v[24:27], v[176:179]
    s_waitcnt lgkmcnt(0)
    s_waitcnt vmcnt(18)
    s_barrier
    s_add_u32 s4, s4, 128
    s_addc_u32 s5, s5, 0
    s_add_u32 s6, s6, s18
    s_addc_u32 s7, s7, 0
    s_lshl_b32 s9, s8, 12
    s_add_u32 m0, s9, 0
    s_nop 0
    global_load_lds_dwordx4 v2, s[4:5]
    s_lshl_b32 s9, s8, 12
    s_add_u32 m0, s9, 1024
    s_nop 0
    global_load_lds_dwordx4 v3, s[4:5]
    s_lshl_b32 s9, s8, 12
    s_add_u32 m0, s9, 2048
    s_nop 0
    global_load_lds_dwordx4 v4, s[4:5]
    s_lshl_b32 s9, s8, 12
    s_add_u32 m0, s9, 3072
    s_nop 0
    global_load_lds_dwordx4 v5, s[4:5]
    s_mul_i32 s9, s8, 4608
    s_add_u32 m0, s9, 16384
    s_nop 0
    global_load_lds_dwordx4 v6, s[6:7]
    s_mul_i32 s9, s8, 4608
    s_add_u32 m0, s9, 17408
    s_nop 0
    global_load_lds_dwordx4 v7, s[6:7]
    s_mul_i32 s9, s8, 4608
    s_add_u32 m0, s9, 18432
    s_nop 0
    global_load_lds_dwordx4 v8, s[6:7]
    s_mul_i32 s9, s8, 4608
    s_add_u32 m0, s9, 19456
    s_nop 0
    global_load_lds_dwordx4 v9, s[6:7]
    s_mul_i32 s9, s8, 4608
    s_add_u32 m0, s9, 20480
    s_mov_b32 exec_hi, 0
    global_load_lds_dwordx4 v10, s[6:7]
    s_mov_b64 exec, -1
    v_mfma_f32_16x16x32_bf16 v[108:111], v[72:75], v[28:31], v[108:111]
    v_mfma_f32_16x16x32_bf16 v[144:147], v[72:75], v[32:35], v[144:147]
    ds_read_b64 v[20:21], v11 offset:34816
    ds_read_b64 v[22:23], v12 offset:34816
    ds_read_b64 v[24:25], v11 offset:36864
    v_mfma_f32_16x16x32_bf16 v[112:115], v[76:79], v[28:31], v[112:115]
    v_mfma_f32_16x16x32_bf16 v[148:151], v[76:79], v[32:35], v[148:151]
    ds_read_b64 v[26:27], v12 offset:36864
    ds_read_b64_tr_b16 v[36:37], v15 offset:34816
    ds_read_b64_tr_b16 v[38:39], v15 offset:39424
    v_mfma_f32_16x16x32_bf16 v[116:119], v[80:83], v[28:31], v[116:119]
    v_mfma_f32_16x16x32_bf16 v[152:155], v[80:83], v[32:35], v[152:155]
    ds_read_b64_tr_b16 v[40:41], v15 offset:34848
    ds_read_b64_tr_b16 v[42:43], v15 offset:39456
    ds_read_b64_tr_b16 v[44:45], v15 offset:34880
    v_mfma_f32_16x16x32_bf16 v[120:123], v[84:87], v[28:31], v[120:123]
    v_mfma_f32_16x16x32_bf16 v[156:159], v[84:87], v[32:35], v[156:159]
    ds_read_b64_tr_b16 v[46:47], v15 offset:39488
    ds_read_b64_tr_b16 v[48:49], v15 offset:34912
    ds_read_b64_tr_b16 v[50:51], v15 offset:39520
    v_mfma_f32_16x16x32_bf16 v[124:127], v[88:91], v[28:31], v[124:127]
    v_mfma_f32_16x16x32_bf16 v[160:163], v[88:91], v[32:35], v[160:163]
    ds_read_b64_tr_b16 v[52:53], v15 offset:34944
    ds_read_b64_tr_b16 v[54:55], v15 offset:39552
    ds_read_b64_tr_b16 v[56:57], v15 offset:34976
    v_mfma_f32_16x16x32_bf16 v[128:131], v[92:95], v[28:31], v[128:131]
    v_mfma_f32_16x16x32_bf16 v[164:167], v[92:95], v[32:35], v[164:167]
    ds_read_b64_tr_b16 v[58:59], v15 offset:39584
    ds_read_b64_tr_b16 v[60:61], v15 offset:35008
    ds_read_b64_tr_b16 v[62:63], v15 offset:39616
    v_mfma_f32_16x16x32_bf16 v[132:135], v[96:99], v[28:31], v[132:135]
    v_mfma_f32_16x16x32_bf16 v[168:171], v[96:99], v[32:35], v[168:171]
    ds_read_b64_tr_b16 v[64:65], v15 offset:35040
    ds_read_b64_tr_b16 v[66:67], v15 offset:39648
    ds_read_b64_tr_b16 v[68:69], v15 offset:35072
    v_mfma_f32_16x16x32_bf16 v[136:139], v[100:103], v[28:31], v[136:139]
    v_mfma_f32_16x16x32_bf16 v[172:175], v[100:103], v[32:35], v[172:175]
    ds_read_b64_tr_b16 v[70:71], v15 offset:39680
    v_mfma_f32_16x16x32_bf16 v[140:143], v[104:107], v[28:31], v[140:143]
    v_mfma_f32_16x16x32_bf16 v[176:179], v[104:107], v[32:35], v[176:179]
    s_waitcnt lgkmcnt(15)
    v_mfma_f32_16x16x32_bf16 v[108:111], v[36:39], v[20:23], v[108:111]
    v_mfma_f32_16x16x32_bf16 v[144:147], v[36:39], v[24:27], v[144:147]
    ds_read_b64 v[28:29], v13 offset:34816
    ds_read_b64 v[30:31], v14 offset:34816
    ds_read_b64 v[32:33], v13 offset:36864
    s_waitcnt lgkmcnt(15)
    v_mfma_f32_16x16x32_bf16 v[112:115], v[40:43], v[20:23], v[112:115]
    v_mfma_f32_16x16x32_bf16 v[148:151], v[40:43], v[24:27], v[148:151]
    ds_read_b64 v[34:35], v14 offset:36864
    ds_read_b64_tr_b16 v[72:73], v15 offset:44032
    ds_read_b64_tr_b16 v[74:75], v15 offset:48640
    v_mfma_f32_16x16x32_bf16 v[116:119], v[44:47], v[20:23], v[116:119]
    v_mfma_f32_16x16x32_bf16 v[152:155], v[44:47], v[24:27], v[152:155]
    ds_read_b64_tr_b16 v[76:77], v15 offset:44064
    ds_read_b64_tr_b16 v[78:79], v15 offset:48672
    ds_read_b64_tr_b16 v[80:81], v15 offset:44096
    s_waitcnt lgkmcnt(15)
    v_mfma_f32_16x16x32_bf16 v[120:123], v[48:51], v[20:23], v[120:123]
    v_mfma_f32_16x16x32_bf16 v[156:159], v[48:51], v[24:27], v[156:159]
    ds_read_b64_tr_b16 v[82:83], v15 offset:48704
    ds_read_b64_tr_b16 v[84:85], v15 offset:44128
    ds_read_b64_tr_b16 v[86:87], v15 offset:48736
    v_mfma_f32_16x16x32_bf16 v[124:127], v[52:55], v[20:23], v[124:127]
    v_mfma_f32_16x16x32_bf16 v[160:163], v[52:55], v[24:27], v[160:163]
    ds_read_b64_tr_b16 v[88:89], v15 offset:44160
    ds_read_b64_tr_b16 v[90:91], v15 offset:48768
    ds_read_b64_tr_b16 v[92:93], v15 offset:44192
    v_mfma_f32_16x16x32_bf16 v[128:131], v[56:59], v[20:23], v[128:131]
    v_mfma_f32_16x16x32_bf16 v[164:167], v[56:59], v[24:27], v[164:167]
    ds_read_b64_tr_b16 v[94:95], v15 offset:48800
    ds_read_b64_tr_b16 v[96:97], v15 offset:44224
    ds_read_b64_tr_b16 v[98:99], v15 offset:48832
    s_waitcnt lgkmcnt(15)
    v_mfma_f32_16x16x32_bf16 v[132:135], v[60:63], v[20:23], v[132:135]
    v_mfma_f32_16x16x32_bf16 v[168:171], v[60:63], v[24:27], v[168:171]
    ds_read_b64_tr_b16 v[100:101], v15 offset:44256
    ds_read_b64_tr_b16 v[102:103], v15 offset:48864
    ds_read_b64_tr_b16 v[104:105], v15 offset:44288
    v_mfma_f32_16x16x32_bf16 v[136:139], v[64:67], v[20:23], v[136:139]
    v_mfma_f32_16x16x32_bf16 v[172:175], v[64:67], v[24:27], v[172:175]
    ds_read_b64_tr_b16 v[106:107], v15 offset:48896
    v_mfma_f32_16x16x32_bf16 v[140:143], v[68:71], v[20:23], v[140:143]
    v_mfma_f32_16x16x32_bf16 v[176:179], v[68:71], v[24:27], v[176:179]
    s_waitcnt lgkmcnt(0)
    s_waitcnt vmcnt(18)
    s_barrier
    s_add_u32 s4, s4, 128
    s_addc_u32 s5, s5, 0
    s_add_u32 s6, s6, s18
    s_addc_u32 s7, s7, 0
    s_lshl_b32 s9, s8, 12
    s_add_u32 m0, s9, 34816
    s_nop 0
    global_load_lds_dwordx4 v2, s[4:5]
    s_lshl_b32 s9, s8, 12
    s_add_u32 m0, s9, 35840
    s_nop 0
    global_load_lds_dwordx4 v3, s[4:5]
    s_lshl_b32 s9, s8, 12
    s_add_u32 m0, s9, 36864
    s_nop 0
    global_load_lds_dwordx4 v4, s[4:5]
    s_lshl_b32 s9, s8, 12
    s_add_u32 m0, s9, 37888
    s_nop 0
    global_load_lds_dwordx4 v5, s[4:5]
    s_mul_i32 s9, s8, 4608
    s_add_u32 m0, s9, 51200
    s_nop 0
    global_load_lds_dwordx4 v6, s[6:7]
    s_mul_i32 s9, s8, 4608
    s_add_u32 m0, s9, 52224
    s_nop 0
    global_load_lds_dwordx4 v7, s[6:7]
    s_mul_i32 s9, s8, 4608
    s_add_u32 m0, s9, 53248
    s_nop 0
    global_load_lds_dwordx4 v8, s[6:7]
    s_mul_i32 s9, s8, 4608
    s_add_u32 m0, s9, 54272
    s_nop 0
    global_load_lds_dwordx4 v9, s[6:7]
    s_mul_i32 s9, s8, 4608
    s_add_u32 m0, s9, 55296
    s_mov_b32 exec_hi, 0
    global_load_lds_dwordx4 v10, s[6:7]
    s_mov_b64 exec, -1
    v_mfma_f32_16x16x32_bf16 v[108:111], v[72:75], v[28:31], v[108:111]
    v_mfma_f32_16x16x32_bf16 v[144:147], v[72:75], v[32:35], v[144:147]
    ds_read_b64 v[20:21], v200 offset:0
    ds_read_b64 v[22:23], v201 offset:0
    ds_read_b64 v[24:25], v200 offset:2048
    v_mfma_f32_16x16x32_bf16 v[112:115], v[76:79], v[28:31], v[112:115]
    v_mfma_f32_16x16x32_bf16 v[148:151], v[76:79], v[32:35], v[148:151]
    ds_read_b64 v[26:27], v201 offset:2048
    ds_read_b64_tr_b16 v[36:37], v204 offset:0
    ds_read_b64_tr_b16 v[38:39], v204 offset:4608
    v_mfma_f32_16x16x32_bf16 v[116:119], v[80:83], v[28:31], v[116:119]
    v_mfma_f32_16x16x32_bf16 v[152:155], v[80:83], v[32:35], v[152:155]
    ds_read_b64_tr_b16 v[40:41], v204 offset:32
    ds_read_b64_tr_b16 v[42:43], v204 offset:4640
    ds_read_b64_tr_b16 v[44:45], v204 offset:64
    v_mfma_f32_16x16x32_bf16 v[120:123], v[84:87], v[28:31], v[120:123]
    v_mfma_f32_16x16x32_bf16 v[156:159], v[84:87], v[32:35], v[156:159]
    ds_read_b64_tr_b16 v[46:47], v204 offset:4672
    ds_read_b64_tr_b16 v[48:49], v204 offset:96
    ds_read_b64_tr_b16 v[50:51], v204 offset:4704
    v_mfma_f32_16x16x32_bf16 v[124:127], v[88:91], v[28:31], v[124:127]
    v_mfma_f32_16x16x32_bf16 v[160:163], v[88:91], v[32:35], v[160:163]
    ds_read_b64_tr_b16 v[52:53], v204 offset:128
    ds_read_b64_tr_b16 v[54:55], v204 offset:4736
    ds_read_b64_tr_b16 v[56:57], v204 offset:160
    v_mfma_f32_16x16x32_bf16 v[128:131], v[92:95], v[28:31], v[128:131]
    v_mfma_f32_16x16x32_bf16 v[164:167], v[92:95], v[32:35], v[164:167]
    ds_read_b64_tr_b16 v[58:59], v204 offset:4768
    ds_read_b64_tr_b16 v[60:61], v204 offset:192
    ds_read_b64_tr_b16 v[62:63], v204 offset:4800
    v_mfma_f32_16x16x32_bf16 v[132:135], v[96:99], v[28:31], v[132:135]
    v_mfma_f32_16x16x32_bf16 v[168:171], v[96:99], v[32:35], v[168:171]
    ds_read_b64_tr_b16 v[64:65], v204 offset:224
    ds_read_b64_tr_b16 v[66:67], v204 offset:4832
    ds_read_b64_tr_b16 v[68:69], v204 offset:256
    v_mfma_f32_16x16x32_bf16 v[136:139], v[100:103], v[28:31], v[136:139]
    v_mfma_f32_16x16x32_bf16 v[172:175], v[100:103], v[32:35], v[172:175]
    ds_read_b64_tr_b16 v[70:71], v204 offset:4864
    v_mfma_f32_16x16x32_bf16 v[140:143], v[104:107], v[28:31], v[140:143]
    v_mfma_f32_16x16x32_bf16 v[176:179], v[104:107], v[32:35], v[176:179]
    s_waitcnt lgkmcnt(15)
    v_mfma_f32_16x16x32_bf16 v[108:111], v[36:39], v[20:23], v[108:111]
    v_mfma_f32_16x16x32_bf16 v[144:147], v[36:39], v[24:27], v[144:147]
    ds_read_b64 v[28:29], v202 offset:0
    ds_read_b64 v[30:31], v203 offset:0
    ds_read_b64 v[32:33], v202 offset:2048
    s_waitcnt lgkmcnt(15)
    v_mfma_f32_16x16x32_bf16 v[112:115], v[40:43], v[20:23], v[112:115]
    v_mfma_f32_16x16x32_bf16 v[148:151], v[40:43], v[24:27], v[148:151]
    ds_read_b64 v[34:35], v203 offset:2048
    ds_read_b64_tr_b16 v[72:73], v204 offset:9216
    ds_read_b64_tr_b16 v[74:75], v204 offset:13824
    v_mfma_f32_16x16x32_bf16 v[116:119], v[44:47], v[20:23], v[116:119]
    v_mfma_f32_16x16x32_bf16 v[152:155], v[44:47], v[24:27], v[152:155]
    ds_read_b64_tr_b16 v[76:77], v204 offset:9248
    ds_read_b64_tr_b16 v[78:79], v204 offset:13856
    ds_read_b64_tr_b16 v[80:81], v204 offset:9280
    s_waitcnt lgkmcnt(15)
    v_mfma_f32_16x16x32_bf16 v[120:123], v[48:51], v[20:23], v[120:123]
    v_mfma_f32_16x16x32_bf16 v[156:159], v[48:51], v[24:27], v[156:159]
    ds_read_b64_tr_b16 v[82:83], v204 offset:13888
    ds_read_b64_tr_b16 v[84:85], v204 offset:9312
    ds_read_b64_tr_b16 v[86:87], v204 offset:13920
    v_mfma_f32_16x16x32_bf16 v[124:127], v[52:55], v[20:23], v[124:127]
    v_mfma_f32_16x16x32_bf16 v[160:163], v[52:55], v[24:27], v[160:163]
    ds_read_b64_tr_b16 v[88:89], v204 offset:9344
    ds_read_b64_tr_b16 v[90:91], v204 offset:13952
    ds_read_b64_tr_b16 v[92:93], v204 offset:9376
    v_mfma_f32_16x16x32_bf16 v[128:131], v[56:59], v[20:23], v[128:131]
    v_mfma_f32_16x16x32_bf16 v[164:167], v[56:59], v[24:27], v[164:167]
    ds_read_b64_tr_b16 v[94:95], v204 offset:13984
    ds_read_b64_tr_b16 v[96:97], v204 offset:9408
    ds_read_b64_tr_b16 v[98:99], v204 offset:14016
    s_waitcnt lgkmcnt(15)
    v_mfma_f32_16x16x32_bf16 v[132:135], v[60:63], v[20:23], v[132:135]
    v_mfma_f32_16x16x32_bf16 v[168:171], v[60:63], v[24:27], v[168:171]
    ds_read_b64_tr_b16 v[100:101], v204 offset:9440
    ds_read_b64_tr_b16 v[102:103], v204 offset:14048
    ds_read_b64_tr_b16 v[104:105], v204 offset:9472
    v_mfma_f32_16x16x32_bf16 v[136:139], v[64:67], v[20:23], v[136:139]
    v_mfma_f32_16x16x32_bf16 v[172:175], v[64:67], v[24:27], v[172:175]
    ds_read_b64_tr_b16 v[106:107], v204 offset:14080
    v_mfma_f32_16x16x32_bf16 v[140:143], v[68:71], v[20:23], v[140:143]
    v_mfma_f32_16x16x32_bf16 v[176:179], v[68:71], v[24:27], v[176:179]
    s_waitcnt lgkmcnt(0)
    s_waitcnt vmcnt(18)
    s_barrier
    s_add_u32 s4, s4, 128
    s_addc_u32 s5, s5, 0
    s_add_u32 s6, s6, s18
    s_addc_u32 s7, s7, 0
    s_lshl_b32 s9, s8, 12
    s_add_u32 m0, s9, 69632
    s_nop 0
    global_load_lds_dwordx4 v2, s[4:5]
    s_lshl_b32 s9, s8, 12
    s_add_u32 m0, s9, 70656
    s_nop 0
    global_load_lds_dwordx4 v3, s[4:5]
    s_lshl_b32 s9, s8, 12
    s_add_u32 m0, s9, 71680
    s_nop 0
    global_load_lds_dwordx4 v4, s[4:5]
    s_lshl_b32 s9, s8, 12
    s_add_u32 m0, s9, 72704
    s_nop 0
    global_load_lds_dwordx4 v5, s[4:5]
    s_mul_i32 s9, s8, 4608
    s_add_u32 m0, s9, 86016
    s_nop 0
    global_load_lds_dwordx4 v6, s[6:7]
    s_mul_i32 s9, s8, 4608
    s_add_u32 m0, s9, 87040
    s_nop 0
    global_load_lds_dwordx4 v7, s[6:7]
    s_mul_i32 s9, s8, 4608
    s_add_u32 m0, s9, 88064
    s_nop 0
    global_load_lds_dwordx4 v8, s[6:7]
    s_mul_i32 s9, s8, 4608
    s_add_u32 m0, s9, 89088
    s_nop 0
    global_load_lds_dwordx4 v9, s[6:7]
    s_mul_i32 s9, s8, 4608
    s_add_u32 m0, s9, 90112
    s_mov_b32 exec_hi, 0
    global_load_lds_dwordx4 v10, s[6:7]
    s_mov_b64 exec, -1
    v_mfma_f32_16x16x32_bf16 v[108:111], v[72:75], v[28:31], v[108:111]
    v_mfma_f32_16x16x32_bf16 v[144:147], v[72:75], v[32:35], v[144:147]
    ds_read_b64 v[20:21], v200 offset:34816
    ds_read_b64 v[22:23], v201 offset:34816
    ds_read_b64 v[24:25], v200 offset:36864
    v_mfma_f32_16x16x32_bf16 v[112:115], v[76:79], v[28:31], v[112:115]
    v_mfma_f32_16x16x32_bf16 v[148:151], v[76:79], v[32:35], v[148:151]
    ds_read_b64 v[26:27], v201 offset:36864
    ds_read_b64_tr_b16 v[36:37], v204 offset:34816
    ds_read_b64_tr_b16 v[38:39], v204 offset:39424
    v_mfma_f32_16x16x32_bf16 v[116:119], v[80:83], v[28:31], v[116:119]
    v_mfma_f32_16x16x32_bf16 v[152:155], v[80:83], v[32:35], v[152:155]
    ds_read_b64_tr_b16 v[40:41], v204 offset:34848
    ds_read_b64_tr_b16 v[42:43], v204 offset:39456
    ds_read_b64_tr_b16 v[44:45], v204 offset:34880
    v_mfma_f32_16x16x32_bf16 v[120:123], v[84:87], v[28:31], v[120:123]
    v_mfma_f32_16x16x32_bf16 v[156:159], v[84:87], v[32:35], v[156:159]
    ds_read_b64_tr_b16 v[46:47], v204 offset:39488
    ds_read_b64_tr_b16 v[48:49], v204 offset:34912
    ds_read_b64_tr_b16 v[50:51], v204 offset:39520
    v_mfma_f32_16x16x32_bf16 v[124:127], v[88:91], v[28:31], v[124:127]
    v_mfma_f32_16x16x32_bf16 v[160:163], v[88:91], v[32:35], v[160:163]
    ds_read_b64_tr_b16 v[52:53], v204 offset:34944
    ds_read_b64_tr_b16 v[54:55], v204 offset:39552
    ds_read_b64_tr_b16 v[56:57], v204 offset:34976
    v_mfma_f32_16x16x32_bf16 v[128:131], v[92:95], v[28:31], v[128:131]
    v_mfma_f32_16x16x32_bf16 v[164:167], v[92:95], v[32:35], v[164:167]
    ds_read_b64_tr_b16 v[58:59], v204 offset:39584
    ds_read_b64_tr_b16 v[60:61], v204 offset:35008
    ds_read_b64_tr_b16 v[62:63], v204 offset:39616
    v_mfma_f32_16x16x32_bf16 v[132:135], v[96:99], v[28:31], v[132:135]
    v_mfma_f32_16x16x32_bf16 v[168:171], v[96:99], v[32:35], v[168:171]
    ds_read_b64_tr_b16 v[64:65], v204 offset:35040
    ds_read_b64_tr_b16 v[66:67], v204 offset:39648
    ds_read_b64_tr_b16 v[68:69], v204 offset:35072
    v_mfma_f32_16x16x32_bf16 v[136:139], v[100:103], v[28:31], v[136:139]
    v_mfma_f32_16x16x32_bf16 v[172:175], v[100:103], v[32:35], v[172:175]
    ds_read_b64_tr_b16 v[70:71], v204 offset:39680
    v_mfma_f32_16x16x32_bf16 v[140:143], v[104:107], v[28:31], v[140:143]
    v_mfma_f32_16x16x32_bf16 v[176:179], v[104:107], v[32:35], v[176:179]
    s_waitcnt lgkmcnt(15)
    v_mfma_f32_16x16x32_bf16 v[108:111], v[36:39], v[20:23], v[108:111]
    v_mfma_f32_16x16x32_bf16 v[144:147], v[36:39], v[24:27], v[144:147]
    ds_read_b64 v[28:29], v202 offset:34816
    ds_read_b64 v[30:31], v203 offset:34816
    ds_read_b64 v[32:33], v202 offset:36864
    s_waitcnt lgkmcnt(15)
    v_mfma_f32_16x16x32_bf16 v[112:115], v[40:43], v[20:23], v[112:115]
    v_mfma_f32_16x16x32_bf16 v[148:151], v[40:43], v[24:27], v[148:151]
    ds_read_b64 v[34:35], v203 offset:36864
    ds_read_b64_tr_b16 v[72:73], v204 offset:44032
    ds_read_b64_tr_b16 v[74:75], v204 offset:48640
    v_mfma_f32_16x16x32_bf16 v[116:119], v[44:47], v[20:23], v[116:119]
    v_mfma_f32_16x16x32_bf16 v[152:155], v[44:47], v[24:27], v[152:155]
    ds_read_b64_tr_b16 v[76:77], v204 offset:44064
    ds_read_b64_tr_b16 v[78:79], v204 offset:48672
    ds_read_b64_tr_b16 v[80:81], v204 offset:44096
    s_waitcnt lgkmcnt(15)
    v_mfma_f32_16x16x32_bf16 v[120:123], v[48:51], v[20:23], v[120:123]
    v_mfma_f32_16x16x32_bf16 v[156:159], v[48:51], v[24:27], v[156:159]
    ds_read_b64_tr_b16 v[82:83], v204 offset:48704
    ds_read_b64_tr_b16 v[84:85], v204 offset:44128
    ds_read_b64_tr_b16 v[86:87], v204 offset:48736
    v_mfma_f32_16x16x32_bf16 v[124:127], v[52:55], v[20:23], v[124:127]
    v_mfma_f32_16x16x32_bf16 v[160:163], v[52:55], v[24:27], v[160:163]
    ds_read_b64_tr_b16 v[88:89], v204 offset:44160
    ds_read_b64_tr_b16 v[90:91], v204 offset:48768
    ds_read_b64_tr_b16 v[92:93], v204 offset:44192
    v_mfma_f32_16x16x32_bf16 v[128:131], v[56:59], v[20:23], v[128:131]
    v_mfma_f32_16x16x32_bf16 v[164:167], v[56:59], v[24:27], v[164:167]
    ds_read_b64_tr_b16 v[94:95], v204 offset:48800
    ds_read_b64_tr_b16 v[96:97], v204 offset:44224
    ds_read_b64_tr_b16 v[98:99], v204 offset:48832
    s_waitcnt lgkmcnt(15)
    v_mfma_f32_16x16x32_bf16 v[132:135], v[60:63], v[20:23], v[132:135]
    v_mfma_f32_16x16x32_bf16 v[168:171], v[60:63], v[24:27], v[168:171]
    ds_read_b64_tr_b16 v[100:101], v204 offset:44256
    ds_read_b64_tr_b16 v[102:103], v204 offset:48864
    ds_read_b64_tr_b16 v[104:105], v204 offset:44288
    v_mfma_f32_16x16x32_bf16 v[136:139], v[64:67], v[20:23], v[136:139]
    v_mfma_f32_16x16x32_bf16 v[172:175], v[64:67], v[24:27], v[172:175]
    ds_read_b64_tr_b16 v[106:107], v204 offset:48896
    v_mfma_f32_16x16x32_bf16 v[140:143], v[68:71], v[20:23], v[140:143]
    v_mfma_f32_16x16x32_bf16 v[176:179], v[68:71], v[24:27], v[176:179]
    s_waitcnt lgkmcnt(0)
    s_waitcnt vmcnt(18)
    s_barrier
    s_add_u32 s4, s4, 128
    s_addc_u32 s5, s5, 0
    s_add_u32 s6, s6, s18
    s_addc_u32 s7, s7, 0
    s_lshl_b32 s9, s8, 12
    s_add_u32 m0, s9, 104448
    s_nop 0
    global_load_lds_dwordx4 v2, s[4:5]
    s_lshl_b32 s9, s8, 12
    s_add_u32 m0, s9, 105472
    s_nop 0
    global_load_lds_dwordx4 v3, s[4:5]
    s_lshl_b32 s9, s8, 12
    s_add_u32 m0, s9, 106496
    s_nop 0
    global_load_lds_dwordx4 v4, s[4:5]
    s_lshl_b32 s9, s8, 12
    s_add_u32 m0, s9, 107520
    s_nop 0
    global_load_lds_dwordx4 v5, s[4:5]
    s_mul_i32 s9, s8, 4608
    s_add_u32 m0, s9, 120832
    s_nop 0
    global_load_lds_dwordx4 v6, s[6:7]
    s_mul_i32 s9, s8, 4608
    s_add_u32 m0, s9, 121856
    s_nop 0
    global_load_lds_dwordx4 v7, s[6:7]
    s_mul_i32 s9, s8, 4608
    s_add_u32 m0, s9, 122880
    s_nop 0
    global_load_lds_dwordx4 v8, s[6:7]
    s_mul_i32 s9, s8, 4608
    s_add_u32 m0, s9, 123904
    s_nop 0
    global_load_lds_dwordx4 v9, s[6:7]
    s_mul_i32 s9, s8, 4608
    s_add_u32 m0, s9, 124928
    s_mov_b32 exec_hi, 0
    global_load_lds_dwordx4 v10, s[6:7]
    s_mov_b64 exec, -1
    v_mfma_f32_16x16x32_bf16 v[108:111], v[72:75], v[28:31], v[108:111]
    v_mfma_f32_16x16x32_bf16 v[144:147], v[72:75], v[32:35], v[144:147]
    ds_read_b64 v[20:21], v11 offset:0
    ds_read_b64 v[22:23], v12 offset:0
    ds_read_b64 v[24:25], v11 offset:2048
    v_mfma_f32_16x16x32_bf16 v[112:115], v[76:79], v[28:31], v[112:115]
    v_mfma_f32_16x16x32_bf16 v[148:151], v[76:79], v[32:35], v[148:151]
    ds_read_b64 v[26:27], v12 offset:2048
    ds_read_b64_tr_b16 v[36:37], v15 offset:0
    ds_read_b64_tr_b16 v[38:39], v15 offset:4608
    v_mfma_f32_16x16x32_bf16 v[116:119], v[80:83], v[28:31], v[116:119]
    v_mfma_f32_16x16x32_bf16 v[152:155], v[80:83], v[32:35], v[152:155]
    ds_read_b64_tr_b16 v[40:41], v15 offset:32
    ds_read_b64_tr_b16 v[42:43], v15 offset:4640
    ds_read_b64_tr_b16 v[44:45], v15 offset:64
    v_mfma_f32_16x16x32_bf16 v[120:123], v[84:87], v[28:31], v[120:123]
    v_mfma_f32_16x16x32_bf16 v[156:159], v[84:87], v[32:35], v[156:159]
    ds_read_b64_tr_b16 v[46:47], v15 offset:4672
    ds_read_b64_tr_b16 v[48:49], v15 offset:96
    ds_read_b64_tr_b16 v[50:51], v15 offset:4704
    v_mfma_f32_16x16x32_bf16 v[124:127], v[88:91], v[28:31], v[124:127]
    v_mfma_f32_16x16x32_bf16 v[160:163], v[88:91], v[32:35], v[160:163]
    ds_read_b64_tr_b16 v[52:53], v15 offset:128
    ds_read_b64_tr_b16 v[54:55], v15 offset:4736
    ds_read_b64_tr_b16 v[56:57], v15 offset:160
    v_mfma_f32_16x16x32_bf16 v[128:131], v[92:95], v[28:31], v[128:131]
    v_mfma_f32_16x16x32_bf16 v[164:167], v[92:95], v[32:35], v[164:167]
    ds_read_b64_tr_b16 v[58:59], v15 offset:4768
    ds_read_b64_tr_b16 v[60:61], v15 offset:192
    ds_read_b64_tr_b16 v[62:63], v15 offset:4800
    v_mfma_f32_16x16x32_bf16 v[132:135], v[96:99], v[28:31], v[132:135]
    v_mfma_f32_16x16x32_bf16 v[168:171], v[96:99], v[32:35], v[168:171]
    ds_read_b64_tr_b16 v[64:65], v15 offset:224
    ds_read_b64_tr_b16 v[66:67], v15 offset:4832
    ds_read_b64_tr_b16 v[68:69], v15 offset:256
    v_mfma_f32_16x16x32_bf16 v[136:139], v[100:103], v[28:31], v[136:139]
    v_mfma_f32_16x16x32_bf16 v[172:175], v[100:103], v[32:35], v[172:175]
    ds_read_b64_tr_b16 v[70:71], v15 offset:4864
    v_mfma_f32_16x16x32_bf16 v[140:143], v[104:107], v[28:31], v[140:143]
    v_mfma_f32_16x16x32_bf16 v[176:179], v[104:107], v[32:35], v[176:179]
    s_waitcnt lgkmcnt(15)
    v_mfma_f32_16x16x32_bf16 v[108:111], v[36:39], v[20:23], v[108:111]
    v_mfma_f32_16x16x32_bf16 v[144:147], v[36:39], v[24:27], v[144:147]
    ds_read_b64 v[28:29], v13 offset:0
    ds_read_b64 v[30:31], v14 offset:0
    ds_read_b64 v[32:33], v13 offset:2048
    s_waitcnt lgkmcnt(15)
    v_mfma_f32_16x16x32_bf16 v[112:115], v[40:43], v[20:23], v[112:115]
    v_mfma_f32_16x16x32_bf16 v[148:151], v[40:43], v[24:27], v[148:151]
    ds_read_b64 v[34:35], v14 offset:2048
    ds_read_b64_tr_b16 v[72:73], v15 offset:9216
    ds_read_b64_tr_b16 v[74:75], v15 offset:13824
    v_mfma_f32_16x16x32_bf16 v[116:119], v[44:47], v[20:23], v[116:119]
    v_mfma_f32_16x16x32_bf16 v[152:155], v[44:47], v[24:27], v[152:155]
    ds_read_b64_tr_b16 v[76:77], v15 offset:9248
    ds_read_b64_tr_b16 v[78:79], v15 offset:13856
    ds_read_b64_tr_b16 v[80:81], v15 offset:9280
    s_waitcnt lgkmcnt(15)
    v_mfma_f32_16x16x32_bf16 v[120:123], v[48:51], v[20:23], v[120:123]
    v_mfma_f32_16x16x32_bf16 v[156:159], v[48:51], v[24:27], v[156:159]
    ds_read_b64_tr_b16 v[82:83], v15 offset:13888
    ds_read_b64_tr_b16 v[84:85], v15 offset:9312
    ds_read_b64_tr_b16 v[86:87], v15 offset:13920
    v_mfma_f32_16x16x32_bf16 v[124:127], v[52:55], v[20:23], v[124:127]
    v_mfma_f32_16x16x32_bf16 v[160:163], v[52:55], v[24:27], v[160:163]
    ds_read_b64_tr_b16 v[88:89], v15 offset:9344
    ds_read_b64_tr_b16 v[90:91], v15 offset:13952
    ds_read_b64_tr_b16 v[92:93], v15 offset:9376
    v_mfma_f32_16x16x32_bf16 v[128:131], v[56:59], v[20:23], v[128:131]
    v_mfma_f32_16x16x32_bf16 v[164:167], v[56:59], v[24:27], v[164:167]
    ds_read_b64_tr_b16 v[94:95], v15 offset:13984
    ds_read_b64_tr_b16 v[96:97], v15 offset:9408
    ds_read_b64_tr_b16 v[98:99], v15 offset:14016
    s_waitcnt lgkmcnt(15)
    v_mfma_f32_16x16x32_bf16 v[132:135], v[60:63], v[20:23], v[132:135]
    v_mfma_f32_16x16x32_bf16 v[168:171], v[60:63], v[24:27], v[168:171]
    ds_read_b64_tr_b16 v[100:101], v15 offset:9440
    ds_read_b64_tr_b16 v[102:103], v15 offset:14048
    ds_read_b64_tr_b16 v[104:105], v15 offset:9472
    v_mfma_f32_16x16x32_bf16 v[136:139], v[64:67], v[20:23], v[136:139]
    v_mfma_f32_16x16x32_bf16 v[172:175], v[64:67], v[24:27], v[172:175]
    ds_read_b64_tr_b16 v[106:107], v15 offset:14080
    v_mfma_f32_16x16x32_bf16 v[140:143], v[68:71], v[20:23], v[140:143]
    v_mfma_f32_16x16x32_bf16 v[176:179], v[68:71], v[24:27], v[176:179]
    s_waitcnt lgkmcnt(0)
    s_waitcnt vmcnt(18)
    s_barrier
    s_add_u32 s4, s4, 128
    s_addc_u32 s5, s5, 0
    s_add_u32 s6, s6, s18
    s_addc_u32 s7, s7, 0
    s_lshl_b32 s9, s8, 12
    s_add_u32 m0, s9, 0
    s_nop 0
    global_load_lds_dwordx4 v2, s[4:5]
    s_lshl_b32 s9, s8, 12
    s_add_u32 m0, s9, 1024
    s_nop 0
    global_load_lds_dwordx4 v3, s[4:5]
    s_lshl_b32 s9, s8, 12
    s_add_u32 m0, s9, 2048
    s_nop 0
    global_load_lds_dwordx4 v4, s[4:5]
    s_lshl_b32 s9, s8, 12
    s_add_u32 m0, s9, 3072
    s_nop 0
    global_load_lds_dwordx4 v5, s[4:5]
    s_mul_i32 s9, s8, 4608
    s_add_u32 m0, s9, 16384
    s_nop 0
    global_load_lds_dwordx4 v6, s[6:7]
    s_mul_i32 s9, s8, 4608
    s_add_u32 m0, s9, 17408
    s_nop 0
    global_load_lds_dwordx4 v7, s[6:7]
    s_mul_i32 s9, s8, 4608
    s_add_u32 m0, s9, 18432
    s_nop 0
    global_load_lds_dwordx4 v8, s[6:7]
    s_mul_i32 s9, s8, 4608
    s_add_u32 m0, s9, 19456
    s_nop 0
    global_load_lds_dwordx4 v9, s[6:7]
    s_mul_i32 s9, s8, 4608
    s_add_u32 m0, s9, 20480
    s_mov_b32 exec_hi, 0
    global_load_lds_dwordx4 v10, s[6:7]
    s_mov_b64 exec, -1
    v_mfma_f32_16x16x32_bf16 v[108:111], v[72:75], v[28:31], v[108:111]
    v_mfma_f32_16x16x32_bf16 v[144:147], v[72:75], v[32:35], v[144:147]
    ds_read_b64 v[20:21], v11 offset:34816
    ds_read_b64 v[22:23], v12 offset:34816
    ds_read_b64 v[24:25], v11 offset:36864
    v_mfma_f32_16x16x32_bf16 v[112:115], v[76:79], v[28:31], v[112:115]
    v_mfma_f32_16x16x32_bf16 v[148:151], v[76:79], v[32:35], v[148:151]
    ds_read_b64 v[26:27], v12 offset:36864
    ds_read_b64_tr_b16 v[36:37], v15 offset:34816
    ds_read_b64_tr_b16 v[38:39], v15 offset:39424
    v_mfma_f32_16x16x32_bf16 v[116:119], v[80:83], v[28:31], v[116:119]
    v_mfma_f32_16x16x32_bf16 v[152:155], v[80:83], v[32:35], v[152:155]
    ds_read_b64_tr_b16 v[40:41], v15 offset:34848
    ds_read_b64_tr_b16 v[42:43], v15 offset:39456
    ds_read_b64_tr_b16 v[44:45], v15 offset:34880
    v_mfma_f32_16x16x32_bf16 v[120:123], v[84:87], v[28:31], v[120:123]
    v_mfma_f32_16x16x32_bf16 v[156:159], v[84:87], v[32:35], v[156:159]
    ds_read_b64_tr_b16 v[46:47], v15 offset:39488
    ds_read_b64_tr_b16 v[48:49], v15 offset:34912
    ds_read_b64_tr_b16 v[50:51], v15 offset:39520
    v_mfma_f32_16x16x32_bf16 v[124:127], v[88:91], v[28:31], v[124:127]
    v_mfma_f32_16x16x32_bf16 v[160:163], v[88:91], v[32:35], v[160:163]
    ds_read_b64_tr_b16 v[52:53], v15 offset:34944
    ds_read_b64_tr_b16 v[54:55], v15 offset:39552
    ds_read_b64_tr_b16 v[56:57], v15 offset:34976
    v_mfma_f32_16x16x32_bf16 v[128:131], v[92:95], v[28:31], v[128:131]
    v_mfma_f32_16x16x32_bf16 v[164:167], v[92:95], v[32:35], v[164:167]
    ds_read_b64_tr_b16 v[58:59], v15 offset:39584
    ds_read_b64_tr_b16 v[60:61], v15 offset:35008
    ds_read_b64_tr_b16 v[62:63], v15 offset:39616
    v_mfma_f32_16x16x32_bf16 v[132:135], v[96:99], v[28:31], v[132:135]
    v_mfma_f32_16x16x32_bf16 v[168:171], v[96:99], v[32:35], v[168:171]
    ds_read_b64_tr_b16 v[64:65], v15 offset:35040
    ds_read_b64_tr_b16 v[66:67], v15 offset:39648
    ds_read_b64_tr_b16 v[68:69], v15 offset:35072
    v_mfma_f32_16x16x32_bf16 v[136:139], v[100:103], v[28:31], v[136:139]
    v_mfma_f32_16x16x32_bf16 v[172:175], v[100:103], v[32:35], v[172:175]
    ds_read_b64_tr_b16 v[70:71], v15 offset:39680
    v_mfma_f32_16x16x32_bf16 v[140:143], v[104:107], v[28:31], v[140:143]
    v_mfma_f32_16x16x32_bf16 v[176:179], v[104:107], v[32:35], v[176:179]
    s_waitcnt lgkmcnt(15)
    v_mfma_f32_16x16x32_bf16 v[108:111], v[36:39], v[20:23], v[108:111]
    v_mfma_f32_16x16x32_bf16 v[144:147], v[36:39], v[24:27], v[144:147]
    ds_read_b64 v[28:29], v13 offset:34816
    ds_read_b64 v[30:31], v14 offset:34816
    ds_read_b64 v[32:33], v13 offset:36864
    s_waitcnt lgkmcnt(15)
    v_mfma_f32_16x16x32_bf16 v[112:115], v[40:43], v[20:23], v[112:115]
    v_mfma_f32_16x16x32_bf16 v[148:151], v[40:43], v[24:27], v[148:151]
    ds_read_b64 v[34:35], v14 offset:36864
    ds_read_b64_tr_b16 v[72:73], v15 offset:44032
    ds_read_b64_tr_b16 v[74:75], v15 offset:48640
    v_mfma_f32_16x16x32_bf16 v[116:119], v[44:47], v[20:23], v[116:119]
    v_mfma_f32_16x16x32_bf16 v[152:155], v[44:47], v[24:27], v[152:155]
    ds_read_b64_tr_b16 v[76:77], v15 offset:44064
    ds_read_b64_tr_b16 v[78:79], v15 offset:48672
    ds_read_b64_tr_b16 v[80:81], v15 offset:44096
    s_waitcnt lgkmcnt(15)
    v_mfma_f32_16x16x32_bf16 v[120:123], v[48:51], v[20:23], v[120:123]
    v_mfma_f32_16x16x32_bf16 v[156:159], v[48:51], v[24:27], v[156:159]
    ds_read_b64_tr_b16 v[82:83], v15 offset:48704
    ds_read_b64_tr_b16 v[84:85], v15 offset:44128
    ds_read_b64_tr_b16 v[86:87], v15 offset:48736
    v_mfma_f32_16x16x32_bf16 v[124:127], v[52:55], v[20:23], v[124:127]
    v_mfma_f32_16x16x32_bf16 v[160:163], v[52:55], v[24:27], v[160:163]
    ds_read_b64_tr_b16 v[88:89], v15 offset:44160
    ds_read_b64_tr_b16 v[90:91], v15 offset:48768
    ds_read_b64_tr_b16 v[92:93], v15 offset:44192
    v_mfma_f32_16x16x32_bf16 v[128:131], v[56:59], v[20:23], v[128:131]
    v_mfma_f32_16x16x32_bf16 v[164:167], v[56:59], v[24:27], v[164:167]
    ds_read_b64_tr_b16 v[94:95], v15 offset:48800
    ds_read_b64_tr_b16 v[96:97], v15 offset:44224
    ds_read_b64_tr_b16 v[98:99], v15 offset:48832
    s_waitcnt lgkmcnt(15)
    v_mfma_f32_16x16x32_bf16 v[132:135], v[60:63], v[20:23], v[132:135]
    v_mfma_f32_16x16x32_bf16 v[168:171], v[60:63], v[24:27], v[168:171]
    ds_read_b64_tr_b16 v[100:101], v15 offset:44256
    ds_read_b64_tr_b16 v[102:103], v15 offset:48864
    ds_read_b64_tr_b16 v[104:105], v15 offset:44288
    v_mfma_f32_16x16x32_bf16 v[136:139], v[64:67], v[20:23], v[136:139]
    v_mfma_f32_16x16x32_bf16 v[172:175], v[64:67], v[24:27], v[172:175]
    ds_read_b64_tr_b16 v[106:107], v15 offset:48896
    v_mfma_f32_16x16x32_bf16 v[140:143], v[68:71], v[20:23], v[140:143]
    v_mfma_f32_16x16x32_bf16 v[176:179], v[68:71], v[24:27], v[176:179]
    s_waitcnt lgkmcnt(0)
    s_waitcnt vmcnt(18)
    s_barrier
    v_mfma_f32_16x16x32_bf16 v[108:111], v[72:75], v[28:31], v[108:111]
    v_mfma_f32_16x16x32_bf16 v[144:147], v[72:75], v[32:35], v[144:147]
    ds_read_b64 v[20:21], v200 offset:0
    ds_read_b64 v[22:23], v201 offset:0
    ds_read_b64 v[24:25], v200 offset:2048
    v_mfma_f32_16x16x32_bf16 v[112:115], v[76:79], v[28:31], v[112:115]
    v_mfma_f32_16x16x32_bf16 v[148:151], v[76:79], v[32:35], v[148:151]
    ds_read_b64 v[26:27], v201 offset:2048
    ds_read_b64_tr_b16 v[36:37], v204 offset:0
    ds_read_b64_tr_b16 v[38:39], v204 offset:4608
    v_mfma_f32_16x16x32_bf16 v[116:119], v[80:83], v[28:31], v[116:119]
    v_mfma_f32_16x16x32_bf16 v[152:155], v[80:83], v[32:35], v[152:155]
    ds_read_b64_tr_b16 v[40:41], v204 offset:32
    ds_read_b64_tr_b16 v[42:43], v204 offset:4640
    ds_read_b64_tr_b16 v[44:45], v204 offset:64
    v_mfma_f32_16x16x32_bf16 v[120:123], v[84:87], v[28:31], v[120:123]
    v_mfma_f32_16x16x32_bf16 v[156:159], v[84:87], v[32:35], v[156:159]
    ds_read_b64_tr_b16 v[46:47], v204 offset:4672
    ds_read_b64_tr_b16 v[48:49], v204 offset:96
    ds_read_b64_tr_b16 v[50:51], v204 offset:4704
    v_mfma_f32_16x16x32_bf16 v[124:127], v[88:91], v[28:31], v[124:127]
    v_mfma_f32_16x16x32_bf16 v[160:163], v[88:91], v[32:35], v[160:163]
    ds_read_b64_tr_b16 v[52:53], v204 offset:128
    ds_read_b64_tr_b16 v[54:55], v204 offset:4736
    ds_read_b64_tr_b16 v[56:57], v204 offset:160
    v_mfma_f32_16x16x32_bf16 v[128:131], v[92:95], v[28:31], v[128:131]
    v_mfma_f32_16x16x32_bf16 v[164:167], v[92:95], v[32:35], v[164:167]
    ds_read_b64_tr_b16 v[58:59], v204 offset:4768
    ds_read_b64_tr_b16 v[60:61], v204 offset:192
    ds_read_b64_tr_b16 v[62:63], v204 offset:4800
    v_mfma_f32_16x16x32_bf16 v[132:135], v[96:99], v[28:31], v[132:135]
    v_mfma_f32_16x16x32_bf16 v[168:171], v[96:99], v[32:35], v[168:171]
    ds_read_b64_tr_b16 v[64:65], v204 offset:224
    ds_read_b64_tr_b16 v[66:67], v204 offset:4832
    ds_read_b64_tr_b16 v[68:69], v204 offset:256
    v_mfma_f32_16x16x32_bf16 v[136:139], v[100:103], v[28:31], v[136:139]
    v_mfma_f32_16x16x32_bf16 v[172:175], v[100:103], v[32:35], v[172:175]
    ds_read_b64_tr_b16 v[70:71], v204 offset:4864
    v_mfma_f32_16x16x32_bf16 v[140:143], v[104:107], v[28:31], v[140:143]
    v_mfma_f32_16x16x32_bf16 v[176:179], v[104:107], v[32:35], v[176:179]
    s_waitcnt lgkmcnt(15)
    v_mfma_f32_16x16x32_bf16 v[108:111], v[36:39], v[20:23], v[108:111]
    v_mfma_f32_16x16x32_bf16 v[144:147], v[36:39], v[24:27], v[144:147]
    ds_read_b64 v[28:29], v202 offset:0
    ds_read_b64 v[30:31], v203 offset:0
    ds_read_b64 v[32:33], v202 offset:2048
    s_waitcnt lgkmcnt(15)
    v_mfma_f32_16x16x32_bf16 v[112:115], v[40:43], v[20:23], v[112:115]
    v_mfma_f32_16x16x32_bf16 v[148:151], v[40:43], v[24:27], v[148:151]
    ds_read_b64 v[34:35], v203 offset:2048
    ds_read_b64_tr_b16 v[72:73], v204 offset:9216
    ds_read_b64_tr_b16 v[74:75], v204 offset:13824
    v_mfma_f32_16x16x32_bf16 v[116:119], v[44:47], v[20:23], v[116:119]
    v_mfma_f32_16x16x32_bf16 v[152:155], v[44:47], v[24:27], v[152:155]
    ds_read_b64_tr_b16 v[76:77], v204 offset:9248
    ds_read_b64_tr_b16 v[78:79], v204 offset:13856
    ds_read_b64_tr_b16 v[80:81], v204 offset:9280
    s_waitcnt lgkmcnt(15)
    v_mfma_f32_16x16x32_bf16 v[120:123], v[48:51], v[20:23], v[120:123]
    v_mfma_f32_16x16x32_bf16 v[156:159], v[48:51], v[24:27], v[156:159]
    ds_read_b64_tr_b16 v[82:83], v204 offset:13888
    ds_read_b64_tr_b16 v[84:85], v204 offset:9312
    ds_read_b64_tr_b16 v[86:87], v204 offset:13920
    v_mfma_f32_16x16x32_bf16 v[124:127], v[52:55], v[20:23], v[124:127]
    v_mfma_f32_16x16x32_bf16 v[160:163], v[52:55], v[24:27], v[160:163]
    ds_read_b64_tr_b16 v[88:89], v204 offset:9344
    ds_read_b64_tr_b16 v[90:91], v204 offset:13952
    ds_read_b64_tr_b16 v[92:93], v204 offset:9376
    v_mfma_f32_16x16x32_bf16 v[128:131], v[56:59], v[20:23], v[128:131]
    v_mfma_f32_16x16x32_bf16 v[164:167], v[56:59], v[24:27], v[164:167]
    ds_read_b64_tr_b16 v[94:95], v204 offset:13984
    ds_read_b64_tr_b16 v[96:97], v204 offset:9408
    ds_read_b64_tr_b16 v[98:99], v204 offset:14016
    s_waitcnt lgkmcnt(15)
    v_mfma_f32_16x16x32_bf16 v[132:135], v[60:63], v[20:23], v[132:135]
    v_mfma_f32_16x16x32_bf16 v[168:171], v[60:63], v[24:27], v[168:171]
    ds_read_b64_tr_b16 v[100:101], v204 offset:9440
    ds_read_b64_tr_b16 v[102:103], v204 offset:14048
    ds_read_b64_tr_b16 v[104:105], v204 offset:9472
    v_mfma_f32_16x16x32_bf16 v[136:139], v[64:67], v[20:23], v[136:139]
    v_mfma_f32_16x16x32_bf16 v[172:175], v[64:67], v[24:27], v[172:175]
    ds_read_b64_tr_b16 v[106:107], v204 offset:14080
    v_mfma_f32_16x16x32_bf16 v[140:143], v[68:71], v[20:23], v[140:143]
    v_mfma_f32_16x16x32_bf16 v[176:179], v[68:71], v[24:27], v[176:179]
    s_waitcnt lgkmcnt(0)
    s_waitcnt vmcnt(9)
    s_barrier
    v_mfma_f32_16x16x32_bf16 v[108:111], v[72:75], v[28:31], v[108:111]
    v_mfma_f32_16x16x32_bf16 v[144:147], v[72:75], v[32:35], v[144:147]
    ds_read_b64 v[20:21], v200 offset:34816
    ds_read_b64 v[22:23], v201 offset:34816
    ds_read_b64 v[24:25], v200 offset:36864
    v_mfma_f32_16x16x32_bf16 v[112:115], v[76:79], v[28:31], v[112:115]
    v_mfma_f32_16x16x32_bf16 v[148:151], v[76:79], v[32:35], v[148:151]
    ds_read_b64 v[26:27], v201 offset:36864
    ds_read_b64_tr_b16 v[36:37], v204 offset:34816
    ds_read_b64_tr_b16 v[38:39], v204 offset:39424
    v_mfma_f32_16x16x32_bf16 v[116:119], v[80:83], v[28:31], v[116:119]
    v_mfma_f32_16x16x32_bf16 v[152:155], v[80:83], v[32:35], v[152:155]
    ds_read_b64_tr_b16 v[40:41], v204 offset:34848
    ds_read_b64_tr_b16 v[42:43], v204 offset:39456
    ds_read_b64_tr_b16 v[44:45], v204 offset:34880
    v_mfma_f32_16x16x32_bf16 v[120:123], v[84:87], v[28:31], v[120:123]
    v_mfma_f32_16x16x32_bf16 v[156:159], v[84:87], v[32:35], v[156:159]
    ds_read_b64_tr_b16 v[46:47], v204 offset:39488
    ds_read_b64_tr_b16 v[48:49], v204 offset:34912
    ds_read_b64_tr_b16 v[50:51], v204 offset:39520
    v_mfma_f32_16x16x32_bf16 v[124:127], v[88:91], v[28:31], v[124:127]
    v_mfma_f32_16x16x32_bf16 v[160:163], v[88:91], v[32:35], v[160:163]
    ds_read_b64_tr_b16 v[52:53], v204 offset:34944
    ds_read_b64_tr_b16 v[54:55], v204 offset:39552
    ds_read_b64_tr_b16 v[56:57], v204 offset:34976
    v_mfma_f32_16x16x32_bf16 v[128:131], v[92:95], v[28:31], v[128:131]
    v_mfma_f32_16x16x32_bf16 v[164:167], v[92:95], v[32:35], v[164:167]
    ds_read_b64_tr_b16 v[58:59], v204 offset:39584
    ds_read_b64_tr_b16 v[60:61], v204 offset:35008
    ds_read_b64_tr_b16 v[62:63], v204 offset:39616
    v_mfma_f32_16x16x32_bf16 v[132:135], v[96:99], v[28:31], v[132:135]
    v_mfma_f32_16x16x32_bf16 v[168:171], v[96:99], v[32:35], v[168:171]
    ds_read_b64_tr_b16 v[64:65], v204 offset:35040
    ds_read_b64_tr_b16 v[66:67], v204 offset:39648
    ds_read_b64_tr_b16 v[68:69], v204 offset:35072
    v_mfma_f32_16x16x32_bf16 v[136:139], v[100:103], v[28:31], v[136:139]
    v_mfma_f32_16x16x32_bf16 v[172:175], v[100:103], v[32:35], v[172:175]
    ds_read_b64_tr_b16 v[70:71], v204 offset:39680
    v_mfma_f32_16x16x32_bf16 v[140:143], v[104:107], v[28:31], v[140:143]
    v_mfma_f32_16x16x32_bf16 v[176:179], v[104:107], v[32:35], v[176:179]
    s_waitcnt lgkmcnt(15)
    v_mfma_f32_16x16x32_bf16 v[108:111], v[36:39], v[20:23], v[108:111]
    v_mfma_f32_16x16x32_bf16 v[144:147], v[36:39], v[24:27], v[144:147]
    ds_read_b64 v[28:29], v202 offset:34816
    ds_read_b64 v[30:31], v203 offset:34816
    ds_read_b64 v[32:33], v202 offset:36864
    s_waitcnt lgkmcnt(15)
    v_mfma_f32_16x16x32_bf16 v[112:115], v[40:43], v[20:23], v[112:115]
    v_mfma_f32_16x16x32_bf16 v[148:151], v[40:43], v[24:27], v[148:151]
    ds_read_b64 v[34:35], v203 offset:36864
    ds_read_b64_tr_b16 v[72:73], v204 offset:44032
    ds_read_b64_tr_b16 v[74:75], v204 offset:48640
    v_mfma_f32_16x16x32_bf16 v[116:119], v[44:47], v[20:23], v[116:119]
    v_mfma_f32_16x16x32_bf16 v[152:155], v[44:47], v[24:27], v[152:155]
    ds_read_b64_tr_b16 v[76:77], v204 offset:44064
    ds_read_b64_tr_b16 v[78:79], v204 offset:48672
    ds_read_b64_tr_b16 v[80:81], v204 offset:44096
    s_waitcnt lgkmcnt(15)
    v_mfma_f32_16x16x32_bf16 v[120:123], v[48:51], v[20:23], v[120:123]
    v_mfma_f32_16x16x32_bf16 v[156:159], v[48:51], v[24:27], v[156:159]
    ds_read_b64_tr_b16 v[82:83], v204 offset:48704
    ds_read_b64_tr_b16 v[84:85], v204 offset:44128
    ds_read_b64_tr_b16 v[86:87], v204 offset:48736
    v_mfma_f32_16x16x32_bf16 v[124:127], v[52:55], v[20:23], v[124:127]
    v_mfma_f32_16x16x32_bf16 v[160:163], v[52:55], v[24:27], v[160:163]
    ds_read_b64_tr_b16 v[88:89], v204 offset:44160
    ds_read_b64_tr_b16 v[90:91], v204 offset:48768
    ds_read_b64_tr_b16 v[92:93], v204 offset:44192
    v_mfma_f32_16x16x32_bf16 v[128:131], v[56:59], v[20:23], v[128:131]
    v_mfma_f32_16x16x32_bf16 v[164:167], v[56:59], v[24:27], v[164:167]
    ds_read_b64_tr_b16 v[94:95], v204 offset:48800
    ds_read_b64_tr_b16 v[96:97], v204 offset:44224
    ds_read_b64_tr_b16 v[98:99], v204 offset:48832
    s_waitcnt lgkmcnt(15)
    v_mfma_f32_16x16x32_bf16 v[132:135], v[60:63], v[20:23], v[132:135]
    v_mfma_f32_16x16x32_bf16 v[168:171], v[60:63], v[24:27], v[168:171]
    ds_read_b64_tr_b16 v[100:101], v204 offset:44256
    ds_read_b64_tr_b16 v[102:103], v204 offset:48864
    ds_read_b64_tr_b16 v[104:105], v204 offset:44288
    v_mfma_f32_16x16x32_bf16 v[136:139], v[64:67], v[20:23], v[136:139]
    v_mfma_f32_16x16x32_bf16 v[172:175], v[64:67], v[24:27], v[172:175]
    ds_read_b64_tr_b16 v[106:107], v204 offset:48896
    v_mfma_f32_16x16x32_bf16 v[140:143], v[68:71], v[20:23], v[140:143]
    v_mfma_f32_16x16x32_bf16 v[176:179], v[68:71], v[24:27], v[176:179]
    s_waitcnt lgkmcnt(0)
    s_waitcnt vmcnt(0)
    s_barrier
    v_mfma_f32_16x16x32_bf16 v[108:111], v[72:75], v[28:31], v[108:111]
    v_mfma_f32_16x16x32_bf16 v[144:147], v[72:75], v[32:35], v[144:147]
    ds_read_b64 v[20:21], v11 offset:0
    ds_read_b64 v[22:23], v12 offset:0
    ds_read_b64 v[24:25], v11 offset:2048
    v_mfma_f32_16x16x32_bf16 v[112:115], v[76:79], v[28:31], v[112:115]
    v_mfma_f32_16x16x32_bf16 v[148:151], v[76:79], v[32:35], v[148:151]
    ds_read_b64 v[26:27], v12 offset:2048
    ds_read_b64_tr_b16 v[36:37], v15 offset:0
    ds_read_b64_tr_b16 v[38:39], v15 offset:4608
    v_mfma_f32_16x16x32_bf16 v[116:119], v[80:83], v[28:31], v[116:119]
    v_mfma_f32_16x16x32_bf16 v[152:155], v[80:83], v[32:35], v[152:155]
    ds_read_b64_tr_b16 v[40:41], v15 offset:32
    ds_read_b64_tr_b16 v[42:43], v15 offset:4640
    ds_read_b64_tr_b16 v[44:45], v15 offset:64
    v_mfma_f32_16x16x32_bf16 v[120:123], v[84:87], v[28:31], v[120:123]
    v_mfma_f32_16x16x32_bf16 v[156:159], v[84:87], v[32:35], v[156:159]
    ds_read_b64_tr_b16 v[46:47], v15 offset:4672
    ds_read_b64_tr_b16 v[48:49], v15 offset:96
    ds_read_b64_tr_b16 v[50:51], v15 offset:4704
    v_mfma_f32_16x16x32_bf16 v[124:127], v[88:91], v[28:31], v[124:127]
    v_mfma_f32_16x16x32_bf16 v[160:163], v[88:91], v[32:35], v[160:163]
    ds_read_b64_tr_b16 v[52:53], v15 offset:128
    ds_read_b64_tr_b16 v[54:55], v15 offset:4736
    ds_read_b64_tr_b16 v[56:57], v15 offset:160
    v_mfma_f32_16x16x32_bf16 v[128:131], v[92:95], v[28:31], v[128:131]
    v_mfma_f32_16x16x32_bf16 v[164:167], v[92:95], v[32:35], v[164:167]
    ds_read_b64_tr_b16 v[58:59], v15 offset:4768
    ds_read_b64_tr_b16 v[60:61], v15 offset:192
    ds_read_b64_tr_b16 v[62:63], v15 offset:4800
    v_mfma_f32_16x16x32_bf16 v[132:135], v[96:99], v[28:31], v[132:135]
    v_mfma_f32_16x16x32_bf16 v[168:171], v[96:99], v[32:35], v[168:171]
    ds_read_b64_tr_b16 v[64:65], v15 offset:224
    ds_read_b64_tr_b16 v[66:67], v15 offset:4832
    ds_read_b64_tr_b16 v[68:69], v15 offset:256
    v_mfma_f32_16x16x32_bf16 v[136:139], v[100:103], v[28:31], v[136:139]
    v_mfma_f32_16x16x32_bf16 v[172:175], v[100:103], v[32:35], v[172:175]
    ds_read_b64_tr_b16 v[70:71], v15 offset:4864
    v_mfma_f32_16x16x32_bf16 v[140:143], v[104:107], v[28:31], v[140:143]
    v_mfma_f32_16x16x32_bf16 v[176:179], v[104:107], v[32:35], v[176:179]
    s_waitcnt lgkmcnt(15)
    v_mfma_f32_16x16x32_bf16 v[108:111], v[36:39], v[20:23], v[108:111]
    v_mfma_f32_16x16x32_bf16 v[144:147], v[36:39], v[24:27], v[144:147]
    ds_read_b64 v[28:29], v13 offset:0
    ds_read_b64 v[30:31], v14 offset:0
    ds_read_b64 v[32:33], v13 offset:2048
    s_waitcnt lgkmcnt(15)
    v_mfma_f32_16x16x32_bf16 v[112:115], v[40:43], v[20:23], v[112:115]
    v_mfma_f32_16x16x32_bf16 v[148:151], v[40:43], v[24:27], v[148:151]
    ds_read_b64 v[34:35], v14 offset:2048
    ds_read_b64_tr_b16 v[72:73], v15 offset:9216
    ds_read_b64_tr_b16 v[74:75], v15 offset:13824
    v_mfma_f32_16x16x32_bf16 v[116:119], v[44:47], v[20:23], v[116:119]
    v_mfma_f32_16x16x32_bf16 v[152:155], v[44:47], v[24:27], v[152:155]
    ds_read_b64_tr_b16 v[76:77], v15 offset:9248
    ds_read_b64_tr_b16 v[78:79], v15 offset:13856
    ds_read_b64_tr_b16 v[80:81], v15 offset:9280
    s_waitcnt lgkmcnt(15)
    v_mfma_f32_16x16x32_bf16 v[120:123], v[48:51], v[20:23], v[120:123]
    v_mfma_f32_16x16x32_bf16 v[156:159], v[48:51], v[24:27], v[156:159]
    ds_read_b64_tr_b16 v[82:83], v15 offset:13888
    ds_read_b64_tr_b16 v[84:85], v15 offset:9312
    ds_read_b64_tr_b16 v[86:87], v15 offset:13920
    v_mfma_f32_16x16x32_bf16 v[124:127], v[52:55], v[20:23], v[124:127]
    v_mfma_f32_16x16x32_bf16 v[160:163], v[52:55], v[24:27], v[160:163]
    ds_read_b64_tr_b16 v[88:89], v15 offset:9344
    ds_read_b64_tr_b16 v[90:91], v15 offset:13952
    ds_read_b64_tr_b16 v[92:93], v15 offset:9376
    v_mfma_f32_16x16x32_bf16 v[128:131], v[56:59], v[20:23], v[128:131]
    v_mfma_f32_16x16x32_bf16 v[164:167], v[56:59], v[24:27], v[164:167]
    ds_read_b64_tr_b16 v[94:95], v15 offset:13984
    ds_read_b64_tr_b16 v[96:97], v15 offset:9408
    ds_read_b64_tr_b16 v[98:99], v15 offset:14016
    s_waitcnt lgkmcnt(15)
    v_mfma_f32_16x16x32_bf16 v[132:135], v[60:63], v[20:23], v[132:135]
    v_mfma_f32_16x16x32_bf16 v[168:171], v[60:63], v[24:27], v[168:171]
    ds_read_b64_tr_b16 v[100:101], v15 offset:9440
    ds_read_b64_tr_b16 v[102:103], v15 offset:14048
    ds_read_b64_tr_b16 v[104:105], v15 offset:9472
    v_mfma_f32_16x16x32_bf16 v[136:139], v[64:67], v[20:23], v[136:139]
    v_mfma_f32_16x16x32_bf16 v[172:175], v[64:67], v[24:27], v[172:175]
    ds_read_b64_tr_b16 v[106:107], v15 offset:14080
    v_mfma_f32_16x16x32_bf16 v[140:143], v[68:71], v[20:23], v[140:143]
    v_mfma_f32_16x16x32_bf16 v[176:179], v[68:71], v[24:27], v[176:179]
    s_waitcnt lgkmcnt(15)
    v_mfma_f32_16x16x32_bf16 v[108:111], v[72:75], v[28:31], v[108:111]
    v_mfma_f32_16x16x32_bf16 v[144:147], v[72:75], v[32:35], v[144:147]
    s_waitcnt lgkmcnt(14)
    v_mfma_f32_16x16x32_bf16 v[112:115], v[76:79], v[28:31], v[112:115]
    v_mfma_f32_16x16x32_bf16 v[148:151], v[76:79], v[32:35], v[148:151]
    s_waitcnt lgkmcnt(12)
    v_mfma_f32_16x16x32_bf16 v[116:119], v[80:83], v[28:31], v[116:119]
    v_mfma_f32_16x16x32_bf16 v[152:155], v[80:83], v[32:35], v[152:155]
    s_waitcnt lgkmcnt(10)
    v_mfma_f32_16x16x32_bf16 v[120:123], v[84:87], v[28:31], v[120:123]
    v_mfma_f32_16x16x32_bf16 v[156:159], v[84:87], v[32:35], v[156:159]
    s_waitcnt lgkmcnt(8)
    v_mfma_f32_16x16x32_bf16 v[124:127], v[88:91], v[28:31], v[124:127]
    v_mfma_f32_16x16x32_bf16 v[160:163], v[88:91], v[32:35], v[160:163]
    s_waitcnt lgkmcnt(6)
    v_mfma_f32_16x16x32_bf16 v[128:131], v[92:95], v[28:31], v[128:131]
    v_mfma_f32_16x16x32_bf16 v[164:167], v[92:95], v[32:35], v[164:167]
    s_waitcnt lgkmcnt(4)
    v_mfma_f32_16x16x32_bf16 v[132:135], v[96:99], v[28:31], v[132:135]
    v_mfma_f32_16x16x32_bf16 v[168:171], v[96:99], v[32:35], v[168:171]
    s_waitcnt lgkmcnt(2)
    v_mfma_f32_16x16x32_bf16 v[136:139], v[100:103], v[28:31], v[136:139]
    v_mfma_f32_16x16x32_bf16 v[172:175], v[100:103], v[32:35], v[172:175]
    s_waitcnt lgkmcnt(0)
    v_mfma_f32_16x16x32_bf16 v[140:143], v[104:107], v[28:31], v[140:143]
    v_mfma_f32_16x16x32_bf16 v[176:179], v[104:107], v[32:35], v[176:179]
    s_branch K2_EPI
K2_S3:
    s_lshl_b32 s9, s8, 12
    s_add_u32 m0, s9, 0
    s_nop 0
    global_load_lds_dwordx4 v2, s[4:5]
    s_lshl_b32 s9, s8, 12
    s_add_u32 m0, s9, 1024
    s_nop 0
    global_load_lds_dwordx4 v3, s[4:5]
    s_lshl_b32 s9, s8, 12
    s_add_u32 m0, s9, 2048
    s_nop 0
    global_load_lds_dwordx4 v4, s[4:5]
    s_lshl_b32 s9, s8, 12
    s_add_u32 m0, s9, 3072
    s_nop 0
    global_load_lds_dwordx4 v5, s[4:5]
    s_mul_i32 s9, s8, 4608
    s_add_u32 m0, s9, 16384
    s_nop 0
    global_load_lds_dwordx4 v6, s[6:7]
    s_mul_i32 s9, s8, 4608
    s_add_u32 m0, s9, 17408
    s_nop 0
    global_load_lds_dwordx4 v7, s[6:7]
    s_mul_i32 s9, s8, 4608
    s_add_u32 m0, s9, 18432
    s_nop 0
    global_load_lds_dwordx4 v8, s[6:7]
    s_mul_i32 s9, s8, 4608
    s_add_u32 m0, s9, 19456
    s_nop 0
    global_load_lds_dwordx4 v9, s[6:7]
    s_mul_i32 s9, s8, 4608
    s_add_u32 m0, s9, 20480
    s_mov_b32 exec_hi, 0
    global_load_lds_dwordx4 v10, s[6:7]
    s_mov_b64 exec, -1
    s_add_u32 s4, s4, 128
    s_addc_u32 s5, s5, 0
    s_add_u32 s6, s6, s18
    s_addc_u32 s7, s7, 0
    s_lshl_b32 s9, s8, 12
    s_add_u32 m0, s9, 34816
    s_nop 0
    global_load_lds_dwordx4 v2, s[4:5]
    s_lshl_b32 s9, s8, 12
    s_add_u32 m0, s9, 35840
    s_nop 0
    global_load_lds_dwordx4 v3, s[4:5]
    s_lshl_b32 s9, s8, 12
    s_add_u32 m0, s9, 36864
    s_nop 0
    global_load_lds_dwordx4 v4, s[4:5]
    s_lshl_b32 s9, s8, 12
    s_add_u32 m0, s9, 37888
    s_nop 0
    global_load_lds_dwordx4 v5, s[4:5]
    s_mul_i32 s9, s8, 4608
    s_add_u32 m0, s9, 51200
    s_nop 0
    global_load_lds_dwordx4 v6, s[6:7]
    s_mul_i32 s9, s8, 4608
    s_add_u32 m0, s9, 52224
    s_nop 0
    global_load_lds_dwordx4 v7, s[6:7]
    s_mul_i32 s9, s8, 4608
    s_add_u32 m0, s9, 53248
    s_nop 0
    global_load_lds_dwordx4 v8, s[6:7]
    s_mul_i32 s9, s8, 4608
    s_add_u32 m0, s9, 54272
    s_nop 0
    global_load_lds_dwordx4 v9, s[6:7]
    s_mul_i32 s9, s8, 4608
    s_add_u32 m0, s9, 55296
    s_mov_b32 exec_hi, 0
    global_load_lds_dwordx4 v10, s[6:7]
    s_mov_b64 exec, -1
    s_add_u32 s4, s4, 128
    s_addc_u32 s5, s5, 0
    s_add_u32 s6, s6, s18
    s_addc_u32 s7, s7, 0
    s_lshl_b32 s9, s8, 12
    s_add_u32 m0, s9, 69632
    s_nop 0
    global_load_lds_dwordx4 v2, s[4:5]
    s_lshl_b32 s9, s8, 12
    s_add_u32 m0, s9, 70656
    s_nop 0
    global_load_lds_dwordx4 v3, s[4:5]
    s_lshl_b32 s9, s8, 12
    s_add_u32 m0, s9, 71680
    s_nop 0
    global_load_lds_dwordx4 v4, s[4:5]
    s_lshl_b32 s9, s8, 12
    s_add_u32 m0, s9, 72704
    s_nop 0
    global_load_lds_dwordx4 v5, s[4:5]
    s_mul_i32 s9, s8, 4608
    s_add_u32 m0, s9, 86016
    s_nop 0
    global_load_lds_dwordx4 v6, s[6:7]
    s_mul_i32 s9, s8, 4608
    s_add_u32 m0, s9, 87040
    s_nop 0
    global_load_lds_dwordx4 v7, s[6:7]
    s_mul_i32 s9, s8, 4608
    s_add_u32 m0, s9, 88064
    s_nop 0
    global_load_lds_dwordx4 v8, s[6:7]
    s_mul_i32 s9, s8, 4608
    s_add_u32 m0, s9, 89088
    s_nop 0
    global_load_lds_dwordx4 v9, s[6:7]
    s_mul_i32 s9, s8, 4608
    s_add_u32 m0, s9, 90112
    s_mov_b32 exec_hi, 0
    global_load_lds_dwordx4 v10, s[6:7]
    s_mov_b64 exec, -1
    s_add_u32 s4, s4, 128
    s_addc_u32 s5, s5, 0
    s_add_u32 s6, s6, s18
    s_addc_u32 s7, s7, 0
    s_lshl_b32 s9, s8, 12
    s_add_u32 m0, s9, 104448
    s_nop 0
    global_load_lds_dwordx4 v2, s[4:5]
    s_lshl_b32 s9, s8, 12
    s_add_u32 m0, s9, 105472
    s_nop 0
    global_load_lds_dwordx4 v3, s[4:5]
    s_lshl_b32 s9, s8, 12
    s_add_u32 m0, s9, 106496
    s_nop 0
    global_load_lds_dwordx4 v4, s[4:5]
    s_lshl_b32 s9, s8, 12
    s_add_u32 m0, s9, 107520
    s_nop 0
    global_load_lds_dwordx4 v5, s[4:5]
    s_mul_i32 s9, s8, 4608
    s_add_u32 m0, s9, 120832
    s_nop 0
    global_load_lds_dwordx4 v6, s[6:7]
    s_mul_i32 s9, s8, 4608
    s_add_u32 m0, s9, 121856
    s_nop 0
    global_load_lds_dwordx4 v7, s[6:7]
    s_mul_i32 s9, s8, 4608
    s_add_u32 m0, s9, 122880
    s_nop 0
    global_load_lds_dwordx4 v8, s[6:7]
    s_mul_i32 s9, s8, 4608
    s_add_u32 m0, s9, 123904
    s_nop 0
    global_load_lds_dwordx4 v9, s[6:7]
    s_mul_i32 s9, s8, 4608
    s_add_u32 m0, s9, 124928
    s_mov_b32 exec_hi, 0
    global_load_lds_dwordx4 v10, s[6:7]
    s_mov_b64 exec, -1
    s_waitcnt vmcnt(27)
    s_barrier
    ds_read_b64 v[20:21], v11 offset:0
    ds_read_b64 v[22:23], v12 offset:0
    ds_read_b64 v[24:25], v11 offset:2048
    ds_read_b64 v[26:27], v12 offset:2048
    ds_read_b64_tr_b16 v[36:37], v15 offset:0
    ds_read_b64_tr_b16 v[38:39], v15 offset:4608
    ds_read_b64_tr_b16 v[40:41], v15 offset:32
    ds_read_b64_tr_b16 v[42:43], v15 offset:4640
    ds_read_b64_tr_b16 v[44:45], v15 offset:64
    ds_read_b64_tr_b16 v[46:47], v15 offset:4672
    ds_read_b64_tr_b16 v[48:49], v15 offset:96
    ds_read_b64_tr_b16 v[50:51], v15 offset:4704
    ds_read_b64_tr_b16 v[52:53], v15 offset:128
    ds_read_b64_tr_b16 v[54:55], v15 offset:4736
    ds_read_b64_tr_b16 v[56:57], v15 offset:160
    ds_read_b64_tr_b16 v[58:59], v15 offset:4768
    ds_read_b64_tr_b16 v[60:61], v15 offset:192
    ds_read_b64_tr_b16 v[62:63], v15 offset:4800
    ds_read_b64_tr_b16 v[64:65], v15 offset:224
    ds_read_b64_tr_b16 v[66:67], v15 offset:4832
    ds_read_b64_tr_b16 v[68:69], v15 offset:256
    ds_read_b64_tr_b16 v[70:71], v15 offset:4864
    s_waitcnt lgkmcnt(15)
    v_mfma_f32_16x16x32_bf16 v[108:111], v[36:39], v[20:23], v[108:111]
    v_mfma_f32_16x16x32_bf16 v[144:147], v[36:39], v[24:27], v[144:147]
    ds_read_b64 v[28:29], v13 offset:0
    ds_read_b64 v[30:31], v14 offset:0
    ds_read_b64 v[32:33], v13 offset:2048
    s_waitcnt lgkmcnt(15)
    v_mfma_f32_16x16x32_bf16 v[112:115], v[40:43], v[20:23], v[112:115]
    v_mfma_f32_16x16x32_bf16 v[148:151], v[40:43], v[24:27], v[148:151]
    ds_read_b64 v[34:35], v14 offset:2048
    ds_read_b64_tr_b16 v[72:73], v15 offset:9216
    ds_read_b64_tr_b16 v[74:75], v15 offset:13824
    v_mfma_f32_16x16x32_bf16 v[116:119], v[44:47], v[20:23], v[116:119]
    v_mfma_f32_16x16x32_bf16 v[152:155], v[44:47], v[24:27], v[152:155]
    ds_read_b64_tr_b16 v[76:77], v15 offset:9248
    ds_read_b64_tr_b16 v[78:79], v15 offset:13856
    ds_read_b64_tr_b16 v[80:81], v15 offset:9280
    s_waitcnt lgkmcnt(15)
    v_mfma_f32_16x16x32_bf16 v[120:123], v[48:51], v[20:23], v[120:123]
    v_mfma_f32_16x16x32_bf16 v[156:159], v[48:51], v[24:27], v[156:159]
    ds_read_b64_tr_b16 v[82:83], v15 offset:13888
    ds_read_b64_tr_b16 v[84:85], v15 offset:9312
    ds_read_b64_tr_b16 v[86:87], v15 offset:13920
    v_mfma_f32_16x16x32_bf16 v[124:127], v[52:55], v[20:23], v[124:127]
    v_mfma_f32_16x16x32_bf16 v[160:163], v[52:55], v[24:27], v[160:163]
    ds_read_b64_tr_b16 v[88:89], v15 offset:9344
    ds_read_b64_tr_b16 v[90:91], v15 offset:13952
    ds_read_b64_tr_b16 v[92:93], v15 offset:9376
    v_mfma_f32_16x16x32_bf16 v[128:131], v[56:59], v[20:23], v[128:131]
    v_mfma_f32_16x16x32_bf16 v[164:167], v[56:59], v[24:27], v[164:167]
    ds_read_b64_tr_b16 v[94:95], v15 offset:13984
    ds_read_b64_tr_b16 v[96:97], v15 offset:9408
    ds_read_b64_tr_b16 v[98:99], v15 offset:14016
    s_waitcnt lgkmcnt(15)
    v_mfma_f32_16x16x32_bf16 v[132:135], v[60:63], v[20:23], v[132:135]
    v_mfma_f32_16x16x32_bf16 v[168:171], v[60:63], v[24:27], v[168:171]
    ds_read_b64_tr_b16 v[100:101], v15 offset:9440
    ds_read_b64_tr_b16 v[102:103], v15 offset:14048
    ds_read_b64_tr_b16 v[104:105], v15 offset:9472
    v_mfma_f32_16x16x32_bf16 v[136:139], v[64:67], v[20:23], v[136:139]
    v_mfma_f32_16x16x32_bf16 v[172:175], v[64:67], v[24:27], v[172:175]
    ds_read_b64_tr_b16 v[106:107], v15 offset:14080
    v_mfma_f32_16x16x32_bf16 v[140:143], v[68:71], v[20:23], v[140:143]
    v_mfma_f32_16x16x32_bf16 v[176:179], v[68:71], v[24:27], v[176:179]
    s_waitcnt lgkmcnt(0)
    s_waitcnt vmcnt(18)
    s_barrier
    s_add_u32 s4, s4, 128
    s_addc_u32 s5, s5, 0
    s_add_u32 s6, s6, s18
    s_addc_u32 s7, s7, 0
    s_lshl_b32 s9, s8, 12
    s_add_u32 m0, s9, 0
    s_nop 0
    global_load_lds_dwordx4 v2, s[4:5]
    s_lshl_b32 s9, s8, 12
    s_add_u32 m0, s9, 1024
    s_nop 0
    global_load_lds_dwordx4 v3, s[4:5]
    s_lshl_b32 s9, s8, 12
    s_add_u32 m0, s9, 2048
    s_nop 0
    global_load_lds_dwordx4 v4, s[4:5]
    s_lshl_b32 s9, s8, 12
    s_add_u32 m0, s9, 3072
    s_nop 0
    global_load_lds_dwordx4 v5, s[4:5]
    s_mul_i32 s9, s8, 4608
    s_add_u32 m0, s9, 16384
    s_nop 0
    global_load_lds_dwordx4 v6, s[6:7]
    s_mul_i32 s9, s8, 4608
    s_add_u32 m0, s9, 17408
    s_nop 0
    global_load_lds_dwordx4 v7, s[6:7]
    s_mul_i32 s9, s8, 4608
    s_add_u32 m0, s9, 18432
    s_nop 0
    global_load_lds_dwordx4 v8, s[6:7]
    s_mul_i32 s9, s8, 4608
    s_add_u32 m0, s9, 19456
    s_nop 0
    global_load_lds_dwordx4 v9, s[6:7]
    s_mul_i32 s9, s8, 4608
    s_add_u32 m0, s9, 20480
    s_mov_b32 exec_hi, 0
    global_load_lds_dwordx4 v10, s[6:7]
    s_mov_b64 exec, -1
    v_mfma_f32_16x16x32_bf16 v[108:111], v[72:75], v[28:31], v[108:111]
    v_mfma_f32_16x16x32_bf16 v[144:147], v[72:75], v[32:35], v[144:147]
    ds_read_b64 v[20:21], v11 offset:34816
    ds_read_b64 v[22:23], v12 offset:34816
    ds_read_b64 v[24:25], v11 offset:36864
    v_mfma_f32_16x16x32_bf16 v[112:115], v[76:79], v[28:31], v[112:115]
    v_mfma_f32_16x16x32_bf16 v[148:151], v[76:79], v[32:35], v[148:151]
    ds_read_b64 v[26:27], v12 offset:36864
    ds_read_b64_tr_b16 v[36:37], v15 offset:34816
    ds_read_b64_tr_b16 v[38:39], v15 offset:39424
    v_mfma_f32_16x16x32_bf16 v[116:119], v[80:83], v[28:31], v[116:119]
    v_mfma_f32_16x16x32_bf16 v[152:155], v[80:83], v[32:35], v[152:155]
    ds_read_b64_tr_b16 v[40:41], v15 offset:34848
    ds_read_b64_tr_b16 v[42:43], v15 offset:39456
    ds_read_b64_tr_b16 v[44:45], v15 offset:34880
    v_mfma_f32_16x16x32_bf16 v[120:123], v[84:87], v[28:31], v[120:123]
    v_mfma_f32_16x16x32_bf16 v[156:159], v[84:87], v[32:35], v[156:159]
    ds_read_b64_tr_b16 v[46:47], v15 offset:39488
    ds_read_b64_tr_b16 v[48:49], v15 offset:34912
    ds_read_b64_tr_b16 v[50:51], v15 offset:39520
    v_mfma_f32_16x16x32_bf16 v[124:127], v[88:91], v[28:31], v[124:127]
    v_mfma_f32_16x16x32_bf16 v[160:163], v[88:91], v[32:35], v[160:163]
    ds_read_b64_tr_b16 v[52:53], v15 offset:34944
    ds_read_b64_tr_b16 v[54:55], v15 offset:39552
    ds_read_b64_tr_b16 v[56:57], v15 offset:34976
    v_mfma_f32_16x16x32_bf16 v[128:131], v[92:95], v[28:31], v[128:131]
    v_mfma_f32_16x16x32_bf16 v[164:167], v[92:95], v[32:35], v[164:167]
    ds_read_b64_tr_b16 v[58:59], v15 offset:39584
    ds_read_b64_tr_b16 v[60:61], v15 offset:35008
    ds_read_b64_tr_b16 v[62:63], v15 offset:39616
    v_mfma_f32_16x16x32_bf16 v[132:135], v[96:99], v[28:31], v[132:135]
    v_mfma_f32_16x16x32_bf16 v[168:171], v[96:99], v[32:35], v[168:171]
    ds_read_b64_tr_b16 v[64:65], v15 offset:35040
    ds_read_b64_tr_b16 v[66:67], v15 offset:39648
    ds_read_b64_tr_b16 v[68:69], v15 offset:35072
    v_mfma_f32_16x16x32_bf16 v[136:139], v[100:103], v[28:31], v[136:139]
    v_mfma_f32_16x16x32_bf16 v[172:175], v[100:103], v[32:35], v[172:175]
    ds_read_b64_tr_b16 v[70:71], v15 offset:39680
    v_mfma_f32_16x16x32_bf16 v[140:143], v[104:107], v[28:31], v[140:143]
    v_mfma_f32_16x16x32_bf16 v[176:179], v[104:107], v[32:35], v[176:179]
    s_waitcnt lgkmcnt(15)
    v_mfma_f32_16x16x32_bf16 v[108:111], v[36:39], v[20:23], v[108:111]
    v_mfma_f32_16x16x32_bf16 v[144:147], v[36:39], v[24:27], v[144:147]
    ds_read_b64 v[28:29], v13 offset:34816
    ds_read_b64 v[30:31], v14 offset:34816
    ds_read_b64 v[32:33], v13 offset:36864
    s_waitcnt lgkmcnt(15)
    v_mfma_f32_16x16x32_bf16 v[112:115], v[40:43], v[20:23], v[112:115]
    v_mfma_f32_16x16x32_bf16 v[148:151], v[40:43], v[24:27], v[148:151]
    ds_read_b64 v[34:35], v14 offset:36864
    ds_read_b64_tr_b16 v[72:73], v15 offset:44032
    ds_read_b64_tr_b16 v[74:75], v15 offset:48640
    v_mfma_f32_16x16x32_bf16 v[116:119], v[44:47], v[20:23], v[116:119]
    v_mfma_f32_16x16x32_bf16 v[152:155], v[44:47], v[24:27], v[152:155]
    ds_read_b64_tr_b16 v[76:77], v15 offset:44064
    ds_read_b64_tr_b16 v[78:79], v15 offset:48672
    ds_read_b64_tr_b16 v[80:81], v15 offset:44096
    s_waitcnt lgkmcnt(15)
    v_mfma_f32_16x16x32_bf16 v[120:123], v[48:51], v[20:23], v[120:123]
    v_mfma_f32_16x16x32_bf16 v[156:159], v[48:51], v[24:27], v[156:159]
    ds_read_b64_tr_b16 v[82:83], v15 offset:48704
    ds_read_b64_tr_b16 v[84:85], v15 offset:44128
    ds_read_b64_tr_b16 v[86:87], v15 offset:48736
    v_mfma_f32_16x16x32_bf16 v[124:127], v[52:55], v[20:23], v[124:127]
    v_mfma_f32_16x16x32_bf16 v[160:163], v[52:55], v[24:27], v[160:163]
    ds_read_b64_tr_b16 v[88:89], v15 offset:44160
    ds_read_b64_tr_b16 v[90:91], v15 offset:48768
    ds_read_b64_tr_b16 v[92:93], v15 offset:44192
    v_mfma_f32_16x16x32_bf16 v[128:131], v[56:59], v[20:23], v[128:131]
    v_mfma_f32_16x16x32_bf16 v[164:167], v[56:59], v[24:27], v[164:167]
    ds_read_b64_tr_b16 v[94:95], v15 offset:48800
    ds_read_b64_tr_b16 v[96:97], v15 offset:44224
    ds_read_b64_tr_b16 v[98:99], v15 offset:48832
    s_waitcnt lgkmcnt(15)
    v_mfma_f32_16x16x32_bf16 v[132:135], v[60:63], v[20:23], v[132:135]
    v_mfma_f32_16x16x32_bf16 v[168:171], v[60:63], v[24:27], v[168:171]
    ds_read_b64_tr_b16 v[100:101], v15 offset:44256
    ds_read_b64_tr_b16 v[102:103], v15 offset:48864
    ds_read_b64_tr_b16 v[104:105], v15 offset:44288
    v_mfma_f32_16x16x32_bf16 v[136:139], v[64:67], v[20:23], v[136:139]
    v_mfma_f32_16x16x32_bf16 v[172:175], v[64:67], v[24:27], v[172:175]
    ds_read_b64_tr_b16 v[106:107], v15 offset:48896
    v_mfma_f32_16x16x32_bf16 v[140:143], v[68:71], v[20:23], v[140:143]
    v_mfma_f32_16x16x32_bf16 v[176:179], v[68:71], v[24:27], v[176:179]
    s_waitcnt lgkmcnt(0)
    s_waitcnt vmcnt(18)
    s_barrier
    s_add_u32 s4, s4, 128
    s_addc_u32 s5, s5, 0
    s_add_u32 s6, s6, s18
    s_addc_u32 s7, s7, 0
    s_lshl_b32 s9, s8, 12
    s_add_u32 m0, s9, 34816
    s_nop 0
    global_load_lds_dwordx4 v2, s[4:5]
    s_lshl_b32 s9, s8, 12
    s_add_u32 m0, s9, 35840
    s_nop 0
    global_load_lds_dwordx4 v3, s[4:5]
    s_lshl_b32 s9, s8, 12
    s_add_u32 m0, s9, 36864
    s_nop 0
    global_load_lds_dwordx4 v4, s[4:5]
    s_lshl_b32 s9, s8, 12
    s_add_u32 m0, s9, 37888
    s_nop 0
    global_load_lds_dwordx4 v5, s[4:5]
    s_mul_i32 s9, s8, 4608
    s_add_u32 m0, s9, 51200
    s_nop 0
    global_load_lds_dwordx4 v6, s[6:7]
    s_mul_i32 s9, s8, 4608
    s_add_u32 m0, s9, 52224
    s_nop 0
    global_load_lds_dwordx4 v7, s[6:7]
    s_mul_i32 s9, s8, 4608
    s_add_u32 m0, s9, 53248
    s_nop 0
    global_load_lds_dwordx4 v8, s[6:7]
    s_mul_i32 s9, s8, 4608
    s_add_u32 m0, s9, 54272
    s_nop 0
    global_load_lds_dwordx4 v9, s[6:7]
    s_mul_i32 s9, s8, 4608
    s_add_u32 m0, s9, 55296
    s_mov_b32 exec_hi, 0
    global_load_lds_dwordx4 v10, s[6:7]
    s_mov_b64 exec, -1
    v_mfma_f32_16x16x32_bf16 v[108:111], v[72:75], v[28:31], v[108:111]
    v_mfma_f32_16x16x32_bf16 v[144:147], v[72:75], v[32:35], v[144:147]
    ds_read_b64 v[20:21], v200 offset:0
    ds_read_b64 v[22:23], v201 offset:0
    ds_read_b64 v[24:25], v200 offset:2048
    v_mfma_f32_16x16x32_bf16 v[112:115], v[76:79], v[28:31], v[112:115]
    v_mfma_f32_16x16x32_bf16 v[148:151], v[76:79], v[32:35], v[148:151]
    ds_read_b64 v[26:27], v201 offset:2048
    ds_read_b64_tr_b16 v[36:37], v204 offset:0
    ds_read_b64_tr_b16 v[38:39], v204 offset:4608
    v_mfma_f32_16x16x32_bf16 v[116:119], v[80:83], v[28:31], v[116:119]
    v_mfma_f32_16x16x32_bf16 v[152:155], v[80:83], v[32:35], v[152:155]
    ds_read_b64_tr_b16 v[40:41], v204 offset:32
    ds_read_b64_tr_b16 v[42:43], v204 offset:4640
    ds_read_b64_tr_b16 v[44:45], v204 offset:64
    v_mfma_f32_16x16x32_bf16 v[120:123], v[84:87], v[28:31], v[120:123]
    v_mfma_f32_16x16x32_bf16 v[156:159], v[84:87], v[32:35], v[156:159]
    ds_read_b64_tr_b16 v[46:47], v204 offset:4672
    ds_read_b64_tr_b16 v[48:49], v204 offset:96
    ds_read_b64_tr_b16 v[50:51], v204 offset:4704
    v_mfma_f32_16x16x32_bf16 v[124:127], v[88:91], v[28:31], v[124:127]
    v_mfma_f32_16x16x32_bf16 v[160:163], v[88:91], v[32:35], v[160:163]
    ds_read_b64_tr_b16 v[52:53], v204 offset:128
    ds_read_b64_tr_b16 v[54:55], v204 offset:4736
    ds_read_b64_tr_b16 v[56:57], v204 offset:160
    v_mfma_f32_16x16x32_bf16 v[128:131], v[92:95], v[28:31], v[128:131]
    v_mfma_f32_16x16x32_bf16 v[164:167], v[92:95], v[32:35], v[164:167]
    ds_read_b64_tr_b16 v[58:59], v204 offset:4768
    ds_read_b64_tr_b16 v[60:61], v204 offset:192
    ds_read_b64_tr_b16 v[62:63], v204 offset:4800
    v_mfma_f32_16x16x32_bf16 v[132:135], v[96:99], v[28:31], v[132:135]
    v_mfma_f32_16x16x32_bf16 v[168:171], v[96:99], v[32:35], v[168:171]
    ds_read_b64_tr_b16 v[64:65], v204 offset:224
    ds_read_b64_tr_b16 v[66:67], v204 offset:4832
    ds_read_b64_tr_b16 v[68:69], v204 offset:256
    v_mfma_f32_16x16x32_bf16 v[136:139], v[100:103], v[28:31], v[136:139]
    v_mfma_f32_16x16x32_bf16 v[172:175], v[100:103], v[32:35], v[172:175]
    ds_read_b64_tr_b16 v[70:71], v204 offset:4864
    v_mfma_f32_16x16x32_bf16 v[140:143], v[104:107], v[28:31], v[140:143]
    v_mfma_f32_16x16x32_bf16 v[176:179], v[104:107], v[32:35], v[176:179]
    s_waitcnt lgkmcnt(15)
    v_mfma_f32_16x16x32_bf16 v[108:111], v[36:39], v[20:23], v[108:111]
    v_mfma_f32_16x16x32_bf16 v[144:147], v[36:39], v[24:27], v[144:147]
    ds_read_b64 v[28:29], v202 offset:0
    ds_read_b64 v[30:31], v203 offset:0
    ds_read_b64 v[32:33], v202 offset:2048
    s_waitcnt lgkmcnt(15)
    v_mfma_f32_16x16x32_bf16 v[112:115], v[40:43], v[20:23], v[112:115]
    v_mfma_f32_16x16x32_bf16 v[148:151], v[40:43], v[24:27], v[148:151]
    ds_read_b64 v[34:35], v203 offset:2048
    ds_read_b64_tr_b16 v[72:73], v204 offset:9216
    ds_read_b64_tr_b16 v[74:75], v204 offset:13824
    v_mfma_f32_16x16x32_bf16 v[116:119], v[44:47], v[20:23], v[116:119]
    v_mfma_f32_16x16x32_bf16 v[152:155], v[44:47], v[24:27], v[152:155]
    ds_read_b64_tr_b16 v[76:77], v204 offset:9248
    ds_read_b64_tr_b16 v[78:79], v204 offset:13856
    ds_read_b64_tr_b16 v[80:81], v204 offset:9280
    s_waitcnt lgkmcnt(15)
    v_mfma_f32_16x16x32_bf16 v[120:123], v[48:51], v[20:23], v[120:123]
    v_mfma_f32_16x16x32_bf16 v[156:159], v[48:51], v[24:27], v[156:159]
    ds_read_b64_tr_b16 v[82:83], v204 offset:13888
    ds_read_b64_tr_b16 v[84:85], v204 offset:9312
    ds_read_b64_tr_b16 v[86:87], v204 offset:13920
    v_mfma_f32_16x16x32_bf16 v[124:127], v[52:55], v[20:23], v[124:127]
    v_mfma_f32_16x16x32_bf16 v[160:163], v[52:55], v[24:27], v[160:163]
    ds_read_b64_tr_b16 v[88:89], v204 offset:9344
    ds_read_b64_tr_b16 v[90:91], v204 offset:13952
    ds_read_b64_tr_b16 v[92:93], v204 offset:9376
    v_mfma_f32_16x16x32_bf16 v[128:131], v[56:59], v[20:23], v[128:131]
    v_mfma_f32_16x16x32_bf16 v[164:167], v[56:59], v[24:27], v[164:167]
    ds_read_b64_tr_b16 v[94:95], v204 offset:13984
    ds_read_b64_tr_b16 v[96:97], v204 offset:9408
    ds_read_b64_tr_b16 v[98:99], v204 offset:14016
    s_waitcnt lgkmcnt(15)
    v_mfma_f32_16x16x32_bf16 v[132:135], v[60:63], v[20:23], v[132:135]
    v_mfma_f32_16x16x32_bf16 v[168:171], v[60:63], v[24:27], v[168:171]
    ds_read_b64_tr_b16 v[100:101], v204 offset:9440
    ds_read_b64_tr_b16 v[102:103], v204 offset:14048
    ds_read_b64_tr_b16 v[104:105], v204 offset:9472
    v_mfma_f32_16x16x32_bf16 v[136:139], v[64:67], v[20:23], v[136:139]
    v_mfma_f32_16x16x32_bf16 v[172:175], v[64:67], v[24:27], v[172:175]
    ds_read_b64_tr_b16 v[106:107], v204 offset:14080
    v_mfma_f32_16x16x32_bf16 v[140:143], v[68:71], v[20:23], v[140:143]
    v_mfma_f32_16x16x32_bf16 v[176:179], v[68:71], v[24:27], v[176:179]
    s_waitcnt lgkmcnt(0)
    s_waitcnt vmcnt(18)
    s_barrier
    s_add_u32 s4, s4, 128
    s_addc_u32 s5, s5, 0
    s_add_u32 s6, s6, s18
    s_addc_u32 s7, s7, 0
    s_lshl_b32 s9, s8, 12
    s_add_u32 m0, s9, 69632
    s_nop 0
    global_load_lds_dwordx4 v2, s[4:5]
    s_lshl_b32 s9, s8, 12
    s_add_u32 m0, s9, 70656
    s_nop 0
    global_load_lds_dwordx4 v3, s[4:5]
    s_lshl_b32 s9, s8, 12
    s_add_u32 m0, s9, 71680
    s_nop 0
    global_load_lds_dwordx4 v4, s[4:5]
    s_lshl_b32 s9, s8, 12
    s_add_u32 m0, s9, 72704
    s_nop 0
    global_load_lds_dwordx4 v5, s[4:5]
    s_mul_i32 s9, s8, 4608
    s_add_u32 m0, s9, 86016
    s_nop 0
    global_load_lds_dwordx4 v6, s[6:7]
    s_mul_i32 s9, s8, 4608
    s_add_u32 m0, s9, 87040
    s_nop 0
    global_load_lds_dwordx4 v7, s[6:7]
    s_mul_i32 s9, s8, 4608
    s_add_u32 m0, s9, 88064
    s_nop 0
    global_load_lds_dwordx4 v8, s[6:7]
    s_mul_i32 s9, s8, 4608
    s_add_u32 m0, s9, 89088
    s_nop 0
    global_load_lds_dwordx4 v9, s[6:7]
    s_mul_i32 s9, s8, 4608
    s_add_u32 m0, s9, 90112
    s_mov_b32 exec_hi, 0
    global_load_lds_dwordx4 v10, s[6:7]
    s_mov_b64 exec, -1
    v_mfma_f32_16x16x32_bf16 v[108:111], v[72:75], v[28:31], v[108:111]
    v_mfma_f32_16x16x32_bf16 v[144:147], v[72:75], v[32:35], v[144:147]
    ds_read_b64 v[20:21], v200 offset:34816
    ds_read_b64 v[22:23], v201 offset:34816
    ds_read_b64 v[24:25], v200 offset:36864
    v_mfma_f32_16x16x32_bf16 v[112:115], v[76:79], v[28:31], v[112:115]
    v_mfma_f32_16x16x32_bf16 v[148:151], v[76:79], v[32:35], v[148:151]
    ds_read_b64 v[26:27], v201 offset:36864
    ds_read_b64_tr_b16 v[36:37], v204 offset:34816
    ds_read_b64_tr_b16 v[38:39], v204 offset:39424
    v_mfma_f32_16x16x32_bf16 v[116:119], v[80:83], v[28:31], v[116:119]
    v_mfma_f32_16x16x32_bf16 v[152:155], v[80:83], v[32:35], v[152:155]
    ds_read_b64_tr_b16 v[40:41], v204 offset:34848
    ds_read_b64_tr_b16 v[42:43], v204 offset:39456
    ds_read_b64_tr_b16 v[44:45], v204 offset:34880
    v_mfma_f32_16x16x32_bf16 v[120:123], v[84:87], v[28:31], v[120:123]
    v_mfma_f32_16x16x32_bf16 v[156:159], v[84:87], v[32:35], v[156:159]
    ds_read_b64_tr_b16 v[46:47], v204 offset:39488
    ds_read_b64_tr_b16 v[48:49], v204 offset:34912
    ds_read_b64_tr_b16 v[50:51], v204 offset:39520
    v_mfma_f32_16x16x32_bf16 v[124:127], v[88:91], v[28:31], v[124:127]
    v_mfma_f32_16x16x32_bf16 v[160:163], v[88:91], v[32:35], v[160:163]
    ds_read_b64_tr_b16 v[52:53], v204 offset:34944
    ds_read_b64_tr_b16 v[54:55], v204 offset:39552
    ds_read_b64_tr_b16 v[56:57], v204 offset:34976
    v_mfma_f32_16x16x32_bf16 v[128:131], v[92:95], v[28:31], v[128:131]
    v_mfma_f32_16x16x32_bf16 v[164:167], v[92:95], v[32:35], v[164:167]
    ds_read_b64_tr_b16 v[58:59], v204 offset:39584
    ds_read_b64_tr_b16 v[60:61], v204 offset:35008
    ds_read_b64_tr_b16 v[62:63], v204 offset:39616
    v_mfma_f32_16x16x32_bf16 v[132:135], v[96:99], v[28:31], v[132:135]
    v_mfma_f32_16x16x32_bf16 v[168:171], v[96:99], v[32:35], v[168:171]
    ds_read_b64_tr_b16 v[64:65], v204 offset:35040
    ds_read_b64_tr_b16 v[66:67], v204 offset:39648
    ds_read_b64_tr_b16 v[68:69], v204 offset:35072
    v_mfma_f32_16x16x32_bf16 v[136:139], v[100:103], v[28:31], v[136:139]
    v_mfma_f32_16x16x32_bf16 v[172:175], v[100:103], v[32:35], v[172:175]
    ds_read_b64_tr_b16 v[70:71], v204 offset:39680
    v_mfma_f32_16x16x32_bf16 v[140:143], v[104:107], v[28:31], v[140:143]
    v_mfma_f32_16x16x32_bf16 v[176:179], v[104:107], v[32:35], v[176:179]
    s_waitcnt lgkmcnt(15)
    v_mfma_f32_16x16x32_bf16 v[108:111], v[36:39], v[20:23], v[108:111]
    v_mfma_f32_16x16x32_bf16 v[144:147], v[36:39], v[24:27], v[144:147]
    ds_read_b64 v[28:29], v202 offset:34816
    ds_read_b64 v[30:31], v203 offset:34816
    ds_read_b64 v[32:33], v202 offset:36864
    s_waitcnt lgkmcnt(15)
    v_mfma_f32_16x16x32_bf16 v[112:115], v[40:43], v[20:23], v[112:115]
    v_mfma_f32_16x16x32_bf16 v[148:151], v[40:43], v[24:27], v[148:151]
    ds_read_b64 v[34:35], v203 offset:36864
    ds_read_b64_tr_b16 v[72:73], v204 offset:44032
    ds_read_b64_tr_b16 v[74:75], v204 offset:48640
    v_mfma_f32_16x16x32_bf16 v[116:119], v[44:47], v[20:23], v[116:119]
    v_mfma_f32_16x16x32_bf16 v[152:155], v[44:47], v[24:27], v[152:155]
    ds_read_b64_tr_b16 v[76:77], v204 offset:44064
    ds_read_b64_tr_b16 v[78:79], v204 offset:48672
    ds_read_b64_tr_b16 v[80:81], v204 offset:44096
    s_waitcnt lgkmcnt(15)
    v_mfma_f32_16x16x32_bf16 v[120:123], v[48:51], v[20:23], v[120:123]
    v_mfma_f32_16x16x32_bf16 v[156:159], v[48:51], v[24:27], v[156:159]
    ds_read_b64_tr_b16 v[82:83], v204 offset:48704
    ds_read_b64_tr_b16 v[84:85], v204 offset:44128
    ds_read_b64_tr_b16 v[86:87], v204 offset:48736
    v_mfma_f32_16x16x32_bf16 v[124:127], v[52:55], v[20:23], v[124:127]
    v_mfma_f32_16x16x32_bf16 v[160:163], v[52:55], v[24:27], v[160:163]
    ds_read_b64_tr_b16 v[88:89], v204 offset:44160
    ds_read_b64_tr_b16 v[90:91], v204 offset:48768
    ds_read_b64_tr_b16 v[92:93], v204 offset:44192
    v_mfma_f32_16x16x32_bf16 v[128:131], v[56:59], v[20:23], v[128:131]
    v_mfma_f32_16x16x32_bf16 v[164:167], v[56:59], v[24:27], v[164:167]
    ds_read_b64_tr_b16 v[94:95], v204 offset:48800
    ds_read_b64_tr_b16 v[96:97], v204 offset:44224
    ds_read_b64_tr_b16 v[98:99], v204 offset:48832
    s_waitcnt lgkmcnt(15)
    v_mfma_f32_16x16x32_bf16 v[132:135], v[60:63], v[20:23], v[132:135]
    v_mfma_f32_16x16x32_bf16 v[168:171], v[60:63], v[24:27], v[168:171]
    ds_read_b64_tr_b16 v[100:101], v204 offset:44256
    ds_read_b64_tr_b16 v[102:103], v204 offset:48864
    ds_read_b64_tr_b16 v[104:105], v204 offset:44288
    v_mfma_f32_16x16x32_bf16 v[136:139], v[64:67], v[20:23], v[136:139]
    v_mfma_f32_16x16x32_bf16 v[172:175], v[64:67], v[24:27], v[172:175]
    ds_read_b64_tr_b16 v[106:107], v204 offset:48896
    v_mfma_f32_16x16x32_bf16 v[140:143], v[68:71], v[20:23], v[140:143]
    v_mfma_f32_16x16x32_bf16 v[176:179], v[68:71], v[24:27], v[176:179]
    s_waitcnt lgkmcnt(0)
    s_waitcnt vmcnt(18)
    s_barrier
    s_add_u32 s4, s4, 128
    s_addc_u32 s5, s5, 0
    s_add_u32 s6, s6, s18
    s_addc_u32 s7, s7, 0
    s_lshl_b32 s9, s8, 12
    s_add_u32 m0, s9, 104448
    s_nop 0
    global_load_lds_dwordx4 v2, s[4:5]
    s_lshl_b32 s9, s8, 12
    s_add_u32 m0, s9, 105472
    s_nop 0
    global_load_lds_dwordx4 v3, s[4:5]
    s_lshl_b32 s9, s8, 12
    s_add_u32 m0, s9, 106496
    s_nop 0
    global_load_lds_dwordx4 v4, s[4:5]
    s_lshl_b32 s9, s8, 12
    s_add_u32 m0, s9, 107520
    s_nop 0
    global_load_lds_dwordx4 v5, s[4:5]
    s_mul_i32 s9, s8, 4608
    s_add_u32 m0, s9, 120832
    s_nop 0
    global_load_lds_dwordx4 v6, s[6:7]
    s_mul_i32 s9, s8, 4608
    s_add_u32 m0, s9, 121856
    s_nop 0
    global_load_lds_dwordx4 v7, s[6:7]
    s_mul_i32 s9, s8, 4608
    s_add_u32 m0, s9, 122880
    s_nop 0
    global_load_lds_dwordx4 v8, s[6:7]
    s_mul_i32 s9, s8, 4608
    s_add_u32 m0, s9, 123904
    s_nop 0
    global_load_lds_dwordx4 v9, s[6:7]
    s_mul_i32 s9, s8, 4608
    s_add_u32 m0, s9, 124928
    s_mov_b32 exec_hi, 0
    global_load_lds_dwordx4 v10, s[6:7]
    s_mov_b64 exec, -1
    v_mfma_f32_16x16x32_bf16 v[108:111], v[72:75], v[28:31], v[108:111]
    v_mfma_f32_16x16x32_bf16 v[144:147], v[72:75], v[32:35], v[144:147]
    ds_read_b64 v[20:21], v11 offset:0
    ds_read_b64 v[22:23], v12 offset:0
    ds_read_b64 v[24:25], v11 offset:2048
    v_mfma_f32_16x16x32_bf16 v[112:115], v[76:79], v[28:31], v[112:115]
    v_mfma_f32_16x16x32_bf16 v[148:151], v[76:79], v[32:35], v[148:151]
    ds_read_b64 v[26:27], v12 offset:2048
    ds_read_b64_tr_b16 v[36:37], v15 offset:0
    ds_read_b64_tr_b16 v[38:39], v15 offset:4608
    v_mfma_f32_16x16x32_bf16 v[116:119], v[80:83], v[28:31], v[116:119]
    v_mfma_f32_16x16x32_bf16 v[152:155], v[80:83], v[32:35], v[152:155]
    ds_read_b64_tr_b16 v[40:41], v15 offset:32
    ds_read_b64_tr_b16 v[42:43], v15 offset:4640
    ds_read_b64_tr_b16 v[44:45], v15 offset:64
    v_mfma_f32_16x16x32_bf16 v[120:123], v[84:87], v[28:31], v[120:123]
    v_mfma_f32_16x16x32_bf16 v[156:159], v[84:87], v[32:35], v[156:159]
    ds_read_b64_tr_b16 v[46:47], v15 offset:4672
    ds_read_b64_tr_b16 v[48:49], v15 offset:96
    ds_read_b64_tr_b16 v[50:51], v15 offset:4704
    v_mfma_f32_16x16x32_bf16 v[124:127], v[88:91], v[28:31], v[124:127]
    v_mfma_f32_16x16x32_bf16 v[160:163], v[88:91], v[32:35], v[160:163]
    ds_read_b64_tr_b16 v[52:53], v15 offset:128
    ds_read_b64_tr_b16 v[54:55], v15 offset:4736
    ds_read_b64_tr_b16 v[56:57], v15 offset:160
    v_mfma_f32_16x16x32_bf16 v[128:131], v[92:95], v[28:31], v[128:131]
    v_mfma_f32_16x16x32_bf16 v[164:167], v[92:95], v[32:35], v[164:167]
    ds_read_b64_tr_b16 v[58:59], v15 offset:4768
    ds_read_b64_tr_b16 v[60:61], v15 offset:192
    ds_read_b64_tr_b16 v[62:63], v15 offset:4800
    v_mfma_f32_16x16x32_bf16 v[132:135], v[96:99], v[28:31], v[132:135]
    v_mfma_f32_16x16x32_bf16 v[168:171], v[96:99], v[32:35], v[168:171]
    ds_read_b64_tr_b16 v[64:65], v15 offset:224
    ds_read_b64_tr_b16 v[66:67], v15 offset:4832
    ds_read_b64_tr_b16 v[68:69], v15 offset:256
    v_mfma_f32_16x16x32_bf16 v[136:139], v[100:103], v[28:31], v[136:139]
    v_mfma_f32_16x16x32_bf16 v[172:175], v[100:103], v[32:35], v[172:175]
    ds_read_b64_tr_b16 v[70:71], v15 offset:4864
    v_mfma_f32_16x16x32_bf16 v[140:143], v[104:107], v[28:31], v[140:143]
    v_mfma_f32_16x16x32_bf16 v[176:179], v[104:107], v[32:35], v[176:179]
    s_waitcnt lgkmcnt(15)
    v_mfma_f32_16x16x32_bf16 v[108:111], v[36:39], v[20:23], v[108:111]
    v_mfma_f32_16x16x32_bf16 v[144:147], v[36:39], v[24:27], v[144:147]
    ds_read_b64 v[28:29], v13 offset:0
    ds_read_b64 v[30:31], v14 offset:0
    ds_read_b64 v[32:33], v13 offset:2048
    s_waitcnt lgkmcnt(15)
    v_mfma_f32_16x16x32_bf16 v[112:115], v[40:43], v[20:23], v[112:115]
    v_mfma_f32_16x16x32_bf16 v[148:151], v[40:43], v[24:27], v[148:151]
    ds_read_b64 v[34:35], v14 offset:2048
    ds_read_b64_tr_b16 v[72:73], v15 offset:9216
    ds_read_b64_tr_b16 v[74:75], v15 offset:13824
    v_mfma_f32_16x16x32_bf16 v[116:119], v[44:47], v[20:23], v[116:119]
    v_mfma_f32_16x16x32_bf16 v[152:155], v[44:47], v[24:27], v[152:155]
    ds_read_b64_tr_b16 v[76:77], v15 offset:9248
    ds_read_b64_tr_b16 v[78:79], v15 offset:13856
    ds_read_b64_tr_b16 v[80:81], v15 offset:9280
    s_waitcnt lgkmcnt(15)
    v_mfma_f32_16x16x32_bf16 v[120:123], v[48:51], v[20:23], v[120:123]
    v_mfma_f32_16x16x32_bf16 v[156:159], v[48:51], v[24:27], v[156:159]
    ds_read_b64_tr_b16 v[82:83], v15 offset:13888
    ds_read_b64_tr_b16 v[84:85], v15 offset:9312
    ds_read_b64_tr_b16 v[86:87], v15 offset:13920
    v_mfma_f32_16x16x32_bf16 v[124:127], v[52:55], v[20:23], v[124:127]
    v_mfma_f32_16x16x32_bf16 v[160:163], v[52:55], v[24:27], v[160:163]
    ds_read_b64_tr_b16 v[88:89], v15 offset:9344
    ds_read_b64_tr_b16 v[90:91], v15 offset:13952
    ds_read_b64_tr_b16 v[92:93], v15 offset:9376
    v_mfma_f32_16x16x32_bf16 v[128:131], v[56:59], v[20:23], v[128:131]
    v_mfma_f32_16x16x32_bf16 v[164:167], v[56:59], v[24:27], v[164:167]
    ds_read_b64_tr_b16 v[94:95], v15 offset:13984
    ds_read_b64_tr_b16 v[96:97], v15 offset:9408
    ds_read_b64_tr_b16 v[98:99], v15 offset:14016
    s_waitcnt lgkmcnt(15)
    v_mfma_f32_16x16x32_bf16 v[132:135], v[60:63], v[20:23], v[132:135]
    v_mfma_f32_16x16x32_bf16 v[168:171], v[60:63], v[24:27], v[168:171]
    ds_read_b64_tr_b16 v[100:101], v15 offset:9440
    ds_read_b64_tr_b16 v[102:103], v15 offset:14048
    ds_read_b64_tr_b16 v[104:105], v15 offset:9472
    v_mfma_f32_16x16x32_bf16 v[136:139], v[64:67], v[20:23], v[136:139]
    v_mfma_f32_16x16x32_bf16 v[172:175], v[64:67], v[24:27], v[172:175]
    ds_read_b64_tr_b16 v[106:107], v15 offset:14080
    v_mfma_f32_16x16x32_bf16 v[140:143], v[68:71], v[20:23], v[140:143]
    v_mfma_f32_16x16x32_bf16 v[176:179], v[68:71], v[24:27], v[176:179]
    s_waitcnt lgkmcnt(0)
    s_waitcnt vmcnt(18)
    s_barrier
    s_add_u32 s4, s4, 128
    s_addc_u32 s5, s5, 0
    s_add_u32 s6, s6, s18
    s_addc_u32 s7, s7, 0
    s_lshl_b32 s9, s8, 12
    s_add_u32 m0, s9, 0
    s_nop 0
    global_load_lds_dwordx4 v2, s[4:5]
    s_lshl_b32 s9, s8, 12
    s_add_u32 m0, s9, 1024
    s_nop 0
    global_load_lds_dwordx4 v3, s[4:5]
    s_lshl_b32 s9, s8, 12
    s_add_u32 m0, s9, 2048
    s_nop 0
    global_load_lds_dwordx4 v4, s[4:5]
    s_lshl_b32 s9, s8, 12
    s_add_u32 m0, s9, 3072
    s_nop 0
    global_load_lds_dwordx4 v5, s[4:5]
    s_mul_i32 s9, s8, 4608
    s_add_u32 m0, s9, 16384
    s_nop 0
    global_load_lds_dwordx4 v6, s[6:7]
    s_mul_i32 s9, s8, 4608
    s_add_u32 m0, s9, 17408
    s_nop 0
    global_load_lds_dwordx4 v7, s[6:7]
    s_mul_i32 s9, s8, 4608
    s_add_u32 m0, s9, 18432
    s_nop 0
    global_load_lds_dwordx4 v8, s[6:7]
    s_mul_i32 s9, s8, 4608
    s_add_u32 m0, s9, 19456
    s_nop 0
    global_load_lds_dwordx4 v9, s[6:7]
    s_mul_i32 s9, s8, 4608
    s_add_u32 m0, s9, 20480
    s_mov_b32 exec_hi, 0
    global_load_lds_dwordx4 v10, s[6:7]
    s_mov_b64 exec, -1
    v_mfma_f32_16x16x32_bf16 v[108:111], v[72:75], v[28:31], v[108:111]
    v_mfma_f32_16x16x32_bf16 v[144:147], v[72:75], v[32:35], v[144:147]
    ds_read_b64 v[20:21], v11 offset:34816
    ds_read_b64 v[22:23], v12 offset:34816
    ds_read_b64 v[24:25], v11 offset:36864
    v_mfma_f32_16x16x32_bf16 v[112:115], v[76:79], v[28:31], v[112:115]
    v_mfma_f32_16x16x32_bf16 v[148:151], v[76:79], v[32:35], v[148:151]
    ds_read_b64 v[26:27], v12 offset:36864
    ds_read_b64_tr_b16 v[36:37], v15 offset:34816
    ds_read_b64_tr_b16 v[38:39], v15 offset:39424
    v_mfma_f32_16x16x32_bf16 v[116:119], v[80:83], v[28:31], v[116:119]
    v_mfma_f32_16x16x32_bf16 v[152:155], v[80:83], v[32:35], v[152:155]
    ds_read_b64_tr_b16 v[40:41], v15 offset:34848
    ds_read_b64_tr_b16 v[42:43], v15 offset:39456
    ds_read_b64_tr_b16 v[44:45], v15 offset:34880
    v_mfma_f32_16x16x32_bf16 v[120:123], v[84:87], v[28:31], v[120:123]
    v_mfma_f32_16x16x32_bf16 v[156:159], v[84:87], v[32:35], v[156:159]
    ds_read_b64_tr_b16 v[46:47], v15 offset:39488
    ds_read_b64_tr_b16 v[48:49], v15 offset:34912
    ds_read_b64_tr_b16 v[50:51], v15 offset:39520
    v_mfma_f32_16x16x32_bf16 v[124:127], v[88:91], v[28:31], v[124:127]
    v_mfma_f32_16x16x32_bf16 v[160:163], v[88:91], v[32:35], v[160:163]
    ds_read_b64_tr_b16 v[52:53], v15 offset:34944
    ds_read_b64_tr_b16 v[54:55], v15 offset:39552
    ds_read_b64_tr_b16 v[56:57], v15 offset:34976
    v_mfma_f32_16x16x32_bf16 v[128:131], v[92:95], v[28:31], v[128:131]
    v_mfma_f32_16x16x32_bf16 v[164:167], v[92:95], v[32:35], v[164:167]
    ds_read_b64_tr_b16 v[58:59], v15 offset:39584
    ds_read_b64_tr_b16 v[60:61], v15 offset:35008
    ds_read_b64_tr_b16 v[62:63], v15 offset:39616
    v_mfma_f32_16x16x32_bf16 v[132:135], v[96:99], v[28:31], v[132:135]
    v_mfma_f32_16x16x32_bf16 v[168:171], v[96:99], v[32:35], v[168:171]
    ds_read_b64_tr_b16 v[64:65], v15 offset:35040
    ds_read_b64_tr_b16 v[66:67], v15 offset:39648
    ds_read_b64_tr_b16 v[68:69], v15 offset:35072
    v_mfma_f32_16x16x32_bf16 v[136:139], v[100:103], v[28:31], v[136:139]
    v_mfma_f32_16x16x32_bf16 v[172:175], v[100:103], v[32:35], v[172:175]
    ds_read_b64_tr_b16 v[70:71], v15 offset:39680
    v_mfma_f32_16x16x32_bf16 v[140:143], v[104:107], v[28:31], v[140:143]
    v_mfma_f32_16x16x32_bf16 v[176:179], v[104:107], v[32:35], v[176:179]
    s_waitcnt lgkmcnt(15)
    v_mfma_f32_16x16x32_bf16 v[108:111], v[36:39], v[20:23], v[108:111]
    v_mfma_f32_16x16x32_bf16 v[144:147], v[36:39], v[24:27], v[144:147]
    ds_read_b64 v[28:29], v13 offset:34816
    ds_read_b64 v[30:31], v14 offset:34816
    ds_read_b64 v[32:33], v13 offset:36864
    s_waitcnt lgkmcnt(15)
    v_mfma_f32_16x16x32_bf16 v[112:115], v[40:43], v[20:23], v[112:115]
    v_mfma_f32_16x16x32_bf16 v[148:151], v[40:43], v[24:27], v[148:151]
    ds_read_b64 v[34:35], v14 offset:36864
    ds_read_b64_tr_b16 v[72:73], v15 offset:44032
    ds_read_b64_tr_b16 v[74:75], v15 offset:48640
    v_mfma_f32_16x16x32_bf16 v[116:119], v[44:47], v[20:23], v[116:119]
    v_mfma_f32_16x16x32_bf16 v[152:155], v[44:47], v[24:27], v[152:155]
    ds_read_b64_tr_b16 v[76:77], v15 offset:44064
    ds_read_b64_tr_b16 v[78:79], v15 offset:48672
    ds_read_b64_tr_b16 v[80:81], v15 offset:44096
    s_waitcnt lgkmcnt(15)
    v_mfma_f32_16x16x32_bf16 v[120:123], v[48:51], v[20:23], v[120:123]
    v_mfma_f32_16x16x32_bf16 v[156:159], v[48:51], v[24:27], v[156:159]
    ds_read_b64_tr_b16 v[82:83], v15 offset:48704
    ds_read_b64_tr_b16 v[84:85], v15 offset:44128
    ds_read_b64_tr_b16 v[86:87], v15 offset:48736
    v_mfma_f32_16x16x32_bf16 v[124:127], v[52:55], v[20:23], v[124:127]
    v_mfma_f32_16x16x32_bf16 v[160:163], v[52:55], v[24:27], v[160:163]
    ds_read_b64_tr_b16 v[88:89], v15 offset:44160
    ds_read_b64_tr_b16 v[90:91], v15 offset:48768
    ds_read_b64_tr_b16 v[92:93], v15 offset:44192
    v_mfma_f32_16x16x32_bf16 v[128:131], v[56:59], v[20:23], v[128:131]
    v_mfma_f32_16x16x32_bf16 v[164:167], v[56:59], v[24:27], v[164:167]
    ds_read_b64_tr_b16 v[94:95], v15 offset:48800
    ds_read_b64_tr_b16 v[96:97], v15 offset:44224
    ds_read_b64_tr_b16 v[98:99], v15 offset:48832
    s_waitcnt lgkmcnt(15)
    v_mfma_f32_16x16x32_bf16 v[132:135], v[60:63], v[20:23], v[132:135]
    v_mfma_f32_16x16x32_bf16 v[168:171], v[60:63], v[24:27], v[168:171]
    ds_read_b64_tr_b16 v[100:101], v15 offset:44256
    ds_read_b64_tr_b16 v[102:103], v15 offset:48864
    ds_read_b64_tr_b16 v[104:105], v15 offset:44288
    v_mfma_f32_16x16x32_bf16 v[136:139], v[64:67], v[20:23], v[136:139]
    v_mfma_f32_16x16x32_bf16 v[172:175], v[64:67], v[24:27], v[172:175]
    ds_read_b64_tr_b16 v[106:107], v15 offset:48896
    v_mfma_f32_16x16x32_bf16 v[140:143], v[68:71], v[20:23], v[140:143]
    v_mfma_f32_16x16x32_bf16 v[176:179], v[68:71], v[24:27], v[176:179]
    s_waitcnt lgkmcnt(0)
    s_waitcnt vmcnt(18)
    s_barrier
    s_add_u32 s4, s4, 128
    s_addc_u32 s5, s5, 0
    s_add_u32 s6, s6, s18
    s_addc_u32 s7, s7, 0
    s_lshl_b32 s9, s8, 12
    s_add_u32 m0, s9, 34816
    s_nop 0
    global_load_lds_dwordx4 v2, s[4:5]
    s_lshl_b32 s9, s8, 12
    s_add_u32 m0, s9, 35840
    s_nop 0
    global_load_lds_dwordx4 v3, s[4:5]
    s_lshl_b32 s9, s8, 12
    s_add_u32 m0, s9, 36864
    s_nop 0
    global_load_lds_dwordx4 v4, s[4:5]
    s_lshl_b32 s9, s8, 12
    s_add_u32 m0, s9, 37888
    s_nop 0
    global_load_lds_dwordx4 v5, s[4:5]
    s_mul_i32 s9, s8, 4608
    s_add_u32 m0, s9, 51200
    s_nop 0
    global_load_lds_dwordx4 v6, s[6:7]
    s_mul_i32 s9, s8, 4608
    s_add_u32 m0, s9, 52224
    s_nop 0
    global_load_lds_dwordx4 v7, s[6:7]
    s_mul_i32 s9, s8, 4608
    s_add_u32 m0, s9, 53248
    s_nop 0
    global_load_lds_dwordx4 v8, s[6:7]
    s_mul_i32 s9, s8, 4608
    s_add_u32 m0, s9, 54272
    s_nop 0
    global_load_lds_dwordx4 v9, s[6:7]
    s_mul_i32 s9, s8, 4608
    s_add_u32 m0, s9, 55296
    s_mov_b32 exec_hi, 0
    global_load_lds_dwordx4 v10, s[6:7]
    s_mov_b64 exec, -1
    v_mfma_f32_16x16x32_bf16 v[108:111], v[72:75], v[28:31], v[108:111]
    v_mfma_f32_16x16x32_bf16 v[144:147], v[72:75], v[32:35], v[144:147]
    ds_read_b64 v[20:21], v200 offset:0
    ds_read_b64 v[22:23], v201 offset:0
    ds_read_b64 v[24:25], v200 offset:2048
    v_mfma_f32_16x16x32_bf16 v[112:115], v[76:79], v[28:31], v[112:115]
    v_mfma_f32_16x16x32_bf16 v[148:151], v[76:79], v[32:35], v[148:151]
    ds_read_b64 v[26:27], v201 offset:2048
    ds_read_b64_tr_b16 v[36:37], v204 offset:0
    ds_read_b64_tr_b16 v[38:39], v204 offset:4608
    v_mfma_f32_16x16x32_bf16 v[116:119], v[80:83], v[28:31], v[116:119]
    v_mfma_f32_16x16x32_bf16 v[152:155], v[80:83], v[32:35], v[152:155]
    ds_read_b64_tr_b16 v[40:41], v204 offset:32
    ds_read_b64_tr_b16 v[42:43], v204 offset:4640
    ds_read_b64_tr_b16 v[44:45], v204 offset:64
    v_mfma_f32_16x16x32_bf16 v[120:123], v[84:87], v[28:31], v[120:123]
    v_mfma_f32_16x16x32_bf16 v[156:159], v[84:87], v[32:35], v[156:159]
    ds_read_b64_tr_b16 v[46:47], v204 offset:4672
    ds_read_b64_tr_b16 v[48:49], v204 offset:96
    ds_read_b64_tr_b16 v[50:51], v204 offset:4704
    v_mfma_f32_16x16x32_bf16 v[124:127], v[88:91], v[28:31], v[124:127]
    v_mfma_f32_16x16x32_bf16 v[160:163], v[88:91], v[32:35], v[160:163]
    ds_read_b64_tr_b16 v[52:53], v204 offset:128
    ds_read_b64_tr_b16 v[54:55], v204 offset:4736
    ds_read_b64_tr_b16 v[56:57], v204 offset:160
    v_mfma_f32_16x16x32_bf16 v[128:131], v[92:95], v[28:31], v[128:131]
    v_mfma_f32_16x16x32_bf16 v[164:167], v[92:95], v[32:35], v[164:167]
    ds_read_b64_tr_b16 v[58:59], v204 offset:4768
    ds_read_b64_tr_b16 v[60:61], v204 offset:192
    ds_read_b64_tr_b16 v[62:63], v204 offset:4800
    v_mfma_f32_16x16x32_bf16 v[132:135], v[96:99], v[28:31], v[132:135]
    v_mfma_f32_16x16x32_bf16 v[168:171], v[96:99], v[32:35], v[168:171]
    ds_read_b64_tr_b16 v[64:65], v204 offset:224
    ds_read_b64_tr_b16 v[66:67], v204 offset:4832
    ds_read_b64_tr_b16 v[68:69], v204 offset:256
    v_mfma_f32_16x16x32_bf16 v[136:139], v[100:103], v[28:31], v[136:139]
    v_mfma_f32_16x16x32_bf16 v[172:175], v[100:103], v[32:35], v[172:175]
    ds_read_b64_tr_b16 v[70:71], v204 offset:4864
    v_mfma_f32_16x16x32_bf16 v[140:143], v[104:107], v[28:31], v[140:143]
    v_mfma_f32_16x16x32_bf16 v[176:179], v[104:107], v[32:35], v[176:179]
    s_waitcnt lgkmcnt(15)
    v_mfma_f32_16x16x32_bf16 v[108:111], v[36:39], v[20:23], v[108:111]
    v_mfma_f32_16x16x32_bf16 v[144:147], v[36:39], v[24:27], v[144:147]
    ds_read_b64 v[28:29], v202 offset:0
    ds_read_b64 v[30:31], v203 offset:0
    ds_read_b64 v[32:33], v202 offset:2048
    s_waitcnt lgkmcnt(15)
    v_mfma_f32_16x16x32_bf16 v[112:115], v[40:43], v[20:23], v[112:115]
    v_mfma_f32_16x16x32_bf16 v[148:151], v[40:43], v[24:27], v[148:151]
    ds_read_b64 v[34:35], v203 offset:2048
    ds_read_b64_tr_b16 v[72:73], v204 offset:9216
    ds_read_b64_tr_b16 v[74:75], v204 offset:13824
    v_mfma_f32_16x16x32_bf16 v[116:119], v[44:47], v[20:23], v[116:119]
    v_mfma_f32_16x16x32_bf16 v[152:155], v[44:47], v[24:27], v[152:155]
    ds_read_b64_tr_b16 v[76:77], v204 offset:9248
    ds_read_b64_tr_b16 v[78:79], v204 offset:13856
    ds_read_b64_tr_b16 v[80:81], v204 offset:9280
    s_waitcnt lgkmcnt(15)
    v_mfma_f32_16x16x32_bf16 v[120:123], v[48:51], v[20:23], v[120:123]
    v_mfma_f32_16x16x32_bf16 v[156:159], v[48:51], v[24:27], v[156:159]
    ds_read_b64_tr_b16 v[82:83], v204 offset:13888
    ds_read_b64_tr_b16 v[84:85], v204 offset:9312
    ds_read_b64_tr_b16 v[86:87], v204 offset:13920
    v_mfma_f32_16x16x32_bf16 v[124:127], v[52:55], v[20:23], v[124:127]
    v_mfma_f32_16x16x32_bf16 v[160:163], v[52:55], v[24:27], v[160:163]
    ds_read_b64_tr_b16 v[88:89], v204 offset:9344
    ds_read_b64_tr_b16 v[90:91], v204 offset:13952
    ds_read_b64_tr_b16 v[92:93], v204 offset:9376
    v_mfma_f32_16x16x32_bf16 v[128:131], v[56:59], v[20:23], v[128:131]
    v_mfma_f32_16x16x32_bf16 v[164:167], v[56:59], v[24:27], v[164:167]
    ds_read_b64_tr_b16 v[94:95], v204 offset:13984
    ds_read_b64_tr_b16 v[96:97], v204 offset:9408
    ds_read_b64_tr_b16 v[98:99], v204 offset:14016
    s_waitcnt lgkmcnt(15)
    v_mfma_f32_16x16x32_bf16 v[132:135], v[60:63], v[20:23], v[132:135]
    v_mfma_f32_16x16x32_bf16 v[168:171], v[60:63], v[24:27], v[168:171]
    ds_read_b64_tr_b16 v[100:101], v204 offset:9440
    ds_read_b64_tr_b16 v[102:103], v204 offset:14048
    ds_read_b64_tr_b16 v[104:105], v204 offset:9472
    v_mfma_f32_16x16x32_bf16 v[136:139], v[64:67], v[20:23], v[136:139]
    v_mfma_f32_16x16x32_bf16 v[172:175], v[64:67], v[24:27], v[172:175]
    ds_read_b64_tr_b16 v[106:107], v204 offset:14080
    v_mfma_f32_16x16x32_bf16 v[140:143], v[68:71], v[20:23], v[140:143]
    v_mfma_f32_16x16x32_bf16 v[176:179], v[68:71], v[24:27], v[176:179]
    s_waitcnt lgkmcnt(0)
    s_waitcnt vmcnt(18)
    s_barrier
    s_add_u32 s4, s4, 128
    s_addc_u32 s5, s5, 0
    s_add_u32 s6, s6, s18
    s_addc_u32 s7, s7, 0
    s_lshl_b32 s9, s8, 12
    s_add_u32 m0, s9, 69632
    s_nop 0
    global_load_lds_dwordx4 v2, s[4:5]
    s_lshl_b32 s9, s8, 12
    s_add_u32 m0, s9, 70656
    s_nop 0
    global_load_lds_dwordx4 v3, s[4:5]
    s_lshl_b32 s9, s8, 12
    s_add_u32 m0, s9, 71680
    s_nop 0
    global_load_lds_dwordx4 v4, s[4:5]
    s_lshl_b32 s9, s8, 12
    s_add_u32 m0, s9, 72704
    s_nop 0
    global_load_lds_dwordx4 v5, s[4:5]
    s_mul_i32 s9, s8, 4608
    s_add_u32 m0, s9, 86016
    s_nop 0
    global_load_lds_dwordx4 v6, s[6:7]
    s_mul_i32 s9, s8, 4608
    s_add_u32 m0, s9, 87040
    s_nop 0
    global_load_lds_dwordx4 v7, s[6:7]
    s_mul_i32 s9, s8, 4608
    s_add_u32 m0, s9, 88064
    s_nop 0
    global_load_lds_dwordx4 v8, s[6:7]
    s_mul_i32 s9, s8, 4608
    s_add_u32 m0, s9, 89088
    s_nop 0
    global_load_lds_dwordx4 v9, s[6:7]
    s_mul_i32 s9, s8, 4608
    s_add_u32 m0, s9, 90112
    s_mov_b32 exec_hi, 0
    global_load_lds_dwordx4 v10, s[6:7]
    s_mov_b64 exec, -1
    v_mfma_f32_16x16x32_bf16 v[108:111], v[72:75], v[28:31], v[108:111]
    v_mfma_f32_16x16x32_bf16 v[144:147], v[72:75], v[32:35], v[144:147]
    ds_read_b64 v[20:21], v200 offset:34816
    ds_read_b64 v[22:23], v201 offset:34816
    ds_read_b64 v[24:25], v200 offset:36864
    v_mfma_f32_16x16x32_bf16 v[112:115], v[76:79], v[28:31], v[112:115]
    v_mfma_f32_16x16x32_bf16 v[148:151], v[76:79], v[32:35], v[148:151]
    ds_read_b64 v[26:27], v201 offset:36864
    ds_read_b64_tr_b16 v[36:37], v204 offset:34816
    ds_read_b64_tr_b16 v[38:39], v204 offset:39424
    v_mfma_f32_16x16x32_bf16 v[116:119], v[80:83], v[28:31], v[116:119]
    v_mfma_f32_16x16x32_bf16 v[152:155], v[80:83], v[32:35], v[152:155]
    ds_read_b64_tr_b16 v[40:41], v204 offset:34848
    ds_read_b64_tr_b16 v[42:43], v204 offset:39456
    ds_read_b64_tr_b16 v[44:45], v204 offset:34880
    v_mfma_f32_16x16x32_bf16 v[120:123], v[84:87], v[28:31], v[120:123]
    v_mfma_f32_16x16x32_bf16 v[156:159], v[84:87], v[32:35], v[156:159]
    ds_read_b64_tr_b16 v[46:47], v204 offset:39488
    ds_read_b64_tr_b16 v[48:49], v204 offset:34912
    ds_read_b64_tr_b16 v[50:51], v204 offset:39520
    v_mfma_f32_16x16x32_bf16 v[124:127], v[88:91], v[28:31], v[124:127]
    v_mfma_f32_16x16x32_bf16 v[160:163], v[88:91], v[32:35], v[160:163]
    ds_read_b64_tr_b16 v[52:53], v204 offset:34944
    ds_read_b64_tr_b16 v[54:55], v204 offset:39552
    ds_read_b64_tr_b16 v[56:57], v204 offset:34976
    v_mfma_f32_16x16x32_bf16 v[128:131], v[92:95], v[28:31], v[128:131]
    v_mfma_f32_16x16x32_bf16 v[164:167], v[92:95], v[32:35], v[164:167]
    ds_read_b64_tr_b16 v[58:59], v204 offset:39584
    ds_read_b64_tr_b16 v[60:61], v204 offset:35008
    ds_read_b64_tr_b16 v[62:63], v204 offset:39616
    v_mfma_f32_16x16x32_bf16 v[132:135], v[96:99], v[28:31], v[132:135]
    v_mfma_f32_16x16x32_bf16 v[168:171], v[96:99], v[32:35], v[168:171]
    ds_read_b64_tr_b16 v[64:65], v204 offset:35040
    ds_read_b64_tr_b16 v[66:67], v204 offset:39648
    ds_read_b64_tr_b16 v[68:69], v204 offset:35072
    v_mfma_f32_16x16x32_bf16 v[136:139], v[100:103], v[28:31], v[136:139]
    v_mfma_f32_16x16x32_bf16 v[172:175], v[100:103], v[32:35], v[172:175]
    ds_read_b64_tr_b16 v[70:71], v204 offset:39680
    v_mfma_f32_16x16x32_bf16 v[140:143], v[104:107], v[28:31], v[140:143]
    v_mfma_f32_16x16x32_bf16 v[176:179], v[104:107], v[32:35], v[176:179]
    s_waitcnt lgkmcnt(15)
    v_mfma_f32_16x16x32_bf16 v[108:111], v[36:39], v[20:23], v[108:111]
    v_mfma_f32_16x16x32_bf16 v[144:147], v[36:39], v[24:27], v[144:147]
    ds_read_b64 v[28:29], v202 offset:34816
    ds_read_b64 v[30:31], v203 offset:34816
    ds_read_b64 v[32:33], v202 offset:36864
    s_waitcnt lgkmcnt(15)
    v_mfma_f32_16x16x32_bf16 v[112:115], v[40:43], v[20:23], v[112:115]
    v_mfma_f32_16x16x32_bf16 v[148:151], v[40:43], v[24:27], v[148:151]
    ds_read_b64 v[34:35], v203 offset:36864
    ds_read_b64_tr_b16 v[72:73], v204 offset:44032
    ds_read_b64_tr_b16 v[74:75], v204 offset:48640
    v_mfma_f32_16x16x32_bf16 v[116:119], v[44:47], v[20:23], v[116:119]
    v_mfma_f32_16x16x32_bf16 v[152:155], v[44:47], v[24:27], v[152:155]
    ds_read_b64_tr_b16 v[76:77], v204 offset:44064
    ds_read_b64_tr_b16 v[78:79], v204 offset:48672
    ds_read_b64_tr_b16 v[80:81], v204 offset:44096
    s_waitcnt lgkmcnt(15)
    v_mfma_f32_16x16x32_bf16 v[120:123], v[48:51], v[20:23], v[120:123]
    v_mfma_f32_16x16x32_bf16 v[156:159], v[48:51], v[24:27], v[156:159]
    ds_read_b64_tr_b16 v[82:83], v204 offset:48704
    ds_read_b64_tr_b16 v[84:85], v204 offset:44128
    ds_read_b64_tr_b16 v[86:87], v204 offset:48736
    v_mfma_f32_16x16x32_bf16 v[124:127], v[52:55], v[20:23], v[124:127]
    v_mfma_f32_16x16x32_bf16 v[160:163], v[52:55], v[24:27], v[160:163]
    ds_read_b64_tr_b16 v[88:89], v204 offset:44160
    ds_read_b64_tr_b16 v[90:91], v204 offset:48768
    ds_read_b64_tr_b16 v[92:93], v204 offset:44192
    v_mfma_f32_16x16x32_bf16 v[128:131], v[56:59], v[20:23], v[128:131]
    v_mfma_f32_16x16x32_bf16 v[164:167], v[56:59], v[24:27], v[164:167]
    ds_read_b64_tr_b16 v[94:95], v204 offset:48800
    ds_read_b64_tr_b16 v[96:97], v204 offset:44224
    ds_read_b64_tr_b16 v[98:99], v204 offset:48832
    s_waitcnt lgkmcnt(15)
    v_mfma_f32_16x16x32_bf16 v[132:135], v[60:63], v[20:23], v[132:135]
    v_mfma_f32_16x16x32_bf16 v[168:171], v[60:63], v[24:27], v[168:171]
    ds_read_b64_tr_b16 v[100:101], v204 offset:44256
    ds_read_b64_tr_b16 v[102:103], v204 offset:48864
    ds_read_b64_tr_b16 v[104:105], v204 offset:44288
    v_mfma_f32_16x16x32_bf16 v[136:139], v[64:67], v[20:23], v[136:139]
    v_mfma_f32_16x16x32_bf16 v[172:175], v[64:67], v[24:27], v[172:175]
    ds_read_b64_tr_b16 v[106:107], v204 offset:48896
    v_mfma_f32_16x16x32_bf16 v[140:143], v[68:71], v[20:23], v[140:143]
    v_mfma_f32_16x16x32_bf16 v[176:179], v[68:71], v[24:27], v[176:179]
    s_waitcnt lgkmcnt(0)
    s_waitcnt vmcnt(18)
    s_barrier
    v_mfma_f32_16x16x32_bf16 v[108:111], v[72:75], v[28:31], v[108:111]
    v_mfma_f32_16x16x32_bf16 v[144:147], v[72:75], v[32:35], v[144:147]
    ds_read_b64 v[20:21], v11 offset:0
    ds_read_b64 v[22:23], v12 offset:0
    ds_read_b64 v[24:25], v11 offset:2048
    v_mfma_f32_16x16x32_bf16 v[112:115], v[76:79], v[28:31], v[112:115]
    v_mfma_f32_16x16x32_bf16 v[148:151], v[76:79], v[32:35], v[148:151]
    ds_read_b64 v[26:27], v12 offset:2048
    ds_read_b64_tr_b16 v[36:37], v15 offset:0
    ds_read_b64_tr_b16 v[38:39], v15 offset:4608
    v_mfma_f32_16x16x32_bf16 v[116:119], v[80:83], v[28:31], v[116:119]
    v_mfma_f32_16x16x32_bf16 v[152:155], v[80:83], v[32:35], v[152:155]
    ds_read_b64_tr_b16 v[40:41], v15 offset:32
    ds_read_b64_tr_b16 v[42:43], v15 offset:4640
    ds_read_b64_tr_b16 v[44:45], v15 offset:64
    v_mfma_f32_16x16x32_bf16 v[120:123], v[84:87], v[28:31], v[120:123]
    v_mfma_f32_16x16x32_bf16 v[156:159], v[84:87], v[32:35], v[156:159]
    ds_read_b64_tr_b16 v[46:47], v15 offset:4672
    ds_read_b64_tr_b16 v[48:49], v15 offset:96
    ds_read_b64_tr_b16 v[50:51], v15 offset:4704
    v_mfma_f32_16x16x32_bf16 v[124:127], v[88:91], v[28:31], v[124:127]
    v_mfma_f32_16x16x32_bf16 v[160:163], v[88:91], v[32:35], v[160:163]
    ds_read_b64_tr_b16 v[52:53], v15 offset:128
    ds_read_b64_tr_b16 v[54:55], v15 offset:4736
    ds_read_b64_tr_b16 v[56:57], v15 offset:160
    v_mfma_f32_16x16x32_bf16 v[128:131], v[92:95], v[28:31], v[128:131]
    v_mfma_f32_16x16x32_bf16 v[164:167], v[92:95], v[32:35], v[164:167]
    ds_read_b64_tr_b16 v[58:59], v15 offset:4768
    ds_read_b64_tr_b16 v[60:61], v15 offset:192
    ds_read_b64_tr_b16 v[62:63], v15 offset:4800
    v_mfma_f32_16x16x32_bf16 v[132:135], v[96:99], v[28:31], v[132:135]
    v_mfma_f32_16x16x32_bf16 v[168:171], v[96:99], v[32:35], v[168:171]
    ds_read_b64_tr_b16 v[64:65], v15 offset:224
    ds_read_b64_tr_b16 v[66:67], v15 offset:4832
    ds_read_b64_tr_b16 v[68:69], v15 offset:256
    v_mfma_f32_16x16x32_bf16 v[136:139], v[100:103], v[28:31], v[136:139]
    v_mfma_f32_16x16x32_bf16 v[172:175], v[100:103], v[32:35], v[172:175]
    ds_read_b64_tr_b16 v[70:71], v15 offset:4864
    v_mfma_f32_16x16x32_bf16 v[140:143], v[104:107], v[28:31], v[140:143]
    v_mfma_f32_16x16x32_bf16 v[176:179], v[104:107], v[32:35], v[176:179]
    s_waitcnt lgkmcnt(15)
    v_mfma_f32_16x16x32_bf16 v[108:111], v[36:39], v[20:23], v[108:111]
    v_mfma_f32_16x16x32_bf16 v[144:147], v[36:39], v[24:27], v[144:147]
    ds_read_b64 v[28:29], v13 offset:0
    ds_read_b64 v[30:31], v14 offset:0
    ds_read_b64 v[32:33], v13 offset:2048
    s_waitcnt lgkmcnt(15)
    v_mfma_f32_16x16x32_bf16 v[112:115], v[40:43], v[20:23], v[112:115]
    v_mfma_f32_16x16x32_bf16 v[148:151], v[40:43], v[24:27], v[148:151]
    ds_read_b64 v[34:35], v14 offset:2048
    ds_read_b64_tr_b16 v[72:73], v15 offset:9216
    ds_read_b64_tr_b16 v[74:75], v15 offset:13824
    v_mfma_f32_16x16x32_bf16 v[116:119], v[44:47], v[20:23], v[116:119]
    v_mfma_f32_16x16x32_bf16 v[152:155], v[44:47], v[24:27], v[152:155]
    ds_read_b64_tr_b16 v[76:77], v15 offset:9248
    ds_read_b64_tr_b16 v[78:79], v15 offset:13856
    ds_read_b64_tr_b16 v[80:81], v15 offset:9280
    s_waitcnt lgkmcnt(15)
    v_mfma_f32_16x16x32_bf16 v[120:123], v[48:51], v[20:23], v[120:123]
    v_mfma_f32_16x16x32_bf16 v[156:159], v[48:51], v[24:27], v[156:159]
    ds_read_b64_tr_b16 v[82:83], v15 offset:13888
    ds_read_b64_tr_b16 v[84:85], v15 offset:9312
    ds_read_b64_tr_b16 v[86:87], v15 offset:13920
    v_mfma_f32_16x16x32_bf16 v[124:127], v[52:55], v[20:23], v[124:127]
    v_mfma_f32_16x16x32_bf16 v[160:163], v[52:55], v[24:27], v[160:163]
    ds_read_b64_tr_b16 v[88:89], v15 offset:9344
    ds_read_b64_tr_b16 v[90:91], v15 offset:13952
    ds_read_b64_tr_b16 v[92:93], v15 offset:9376
    v_mfma_f32_16x16x32_bf16 v[128:131], v[56:59], v[20:23], v[128:131]
    v_mfma_f32_16x16x32_bf16 v[164:167], v[56:59], v[24:27], v[164:167]
    ds_read_b64_tr_b16 v[94:95], v15 offset:13984
    ds_read_b64_tr_b16 v[96:97], v15 offset:9408
    ds_read_b64_tr_b16 v[98:99], v15 offset:14016
    s_waitcnt lgkmcnt(15)
    v_mfma_f32_16x16x32_bf16 v[132:135], v[60:63], v[20:23], v[132:135]
    v_mfma_f32_16x16x32_bf16 v[168:171], v[60:63], v[24:27], v[168:171]
    ds_read_b64_tr_b16 v[100:101], v15 offset:9440
    ds_read_b64_tr_b16 v[102:103], v15 offset:14048
    ds_read_b64_tr_b16 v[104:105], v15 offset:9472
    v_mfma_f32_16x16x32_bf16 v[136:139], v[64:67], v[20:23], v[136:139]
    v_mfma_f32_16x16x32_bf16 v[172:175], v[64:67], v[24:27], v[172:175]
    ds_read_b64_tr_b16 v[106:107], v15 offset:14080
    v_mfma_f32_16x16x32_bf16 v[140:143], v[68:71], v[20:23], v[140:143]
    v_mfma_f32_16x16x32_bf16 v[176:179], v[68:71], v[24:27], v[176:179]
    s_waitcnt lgkmcnt(0)
    s_waitcnt vmcnt(9)
    s_barrier
    v_mfma_f32_16x16x32_bf16 v[108:111], v[72:75], v[28:31], v[108:111]
    v_mfma_f32_16x16x32_bf16 v[144:147], v[72:75], v[32:35], v[144:147]
    ds_read_b64 v[20:21], v11 offset:34816
    ds_read_b64 v[22:23], v12 offset:34816
    ds_read_b64 v[24:25], v11 offset:36864
    v_mfma_f32_16x16x32_bf16 v[112:115], v[76:79], v[28:31], v[112:115]
    v_mfma_f32_16x16x32_bf16 v[148:151], v[76:79], v[32:35], v[148:151]
    ds_read_b64 v[26:27], v12 offset:36864
    ds_read_b64_tr_b16 v[36:37], v15 offset:34816
    ds_read_b64_tr_b16 v[38:39], v15 offset:39424
    v_mfma_f32_16x16x32_bf16 v[116:119], v[80:83], v[28:31], v[116:119]
    v_mfma_f32_16x16x32_bf16 v[152:155], v[80:83], v[32:35], v[152:155]
    ds_read_b64_tr_b16 v[40:41], v15 offset:34848
    ds_read_b64_tr_b16 v[42:43], v15 offset:39456
    ds_read_b64_tr_b16 v[44:45], v15 offset:34880
    v_mfma_f32_16x16x32_bf16 v[120:123], v[84:87], v[28:31], v[120:123]
    v_mfma_f32_16x16x32_bf16 v[156:159], v[84:87], v[32:35], v[156:159]
    ds_read_b64_tr_b16 v[46:47], v15 offset:39488
    ds_read_b64_tr_b16 v[48:49], v15 offset:34912
    ds_read_b64_tr_b16 v[50:51], v15 offset:39520
    v_mfma_f32_16x16x32_bf16 v[124:127], v[88:91], v[28:31], v[124:127]
    v_mfma_f32_16x16x32_bf16 v[160:163], v[88:91], v[32:35], v[160:163]
    ds_read_b64_tr_b16 v[52:53], v15 offset:34944
    ds_read_b64_tr_b16 v[54:55], v15 offset:39552
    ds_read_b64_tr_b16 v[56:57], v15 offset:34976
    v_mfma_f32_16x16x32_bf16 v[128:131], v[92:95], v[28:31], v[128:131]
    v_mfma_f32_16x16x32_bf16 v[164:167], v[92:95], v[32:35], v[164:167]
    ds_read_b64_tr_b16 v[58:59], v15 offset:39584
    ds_read_b64_tr_b16 v[60:61], v15 offset:35008
    ds_read_b64_tr_b16 v[62:63], v15 offset:39616
    v_mfma_f32_16x16x32_bf16 v[132:135], v[96:99], v[28:31], v[132:135]
    v_mfma_f32_16x16x32_bf16 v[168:171], v[96:99], v[32:35], v[168:171]
    ds_read_b64_tr_b16 v[64:65], v15 offset:35040
    ds_read_b64_tr_b16 v[66:67], v15 offset:39648
    ds_read_b64_tr_b16 v[68:69], v15 offset:35072
    v_mfma_f32_16x16x32_bf16 v[136:139], v[100:103], v[28:31], v[136:139]
    v_mfma_f32_16x16x32_bf16 v[172:175], v[100:103], v[32:35], v[172:175]
    ds_read_b64_tr_b16 v[70:71], v15 offset:39680
    v_mfma_f32_16x16x32_bf16 v[140:143], v[104:107], v[28:31], v[140:143]
    v_mfma_f32_16x16x32_bf16 v[176:179], v[104:107], v[32:35], v[176:179]
    s_waitcnt lgkmcnt(15)
    v_mfma_f32_16x16x32_bf16 v[108:111], v[36:39], v[20:23], v[108:111]
    v_mfma_f32_16x16x32_bf16 v[144:147], v[36:39], v[24:27], v[144:147]
    ds_read_b64 v[28:29], v13 offset:34816
    ds_read_b64 v[30:31], v14 offset:34816
    ds_read_b64 v[32:33], v13 offset:36864
    s_waitcnt lgkmcnt(15)
    v_mfma_f32_16x16x32_bf16 v[112:115], v[40:43], v[20:23], v[112:115]
    v_mfma_f32_16x16x32_bf16 v[148:151], v[40:43], v[24:27], v[148:151]
    ds_read_b64 v[34:35], v14 offset:36864
    ds_read_b64_tr_b16 v[72:73], v15 offset:44032
    ds_read_b64_tr_b16 v[74:75], v15 offset:48640
    v_mfma_f32_16x16x32_bf16 v[116:119], v[44:47], v[20:23], v[116:119]
    v_mfma_f32_16x16x32_bf16 v[152:155], v[44:47], v[24:27], v[152:155]
    ds_read_b64_tr_b16 v[76:77], v15 offset:44064
    ds_read_b64_tr_b16 v[78:79], v15 offset:48672
    ds_read_b64_tr_b16 v[80:81], v15 offset:44096
    s_waitcnt lgkmcnt(15)
    v_mfma_f32_16x16x32_bf16 v[120:123], v[48:51], v[20:23], v[120:123]
    v_mfma_f32_16x16x32_bf16 v[156:159], v[48:51], v[24:27], v[156:159]
    ds_read_b64_tr_b16 v[82:83], v15 offset:48704
    ds_read_b64_tr_b16 v[84:85], v15 offset:44128
    ds_read_b64_tr_b16 v[86:87], v15 offset:48736
    v_mfma_f32_16x16x32_bf16 v[124:127], v[52:55], v[20:23], v[124:127]
    v_mfma_f32_16x16x32_bf16 v[160:163], v[52:55], v[24:27], v[160:163]
    ds_read_b64_tr_b16 v[88:89], v15 offset:44160
    ds_read_b64_tr_b16 v[90:91], v15 offset:48768
    ds_read_b64_tr_b16 v[92:93], v15 offset:44192
    v_mfma_f32_16x16x32_bf16 v[128:131], v[56:59], v[20:23], v[128:131]
    v_mfma_f32_16x16x32_bf16 v[164:167], v[56:59], v[24:27], v[164:167]
    ds_read_b64_tr_b16 v[94:95], v15 offset:48800
    ds_read_b64_tr_b16 v[96:97], v15 offset:44224
    ds_read_b64_tr_b16 v[98:99], v15 offset:48832
    s_waitcnt lgkmcnt(15)
    v_mfma_f32_16x16x32_bf16 v[132:135], v[60:63], v[20:23], v[132:135]
    v_mfma_f32_16x16x32_bf16 v[168:171], v[60:63], v[24:27], v[168:171]
    ds_read_b64_tr_b16 v[100:101], v15 offset:44256
    ds_read_b64_tr_b16 v[102:103], v15 offset:48864
    ds_read_b64_tr_b16 v[104:105], v15 offset:44288
    v_mfma_f32_16x16x32_bf16 v[136:139], v[64:67], v[20:23], v[136:139]
    v_mfma_f32_16x16x32_bf16 v[172:175], v[64:67], v[24:27], v[172:175]
    ds_read_b64_tr_b16 v[106:107], v15 offset:48896
    v_mfma_f32_16x16x32_bf16 v[140:143], v[68:71], v[20:23], v[140:143]
    v_mfma_f32_16x16x32_bf16 v[176:179], v[68:71], v[24:27], v[176:179]
    s_waitcnt lgkmcnt(0)
    s_waitcnt vmcnt(0)
    s_barrier
    v_mfma_f32_16x16x32_bf16 v[108:111], v[72:75], v[28:31], v[108:111]
    v_mfma_f32_16x16x32_bf16 v[144:147], v[72:75], v[32:35], v[144:147]
    ds_read_b64 v[20:21], v200 offset:0
    ds_read_b64 v[22:23], v201 offset:0
    ds_read_b64 v[24:25], v200 offset:2048
    v_mfma_f32_16x16x32_bf16 v[112:115], v[76:79], v[28:31], v[112:115]
    v_mfma_f32_16x16x32_bf16 v[148:151], v[76:79], v[32:35], v[148:151]
    ds_read_b64 v[26:27], v201 offset:2048
    ds_read_b64_tr_b16 v[36:37], v204 offset:0
    ds_read_b64_tr_b16 v[38:39], v204 offset:4608
    v_mfma_f32_16x16x32_bf16 v[116:119], v[80:83], v[28:31], v[116:119]
    v_mfma_f32_16x16x32_bf16 v[152:155], v[80:83], v[32:35], v[152:155]
    ds_read_b64_tr_b16 v[40:41], v204 offset:32
    ds_read_b64_tr_b16 v[42:43], v204 offset:4640
    ds_read_b64_tr_b16 v[44:45], v204 offset:64
    v_mfma_f32_16x16x32_bf16 v[120:123], v[84:87], v[28:31], v[120:123]
    v_mfma_f32_16x16x32_bf16 v[156:159], v[84:87], v[32:35], v[156:159]
    ds_read_b64_tr_b16 v[46:47], v204 offset:4672
    ds_read_b64_tr_b16 v[48:49], v204 offset:96
    ds_read_b64_tr_b16 v[50:51], v204 offset:4704
    v_mfma_f32_16x16x32_bf16 v[124:127], v[88:91], v[28:31], v[124:127]
    v_mfma_f32_16x16x32_bf16 v[160:163], v[88:91], v[32:35], v[160:163]
    ds_read_b64_tr_b16 v[52:53], v204 offset:128
    ds_read_b64_tr_b16 v[54:55], v204 offset:4736
    ds_read_b64_tr_b16 v[56:57], v204 offset:160
    v_mfma_f32_16x16x32_bf16 v[128:131], v[92:95], v[28:31], v[128:131]
    v_mfma_f32_16x16x32_bf16 v[164:167], v[92:95], v[32:35], v[164:167]
    ds_read_b64_tr_b16 v[58:59], v204 offset:4768
    ds_read_b64_tr_b16 v[60:61], v204 offset:192
    ds_read_b64_tr_b16 v[62:63], v204 offset:4800
    v_mfma_f32_16x16x32_bf16 v[132:135], v[96:99], v[28:31], v[132:135]
    v_mfma_f32_16x16x32_bf16 v[168:171], v[96:99], v[32:35], v[168:171]
    ds_read_b64_tr_b16 v[64:65], v204 offset:224
    ds_read_b64_tr_b16 v[66:67], v204 offset:4832
    ds_read_b64_tr_b16 v[68:69], v204 offset:256
    v_mfma_f32_16x16x32_bf16 v[136:139], v[100:103], v[28:31], v[136:139]
    v_mfma_f32_16x16x32_bf16 v[172:175], v[100:103], v[32:35], v[172:175]
    ds_read_b64_tr_b16 v[70:71], v204 offset:4864
    v_mfma_f32_16x16x32_bf16 v[140:143], v[104:107], v[28:31], v[140:143]
    v_mfma_f32_16x16x32_bf16 v[176:179], v[104:107], v[32:35], v[176:179]
    s_waitcnt lgkmcnt(15)
    v_mfma_f32_16x16x32_bf16 v[108:111], v[36:39], v[20:23], v[108:111]
    v_mfma_f32_16x16x32_bf16 v[144:147], v[36:39], v[24:27], v[144:147]
    ds_read_b64 v[28:29], v202 offset:0
    ds_read_b64 v[30:31], v203 offset:0
    ds_read_b64 v[32:33], v202 offset:2048
    s_waitcnt lgkmcnt(15)
    v_mfma_f32_16x16x32_bf16 v[112:115], v[40:43], v[20:23], v[112:115]
    v_mfma_f32_16x16x32_bf16 v[148:151], v[40:43], v[24:27], v[148:151]
    ds_read_b64 v[34:35], v203 offset:2048
    ds_read_b64_tr_b16 v[72:73], v204 offset:9216
    ds_read_b64_tr_b16 v[74:75], v204 offset:13824
    v_mfma_f32_16x16x32_bf16 v[116:119], v[44:47], v[20:23], v[116:119]
    v_mfma_f32_16x16x32_bf16 v[152:155], v[44:47], v[24:27], v[152:155]
    ds_read_b64_tr_b16 v[76:77], v204 offset:9248
    ds_read_b64_tr_b16 v[78:79], v204 offset:13856
    ds_read_b64_tr_b16 v[80:81], v204 offset:9280
    s_waitcnt lgkmcnt(15)
    v_mfma_f32_16x16x32_bf16 v[120:123], v[48:51], v[20:23], v[120:123]
    v_mfma_f32_16x16x32_bf16 v[156:159], v[48:51], v[24:27], v[156:159]
    ds_read_b64_tr_b16 v[82:83], v204 offset:13888
    ds_read_b64_tr_b16 v[84:85], v204 offset:9312
    ds_read_b64_tr_b16 v[86:87], v204 offset:13920
    v_mfma_f32_16x16x32_bf16 v[124:127], v[52:55], v[20:23], v[124:127]
    v_mfma_f32_16x16x32_bf16 v[160:163], v[52:55], v[24:27], v[160:163]
    ds_read_b64_tr_b16 v[88:89], v204 offset:9344
    ds_read_b64_tr_b16 v[90:91], v204 offset:13952
    ds_read_b64_tr_b16 v[92:93], v204 offset:9376
    v_mfma_f32_16x16x32_bf16 v[128:131], v[56:59], v[20:23], v[128:131]
    v_mfma_f32_16x16x32_bf16 v[164:167], v[56:59], v[24:27], v[164:167]
    ds_read_b64_tr_b16 v[94:95], v204 offset:13984
    ds_read_b64_tr_b16 v[96:97], v204 offset:9408
    ds_read_b64_tr_b16 v[98:99], v204 offset:14016
    s_waitcnt lgkmcnt(15)
    v_mfma_f32_16x16x32_bf16 v[132:135], v[60:63], v[20:23], v[132:135]
    v_mfma_f32_16x16x32_bf16 v[168:171], v[60:63], v[24:27], v[168:171]
    ds_read_b64_tr_b16 v[100:101], v204 offset:9440
    ds_read_b64_tr_b16 v[102:103], v204 offset:14048
    ds_read_b64_tr_b16 v[104:105], v204 offset:9472
    v_mfma_f32_16x16x32_bf16 v[136:139], v[64:67], v[20:23], v[136:139]
    v_mfma_f32_16x16x32_bf16 v[172:175], v[64:67], v[24:27], v[172:175]
    ds_read_b64_tr_b16 v[106:107], v204 offset:14080
    v_mfma_f32_16x16x32_bf16 v[140:143], v[68:71], v[20:23], v[140:143]
    v_mfma_f32_16x16x32_bf16 v[176:179], v[68:71], v[24:27], v[176:179]
    s_waitcnt lgkmcnt(15)
    v_mfma_f32_16x16x32_bf16 v[108:111], v[72:75], v[28:31], v[108:111]
    v_mfma_f32_16x16x32_bf16 v[144:147], v[72:75], v[32:35], v[144:147]
    s_waitcnt lgkmcnt(14)
    v_mfma_f32_16x16x32_bf16 v[112:115], v[76:79], v[28:31], v[112:115]
    v_mfma_f32_16x16x32_bf16 v[148:151], v[76:79], v[32:35], v[148:151]
    s_waitcnt lgkmcnt(12)
    v_mfma_f32_16x16x32_bf16 v[116:119], v[80:83], v[28:31], v[116:119]
    v_mfma_f32_16x16x32_bf16 v[152:155], v[80:83], v[32:35], v[152:155]
    s_waitcnt lgkmcnt(10)
    v_mfma_f32_16x16x32_bf16 v[120:123], v[84:87], v[28:31], v[120:123]
    v_mfma_f32_16x16x32_bf16 v[156:159], v[84:87], v[32:35], v[156:159]
    s_waitcnt lgkmcnt(8)
    v_mfma_f32_16x16x32_bf16 v[124:127], v[88:91], v[28:31], v[124:127]
    v_mfma_f32_16x16x32_bf16 v[160:163], v[88:91], v[32:35], v[160:163]
    s_waitcnt lgkmcnt(6)
    v_mfma_f32_16x16x32_bf16 v[128:131], v[92:95], v[28:31], v[128:131]
    v_mfma_f32_16x16x32_bf16 v[164:167], v[92:95], v[32:35], v[164:167]
    s_waitcnt lgkmcnt(4)
    v_mfma_f32_16x16x32_bf16 v[132:135], v[96:99], v[28:31], v[132:135]
    v_mfma_f32_16x16x32_bf16 v[168:171], v[96:99], v[32:35], v[168:171]
    s_waitcnt lgkmcnt(2)
    v_mfma_f32_16x16x32_bf16 v[136:139], v[100:103], v[28:31], v[136:139]
    v_mfma_f32_16x16x32_bf16 v[172:175], v[100:103], v[32:35], v[172:175]
    s_waitcnt lgkmcnt(0)
    v_mfma_f32_16x16x32_bf16 v[140:143], v[104:107], v[28:31], v[140:143]
    v_mfma_f32_16x16x32_bf16 v[176:179], v[104:107], v[32:35], v[176:179]
    s_nop 15
    v_and_b32 v19, 15, v1
    s_lshl_b32 s9, s8, 5
    s_add_u32 s9, s9, s15
    v_add_u32 v19, s9, v19
    v_lshlrev_b32 v19, 2, v19
    v_add_u32 v19, 24956928, v19
    global_load_dword v180, v19, s[24:25]
    global_load_dword v181, v19, s[24:25] offset:64
    s_waitcnt vmcnt(0)
    v_sub_f32 v180, 1.0, v180
    v_cvt_pk_bf16_f32 v182, v180, v180
    v_lshlrev_b32 v180, 16, v182
    v_sub_f32 v181, 1.0, v181
    v_cvt_pk_bf16_f32 v182, v181, v181
    v_lshlrev_b32 v181, 16, v182
    v_mul_f32 v108, v108, v180
    v_mul_f32 v109, v109, v180
    v_mul_f32 v110, v110, v180
    v_mul_f32 v111, v111, v180
    v_mul_f32 v112, v112, v180
    v_mul_f32 v113, v113, v180
    v_mul_f32 v114, v114, v180
    v_mul_f32 v115, v115, v180
    v_mul_f32 v116, v116, v180
    v_mul_f32 v117, v117, v180
    v_mul_f32 v118, v118, v180
    v_mul_f32 v119, v119, v180
    v_mul_f32 v120, v120, v180
    v_mul_f32 v121, v121, v180
    v_mul_f32 v122, v122, v180
    v_mul_f32 v123, v123, v180
    v_mul_f32 v124, v124, v180
    v_mul_f32 v125, v125, v180
    v_mul_f32 v126, v126, v180
    v_mul_f32 v127, v127, v180
    v_mul_f32 v128, v128, v180
    v_mul_f32 v129, v129, v180
    v_mul_f32 v130, v130, v180
    v_mul_f32 v131, v131, v180
    v_mul_f32 v132, v132, v180
    v_mul_f32 v133, v133, v180
    v_mul_f32 v134, v134, v180
    v_mul_f32 v135, v135, v180
    v_mul_f32 v136, v136, v180
    v_mul_f32 v137, v137, v180
    v_mul_f32 v138, v138, v180
    v_mul_f32 v139, v139, v180
    v_mul_f32 v140, v140, v180
    v_mul_f32 v141, v141, v180
    v_mul_f32 v142, v142, v180
    v_mul_f32 v143, v143, v180
    v_mul_f32 v144, v144, v181
    v_mul_f32 v145, v145, v181
    v_mul_f32 v146, v146, v181
    v_mul_f32 v147, v147, v181
    v_mul_f32 v148, v148, v181
    v_mul_f32 v149, v149, v181
    v_mul_f32 v150, v150, v181
    v_mul_f32 v151, v151, v181
    v_mul_f32 v152, v152, v181
    v_mul_f32 v153, v153, v181
    v_mul_f32 v154, v154, v181
    v_mul_f32 v155, v155, v181
    v_mul_f32 v156, v156, v181
    v_mul_f32 v157, v157, v181
    v_mul_f32 v158, v158, v181
    v_mul_f32 v159, v159, v181
    v_mul_f32 v160, v160, v181
    v_mul_f32 v161, v161, v181
    v_mul_f32 v162, v162, v181
    v_mul_f32 v163, v163, v181
    v_mul_f32 v164, v164, v181
    v_mul_f32 v165, v165, v181
    v_mul_f32 v166, v166, v181
    v_mul_f32 v167, v167, v181
    v_mul_f32 v168, v168, v181
    v_mul_f32 v169, v169, v181
    v_mul_f32 v170, v170, v181
    v_mul_f32 v171, v171, v181
    v_mul_f32 v172, v172, v181
    v_mul_f32 v173, v173, v181
    v_mul_f32 v174, v174, v181
    v_mul_f32 v175, v175, v181
    v_mul_f32 v176, v176, v181
    v_mul_f32 v177, v177, v181
    v_mul_f32 v178, v178, v181
    v_mul_f32 v179, v179, v181
    s_nop 1
    s_add_u32 s4, s24, 21233664
    s_addc_u32 s5, s25, 0
    s_add_u32 s6, s24, 24293376
    s_addc_u32 s7, s25, 0
    s_mov_b32 s19, 1152
    s_lshl_b32 s9, s8, 8
    s_add_u32 s9, s9, 0
    v_add_u32 v16, s9, v1
    v_lshrrev_b32 v17, 3, v16
    v_and_b32 v18, 7, v16
    v_lshrrev_b32 v19, 1, v17
    v_and_b32 v19, 7, v19
    v_xor_b32 v18, v18, v19
    v_lshlrev_b32 v18, 4, v18
    v_add_u32 v17, s15, v17
    v_mul_lo_u32 v17, v17, s19
    v_add_u32 v2, v17, v18
    s_lshl_b32 s9, s8, 8
    s_add_u32 s9, s9, 64
    v_add_u32 v16, s9, v1
    v_lshrrev_b32 v17, 3, v16
    v_and_b32 v18, 7, v16
    v_lshrrev_b32 v19, 1, v17
    v_and_b32 v19, 7, v19
    v_xor_b32 v18, v18, v19
    v_lshlrev_b32 v18, 4, v18
    v_add_u32 v17, s15, v17
    v_mul_lo_u32 v17, v17, s19
    v_add_u32 v3, v17, v18
    s_lshl_b32 s9, s8, 8
    s_add_u32 s9, s9, 128
    v_add_u32 v16, s9, v1
    v_lshrrev_b32 v17, 3, v16
    v_and_b32 v18, 7, v16
    v_lshrrev_b32 v19, 1, v17
    v_and_b32 v19, 7, v19
    v_xor_b32 v18, v18, v19
    v_lshlrev_b32 v18, 4, v18
    v_add_u32 v17, s15, v17
    v_mul_lo_u32 v17, v17, s19
    v_add_u32 v4, v17, v18
    s_lshl_b32 s9, s8, 8
    s_add_u32 s9, s9, 192
    v_add_u32 v16, s9, v1
    v_lshrrev_b32 v17, 3, v16
    v_and_b32 v18, 7, v16
    v_lshrrev_b32 v19, 1, v17
    v_and_b32 v19, 7, v19
    v_xor_b32 v18, v18, v19
    v_lshlrev_b32 v18, 4, v18
    v_add_u32 v17, s15, v17
    v_mul_lo_u32 v17, v17, s19
    v_add_u32 v5, v17, v18
    s_barrier
    s_lshl_b32 s9, s8, 12
    s_add_u32 m0, s9, 104448
    s_nop 0
    global_load_lds_dwordx4 v2, s[4:5]
    s_lshl_b32 s9, s8, 12
    s_add_u32 m0, s9, 105472
    s_nop 0
    global_load_lds_dwordx4 v3, s[4:5]
    s_lshl_b32 s9, s8, 12
    s_add_u32 m0, s9, 106496
    s_nop 0
    global_load_lds_dwordx4 v4, s[4:5]
    s_lshl_b32 s9, s8, 12
    s_add_u32 m0, s9, 107520
    s_nop 0
    global_load_lds_dwordx4 v5, s[4:5]
    s_mul_i32 s9, s8, 4608
    s_add_u32 m0, s9, 120832
    s_nop 0
    global_load_lds_dwordx4 v6, s[6:7]
    s_mul_i32 s9, s8, 4608
    s_add_u32 m0, s9, 121856
    s_nop 0
    global_load_lds_dwordx4 v7, s[6:7]
    s_mul_i32 s9, s8, 4608
    s_add_u32 m0, s9, 122880
    s_nop 0
    global_load_lds_dwordx4 v8, s[6:7]
    s_mul_i32 s9, s8, 4608
    s_add_u32 m0, s9, 123904
    s_nop 0
    global_load_lds_dwordx4 v9, s[6:7]
    s_mul_i32 s9, s8, 4608
    s_add_u32 m0, s9, 124928
    s_mov_b32 exec_hi, 0
    global_load_lds_dwordx4 v10, s[6:7]
    s_mov_b64 exec, -1
    s_add_u32 s4, s4, 128
    s_addc_u32 s5, s5, 0
    s_add_u32 s6, s6, s18
    s_addc_u32 s7, s7, 0
    s_lshl_b32 s9, s8, 12
    s_add_u32 m0, s9, 0
    s_nop 0
    global_load_lds_dwordx4 v2, s[4:5]
    s_lshl_b32 s9, s8, 12
    s_add_u32 m0, s9, 1024
    s_nop 0
    global_load_lds_dwordx4 v3, s[4:5]
    s_lshl_b32 s9, s8, 12
    s_add_u32 m0, s9, 2048
    s_nop 0
    global_load_lds_dwordx4 v4, s[4:5]
    s_lshl_b32 s9, s8, 12
    s_add_u32 m0, s9, 3072
    s_nop 0
    global_load_lds_dwordx4 v5, s[4:5]
    s_mul_i32 s9, s8, 4608
    s_add_u32 m0, s9, 16384
    s_nop 0
    global_load_lds_dwordx4 v6, s[6:7]
    s_mul_i32 s9, s8, 4608
    s_add_u32 m0, s9, 17408
    s_nop 0
    global_load_lds_dwordx4 v7, s[6:7]
    s_mul_i32 s9, s8, 4608
    s_add_u32 m0, s9, 18432
    s_nop 0
    global_load_lds_dwordx4 v8, s[6:7]
    s_mul_i32 s9, s8, 4608
    s_add_u32 m0, s9, 19456
    s_nop 0
    global_load_lds_dwordx4 v9, s[6:7]
    s_mul_i32 s9, s8, 4608
    s_add_u32 m0, s9, 20480
    s_mov_b32 exec_hi, 0
    global_load_lds_dwordx4 v10, s[6:7]
    s_mov_b64 exec, -1
    s_add_u32 s4, s4, 128
    s_addc_u32 s5, s5, 0
    s_add_u32 s6, s6, s18
    s_addc_u32 s7, s7, 0
    s_lshl_b32 s9, s8, 12
    s_add_u32 m0, s9, 34816
    s_nop 0
    global_load_lds_dwordx4 v2, s[4:5]
    s_lshl_b32 s9, s8, 12
    s_add_u32 m0, s9, 35840
    s_nop 0
    global_load_lds_dwordx4 v3, s[4:5]
    s_lshl_b32 s9, s8, 12
    s_add_u32 m0, s9, 36864
    s_nop 0
    global_load_lds_dwordx4 v4, s[4:5]
    s_lshl_b32 s9, s8, 12
    s_add_u32 m0, s9, 37888
    s_nop 0
    global_load_lds_dwordx4 v5, s[4:5]
    s_mul_i32 s9, s8, 4608
    s_add_u32 m0, s9, 51200
    s_nop 0
    global_load_lds_dwordx4 v6, s[6:7]
    s_mul_i32 s9, s8, 4608
    s_add_u32 m0, s9, 52224
    s_nop 0
    global_load_lds_dwordx4 v7, s[6:7]
    s_mul_i32 s9, s8, 4608
    s_add_u32 m0, s9, 53248
    s_nop 0
    global_load_lds_dwordx4 v8, s[6:7]
    s_mul_i32 s9, s8, 4608
    s_add_u32 m0, s9, 54272
    s_nop 0
    global_load_lds_dwordx4 v9, s[6:7]
    s_mul_i32 s9, s8, 4608
    s_add_u32 m0, s9, 55296
    s_mov_b32 exec_hi, 0
    global_load_lds_dwordx4 v10, s[6:7]
    s_mov_b64 exec, -1
    s_add_u32 s4, s4, 128
    s_addc_u32 s5, s5, 0
    s_add_u32 s6, s6, s18
    s_addc_u32 s7, s7, 0
    s_lshl_b32 s9, s8, 12
    s_add_u32 m0, s9, 69632
    s_nop 0
    global_load_lds_dwordx4 v2, s[4:5]
    s_lshl_b32 s9, s8, 12
    s_add_u32 m0, s9, 70656
    s_nop 0
    global_load_lds_dwordx4 v3, s[4:5]
    s_lshl_b32 s9, s8, 12
    s_add_u32 m0, s9, 71680
    s_nop 0
    global_load_lds_dwordx4 v4, s[4:5]
    s_lshl_b32 s9, s8, 12
    s_add_u32 m0, s9, 72704
    s_nop 0
    global_load_lds_dwordx4 v5, s[4:5]
    s_mul_i32 s9, s8, 4608
    s_add_u32 m0, s9, 86016
    s_nop 0
    global_load_lds_dwordx4 v6, s[6:7]
    s_mul_i32 s9, s8, 4608
    s_add_u32 m0, s9, 87040
    s_nop 0
    global_load_lds_dwordx4 v7, s[6:7]
    s_mul_i32 s9, s8, 4608
    s_add_u32 m0, s9, 88064
    s_nop 0
    global_load_lds_dwordx4 v8, s[6:7]
    s_mul_i32 s9, s8, 4608
    s_add_u32 m0, s9, 89088
    s_nop 0
    global_load_lds_dwordx4 v9, s[6:7]
    s_mul_i32 s9, s8, 4608
    s_add_u32 m0, s9, 90112
    s_mov_b32 exec_hi, 0
    global_load_lds_dwordx4 v10, s[6:7]
    s_mov_b64 exec, -1
    s_waitcnt vmcnt(27)
    s_barrier
    ds_read_b64 v[20:21], v200 offset:34816
    ds_read_b64 v[22:23], v201 offset:34816
    ds_read_b64 v[24:25], v200 offset:36864
    ds_read_b64 v[26:27], v201 offset:36864
    ds_read_b64_tr_b16 v[36:37], v204 offset:34816
    ds_read_b64_tr_b16 v[38:39], v204 offset:39424
    ds_read_b64_tr_b16 v[40:41], v204 offset:34848
    ds_read_b64_tr_b16 v[42:43], v204 offset:39456
    ds_read_b64_tr_b16 v[44:45], v204 offset:34880
    ds_read_b64_tr_b16 v[46:47], v204 offset:39488
    ds_read_b64_tr_b16 v[48:49], v204 offset:34912
    ds_read_b64_tr_b16 v[50:51], v204 offset:39520
    ds_read_b64_tr_b16 v[52:53], v204 offset:34944
    ds_read_b64_tr_b16 v[54:55], v204 offset:39552
    ds_read_b64_tr_b16 v[56:57], v204 offset:34976
    ds_read_b64_tr_b16 v[58:59], v204 offset:39584
    ds_read_b64_tr_b16 v[60:61], v204 offset:35008
    ds_read_b64_tr_b16 v[62:63], v204 offset:39616
    ds_read_b64_tr_b16 v[64:65], v204 offset:35040
    ds_read_b64_tr_b16 v[66:67], v204 offset:39648
    ds_read_b64_tr_b16 v[68:69], v204 offset:35072
    ds_read_b64_tr_b16 v[70:71], v204 offset:39680
    s_waitcnt lgkmcnt(15)
    v_mfma_f32_16x16x32_bf16 v[108:111], v[36:39], v[20:23], v[108:111]
    v_mfma_f32_16x16x32_bf16 v[144:147], v[36:39], v[24:27], v[144:147]
    ds_read_b64 v[28:29], v202 offset:34816
    ds_read_b64 v[30:31], v203 offset:34816
    ds_read_b64 v[32:33], v202 offset:36864
    s_waitcnt lgkmcnt(15)
    v_mfma_f32_16x16x32_bf16 v[112:115], v[40:43], v[20:23], v[112:115]
    v_mfma_f32_16x16x32_bf16 v[148:151], v[40:43], v[24:27], v[148:151]
    ds_read_b64 v[34:35], v203 offset:36864
    ds_read_b64_tr_b16 v[72:73], v204 offset:44032
    ds_read_b64_tr_b16 v[74:75], v204 offset:48640
    v_mfma_f32_16x16x32_bf16 v[116:119], v[44:47], v[20:23], v[116:119]
    v_mfma_f32_16x16x32_bf16 v[152:155], v[44:47], v[24:27], v[152:155]
    ds_read_b64_tr_b16 v[76:77], v204 offset:44064
    ds_read_b64_tr_b16 v[78:79], v204 offset:48672
    ds_read_b64_tr_b16 v[80:81], v204 offset:44096
    s_waitcnt lgkmcnt(15)
    v_mfma_f32_16x16x32_bf16 v[120:123], v[48:51], v[20:23], v[120:123]
    v_mfma_f32_16x16x32_bf16 v[156:159], v[48:51], v[24:27], v[156:159]
    ds_read_b64_tr_b16 v[82:83], v204 offset:48704
    ds_read_b64_tr_b16 v[84:85], v204 offset:44128
    ds_read_b64_tr_b16 v[86:87], v204 offset:48736
    v_mfma_f32_16x16x32_bf16 v[124:127], v[52:55], v[20:23], v[124:127]
    v_mfma_f32_16x16x32_bf16 v[160:163], v[52:55], v[24:27], v[160:163]
    ds_read_b64_tr_b16 v[88:89], v204 offset:44160
    ds_read_b64_tr_b16 v[90:91], v204 offset:48768
    ds_read_b64_tr_b16 v[92:93], v204 offset:44192
    v_mfma_f32_16x16x32_bf16 v[128:131], v[56:59], v[20:23], v[128:131]
    v_mfma_f32_16x16x32_bf16 v[164:167], v[56:59], v[24:27], v[164:167]
    ds_read_b64_tr_b16 v[94:95], v204 offset:48800
    ds_read_b64_tr_b16 v[96:97], v204 offset:44224
    ds_read_b64_tr_b16 v[98:99], v204 offset:48832
    s_waitcnt lgkmcnt(15)
    v_mfma_f32_16x16x32_bf16 v[132:135], v[60:63], v[20:23], v[132:135]
    v_mfma_f32_16x16x32_bf16 v[168:171], v[60:63], v[24:27], v[168:171]
    ds_read_b64_tr_b16 v[100:101], v204 offset:44256
    ds_read_b64_tr_b16 v[102:103], v204 offset:48864
    ds_read_b64_tr_b16 v[104:105], v204 offset:44288
    v_mfma_f32_16x16x32_bf16 v[136:139], v[64:67], v[20:23], v[136:139]
    v_mfma_f32_16x16x32_bf16 v[172:175], v[64:67], v[24:27], v[172:175]
    ds_read_b64_tr_b16 v[106:107], v204 offset:48896
    v_mfma_f32_16x16x32_bf16 v[140:143], v[68:71], v[20:23], v[140:143]
    v_mfma_f32_16x16x32_bf16 v[176:179], v[68:71], v[24:27], v[176:179]
    s_waitcnt lgkmcnt(0)
    s_waitcnt vmcnt(18)
    s_barrier
    s_add_u32 s4, s4, 128
    s_addc_u32 s5, s5, 0
    s_add_u32 s6, s6, s18
    s_addc_u32 s7, s7, 0
    s_lshl_b32 s9, s8, 12
    s_add_u32 m0, s9, 104448
    s_nop 0
    global_load_lds_dwordx4 v2, s[4:5]
    s_lshl_b32 s9, s8, 12
    s_add_u32 m0, s9, 105472
    s_nop 0
    global_load_lds_dwordx4 v3, s[4:5]
    s_lshl_b32 s9, s8, 12
    s_add_u32 m0, s9, 106496
    s_nop 0
    global_load_lds_dwordx4 v4, s[4:5]
    s_lshl_b32 s9, s8, 12
    s_add_u32 m0, s9, 107520
    s_nop 0
    global_load_lds_dwordx4 v5, s[4:5]
    s_mul_i32 s9, s8, 4608
    s_add_u32 m0, s9, 120832
    s_nop 0
    global_load_lds_dwordx4 v6, s[6:7]
    s_mul_i32 s9, s8, 4608
    s_add_u32 m0, s9, 121856
    s_nop 0
    global_load_lds_dwordx4 v7, s[6:7]
    s_mul_i32 s9, s8, 4608
    s_add_u32 m0, s9, 122880
    s_nop 0
    global_load_lds_dwordx4 v8, s[6:7]
    s_mul_i32 s9, s8, 4608
    s_add_u32 m0, s9, 123904
    s_nop 0
    global_load_lds_dwordx4 v9, s[6:7]
    s_mul_i32 s9, s8, 4608
    s_add_u32 m0, s9, 124928
    s_mov_b32 exec_hi, 0
    global_load_lds_dwordx4 v10, s[6:7]
    s_mov_b64 exec, -1
    v_mfma_f32_16x16x32_bf16 v[108:111], v[72:75], v[28:31], v[108:111]
    v_mfma_f32_16x16x32_bf16 v[144:147], v[72:75], v[32:35], v[144:147]
    ds_read_b64 v[20:21], v11 offset:0
    ds_read_b64 v[22:23], v12 offset:0
    ds_read_b64 v[24:25], v11 offset:2048
    v_mfma_f32_16x16x32_bf16 v[112:115], v[76:79], v[28:31], v[112:115]
    v_mfma_f32_16x16x32_bf16 v[148:151], v[76:79], v[32:35], v[148:151]
    ds_read_b64 v[26:27], v12 offset:2048
    ds_read_b64_tr_b16 v[36:37], v15 offset:0
    ds_read_b64_tr_b16 v[38:39], v15 offset:4608
    v_mfma_f32_16x16x32_bf16 v[116:119], v[80:83], v[28:31], v[116:119]
    v_mfma_f32_16x16x32_bf16 v[152:155], v[80:83], v[32:35], v[152:155]
    ds_read_b64_tr_b16 v[40:41], v15 offset:32
    ds_read_b64_tr_b16 v[42:43], v15 offset:4640
    ds_read_b64_tr_b16 v[44:45], v15 offset:64
    v_mfma_f32_16x16x32_bf16 v[120:123], v[84:87], v[28:31], v[120:123]
    v_mfma_f32_16x16x32_bf16 v[156:159], v[84:87], v[32:35], v[156:159]
    ds_read_b64_tr_b16 v[46:47], v15 offset:4672
    ds_read_b64_tr_b16 v[48:49], v15 offset:96
    ds_read_b64_tr_b16 v[50:51], v15 offset:4704
    v_mfma_f32_16x16x32_bf16 v[124:127], v[88:91], v[28:31], v[124:127]
    v_mfma_f32_16x16x32_bf16 v[160:163], v[88:91], v[32:35], v[160:163]
    ds_read_b64_tr_b16 v[52:53], v15 offset:128
    ds_read_b64_tr_b16 v[54:55], v15 offset:4736
    ds_read_b64_tr_b16 v[56:57], v15 offset:160
    v_mfma_f32_16x16x32_bf16 v[128:131], v[92:95], v[28:31], v[128:131]
    v_mfma_f32_16x16x32_bf16 v[164:167], v[92:95], v[32:35], v[164:167]
    ds_read_b64_tr_b16 v[58:59], v15 offset:4768
    ds_read_b64_tr_b16 v[60:61], v15 offset:192
    ds_read_b64_tr_b16 v[62:63], v15 offset:4800
    v_mfma_f32_16x16x32_bf16 v[132:135], v[96:99], v[28:31], v[132:135]
    v_mfma_f32_16x16x32_bf16 v[168:171], v[96:99], v[32:35], v[168:171]
    ds_read_b64_tr_b16 v[64:65], v15 offset:224
    ds_read_b64_tr_b16 v[66:67], v15 offset:4832
    ds_read_b64_tr_b16 v[68:69], v15 offset:256
    v_mfma_f32_16x16x32_bf16 v[136:139], v[100:103], v[28:31], v[136:139]
    v_mfma_f32_16x16x32_bf16 v[172:175], v[100:103], v[32:35], v[172:175]
    ds_read_b64_tr_b16 v[70:71], v15 offset:4864
    v_mfma_f32_16x16x32_bf16 v[140:143], v[104:107], v[28:31], v[140:143]
    v_mfma_f32_16x16x32_bf16 v[176:179], v[104:107], v[32:35], v[176:179]
    s_waitcnt lgkmcnt(15)
    v_mfma_f32_16x16x32_bf16 v[108:111], v[36:39], v[20:23], v[108:111]
    v_mfma_f32_16x16x32_bf16 v[144:147], v[36:39], v[24:27], v[144:147]
    ds_read_b64 v[28:29], v13 offset:0
    ds_read_b64 v[30:31], v14 offset:0
    ds_read_b64 v[32:33], v13 offset:2048
    s_waitcnt lgkmcnt(15)
    v_mfma_f32_16x16x32_bf16 v[112:115], v[40:43], v[20:23], v[112:115]
    v_mfma_f32_16x16x32_bf16 v[148:151], v[40:43], v[24:27], v[148:151]
    ds_read_b64 v[34:35], v14 offset:2048
    ds_read_b64_tr_b16 v[72:73], v15 offset:9216
    ds_read_b64_tr_b16 v[74:75], v15 offset:13824
    v_mfma_f32_16x16x32_bf16 v[116:119], v[44:47], v[20:23], v[116:119]
    v_mfma_f32_16x16x32_bf16 v[152:155], v[44:47], v[24:27], v[152:155]
    ds_read_b64_tr_b16 v[76:77], v15 offset:9248
    ds_read_b64_tr_b16 v[78:79], v15 offset:13856
    ds_read_b64_tr_b16 v[80:81], v15 offset:9280
    s_waitcnt lgkmcnt(15)
    v_mfma_f32_16x16x32_bf16 v[120:123], v[48:51], v[20:23], v[120:123]
    v_mfma_f32_16x16x32_bf16 v[156:159], v[48:51], v[24:27], v[156:159]
    ds_read_b64_tr_b16 v[82:83], v15 offset:13888
    ds_read_b64_tr_b16 v[84:85], v15 offset:9312
    ds_read_b64_tr_b16 v[86:87], v15 offset:13920
    v_mfma_f32_16x16x32_bf16 v[124:127], v[52:55], v[20:23], v[124:127]
    v_mfma_f32_16x16x32_bf16 v[160:163], v[52:55], v[24:27], v[160:163]
    ds_read_b64_tr_b16 v[88:89], v15 offset:9344
    ds_read_b64_tr_b16 v[90:91], v15 offset:13952
    ds_read_b64_tr_b16 v[92:93], v15 offset:9376
    v_mfma_f32_16x16x32_bf16 v[128:131], v[56:59], v[20:23], v[128:131]
    v_mfma_f32_16x16x32_bf16 v[164:167], v[56:59], v[24:27], v[164:167]
    ds_read_b64_tr_b16 v[94:95], v15 offset:13984
    ds_read_b64_tr_b16 v[96:97], v15 offset:9408
    ds_read_b64_tr_b16 v[98:99], v15 offset:14016
    s_waitcnt lgkmcnt(15)
    v_mfma_f32_16x16x32_bf16 v[132:135], v[60:63], v[20:23], v[132:135]
    v_mfma_f32_16x16x32_bf16 v[168:171], v[60:63], v[24:27], v[168:171]
    ds_read_b64_tr_b16 v[100:101], v15 offset:9440
    ds_read_b64_tr_b16 v[102:103], v15 offset:14048
    ds_read_b64_tr_b16 v[104:105], v15 offset:9472
    v_mfma_f32_16x16x32_bf16 v[136:139], v[64:67], v[20:23], v[136:139]
    v_mfma_f32_16x16x32_bf16 v[172:175], v[64:67], v[24:27], v[172:175]
    ds_read_b64_tr_b16 v[106:107], v15 offset:14080
    v_mfma_f32_16x16x32_bf16 v[140:143], v[68:71], v[20:23], v[140:143]
    v_mfma_f32_16x16x32_bf16 v[176:179], v[68:71], v[24:27], v[176:179]
    s_waitcnt lgkmcnt(0)
    s_waitcnt vmcnt(18)
    s_barrier
    s_add_u32 s4, s4, 128
    s_addc_u32 s5, s5, 0
    s_add_u32 s6, s6, s18
    s_addc_u32 s7, s7, 0
    s_lshl_b32 s9, s8, 12
    s_add_u32 m0, s9, 0
    s_nop 0
    global_load_lds_dwordx4 v2, s[4:5]
    s_lshl_b32 s9, s8, 12
    s_add_u32 m0, s9, 1024
    s_nop 0
    global_load_lds_dwordx4 v3, s[4:5]
    s_lshl_b32 s9, s8, 12
    s_add_u32 m0, s9, 2048
    s_nop 0
    global_load_lds_dwordx4 v4, s[4:5]
    s_lshl_b32 s9, s8, 12
    s_add_u32 m0, s9, 3072
    s_nop 0
    global_load_lds_dwordx4 v5, s[4:5]
    s_mul_i32 s9, s8, 4608
    s_add_u32 m0, s9, 16384
    s_nop 0
    global_load_lds_dwordx4 v6, s[6:7]
    s_mul_i32 s9, s8, 4608
    s_add_u32 m0, s9, 17408
    s_nop 0
    global_load_lds_dwordx4 v7, s[6:7]
    s_mul_i32 s9, s8, 4608
    s_add_u32 m0, s9, 18432
    s_nop 0
    global_load_lds_dwordx4 v8, s[6:7]
    s_mul_i32 s9, s8, 4608
    s_add_u32 m0, s9, 19456
    s_nop 0
    global_load_lds_dwordx4 v9, s[6:7]
    s_mul_i32 s9, s8, 4608
    s_add_u32 m0, s9, 20480
    s_mov_b32 exec_hi, 0
    global_load_lds_dwordx4 v10, s[6:7]
    s_mov_b64 exec, -1
    v_mfma_f32_16x16x32_bf16 v[108:111], v[72:75], v[28:31], v[108:111]
    v_mfma_f32_16x16x32_bf16 v[144:147], v[72:75], v[32:35], v[144:147]
    ds_read_b64 v[20:21], v11 offset:34816
    ds_read_b64 v[22:23], v12 offset:34816
    ds_read_b64 v[24:25], v11 offset:36864
    v_mfma_f32_16x16x32_bf16 v[112:115], v[76:79], v[28:31], v[112:115]
    v_mfma_f32_16x16x32_bf16 v[148:151], v[76:79], v[32:35], v[148:151]
    ds_read_b64 v[26:27], v12 offset:36864
    ds_read_b64_tr_b16 v[36:37], v15 offset:34816
    ds_read_b64_tr_b16 v[38:39], v15 offset:39424
    v_mfma_f32_16x16x32_bf16 v[116:119], v[80:83], v[28:31], v[116:119]
    v_mfma_f32_16x16x32_bf16 v[152:155], v[80:83], v[32:35], v[152:155]
    ds_read_b64_tr_b16 v[40:41], v15 offset:34848
    ds_read_b64_tr_b16 v[42:43], v15 offset:39456
    ds_read_b64_tr_b16 v[44:45], v15 offset:34880
    v_mfma_f32_16x16x32_bf16 v[120:123], v[84:87], v[28:31], v[120:123]
    v_mfma_f32_16x16x32_bf16 v[156:159], v[84:87], v[32:35], v[156:159]
    ds_read_b64_tr_b16 v[46:47], v15 offset:39488
    ds_read_b64_tr_b16 v[48:49], v15 offset:34912
    ds_read_b64_tr_b16 v[50:51], v15 offset:39520
    v_mfma_f32_16x16x32_bf16 v[124:127], v[88:91], v[28:31], v[124:127]
    v_mfma_f32_16x16x32_bf16 v[160:163], v[88:91], v[32:35], v[160:163]
    ds_read_b64_tr_b16 v[52:53], v15 offset:34944
    ds_read_b64_tr_b16 v[54:55], v15 offset:39552
    ds_read_b64_tr_b16 v[56:57], v15 offset:34976
    v_mfma_f32_16x16x32_bf16 v[128:131], v[92:95], v[28:31], v[128:131]
    v_mfma_f32_16x16x32_bf16 v[164:167], v[92:95], v[32:35], v[164:167]
    ds_read_b64_tr_b16 v[58:59], v15 offset:39584
    ds_read_b64_tr_b16 v[60:61], v15 offset:35008
    ds_read_b64_tr_b16 v[62:63], v15 offset:39616
    v_mfma_f32_16x16x32_bf16 v[132:135], v[96:99], v[28:31], v[132:135]
    v_mfma_f32_16x16x32_bf16 v[168:171], v[96:99], v[32:35], v[168:171]
    ds_read_b64_tr_b16 v[64:65], v15 offset:35040
    ds_read_b64_tr_b16 v[66:67], v15 offset:39648
    ds_read_b64_tr_b16 v[68:69], v15 offset:35072
    v_mfma_f32_16x16x32_bf16 v[136:139], v[100:103], v[28:31], v[136:139]
    v_mfma_f32_16x16x32_bf16 v[172:175], v[100:103], v[32:35], v[172:175]
    ds_read_b64_tr_b16 v[70:71], v15 offset:39680
    v_mfma_f32_16x16x32_bf16 v[140:143], v[104:107], v[28:31], v[140:143]
    v_mfma_f32_16x16x32_bf16 v[176:179], v[104:107], v[32:35], v[176:179]
    s_waitcnt lgkmcnt(15)
    v_mfma_f32_16x16x32_bf16 v[108:111], v[36:39], v[20:23], v[108:111]
    v_mfma_f32_16x16x32_bf16 v[144:147], v[36:39], v[24:27], v[144:147]
    ds_read_b64 v[28:29], v13 offset:34816
    ds_read_b64 v[30:31], v14 offset:34816
    ds_read_b64 v[32:33], v13 offset:36864
    s_waitcnt lgkmcnt(15)
    v_mfma_f32_16x16x32_bf16 v[112:115], v[40:43], v[20:23], v[112:115]
    v_mfma_f32_16x16x32_bf16 v[148:151], v[40:43], v[24:27], v[148:151]
    ds_read_b64 v[34:35], v14 offset:36864
    ds_read_b64_tr_b16 v[72:73], v15 offset:44032
    ds_read_b64_tr_b16 v[74:75], v15 offset:48640
    v_mfma_f32_16x16x32_bf16 v[116:119], v[44:47], v[20:23], v[116:119]
    v_mfma_f32_16x16x32_bf16 v[152:155], v[44:47], v[24:27], v[152:155]
    ds_read_b64_tr_b16 v[76:77], v15 offset:44064
    ds_read_b64_tr_b16 v[78:79], v15 offset:48672
    ds_read_b64_tr_b16 v[80:81], v15 offset:44096
    s_waitcnt lgkmcnt(15)
    v_mfma_f32_16x16x32_bf16 v[120:123], v[48:51], v[20:23], v[120:123]
    v_mfma_f32_16x16x32_bf16 v[156:159], v[48:51], v[24:27], v[156:159]
    ds_read_b64_tr_b16 v[82:83], v15 offset:48704
    ds_read_b64_tr_b16 v[84:85], v15 offset:44128
    ds_read_b64_tr_b16 v[86:87], v15 offset:48736
    v_mfma_f32_16x16x32_bf16 v[124:127], v[52:55], v[20:23], v[124:127]
    v_mfma_f32_16x16x32_bf16 v[160:163], v[52:55], v[24:27], v[160:163]
    ds_read_b64_tr_b16 v[88:89], v15 offset:44160
    ds_read_b64_tr_b16 v[90:91], v15 offset:48768
    ds_read_b64_tr_b16 v[92:93], v15 offset:44192
    v_mfma_f32_16x16x32_bf16 v[128:131], v[56:59], v[20:23], v[128:131]
    v_mfma_f32_16x16x32_bf16 v[164:167], v[56:59], v[24:27], v[164:167]
    ds_read_b64_tr_b16 v[94:95], v15 offset:48800
    ds_read_b64_tr_b16 v[96:97], v15 offset:44224
    ds_read_b64_tr_b16 v[98:99], v15 offset:48832
    s_waitcnt lgkmcnt(15)
    v_mfma_f32_16x16x32_bf16 v[132:135], v[60:63], v[20:23], v[132:135]
    v_mfma_f32_16x16x32_bf16 v[168:171], v[60:63], v[24:27], v[168:171]
    ds_read_b64_tr_b16 v[100:101], v15 offset:44256
    ds_read_b64_tr_b16 v[102:103], v15 offset:48864
    ds_read_b64_tr_b16 v[104:105], v15 offset:44288
    v_mfma_f32_16x16x32_bf16 v[136:139], v[64:67], v[20:23], v[136:139]
    v_mfma_f32_16x16x32_bf16 v[172:175], v[64:67], v[24:27], v[172:175]
    ds_read_b64_tr_b16 v[106:107], v15 offset:48896
    v_mfma_f32_16x16x32_bf16 v[140:143], v[68:71], v[20:23], v[140:143]
    v_mfma_f32_16x16x32_bf16 v[176:179], v[68:71], v[24:27], v[176:179]
    s_waitcnt lgkmcnt(0)
    s_waitcnt vmcnt(18)
    s_barrier
    s_add_u32 s4, s4, 128
    s_addc_u32 s5, s5, 0
    s_add_u32 s6, s6, s18
    s_addc_u32 s7, s7, 0
    s_lshl_b32 s9, s8, 12
    s_add_u32 m0, s9, 34816
    s_nop 0
    global_load_lds_dwordx4 v2, s[4:5]
    s_lshl_b32 s9, s8, 12
    s_add_u32 m0, s9, 35840
    s_nop 0
    global_load_lds_dwordx4 v3, s[4:5]
    s_lshl_b32 s9, s8, 12
    s_add_u32 m0, s9, 36864
    s_nop 0
    global_load_lds_dwordx4 v4, s[4:5]
    s_lshl_b32 s9, s8, 12
    s_add_u32 m0, s9, 37888
    s_nop 0
    global_load_lds_dwordx4 v5, s[4:5]
    s_mul_i32 s9, s8, 4608
    s_add_u32 m0, s9, 51200
    s_nop 0
    global_load_lds_dwordx4 v6, s[6:7]
    s_mul_i32 s9, s8, 4608
    s_add_u32 m0, s9, 52224
    s_nop 0
    global_load_lds_dwordx4 v7, s[6:7]
    s_mul_i32 s9, s8, 4608
    s_add_u32 m0, s9, 53248
    s_nop 0
    global_load_lds_dwordx4 v8, s[6:7]
    s_mul_i32 s9, s8, 4608
    s_add_u32 m0, s9, 54272
    s_nop 0
    global_load_lds_dwordx4 v9, s[6:7]
    s_mul_i32 s9, s8, 4608
    s_add_u32 m0, s9, 55296
    s_mov_b32 exec_hi, 0
    global_load_lds_dwordx4 v10, s[6:7]
    s_mov_b64 exec, -1
    v_mfma_f32_16x16x32_bf16 v[108:111], v[72:75], v[28:31], v[108:111]
    v_mfma_f32_16x16x32_bf16 v[144:147], v[72:75], v[32:35], v[144:147]
    ds_read_b64 v[20:21], v200 offset:0
    ds_read_b64 v[22:23], v201 offset:0
    ds_read_b64 v[24:25], v200 offset:2048
    v_mfma_f32_16x16x32_bf16 v[112:115], v[76:79], v[28:31], v[112:115]
    v_mfma_f32_16x16x32_bf16 v[148:151], v[76:79], v[32:35], v[148:151]
    ds_read_b64 v[26:27], v201 offset:2048
    ds_read_b64_tr_b16 v[36:37], v204 offset:0
    ds_read_b64_tr_b16 v[38:39], v204 offset:4608
    v_mfma_f32_16x16x32_bf16 v[116:119], v[80:83], v[28:31], v[116:119]
    v_mfma_f32_16x16x32_bf16 v[152:155], v[80:83], v[32:35], v[152:155]
    ds_read_b64_tr_b16 v[40:41], v204 offset:32
    ds_read_b64_tr_b16 v[42:43], v204 offset:4640
    ds_read_b64_tr_b16 v[44:45], v204 offset:64
    v_mfma_f32_16x16x32_bf16 v[120:123], v[84:87], v[28:31], v[120:123]
    v_mfma_f32_16x16x32_bf16 v[156:159], v[84:87], v[32:35], v[156:159]
    ds_read_b64_tr_b16 v[46:47], v204 offset:4672
    ds_read_b64_tr_b16 v[48:49], v204 offset:96
    ds_read_b64_tr_b16 v[50:51], v204 offset:4704
    v_mfma_f32_16x16x32_bf16 v[124:127], v[88:91], v[28:31], v[124:127]
    v_mfma_f32_16x16x32_bf16 v[160:163], v[88:91], v[32:35], v[160:163]
    ds_read_b64_tr_b16 v[52:53], v204 offset:128
    ds_read_b64_tr_b16 v[54:55], v204 offset:4736
    ds_read_b64_tr_b16 v[56:57], v204 offset:160
    v_mfma_f32_16x16x32_bf16 v[128:131], v[92:95], v[28:31], v[128:131]
    v_mfma_f32_16x16x32_bf16 v[164:167], v[92:95], v[32:35], v[164:167]
    ds_read_b64_tr_b16 v[58:59], v204 offset:4768
    ds_read_b64_tr_b16 v[60:61], v204 offset:192
    ds_read_b64_tr_b16 v[62:63], v204 offset:4800
    v_mfma_f32_16x16x32_bf16 v[132:135], v[96:99], v[28:31], v[132:135]
    v_mfma_f32_16x16x32_bf16 v[168:171], v[96:99], v[32:35], v[168:171]
    ds_read_b64_tr_b16 v[64:65], v204 offset:224
    ds_read_b64_tr_b16 v[66:67], v204 offset:4832
    ds_read_b64_tr_b16 v[68:69], v204 offset:256
    v_mfma_f32_16x16x32_bf16 v[136:139], v[100:103], v[28:31], v[136:139]
    v_mfma_f32_16x16x32_bf16 v[172:175], v[100:103], v[32:35], v[172:175]
    ds_read_b64_tr_b16 v[70:71], v204 offset:4864
    v_mfma_f32_16x16x32_bf16 v[140:143], v[104:107], v[28:31], v[140:143]
    v_mfma_f32_16x16x32_bf16 v[176:179], v[104:107], v[32:35], v[176:179]
    s_waitcnt lgkmcnt(15)
    v_mfma_f32_16x16x32_bf16 v[108:111], v[36:39], v[20:23], v[108:111]
    v_mfma_f32_16x16x32_bf16 v[144:147], v[36:39], v[24:27], v[144:147]
    ds_read_b64 v[28:29], v202 offset:0
    ds_read_b64 v[30:31], v203 offset:0
    ds_read_b64 v[32:33], v202 offset:2048
    s_waitcnt lgkmcnt(15)
    v_mfma_f32_16x16x32_bf16 v[112:115], v[40:43], v[20:23], v[112:115]
    v_mfma_f32_16x16x32_bf16 v[148:151], v[40:43], v[24:27], v[148:151]
    ds_read_b64 v[34:35], v203 offset:2048
    ds_read_b64_tr_b16 v[72:73], v204 offset:9216
    ds_read_b64_tr_b16 v[74:75], v204 offset:13824
    v_mfma_f32_16x16x32_bf16 v[116:119], v[44:47], v[20:23], v[116:119]
    v_mfma_f32_16x16x32_bf16 v[152:155], v[44:47], v[24:27], v[152:155]
    ds_read_b64_tr_b16 v[76:77], v204 offset:9248
    ds_read_b64_tr_b16 v[78:79], v204 offset:13856
    ds_read_b64_tr_b16 v[80:81], v204 offset:9280
    s_waitcnt lgkmcnt(15)
    v_mfma_f32_16x16x32_bf16 v[120:123], v[48:51], v[20:23], v[120:123]
    v_mfma_f32_16x16x32_bf16 v[156:159], v[48:51], v[24:27], v[156:159]
    ds_read_b64_tr_b16 v[82:83], v204 offset:13888
    ds_read_b64_tr_b16 v[84:85], v204 offset:9312
    ds_read_b64_tr_b16 v[86:87], v204 offset:13920
    v_mfma_f32_16x16x32_bf16 v[124:127], v[52:55], v[20:23], v[124:127]
    v_mfma_f32_16x16x32_bf16 v[160:163], v[52:55], v[24:27], v[160:163]
    ds_read_b64_tr_b16 v[88:89], v204 offset:9344
    ds_read_b64_tr_b16 v[90:91], v204 offset:13952
    ds_read_b64_tr_b16 v[92:93], v204 offset:9376
    v_mfma_f32_16x16x32_bf16 v[128:131], v[56:59], v[20:23], v[128:131]
    v_mfma_f32_16x16x32_bf16 v[164:167], v[56:59], v[24:27], v[164:167]
    ds_read_b64_tr_b16 v[94:95], v204 offset:13984
    ds_read_b64_tr_b16 v[96:97], v204 offset:9408
    ds_read_b64_tr_b16 v[98:99], v204 offset:14016
    s_waitcnt lgkmcnt(15)
    v_mfma_f32_16x16x32_bf16 v[132:135], v[60:63], v[20:23], v[132:135]
    v_mfma_f32_16x16x32_bf16 v[168:171], v[60:63], v[24:27], v[168:171]
    ds_read_b64_tr_b16 v[100:101], v204 offset:9440
    ds_read_b64_tr_b16 v[102:103], v204 offset:14048
    ds_read_b64_tr_b16 v[104:105], v204 offset:9472
    v_mfma_f32_16x16x32_bf16 v[136:139], v[64:67], v[20:23], v[136:139]
    v_mfma_f32_16x16x32_bf16 v[172:175], v[64:67], v[24:27], v[172:175]
    ds_read_b64_tr_b16 v[106:107], v204 offset:14080
    v_mfma_f32_16x16x32_bf16 v[140:143], v[68:71], v[20:23], v[140:143]
    v_mfma_f32_16x16x32_bf16 v[176:179], v[68:71], v[24:27], v[176:179]
    s_waitcnt lgkmcnt(0)
    s_waitcnt vmcnt(18)
    s_barrier
    s_add_u32 s4, s4, 128
    s_addc_u32 s5, s5, 0
    s_add_u32 s6, s6, s18
    s_addc_u32 s7, s7, 0
    s_lshl_b32 s9, s8, 12
    s_add_u32 m0, s9, 69632
    s_nop 0
    global_load_lds_dwordx4 v2, s[4:5]
    s_lshl_b32 s9, s8, 12
    s_add_u32 m0, s9, 70656
    s_nop 0
    global_load_lds_dwordx4 v3, s[4:5]
    s_lshl_b32 s9, s8, 12
    s_add_u32 m0, s9, 71680
    s_nop 0
    global_load_lds_dwordx4 v4, s[4:5]
    s_lshl_b32 s9, s8, 12
    s_add_u32 m0, s9, 72704
    s_nop 0
    global_load_lds_dwordx4 v5, s[4:5]
    s_mul_i32 s9, s8, 4608
    s_add_u32 m0, s9, 86016
    s_nop 0
    global_load_lds_dwordx4 v6, s[6:7]
    s_mul_i32 s9, s8, 4608
    s_add_u32 m0, s9, 87040
    s_nop 0
    global_load_lds_dwordx4 v7, s[6:7]
    s_mul_i32 s9, s8, 4608
    s_add_u32 m0, s9, 88064
    s_nop 0
    global_load_lds_dwordx4 v8, s[6:7]
    s_mul_i32 s9, s8, 4608
    s_add_u32 m0, s9, 89088
    s_nop 0
    global_load_lds_dwordx4 v9, s[6:7]
    s_mul_i32 s9, s8, 4608
    s_add_u32 m0, s9, 90112
    s_mov_b32 exec_hi, 0
    global_load_lds_dwordx4 v10, s[6:7]
    s_mov_b64 exec, -1
    v_mfma_f32_16x16x32_bf16 v[108:111], v[72:75], v[28:31], v[108:111]
    v_mfma_f32_16x16x32_bf16 v[144:147], v[72:75], v[32:35], v[144:147]
    ds_read_b64 v[20:21], v200 offset:34816
    ds_read_b64 v[22:23], v201 offset:34816
    ds_read_b64 v[24:25], v200 offset:36864
    v_mfma_f32_16x16x32_bf16 v[112:115], v[76:79], v[28:31], v[112:115]
    v_mfma_f32_16x16x32_bf16 v[148:151], v[76:79], v[32:35], v[148:151]
    ds_read_b64 v[26:27], v201 offset:36864
    ds_read_b64_tr_b16 v[36:37], v204 offset:34816
    ds_read_b64_tr_b16 v[38:39], v204 offset:39424
    v_mfma_f32_16x16x32_bf16 v[116:119], v[80:83], v[28:31], v[116:119]
    v_mfma_f32_16x16x32_bf16 v[152:155], v[80:83], v[32:35], v[152:155]
    ds_read_b64_tr_b16 v[40:41], v204 offset:34848
    ds_read_b64_tr_b16 v[42:43], v204 offset:39456
    ds_read_b64_tr_b16 v[44:45], v204 offset:34880
    v_mfma_f32_16x16x32_bf16 v[120:123], v[84:87], v[28:31], v[120:123]
    v_mfma_f32_16x16x32_bf16 v[156:159], v[84:87], v[32:35], v[156:159]
    ds_read_b64_tr_b16 v[46:47], v204 offset:39488
    ds_read_b64_tr_b16 v[48:49], v204 offset:34912
    ds_read_b64_tr_b16 v[50:51], v204 offset:39520
    v_mfma_f32_16x16x32_bf16 v[124:127], v[88:91], v[28:31], v[124:127]
    v_mfma_f32_16x16x32_bf16 v[160:163], v[88:91], v[32:35], v[160:163]
    ds_read_b64_tr_b16 v[52:53], v204 offset:34944
    ds_read_b64_tr_b16 v[54:55], v204 offset:39552
    ds_read_b64_tr_b16 v[56:57], v204 offset:34976
    v_mfma_f32_16x16x32_bf16 v[128:131], v[92:95], v[28:31], v[128:131]
    v_mfma_f32_16x16x32_bf16 v[164:167], v[92:95], v[32:35], v[164:167]
    ds_read_b64_tr_b16 v[58:59], v204 offset:39584
    ds_read_b64_tr_b16 v[60:61], v204 offset:35008
    ds_read_b64_tr_b16 v[62:63], v204 offset:39616
    v_mfma_f32_16x16x32_bf16 v[132:135], v[96:99], v[28:31], v[132:135]
    v_mfma_f32_16x16x32_bf16 v[168:171], v[96:99], v[32:35], v[168:171]
    ds_read_b64_tr_b16 v[64:65], v204 offset:35040
    ds_read_b64_tr_b16 v[66:67], v204 offset:39648
    ds_read_b64_tr_b16 v[68:69], v204 offset:35072
    v_mfma_f32_16x16x32_bf16 v[136:139], v[100:103], v[28:31], v[136:139]
    v_mfma_f32_16x16x32_bf16 v[172:175], v[100:103], v[32:35], v[172:175]
    ds_read_b64_tr_b16 v[70:71], v204 offset:39680
    v_mfma_f32_16x16x32_bf16 v[140:143], v[104:107], v[28:31], v[140:143]
    v_mfma_f32_16x16x32_bf16 v[176:179], v[104:107], v[32:35], v[176:179]
    s_waitcnt lgkmcnt(15)
    v_mfma_f32_16x16x32_bf16 v[108:111], v[36:39], v[20:23], v[108:111]
    v_mfma_f32_16x16x32_bf16 v[144:147], v[36:39], v[24:27], v[144:147]
    ds_read_b64 v[28:29], v202 offset:34816
    ds_read_b64 v[30:31], v203 offset:34816
    ds_read_b64 v[32:33], v202 offset:36864
    s_waitcnt lgkmcnt(15)
    v_mfma_f32_16x16x32_bf16 v[112:115], v[40:43], v[20:23], v[112:115]
    v_mfma_f32_16x16x32_bf16 v[148:151], v[40:43], v[24:27], v[148:151]
    ds_read_b64 v[34:35], v203 offset:36864
    ds_read_b64_tr_b16 v[72:73], v204 offset:44032
    ds_read_b64_tr_b16 v[74:75], v204 offset:48640
    v_mfma_f32_16x16x32_bf16 v[116:119], v[44:47], v[20:23], v[116:119]
    v_mfma_f32_16x16x32_bf16 v[152:155], v[44:47], v[24:27], v[152:155]
    ds_read_b64_tr_b16 v[76:77], v204 offset:44064
    ds_read_b64_tr_b16 v[78:79], v204 offset:48672
    ds_read_b64_tr_b16 v[80:81], v204 offset:44096
    s_waitcnt lgkmcnt(15)
    v_mfma_f32_16x16x32_bf16 v[120:123], v[48:51], v[20:23], v[120:123]
    v_mfma_f32_16x16x32_bf16 v[156:159], v[48:51], v[24:27], v[156:159]
    ds_read_b64_tr_b16 v[82:83], v204 offset:48704
    ds_read_b64_tr_b16 v[84:85], v204 offset:44128
    ds_read_b64_tr_b16 v[86:87], v204 offset:48736
    v_mfma_f32_16x16x32_bf16 v[124:127], v[52:55], v[20:23], v[124:127]
    v_mfma_f32_16x16x32_bf16 v[160:163], v[52:55], v[24:27], v[160:163]
    ds_read_b64_tr_b16 v[88:89], v204 offset:44160
    ds_read_b64_tr_b16 v[90:91], v204 offset:48768
    ds_read_b64_tr_b16 v[92:93], v204 offset:44192
    v_mfma_f32_16x16x32_bf16 v[128:131], v[56:59], v[20:23], v[128:131]
    v_mfma_f32_16x16x32_bf16 v[164:167], v[56:59], v[24:27], v[164:167]
    ds_read_b64_tr_b16 v[94:95], v204 offset:48800
    ds_read_b64_tr_b16 v[96:97], v204 offset:44224
    ds_read_b64_tr_b16 v[98:99], v204 offset:48832
    s_waitcnt lgkmcnt(15)
    v_mfma_f32_16x16x32_bf16 v[132:135], v[60:63], v[20:23], v[132:135]
    v_mfma_f32_16x16x32_bf16 v[168:171], v[60:63], v[24:27], v[168:171]
    ds_read_b64_tr_b16 v[100:101], v204 offset:44256
    ds_read_b64_tr_b16 v[102:103], v204 offset:48864
    ds_read_b64_tr_b16 v[104:105], v204 offset:44288
    v_mfma_f32_16x16x32_bf16 v[136:139], v[64:67], v[20:23], v[136:139]
    v_mfma_f32_16x16x32_bf16 v[172:175], v[64:67], v[24:27], v[172:175]
    ds_read_b64_tr_b16 v[106:107], v204 offset:48896
    v_mfma_f32_16x16x32_bf16 v[140:143], v[68:71], v[20:23], v[140:143]
    v_mfma_f32_16x16x32_bf16 v[176:179], v[68:71], v[24:27], v[176:179]
    s_waitcnt lgkmcnt(0)
    s_waitcnt vmcnt(18)
    s_barrier
    s_add_u32 s4, s4, 128
    s_addc_u32 s5, s5, 0
    s_add_u32 s6, s6, s18
    s_addc_u32 s7, s7, 0
    s_lshl_b32 s9, s8, 12
    s_add_u32 m0, s9, 104448
    s_nop 0
    global_load_lds_dwordx4 v2, s[4:5]
    s_lshl_b32 s9, s8, 12
    s_add_u32 m0, s9, 105472
    s_nop 0
    global_load_lds_dwordx4 v3, s[4:5]
    s_lshl_b32 s9, s8, 12
    s_add_u32 m0, s9, 106496
    s_nop 0
    global_load_lds_dwordx4 v4, s[4:5]
    s_lshl_b32 s9, s8, 12
    s_add_u32 m0, s9, 107520
    s_nop 0
    global_load_lds_dwordx4 v5, s[4:5]
    s_mul_i32 s9, s8, 4608
    s_add_u32 m0, s9, 120832
    s_nop 0
    global_load_lds_dwordx4 v6, s[6:7]
    s_mul_i32 s9, s8, 4608
    s_add_u32 m0, s9, 121856
    s_nop 0
    global_load_lds_dwordx4 v7, s[6:7]
    s_mul_i32 s9, s8, 4608
    s_add_u32 m0, s9, 122880
    s_nop 0
    global_load_lds_dwordx4 v8, s[6:7]
    s_mul_i32 s9, s8, 4608
    s_add_u32 m0, s9, 123904
    s_nop 0
    global_load_lds_dwordx4 v9, s[6:7]
    s_mul_i32 s9, s8, 4608
    s_add_u32 m0, s9, 124928
    s_mov_b32 exec_hi, 0
    global_load_lds_dwordx4 v10, s[6:7]
    s_mov_b64 exec, -1
    v_mfma_f32_16x16x32_bf16 v[108:111], v[72:75], v[28:31], v[108:111]
    v_mfma_f32_16x16x32_bf16 v[144:147], v[72:75], v[32:35], v[144:147]
    ds_read_b64 v[20:21], v11 offset:0
    ds_read_b64 v[22:23], v12 offset:0
    ds_read_b64 v[24:25], v11 offset:2048
    v_mfma_f32_16x16x32_bf16 v[112:115], v[76:79], v[28:31], v[112:115]
    v_mfma_f32_16x16x32_bf16 v[148:151], v[76:79], v[32:35], v[148:151]
    ds_read_b64 v[26:27], v12 offset:2048
    ds_read_b64_tr_b16 v[36:37], v15 offset:0
    ds_read_b64_tr_b16 v[38:39], v15 offset:4608
    v_mfma_f32_16x16x32_bf16 v[116:119], v[80:83], v[28:31], v[116:119]
    v_mfma_f32_16x16x32_bf16 v[152:155], v[80:83], v[32:35], v[152:155]
    ds_read_b64_tr_b16 v[40:41], v15 offset:32
    ds_read_b64_tr_b16 v[42:43], v15 offset:4640
    ds_read_b64_tr_b16 v[44:45], v15 offset:64
    v_mfma_f32_16x16x32_bf16 v[120:123], v[84:87], v[28:31], v[120:123]
    v_mfma_f32_16x16x32_bf16 v[156:159], v[84:87], v[32:35], v[156:159]
    ds_read_b64_tr_b16 v[46:47], v15 offset:4672
    ds_read_b64_tr_b16 v[48:49], v15 offset:96
    ds_read_b64_tr_b16 v[50:51], v15 offset:4704
    v_mfma_f32_16x16x32_bf16 v[124:127], v[88:91], v[28:31], v[124:127]
    v_mfma_f32_16x16x32_bf16 v[160:163], v[88:91], v[32:35], v[160:163]
    ds_read_b64_tr_b16 v[52:53], v15 offset:128
    ds_read_b64_tr_b16 v[54:55], v15 offset:4736
    ds_read_b64_tr_b16 v[56:57], v15 offset:160
    v_mfma_f32_16x16x32_bf16 v[128:131], v[92:95], v[28:31], v[128:131]
    v_mfma_f32_16x16x32_bf16 v[164:167], v[92:95], v[32:35], v[164:167]
    ds_read_b64_tr_b16 v[58:59], v15 offset:4768
    ds_read_b64_tr_b16 v[60:61], v15 offset:192
    ds_read_b64_tr_b16 v[62:63], v15 offset:4800
    v_mfma_f32_16x16x32_bf16 v[132:135], v[96:99], v[28:31], v[132:135]
    v_mfma_f32_16x16x32_bf16 v[168:171], v[96:99], v[32:35], v[168:171]
    ds_read_b64_tr_b16 v[64:65], v15 offset:224
    ds_read_b64_tr_b16 v[66:67], v15 offset:4832
    ds_read_b64_tr_b16 v[68:69], v15 offset:256
    v_mfma_f32_16x16x32_bf16 v[136:139], v[100:103], v[28:31], v[136:139]
    v_mfma_f32_16x16x32_bf16 v[172:175], v[100:103], v[32:35], v[172:175]
    ds_read_b64_tr_b16 v[70:71], v15 offset:4864
    v_mfma_f32_16x16x32_bf16 v[140:143], v[104:107], v[28:31], v[140:143]
    v_mfma_f32_16x16x32_bf16 v[176:179], v[104:107], v[32:35], v[176:179]
    s_waitcnt lgkmcnt(15)
    v_mfma_f32_16x16x32_bf16 v[108:111], v[36:39], v[20:23], v[108:111]
    v_mfma_f32_16x16x32_bf16 v[144:147], v[36:39], v[24:27], v[144:147]
    ds_read_b64 v[28:29], v13 offset:0
    ds_read_b64 v[30:31], v14 offset:0
    ds_read_b64 v[32:33], v13 offset:2048
    s_waitcnt lgkmcnt(15)
    v_mfma_f32_16x16x32_bf16 v[112:115], v[40:43], v[20:23], v[112:115]
    v_mfma_f32_16x16x32_bf16 v[148:151], v[40:43], v[24:27], v[148:151]
    ds_read_b64 v[34:35], v14 offset:2048
    ds_read_b64_tr_b16 v[72:73], v15 offset:9216
    ds_read_b64_tr_b16 v[74:75], v15 offset:13824
    v_mfma_f32_16x16x32_bf16 v[116:119], v[44:47], v[20:23], v[116:119]
    v_mfma_f32_16x16x32_bf16 v[152:155], v[44:47], v[24:27], v[152:155]
    ds_read_b64_tr_b16 v[76:77], v15 offset:9248
    ds_read_b64_tr_b16 v[78:79], v15 offset:13856
    ds_read_b64_tr_b16 v[80:81], v15 offset:9280
    s_waitcnt lgkmcnt(15)
    v_mfma_f32_16x16x32_bf16 v[120:123], v[48:51], v[20:23], v[120:123]
    v_mfma_f32_16x16x32_bf16 v[156:159], v[48:51], v[24:27], v[156:159]
    ds_read_b64_tr_b16 v[82:83], v15 offset:13888
    ds_read_b64_tr_b16 v[84:85], v15 offset:9312
    ds_read_b64_tr_b16 v[86:87], v15 offset:13920
    v_mfma_f32_16x16x32_bf16 v[124:127], v[52:55], v[20:23], v[124:127]
    v_mfma_f32_16x16x32_bf16 v[160:163], v[52:55], v[24:27], v[160:163]
    ds_read_b64_tr_b16 v[88:89], v15 offset:9344
    ds_read_b64_tr_b16 v[90:91], v15 offset:13952
    ds_read_b64_tr_b16 v[92:93], v15 offset:9376
    v_mfma_f32_16x16x32_bf16 v[128:131], v[56:59], v[20:23], v[128:131]
    v_mfma_f32_16x16x32_bf16 v[164:167], v[56:59], v[24:27], v[164:167]
    ds_read_b64_tr_b16 v[94:95], v15 offset:13984
    ds_read_b64_tr_b16 v[96:97], v15 offset:9408
    ds_read_b64_tr_b16 v[98:99], v15 offset:14016
    s_waitcnt lgkmcnt(15)
    v_mfma_f32_16x16x32_bf16 v[132:135], v[60:63], v[20:23], v[132:135]
    v_mfma_f32_16x16x32_bf16 v[168:171], v[60:63], v[24:27], v[168:171]
    ds_read_b64_tr_b16 v[100:101], v15 offset:9440
    ds_read_b64_tr_b16 v[102:103], v15 offset:14048
    ds_read_b64_tr_b16 v[104:105], v15 offset:9472
    v_mfma_f32_16x16x32_bf16 v[136:139], v[64:67], v[20:23], v[136:139]
    v_mfma_f32_16x16x32_bf16 v[172:175], v[64:67], v[24:27], v[172:175]
    ds_read_b64_tr_b16 v[106:107], v15 offset:14080
    v_mfma_f32_16x16x32_bf16 v[140:143], v[68:71], v[20:23], v[140:143]
    v_mfma_f32_16x16x32_bf16 v[176:179], v[68:71], v[24:27], v[176:179]
    s_waitcnt lgkmcnt(0)
    s_waitcnt vmcnt(18)
    s_barrier
    v_mfma_f32_16x16x32_bf16 v[108:111], v[72:75], v[28:31], v[108:111]
    v_mfma_f32_16x16x32_bf16 v[144:147], v[72:75], v[32:35], v[144:147]
    ds_read_b64 v[20:21], v11 offset:34816
    ds_read_b64 v[22:23], v12 offset:34816
    ds_read_b64 v[24:25], v11 offset:36864
    v_mfma_f32_16x16x32_bf16 v[112:115], v[76:79], v[28:31], v[112:115]
    v_mfma_f32_16x16x32_bf16 v[148:151], v[76:79], v[32:35], v[148:151]
    ds_read_b64 v[26:27], v12 offset:36864
    ds_read_b64_tr_b16 v[36:37], v15 offset:34816
    ds_read_b64_tr_b16 v[38:39], v15 offset:39424
    v_mfma_f32_16x16x32_bf16 v[116:119], v[80:83], v[28:31], v[116:119]
    v_mfma_f32_16x16x32_bf16 v[152:155], v[80:83], v[32:35], v[152:155]
    ds_read_b64_tr_b16 v[40:41], v15 offset:34848
    ds_read_b64_tr_b16 v[42:43], v15 offset:39456
    ds_read_b64_tr_b16 v[44:45], v15 offset:34880
    v_mfma_f32_16x16x32_bf16 v[120:123], v[84:87], v[28:31], v[120:123]
    v_mfma_f32_16x16x32_bf16 v[156:159], v[84:87], v[32:35], v[156:159]
    ds_read_b64_tr_b16 v[46:47], v15 offset:39488
    ds_read_b64_tr_b16 v[48:49], v15 offset:34912
    ds_read_b64_tr_b16 v[50:51], v15 offset:39520
    v_mfma_f32_16x16x32_bf16 v[124:127], v[88:91], v[28:31], v[124:127]
    v_mfma_f32_16x16x32_bf16 v[160:163], v[88:91], v[32:35], v[160:163]
    ds_read_b64_tr_b16 v[52:53], v15 offset:34944
    ds_read_b64_tr_b16 v[54:55], v15 offset:39552
    ds_read_b64_tr_b16 v[56:57], v15 offset:34976
    v_mfma_f32_16x16x32_bf16 v[128:131], v[92:95], v[28:31], v[128:131]
    v_mfma_f32_16x16x32_bf16 v[164:167], v[92:95], v[32:35], v[164:167]
    ds_read_b64_tr_b16 v[58:59], v15 offset:39584
    ds_read_b64_tr_b16 v[60:61], v15 offset:35008
    ds_read_b64_tr_b16 v[62:63], v15 offset:39616
    v_mfma_f32_16x16x32_bf16 v[132:135], v[96:99], v[28:31], v[132:135]
    v_mfma_f32_16x16x32_bf16 v[168:171], v[96:99], v[32:35], v[168:171]
    ds_read_b64_tr_b16 v[64:65], v15 offset:35040
    ds_read_b64_tr_b16 v[66:67], v15 offset:39648
    ds_read_b64_tr_b16 v[68:69], v15 offset:35072
    v_mfma_f32_16x16x32_bf16 v[136:139], v[100:103], v[28:31], v[136:139]
    v_mfma_f32_16x16x32_bf16 v[172:175], v[100:103], v[32:35], v[172:175]
    ds_read_b64_tr_b16 v[70:71], v15 offset:39680
    v_mfma_f32_16x16x32_bf16 v[140:143], v[104:107], v[28:31], v[140:143]
    v_mfma_f32_16x16x32_bf16 v[176:179], v[104:107], v[32:35], v[176:179]
    s_waitcnt lgkmcnt(15)
    v_mfma_f32_16x16x32_bf16 v[108:111], v[36:39], v[20:23], v[108:111]
    v_mfma_f32_16x16x32_bf16 v[144:147], v[36:39], v[24:27], v[144:147]
    ds_read_b64 v[28:29], v13 offset:34816
    ds_read_b64 v[30:31], v14 offset:34816
    ds_read_b64 v[32:33], v13 offset:36864
    s_waitcnt lgkmcnt(15)
    v_mfma_f32_16x16x32_bf16 v[112:115], v[40:43], v[20:23], v[112:115]
    v_mfma_f32_16x16x32_bf16 v[148:151], v[40:43], v[24:27], v[148:151]
    ds_read_b64 v[34:35], v14 offset:36864
    ds_read_b64_tr_b16 v[72:73], v15 offset:44032
    ds_read_b64_tr_b16 v[74:75], v15 offset:48640
    v_mfma_f32_16x16x32_bf16 v[116:119], v[44:47], v[20:23], v[116:119]
    v_mfma_f32_16x16x32_bf16 v[152:155], v[44:47], v[24:27], v[152:155]
    ds_read_b64_tr_b16 v[76:77], v15 offset:44064
    ds_read_b64_tr_b16 v[78:79], v15 offset:48672
    ds_read_b64_tr_b16 v[80:81], v15 offset:44096
    s_waitcnt lgkmcnt(15)
    v_mfma_f32_16x16x32_bf16 v[120:123], v[48:51], v[20:23], v[120:123]
    v_mfma_f32_16x16x32_bf16 v[156:159], v[48:51], v[24:27], v[156:159]
    ds_read_b64_tr_b16 v[82:83], v15 offset:48704
    ds_read_b64_tr_b16 v[84:85], v15 offset:44128
    ds_read_b64_tr_b16 v[86:87], v15 offset:48736
    v_mfma_f32_16x16x32_bf16 v[124:127], v[52:55], v[20:23], v[124:127]
    v_mfma_f32_16x16x32_bf16 v[160:163], v[52:55], v[24:27], v[160:163]
    ds_read_b64_tr_b16 v[88:89], v15 offset:44160
    ds_read_b64_tr_b16 v[90:91], v15 offset:48768
    ds_read_b64_tr_b16 v[92:93], v15 offset:44192
    v_mfma_f32_16x16x32_bf16 v[128:131], v[56:59], v[20:23], v[128:131]
    v_mfma_f32_16x16x32_bf16 v[164:167], v[56:59], v[24:27], v[164:167]
    ds_read_b64_tr_b16 v[94:95], v15 offset:48800
    ds_read_b64_tr_b16 v[96:97], v15 offset:44224
    ds_read_b64_tr_b16 v[98:99], v15 offset:48832
    s_waitcnt lgkmcnt(15)
    v_mfma_f32_16x16x32_bf16 v[132:135], v[60:63], v[20:23], v[132:135]
    v_mfma_f32_16x16x32_bf16 v[168:171], v[60:63], v[24:27], v[168:171]
    ds_read_b64_tr_b16 v[100:101], v15 offset:44256
    ds_read_b64_tr_b16 v[102:103], v15 offset:48864
    ds_read_b64_tr_b16 v[104:105], v15 offset:44288
    v_mfma_f32_16x16x32_bf16 v[136:139], v[64:67], v[20:23], v[136:139]
    v_mfma_f32_16x16x32_bf16 v[172:175], v[64:67], v[24:27], v[172:175]
    ds_read_b64_tr_b16 v[106:107], v15 offset:48896
    v_mfma_f32_16x16x32_bf16 v[140:143], v[68:71], v[20:23], v[140:143]
    v_mfma_f32_16x16x32_bf16 v[176:179], v[68:71], v[24:27], v[176:179]
    s_waitcnt lgkmcnt(0)
    s_waitcnt vmcnt(9)
    s_barrier
    v_mfma_f32_16x16x32_bf16 v[108:111], v[72:75], v[28:31], v[108:111]
    v_mfma_f32_16x16x32_bf16 v[144:147], v[72:75], v[32:35], v[144:147]
    ds_read_b64 v[20:21], v200 offset:0
    ds_read_b64 v[22:23], v201 offset:0
    ds_read_b64 v[24:25], v200 offset:2048
    v_mfma_f32_16x16x32_bf16 v[112:115], v[76:79], v[28:31], v[112:115]
    v_mfma_f32_16x16x32_bf16 v[148:151], v[76:79], v[32:35], v[148:151]
    ds_read_b64 v[26:27], v201 offset:2048
    ds_read_b64_tr_b16 v[36:37], v204 offset:0
    ds_read_b64_tr_b16 v[38:39], v204 offset:4608
    v_mfma_f32_16x16x32_bf16 v[116:119], v[80:83], v[28:31], v[116:119]
    v_mfma_f32_16x16x32_bf16 v[152:155], v[80:83], v[32:35], v[152:155]
    ds_read_b64_tr_b16 v[40:41], v204 offset:32
    ds_read_b64_tr_b16 v[42:43], v204 offset:4640
    ds_read_b64_tr_b16 v[44:45], v204 offset:64
    v_mfma_f32_16x16x32_bf16 v[120:123], v[84:87], v[28:31], v[120:123]
    v_mfma_f32_16x16x32_bf16 v[156:159], v[84:87], v[32:35], v[156:159]
    ds_read_b64_tr_b16 v[46:47], v204 offset:4672
    ds_read_b64_tr_b16 v[48:49], v204 offset:96
    ds_read_b64_tr_b16 v[50:51], v204 offset:4704
    v_mfma_f32_16x16x32_bf16 v[124:127], v[88:91], v[28:31], v[124:127]
    v_mfma_f32_16x16x32_bf16 v[160:163], v[88:91], v[32:35], v[160:163]
    ds_read_b64_tr_b16 v[52:53], v204 offset:128
    ds_read_b64_tr_b16 v[54:55], v204 offset:4736
    ds_read_b64_tr_b16 v[56:57], v204 offset:160
    v_mfma_f32_16x16x32_bf16 v[128:131], v[92:95], v[28:31], v[128:131]
    v_mfma_f32_16x16x32_bf16 v[164:167], v[92:95], v[32:35], v[164:167]
    ds_read_b64_tr_b16 v[58:59], v204 offset:4768
    ds_read_b64_tr_b16 v[60:61], v204 offset:192
    ds_read_b64_tr_b16 v[62:63], v204 offset:4800
    v_mfma_f32_16x16x32_bf16 v[132:135], v[96:99], v[28:31], v[132:135]
    v_mfma_f32_16x16x32_bf16 v[168:171], v[96:99], v[32:35], v[168:171]
    ds_read_b64_tr_b16 v[64:65], v204 offset:224
    ds_read_b64_tr_b16 v[66:67], v204 offset:4832
    ds_read_b64_tr_b16 v[68:69], v204 offset:256
    v_mfma_f32_16x16x32_bf16 v[136:139], v[100:103], v[28:31], v[136:139]
    v_mfma_f32_16x16x32_bf16 v[172:175], v[100:103], v[32:35], v[172:175]
    ds_read_b64_tr_b16 v[70:71], v204 offset:4864
    v_mfma_f32_16x16x32_bf16 v[140:143], v[104:107], v[28:31], v[140:143]
    v_mfma_f32_16x16x32_bf16 v[176:179], v[104:107], v[32:35], v[176:179]
    s_waitcnt lgkmcnt(15)
    v_mfma_f32_16x16x32_bf16 v[108:111], v[36:39], v[20:23], v[108:111]
    v_mfma_f32_16x16x32_bf16 v[144:147], v[36:39], v[24:27], v[144:147]
    ds_read_b64 v[28:29], v202 offset:0
    ds_read_b64 v[30:31], v203 offset:0
    ds_read_b64 v[32:33], v202 offset:2048
    s_waitcnt lgkmcnt(15)
    v_mfma_f32_16x16x32_bf16 v[112:115], v[40:43], v[20:23], v[112:115]
    v_mfma_f32_16x16x32_bf16 v[148:151], v[40:43], v[24:27], v[148:151]
    ds_read_b64 v[34:35], v203 offset:2048
    ds_read_b64_tr_b16 v[72:73], v204 offset:9216
    ds_read_b64_tr_b16 v[74:75], v204 offset:13824
    v_mfma_f32_16x16x32_bf16 v[116:119], v[44:47], v[20:23], v[116:119]
    v_mfma_f32_16x16x32_bf16 v[152:155], v[44:47], v[24:27], v[152:155]
    ds_read_b64_tr_b16 v[76:77], v204 offset:9248
    ds_read_b64_tr_b16 v[78:79], v204 offset:13856
    ds_read_b64_tr_b16 v[80:81], v204 offset:9280
    s_waitcnt lgkmcnt(15)
    v_mfma_f32_16x16x32_bf16 v[120:123], v[48:51], v[20:23], v[120:123]
    v_mfma_f32_16x16x32_bf16 v[156:159], v[48:51], v[24:27], v[156:159]
    ds_read_b64_tr_b16 v[82:83], v204 offset:13888
    ds_read_b64_tr_b16 v[84:85], v204 offset:9312
    ds_read_b64_tr_b16 v[86:87], v204 offset:13920
    v_mfma_f32_16x16x32_bf16 v[124:127], v[52:55], v[20:23], v[124:127]
    v_mfma_f32_16x16x32_bf16 v[160:163], v[52:55], v[24:27], v[160:163]
    ds_read_b64_tr_b16 v[88:89], v204 offset:9344
    ds_read_b64_tr_b16 v[90:91], v204 offset:13952
    ds_read_b64_tr_b16 v[92:93], v204 offset:9376
    v_mfma_f32_16x16x32_bf16 v[128:131], v[56:59], v[20:23], v[128:131]
    v_mfma_f32_16x16x32_bf16 v[164:167], v[56:59], v[24:27], v[164:167]
    ds_read_b64_tr_b16 v[94:95], v204 offset:13984
    ds_read_b64_tr_b16 v[96:97], v204 offset:9408
    ds_read_b64_tr_b16 v[98:99], v204 offset:14016
    s_waitcnt lgkmcnt(15)
    v_mfma_f32_16x16x32_bf16 v[132:135], v[60:63], v[20:23], v[132:135]
    v_mfma_f32_16x16x32_bf16 v[168:171], v[60:63], v[24:27], v[168:171]
    ds_read_b64_tr_b16 v[100:101], v204 offset:9440
    ds_read_b64_tr_b16 v[102:103], v204 offset:14048
    ds_read_b64_tr_b16 v[104:105], v204 offset:9472
    v_mfma_f32_16x16x32_bf16 v[136:139], v[64:67], v[20:23], v[136:139]
    v_mfma_f32_16x16x32_bf16 v[172:175], v[64:67], v[24:27], v[172:175]
    ds_read_b64_tr_b16 v[106:107], v204 offset:14080
    v_mfma_f32_16x16x32_bf16 v[140:143], v[68:71], v[20:23], v[140:143]
    v_mfma_f32_16x16x32_bf16 v[176:179], v[68:71], v[24:27], v[176:179]
    s_waitcnt lgkmcnt(0)
    s_waitcnt vmcnt(0)
    s_barrier
    v_mfma_f32_16x16x32_bf16 v[108:111], v[72:75], v[28:31], v[108:111]
    v_mfma_f32_16x16x32_bf16 v[144:147], v[72:75], v[32:35], v[144:147]
    ds_read_b64 v[20:21], v200 offset:34816
    ds_read_b64 v[22:23], v201 offset:34816
    ds_read_b64 v[24:25], v200 offset:36864
    v_mfma_f32_16x16x32_bf16 v[112:115], v[76:79], v[28:31], v[112:115]
    v_mfma_f32_16x16x32_bf16 v[148:151], v[76:79], v[32:35], v[148:151]
    ds_read_b64 v[26:27], v201 offset:36864
    ds_read_b64_tr_b16 v[36:37], v204 offset:34816
    ds_read_b64_tr_b16 v[38:39], v204 offset:39424
    v_mfma_f32_16x16x32_bf16 v[116:119], v[80:83], v[28:31], v[116:119]
    v_mfma_f32_16x16x32_bf16 v[152:155], v[80:83], v[32:35], v[152:155]
    ds_read_b64_tr_b16 v[40:41], v204 offset:34848
    ds_read_b64_tr_b16 v[42:43], v204 offset:39456
    ds_read_b64_tr_b16 v[44:45], v204 offset:34880
    v_mfma_f32_16x16x32_bf16 v[120:123], v[84:87], v[28:31], v[120:123]
    v_mfma_f32_16x16x32_bf16 v[156:159], v[84:87], v[32:35], v[156:159]
    ds_read_b64_tr_b16 v[46:47], v204 offset:39488
    ds_read_b64_tr_b16 v[48:49], v204 offset:34912
    ds_read_b64_tr_b16 v[50:51], v204 offset:39520
    v_mfma_f32_16x16x32_bf16 v[124:127], v[88:91], v[28:31], v[124:127]
    v_mfma_f32_16x16x32_bf16 v[160:163], v[88:91], v[32:35], v[160:163]
    ds_read_b64_tr_b16 v[52:53], v204 offset:34944
    ds_read_b64_tr_b16 v[54:55], v204 offset:39552
    ds_read_b64_tr_b16 v[56:57], v204 offset:34976
    v_mfma_f32_16x16x32_bf16 v[128:131], v[92:95], v[28:31], v[128:131]
    v_mfma_f32_16x16x32_bf16 v[164:167], v[92:95], v[32:35], v[164:167]
    ds_read_b64_tr_b16 v[58:59], v204 offset:39584
    ds_read_b64_tr_b16 v[60:61], v204 offset:35008
    ds_read_b64_tr_b16 v[62:63], v204 offset:39616
    v_mfma_f32_16x16x32_bf16 v[132:135], v[96:99], v[28:31], v[132:135]
    v_mfma_f32_16x16x32_bf16 v[168:171], v[96:99], v[32:35], v[168:171]
    ds_read_b64_tr_b16 v[64:65], v204 offset:35040
    ds_read_b64_tr_b16 v[66:67], v204 offset:39648
    ds_read_b64_tr_b16 v[68:69], v204 offset:35072
    v_mfma_f32_16x16x32_bf16 v[136:139], v[100:103], v[28:31], v[136:139]
    v_mfma_f32_16x16x32_bf16 v[172:175], v[100:103], v[32:35], v[172:175]
    ds_read_b64_tr_b16 v[70:71], v204 offset:39680
    v_mfma_f32_16x16x32_bf16 v[140:143], v[104:107], v[28:31], v[140:143]
    v_mfma_f32_16x16x32_bf16 v[176:179], v[104:107], v[32:35], v[176:179]
    s_waitcnt lgkmcnt(15)
    v_mfma_f32_16x16x32_bf16 v[108:111], v[36:39], v[20:23], v[108:111]
    v_mfma_f32_16x16x32_bf16 v[144:147], v[36:39], v[24:27], v[144:147]
    ds_read_b64 v[28:29], v202 offset:34816
    ds_read_b64 v[30:31], v203 offset:34816
    ds_read_b64 v[32:33], v202 offset:36864
    s_waitcnt lgkmcnt(15)
    v_mfma_f32_16x16x32_bf16 v[112:115], v[40:43], v[20:23], v[112:115]
    v_mfma_f32_16x16x32_bf16 v[148:151], v[40:43], v[24:27], v[148:151]
    ds_read_b64 v[34:35], v203 offset:36864
    ds_read_b64_tr_b16 v[72:73], v204 offset:44032
    ds_read_b64_tr_b16 v[74:75], v204 offset:48640
    v_mfma_f32_16x16x32_bf16 v[116:119], v[44:47], v[20:23], v[116:119]
    v_mfma_f32_16x16x32_bf16 v[152:155], v[44:47], v[24:27], v[152:155]
    ds_read_b64_tr_b16 v[76:77], v204 offset:44064
    ds_read_b64_tr_b16 v[78:79], v204 offset:48672
    ds_read_b64_tr_b16 v[80:81], v204 offset:44096
    s_waitcnt lgkmcnt(15)
    v_mfma_f32_16x16x32_bf16 v[120:123], v[48:51], v[20:23], v[120:123]
    v_mfma_f32_16x16x32_bf16 v[156:159], v[48:51], v[24:27], v[156:159]
    ds_read_b64_tr_b16 v[82:83], v204 offset:48704
    ds_read_b64_tr_b16 v[84:85], v204 offset:44128
    ds_read_b64_tr_b16 v[86:87], v204 offset:48736
    v_mfma_f32_16x16x32_bf16 v[124:127], v[52:55], v[20:23], v[124:127]
    v_mfma_f32_16x16x32_bf16 v[160:163], v[52:55], v[24:27], v[160:163]
    ds_read_b64_tr_b16 v[88:89], v204 offset:44160
    ds_read_b64_tr_b16 v[90:91], v204 offset:48768
    ds_read_b64_tr_b16 v[92:93], v204 offset:44192
    v_mfma_f32_16x16x32_bf16 v[128:131], v[56:59], v[20:23], v[128:131]
    v_mfma_f32_16x16x32_bf16 v[164:167], v[56:59], v[24:27], v[164:167]
    ds_read_b64_tr_b16 v[94:95], v204 offset:48800
    ds_read_b64_tr_b16 v[96:97], v204 offset:44224
    ds_read_b64_tr_b16 v[98:99], v204 offset:48832
    s_waitcnt lgkmcnt(15)
    v_mfma_f32_16x16x32_bf16 v[132:135], v[60:63], v[20:23], v[132:135]
    v_mfma_f32_16x16x32_bf16 v[168:171], v[60:63], v[24:27], v[168:171]
    ds_read_b64_tr_b16 v[100:101], v204 offset:44256
    ds_read_b64_tr_b16 v[102:103], v204 offset:48864
    ds_read_b64_tr_b16 v[104:105], v204 offset:44288
    v_mfma_f32_16x16x32_bf16 v[136:139], v[64:67], v[20:23], v[136:139]
    v_mfma_f32_16x16x32_bf16 v[172:175], v[64:67], v[24:27], v[172:175]
    ds_read_b64_tr_b16 v[106:107], v204 offset:48896
    v_mfma_f32_16x16x32_bf16 v[140:143], v[68:71], v[20:23], v[140:143]
    v_mfma_f32_16x16x32_bf16 v[176:179], v[68:71], v[24:27], v[176:179]
    s_waitcnt lgkmcnt(15)
    v_mfma_f32_16x16x32_bf16 v[108:111], v[72:75], v[28:31], v[108:111]
    v_mfma_f32_16x16x32_bf16 v[144:147], v[72:75], v[32:35], v[144:147]
    s_waitcnt lgkmcnt(14)
    v_mfma_f32_16x16x32_bf16 v[112:115], v[76:79], v[28:31], v[112:115]
    v_mfma_f32_16x16x32_bf16 v[148:151], v[76:79], v[32:35], v[148:151]
    s_waitcnt lgkmcnt(12)
    v_mfma_f32_16x16x32_bf16 v[116:119], v[80:83], v[28:31], v[116:119]
    v_mfma_f32_16x16x32_bf16 v[152:155], v[80:83], v[32:35], v[152:155]
    s_waitcnt lgkmcnt(10)
    v_mfma_f32_16x16x32_bf16 v[120:123], v[84:87], v[28:31], v[120:123]
    v_mfma_f32_16x16x32_bf16 v[156:159], v[84:87], v[32:35], v[156:159]
    s_waitcnt lgkmcnt(8)
    v_mfma_f32_16x16x32_bf16 v[124:127], v[88:91], v[28:31], v[124:127]
    v_mfma_f32_16x16x32_bf16 v[160:163], v[88:91], v[32:35], v[160:163]
    s_waitcnt lgkmcnt(6)
    v_mfma_f32_16x16x32_bf16 v[128:131], v[92:95], v[28:31], v[128:131]
    v_mfma_f32_16x16x32_bf16 v[164:167], v[92:95], v[32:35], v[164:167]
    s_waitcnt lgkmcnt(4)
    v_mfma_f32_16x16x32_bf16 v[132:135], v[96:99], v[28:31], v[132:135]
    v_mfma_f32_16x16x32_bf16 v[168:171], v[96:99], v[32:35], v[168:171]
    s_waitcnt lgkmcnt(2)
    v_mfma_f32_16x16x32_bf16 v[136:139], v[100:103], v[28:31], v[136:139]
    v_mfma_f32_16x16x32_bf16 v[172:175], v[100:103], v[32:35], v[172:175]
    s_waitcnt lgkmcnt(0)
    v_mfma_f32_16x16x32_bf16 v[140:143], v[104:107], v[28:31], v[140:143]
    v_mfma_f32_16x16x32_bf16 v[176:179], v[104:107], v[32:35], v[176:179]
    s_nop 15
    s_branch K2_ST
K2_EPI:
    s_nop 15
    v_and_b32 v19, 15, v1
    s_lshl_b32 s9, s8, 5
    s_add_u32 s9, s9, s15
    v_add_u32 v19, s9, v19
    v_lshlrev_b32 v19, 2, v19
    v_add_u32 v19, 24956928, v19
    global_load_dword v180, v19, s[24:25]
    global_load_dword v181, v19, s[24:25] offset:64
    s_waitcnt vmcnt(0)
    v_sub_f32 v180, 1.0, v180
    v_cvt_pk_bf16_f32 v182, v180, v180
    v_lshlrev_b32 v180, 16, v182
    v_sub_f32 v181, 1.0, v181
    v_cvt_pk_bf16_f32 v182, v181, v181
    v_lshlrev_b32 v181, 16, v182
    v_mul_f32 v108, v108, v180
    v_mul_f32 v109, v109, v180
    v_mul_f32 v110, v110, v180
    v_mul_f32 v111, v111, v180
    v_mul_f32 v112, v112, v180
    v_mul_f32 v113, v113, v180
    v_mul_f32 v114, v114, v180
    v_mul_f32 v115, v115, v180
    v_mul_f32 v116, v116, v180
    v_mul_f32 v117, v117, v180
    v_mul_f32 v118, v118, v180
    v_mul_f32 v119, v119, v180
    v_mul_f32 v120, v120, v180
    v_mul_f32 v121, v121, v180
    v_mul_f32 v122, v122, v180
    v_mul_f32 v123, v123, v180
    v_mul_f32 v124, v124, v180
    v_mul_f32 v125, v125, v180
    v_mul_f32 v126, v126, v180
    v_mul_f32 v127, v127, v180
    v_mul_f32 v128, v128, v180
    v_mul_f32 v129, v129, v180
    v_mul_f32 v130, v130, v180
    v_mul_f32 v131, v131, v180
    v_mul_f32 v132, v132, v180
    v_mul_f32 v133, v133, v180
    v_mul_f32 v134, v134, v180
    v_mul_f32 v135, v135, v180
    v_mul_f32 v136, v136, v180
    v_mul_f32 v137, v137, v180
    v_mul_f32 v138, v138, v180
    v_mul_f32 v139, v139, v180
    v_mul_f32 v140, v140, v180
    v_mul_f32 v141, v141, v180
    v_mul_f32 v142, v142, v180
    v_mul_f32 v143, v143, v180
    v_mul_f32 v144, v144, v181
    v_mul_f32 v145, v145, v181
    v_mul_f32 v146, v146, v181
    v_mul_f32 v147, v147, v181
    v_mul_f32 v148, v148, v181
    v_mul_f32 v149, v149, v181
    v_mul_f32 v150, v150, v181
    v_mul_f32 v151, v151, v181
    v_mul_f32 v152, v152, v181
    v_mul_f32 v153, v153, v181
    v_mul_f32 v154, v154, v181
    v_mul_f32 v155, v155, v181
    v_mul_f32 v156, v156, v181
    v_mul_f32 v157, v157, v181
    v_mul_f32 v158, v158, v181
    v_mul_f32 v159, v159, v181
    v_mul_f32 v160, v160, v181
    v_mul_f32 v161, v161, v181
    v_mul_f32 v162, v162, v181
    v_mul_f32 v163, v163, v181
    v_mul_f32 v164, v164, v181
    v_mul_f32 v165, v165, v181
    v_mul_f32 v166, v166, v181
    v_mul_f32 v167, v167, v181
    v_mul_f32 v168, v168, v181
    v_mul_f32 v169, v169, v181
    v_mul_f32 v170, v170, v181
    v_mul_f32 v171, v171, v181
    v_mul_f32 v172, v172, v181
    v_mul_f32 v173, v173, v181
    v_mul_f32 v174, v174, v181
    v_mul_f32 v175, v175, v181
    v_mul_f32 v176, v176, v181
    v_mul_f32 v177, v177, v181
    v_mul_f32 v178, v178, v181
    v_mul_f32 v179, v179, v181
    s_nop 1
K2_ST:
    s_lshl_b32 s13, s12, 1
    v_lshrrev_b32 v18, 4, v1
    v_and_b32 v19, 15, v1
    s_lshl_b32 s9, s8, 5
    s_add_u32 s9, s9, s15
    v_add_u32 v19, s9, v19
    s_mov_b32 s14, 2304
    v_mul_lo_u32 v19, v19, s14
    v_mul_u32_u24 v18, 16, v18
    v_add_u32 v19, v19, v18
    v_add_u32 v16, s13, v19
    v_add_u32 v17, 36864, v16
    s_mul_i32 s9, s20, 4718592
    s_add_u32 s26, s24, s9
    s_addc_u32 s27, s25, 0
    s_add_u32 s26, s26, 24965120
    s_addc_u32 s27, s27, 0
    global_store_dwordx4 v16, v[108:111], s[26:27] offset:0
    global_store_dwordx4 v16, v[112:115], s[26:27] offset:64
    global_store_dwordx4 v16, v[116:119], s[26:27] offset:128
    global_store_dwordx4 v16, v[120:123], s[26:27] offset:192
    global_store_dwordx4 v16, v[124:127], s[26:27] offset:256
    global_store_dwordx4 v16, v[128:131], s[26:27] offset:320
    global_store_dwordx4 v16, v[132:135], s[26:27] offset:384
    global_store_dwordx4 v16, v[136:139], s[26:27] offset:448
    global_store_dwordx4 v16, v[140:143], s[26:27] offset:512
    global_store_dwordx4 v17, v[144:147], s[26:27] offset:0
    global_store_dwordx4 v17, v[148:151], s[26:27] offset:64
    global_store_dwordx4 v17, v[152:155], s[26:27] offset:128
    global_store_dwordx4 v17, v[156:159], s[26:27] offset:192
    global_store_dwordx4 v17, v[160:163], s[26:27] offset:256
    global_store_dwordx4 v17, v[164:167], s[26:27] offset:320
    global_store_dwordx4 v17, v[168:171], s[26:27] offset:384
    global_store_dwordx4 v17, v[172:175], s[26:27] offset:448
    global_store_dwordx4 v17, v[176:179], s[26:27] offset:512
K2_END:
    s_endpgm
.globl k3_kernel
.p2align 8
.type k3_kernel,@function
k3_kernel:
    s_cmp_ge_u32 s2, 576
    s_cbranch_scc1 K3_END
    s_load_dwordx2 s[4:5], s[0:1], 56
    s_load_dwordx2 s[24:25], s[0:1], 72
    s_lshl_b32 s9, s2, 8
    v_add_u32 v1, s9, v0
    v_lshlrev_b32 v2, 5, v1
    v_lshlrev_b32 v3, 4, v1
    s_waitcnt lgkmcnt(0)
    s_add_u32 s24, s24, 24965120
    s_addc_u32 s25, s25, 0
    global_load_dwordx4 v[8:11], v2, s[24:25]
    global_load_dwordx4 v[12:15], v2, s[24:25] offset:16
    s_add_u32 s24, s24, 4718592
    s_addc_u32 s25, s25, 0
    global_load_dwordx4 v[16:19], v2, s[24:25]
    global_load_dwordx4 v[20:23], v2, s[24:25] offset:16
    s_add_u32 s24, s24, 4718592
    s_addc_u32 s25, s25, 0
    global_load_dwordx4 v[24:27], v2, s[24:25]
    global_load_dwordx4 v[28:31], v2, s[24:25] offset:16
    s_add_u32 s24, s24, 4718592
    s_addc_u32 s25, s25, 0
    global_load_dwordx4 v[32:35], v2, s[24:25]
    global_load_dwordx4 v[36:39], v2, s[24:25] offset:16
    s_add_u32 s24, s24, 4718592
    s_addc_u32 s25, s25, 0
    s_waitcnt vmcnt(0)
    v_add_f32 v8, v8, v16
    v_add_f32 v9, v9, v17
    v_add_f32 v10, v10, v18
    v_add_f32 v11, v11, v19
    v_add_f32 v12, v12, v20
    v_add_f32 v13, v13, v21
    v_add_f32 v14, v14, v22
    v_add_f32 v15, v15, v23
    v_add_f32 v8, v8, v24
    v_add_f32 v9, v9, v25
    v_add_f32 v10, v10, v26
    v_add_f32 v11, v11, v27
    v_add_f32 v12, v12, v28
    v_add_f32 v13, v13, v29
    v_add_f32 v14, v14, v30
    v_add_f32 v15, v15, v31
    v_add_f32 v8, v8, v32
    v_add_f32 v9, v9, v33
    v_add_f32 v10, v10, v34
    v_add_f32 v11, v11, v35
    v_add_f32 v12, v12, v36
    v_add_f32 v13, v13, v37
    v_add_f32 v14, v14, v38
    v_add_f32 v15, v15, v39
    v_cvt_pk_bf16_f32 v40, v8, v9
    v_cvt_pk_bf16_f32 v41, v10, v11
    v_cvt_pk_bf16_f32 v42, v12, v13
    v_cvt_pk_bf16_f32 v43, v14, v15
    global_store_dwordx4 v3, v[40:43], s[4:5]
K3_END:
    s_endpgm
.section .rodata,"a"
.p2align 6
.amdhsa_kernel k1_kernel
  .amdhsa_next_free_vgpr 216
  .amdhsa_next_free_sgpr 102
  .amdhsa_accum_offset 216
  .amdhsa_group_segment_fixed_size 0
  .amdhsa_kernarg_size 80
  .amdhsa_user_sgpr_count 2
  .amdhsa_user_sgpr_kernarg_segment_ptr 1
  .amdhsa_system_sgpr_workgroup_id_x 1
.end_amdhsa_kernel
.p2align 6
.amdhsa_kernel k15_kernel
  .amdhsa_next_free_vgpr 96
  .amdhsa_next_free_sgpr 102
  .amdhsa_accum_offset 96
  .amdhsa_group_segment_fixed_size 0
  .amdhsa_kernarg_size 80
  .amdhsa_user_sgpr_count 2
  .amdhsa_user_sgpr_kernarg_segment_ptr 1
  .amdhsa_system_sgpr_workgroup_id_x 1
.end_amdhsa_kernel
.p2align 6
.amdhsa_kernel k2_kernel
  .amdhsa_next_free_vgpr 216
  .amdhsa_next_free_sgpr 102
  .amdhsa_accum_offset 216
  .amdhsa_group_segment_fixed_size 0
  .amdhsa_kernarg_size 80
  .amdhsa_user_sgpr_count 2
  .amdhsa_user_sgpr_kernarg_segment_ptr 1
  .amdhsa_system_sgpr_workgroup_id_x 1
.end_amdhsa_kernel
.p2align 6
.amdhsa_kernel k3_kernel
  .amdhsa_next_free_vgpr 48
  .amdhsa_next_free_sgpr 102
  .amdhsa_accum_offset 48
  .amdhsa_group_segment_fixed_size 0
  .amdhsa_kernarg_size 80
  .amdhsa_user_sgpr_count 2
  .amdhsa_user_sgpr_kernarg_segment_ptr 1
  .amdhsa_system_sgpr_workgroup_id_x 1
.end_amdhsa_kernel
```
